```python
import torch

def _softmax(x, axis=-1):
    return torch.softmax(x, dim=axis)
def _gelu(x):
    return torch.nn.functional.gelu(x, approximate="tanh")
def _silu(x):
    return torch.nn.functional.silu(x)
def _sigmoid(x):
    return torch.sigmoid(x)
def _layernorm(x, axis=-1, eps=1e-5):
    m = x.mean(dim=axis, keepdim=True)
    v = x.var(dim=axis, keepdim=True, unbiased=False)
    return (x - m) / torch.sqrt(v + eps)
def _scatter_add(tgt, idx, src, axis=0):
    return tgt.clone().index_add_(axis, idx, src)
def _segment_sum(src, seg, n):
    out = torch.zeros((n,) + src.shape[1:], dtype=src.dtype)
    return out.index_add_(0, seg, src)
def _pad(x, pw):
    flat = tuple(v for pair in reversed(pw) for v in pair)
    return torch.nn.functional.pad(x, flat)

kernel_name = 'recurrent_scan__spectral_fnet__dense_activation_relu__prompt'

def setup_inputs():

    _w = (lambda a: (lambda t: t.to(torch.bfloat16) if t.is_floating_point() else t)(torch.as_tensor(a)))
    def _A_setup():
        B, S, D = 1, 2048, 448
        ns = torch.arange(S)[:, None] * torch.arange(S)[None, :]
        nd = torch.arange(D)[:, None] * torch.arange(D)[None, :]
        Ws_re = torch.cos(-2.0 * torch.pi * ns / S).to(float)
        Ws_im = torch.sin(-2.0 * torch.pi * ns / S).to(float)
        Wd_re = torch.cos(-2.0 * torch.pi * nd / D).to(float)
        Wd_im = torch.sin(-2.0 * torch.pi * nd / D).to(float)
        return {
            "x": _w((lambda *s: torch.randn(*s, dtype=torch.bfloat16) * 0.05)(B, S, D)),
            "dft_seq_re": _w(Ws_re),
            "dft_seq_im": _w(Ws_im),
            "dft_hid_re": _w(Wd_re),
            "dft_hid_im": _w(Wd_im),
        }
    _A_in = _A_setup()

    def _B_setup():
        B, S, D, Dff = 1, 2048, 448, 1792
        return {
            "x": _w((lambda *s: torch.randn(*s, dtype=torch.bfloat16) * 0.05)(B, S, D)),
            "w1": _w((lambda *s: torch.randn(*s, dtype=torch.bfloat16) * 0.05)(D, Dff)),
            "w2": _w((lambda *s: torch.randn(*s, dtype=torch.bfloat16) * 0.05)(Dff, D)),
        }
    _B_in = _B_setup()

    return {
        "A_x": _A_in["x"],
        "A_dft_seq_re": _A_in["dft_seq_re"],
        "A_dft_seq_im": _A_in["dft_seq_im"],
        "A_dft_hid_re": _A_in["dft_hid_re"],
        "A_dft_hid_im": _A_in["dft_hid_im"],
        "B_x": _B_in["x"],
        "B_w1": _B_in["w1"],
        "B_w2": _B_in["w2"],
    }

def reference(A_x, A_dft_seq_re, A_dft_seq_im, A_dft_hid_re, A_dft_hid_im, B_x, B_w1, B_w2):
    def _A_ref(x, dft_seq_re, dft_seq_im, dft_hid_re, dft_hid_im):
        a = torch.einsum("bsd,ed->bse", x, dft_hid_re)
        b = torch.einsum("bsd,ed->bse", x, dft_hid_im)
        y = torch.einsum("ts,bse->bte", dft_seq_re, a) - torch.einsum("ts,bse->bte", dft_seq_im, b)
        return y

    def _B_ref(x, w1, w2):
        h = torch.einsum("bsd,df->bsf", x, w1)
        zero = torch.zeros_like(h)
        h = torch.maximum(h, zero)
        return torch.einsum("bsf,fd->bsd", h, w2)

    x = A_x
    xn = _layernorm(x, axis=-1)
    s = _A_ref(xn, A_dft_seq_re, A_dft_seq_im, A_dft_hid_re, A_dft_hid_im)
    g = _silu(_B_ref(xn, B_w1, B_w2))
    return x + s * g
```

```asm
; @launch grid=(256,1,1) block=(512,1,1) lds=163840
.amdgcn_target "amdgcn-amd-amdhsa--gfx950"
.text
.p2align 12
.globl recurrent_scan__spectral_fnet__dense_activation_relu__prompt_kernel
.p2align 8
.type recurrent_scan__spectral_fnet__dense_activation_relu__prompt_kernel,@function
recurrent_scan__spectral_fnet__dense_activation_relu__prompt_kernel:
    s_load_dwordx2 s[4:5], s[0:1], 0
    s_load_dwordx8 s[40:47], s[0:1], 48
    s_load_dwordx2 s[48:49], s[0:1], 80
    s_getpc_b64 s[6:7]
L_pc:
    v_readfirstlane_b32 s35, v0
    s_lshr_b32 s35, s35, 6
    s_andn2_b32 s52, s2, 7
    s_add_u32 s52, s52, s35
    s_lshl_b32 s52, s52, 7
    s_lshr_b32 s33, s2, 5
    s_and_b32 s3, s2, 7
    s_cmp_eq_u32 s3, 7
    s_cselect_b32 s3, 0, s3
    v_lshrrev_b32 v5, 3, v0
    s_cmpk_ge_u32 s2, 224
    s_cbranch_scc1 L_first
    v_and_b32 v13, 6, v5
    v_xor_b32 v13, v13, v0
    v_and_b32 v13, 7, v13
    v_and_b32 v8, 7, v5
    v_and_b32 v4, 4, v5
    v_add_u32 v4, v4, v8
    s_movk_i32 s50, 224
    v_mad_u32_u24 v4, v4, s50, v13
    s_lshr_b32 s50, s35, 2
    s_lshl1_add_u32 s50, s3, s50
    s_mulk_i32 s50, 896
    s_and_b32 s51, s35, 3
    s_lshl2_add_u32 s53, s33, s51
    s_add_u32 s50, s50, s53
    s_lshl_b32 s50, s50, 7
    s_lshl_b32 m0, s35, 12
    v_lshl_add_u32 v112, v4, 4, s50
    v_add_u32 v113, 56320, v112
    v_add_u32 v114, 12288, v112
    v_add_u32 v115, 68608, v112
    s_waitcnt lgkmcnt(0)
    global_load_lds_dwordx4 v112, s[40:41] offset:0
    global_load_lds_dwordx4 v113, s[40:41] offset:1024
    global_load_lds_dwordx4 v114, s[40:41] offset:2048
    global_load_lds_dwordx4 v115, s[40:41] offset:3072
L_first:
    s_cmpk_ge_u32 s2, 256
    s_cbranch_scc1 L_end
    s_waitcnt lgkmcnt(0)
    s_load_dword s101, s[6:7], s52
    s_load_dword s101, s[6:7], s52 offset:64
    s_sub_u32 s51, 0, s2
    s_bitcmp1_b32 s2, 3
    s_cselect_b32 s51, s51, s2
    s_and_b32 s51, s51, 7
    s_and_b32 s52, s2, 24
    s_or_b32 s32, s51, s52
    v_and_b32 v6, 7, v0
    s_mov_b32 s8, s4
    s_and_b32 s9, s5, 0xffff
    s_mov_b32 s10, 1835008
    s_mov_b32 s11, 0x00020000
    v_and_b32 v2, 63, v0
    s_cmp_eq_u32 s33, 7
    s_cbranch_scc1 L_dft
    s_add_u32 s34, s33, s3
    s_sub_u32 s51, s34, 7
    s_cmp_ge_u32 s34, 7
    s_cselect_b32 s34, s51, s34
    s_cmp_lt_u32 s35, 4
    s_cbranch_scc1 L_compute
    s_branch L_helper
L_dft:
    s_add_u32 s48, s48, 0x1fffff
    s_addc_u32 s49, s49, 0
    s_and_b32 s48, s48, 0xffe00000
    s_mov_b32 s20, s48
    s_and_b32 s21, s49, 0xffff
    s_mov_b32 s22, 35651584
    s_mov_b32 s23, 0x00020000
    s_cmp_lg_u32 s35, 7
    s_cbranch_scc1 L_dft1
    s_lshl_b32 s58, s32, 20
    s_add_u32 s58, s58, 802816
    v_and_b32 v3, 15, v2
    v_lshlrev_b32 v3, 8, v3
    v_lshrrev_b32 v4, 4, v2
    v_lshl_add_u32 v3, v4, 13, v3
    v_mov_b32 v4, 0
    s_mov_b32 exec_hi, 0
    buffer_store_dword v4, v3, s[20:23], s58 offen sc1
    s_mov_b64 exec, -1
L_dft1:
    v_lshl_add_u32 v7, v5, 5, s32
    v_mul_u32_u24 v10, 896, v7
    v_lshl_add_u32 v7, v6, 4, v10
    v_sub_u32 v8, 19, v6
    v_lshl_add_u32 v8, v8, 4, v10
    buffer_load_dwordx4 v[16:19], v7, s[8:11], 0 offen offset:0
    buffer_load_dwordx4 v[20:23], v8, s[8:11], 0 offen offset:128
    buffer_load_dwordx4 v[24:27], v7, s[8:11], 0 offen offset:448
    buffer_load_dwordx4 v[28:31], v8, s[8:11], 0 offen offset:576
    v_add_u32 v10, 2, v6
    v_lshrrev_b32 v10, 3, v10
    v_lshl_or_b32 v7, v10, 30, v7
    v_lshl_or_b32 v8, v10, 30, v8
    buffer_load_dwordx4 v[32:35], v7, s[8:11], 0 offen offset:128
    buffer_load_dwordx4 v[36:39], v8, s[8:11], 0 offen offset:0
    buffer_load_dwordx4 v[40:43], v7, s[8:11], 0 offen offset:576
    buffer_load_dwordx4 v[44:47], v8, s[8:11], 0 offen offset:448
    s_branch L_dft2
L_helper:
    s_sub_u32 s50, s35, 4
    v_and_b32 v5, 31, v5
    v_lshl_add_u32 v7, v5, 6, s32
    v_mul_u32_u24 v7, 896, v7
    v_xor_b32 v8, v8, v6
    v_lshl_add_u32 v126, v8, 4, v7
    v_add_u32 v127, 28672, v126
    s_lshl_b32 s61, s50, 10
    s_lshl_b32 s60, s3, 7
    s_add_u32 m0, s61, 98304
    s_nop 0
    buffer_load_dwordx4 v126, s[8:11], s60 offen  lds
    s_add_u32 m0, s61, 102400
    s_nop 0
    buffer_load_dwordx4 v127, s[8:11], s60 offen  lds
    s_lshl_b32 s53, s53, 7
    v_lshl_add_u32 v112, v4, 4, s53
    v_add_u32 v113, 56320, v112
    v_add_u32 v114, 12288, v112
    v_add_u32 v115, 68608, v112
    v_lshlrev_b32 v13, 4, v13
    s_lshl_b32 s51, s50, 12
    s_mov_b32 s12, s40
    s_and_b32 s13, s41, 0xffff
    s_mov_b32 s14, 1605632
    s_mov_b32 s15, 0x00020000
    s_mov_b32 s62, 0x6543210
    s_mov_b32 s63, 0x6534120
    s_bitcmp1_b32 s2, 3
    s_cselect_b32 s62, 0x5642310, s62
    s_cselect_b32 s63, 0x6453120, s63
    s_bitcmp1_b32 s2, 4
    s_cselect_b32 s62, s63, s62
    s_mul_i32 s63, s3, 0x1111111
    s_add_u32 s62, s62, s63
    s_add_u32 s63, s62, 0x1111111
    s_and_b32 s63, s63, 0x8888888
    s_lshr_b32 s63, s63, 3
    s_mul_i32 s63, s63, 7
    s_sub_u32 s3, s62, s63
    s_mov_b32 s62, 0x6453210
    s_mov_b32 s63, 0x6542301
    s_bitcmp1_b32 s2, 3
    s_cselect_b32 s62, 0x5643120, s62
    s_cselect_b32 s63, 0x6534201, s63
    s_bitcmp1_b32 s2, 4
    s_cselect_b32 s62, s63, s62
    s_mul_i32 s63, s34, 0x1111111
    s_add_u32 s62, s62, s63
    s_add_u32 s63, s62, 0x1111111
    s_and_b32 s63, s63, 0x8888888
    s_lshr_b32 s63, s63, 3
    s_mul_i32 s63, s63, 7
    s_sub_u32 s62, s62, s63
    s_lshr_b32 s34, s62, 24
    s_lshl_b32 s52, s34, 7
    s_bfe_u32 s53, s62, 0x40000
    s_lshl_b32 s53, s53, 7
    s_bfe_u32 s54, s62, 0x40004
    s_lshl_b32 s54, s54, 7
    s_bfe_u32 s55, s62, 0x40008
    s_lshl_b32 s55, s55, 7
    s_bfe_u32 s56, s62, 0x4000c
    s_lshl_b32 s56, s56, 7
    s_bfe_u32 s57, s62, 0x40010
    s_lshl_b32 s57, s57, 7
    s_bfe_u32 s58, s62, 0x40014
    s_lshl_b32 s58, s58, 7
    v_mov_b32 v12, 0xffff0000
    v_lshrrev_b32 v4, 3, v2
    s_lshl_b32 s62, s33, 8
    s_lshl_b32 s63, s50, 5
    s_add_u32 s62, s62, s63
    v_add_u32 v4, s62, v4
    v_mul_u32_u24 v4, 896, v4
    v_add_u32 v116, v13, v4
    v_add_u32 v117, 6144, v116
    v_add_u32 v118, 12288, v116
    v_add_u32 v119, 18432, v116
    s_mov_b32 s16, s42
    s_and_b32 s17, s43, 0xffff
    s_mov_b32 s18, 1605632
    s_mov_b32 s19, 0x00020000
    s_add_u32 s48, s48, 0x1fffff
    s_addc_u32 s49, s49, 0
    s_and_b32 s48, s48, 0xffe00000
    s_mov_b32 s20, s48
    s_and_b32 s21, s49, 0xffff
    s_mov_b32 s22, 35651584
    s_mov_b32 s23, 0x00020000
    s_mov_b32 s24, s44
    s_and_b32 s25, s45, 0xffff
    s_mov_b32 s26, 1835008
    s_mov_b32 s27, 0x00020000
    s_and_b32 s36, s50, 1
    s_lshr_b32 s37, s50, 1
    s_lshl_b32 s64, s36, 12
    s_add_u32 s64, s64, 131072
    s_lshl_b32 s65, s37, 2
    v_lshrrev_b32 v3, 5, v2
    v_add_u32 v3, s65, v3
    v_xor_b32 v3, v3, v6
    v_lshlrev_b32 v3, 4, v3
    v_bfe_u32 v4, v2, 4, 1
    v_lshl_add_u32 v3, v4, 3, v3
    v_and_b32 v4, 15, v2
    v_lshl_add_u32 v3, v4, 7, v3
    v_xor_b32 v4, 32, v3
    v_add_u32 v109, s64, v3
    v_add_u32 v110, s64, v4
    s_mov_b32 s64, 0
    s_bfe_u32 s65, s3, 0x40004
    s_cmp_eq_u32 s65, s34
    s_cselect_b32 s64, 1, s64
    s_bfe_u32 s65, s3, 0x40008
    s_cmp_eq_u32 s65, s34
    s_cselect_b32 s64, 2, s64
    s_bfe_u32 s65, s3, 0x4000c
    s_cmp_eq_u32 s65, s34
    s_cselect_b32 s64, 3, s64
    s_bfe_u32 s65, s3, 0x40010
    s_cmp_eq_u32 s65, s34
    s_cselect_b32 s64, 4, s64
    s_bfe_u32 s65, s3, 0x40014
    s_cmp_eq_u32 s65, s34
    s_cselect_b32 s64, 5, s64
    s_bfe_u32 s65, s3, 0x40018
    s_cmp_eq_u32 s65, s34
    s_cselect_b32 s64, 6, s64
    s_lshl_b32 s64, s64, 13
    s_sub_u32 s64, s64, 32768
    v_add_u32 v98, s64, v109
    v_add_u32 v99, s64, v110
    s_mov_b32 s5, 0
    s_lshl_b32 s68, s32, 2
    s_lshl_b32 s31, s32, 20
    s_add_u32 s31, s31, 806656
    s_sub_u32 s29, 32, s32
    s_and_b32 s29, s29, 31
    s_lshl_b32 s69, s29, 2
    s_lshl_b32 s29, s29, 20
    s_add_u32 s29, s29, 806656
    s_lshl_b32 s62, s34, 1
    s_add_u32 s62, s62, s37
    s_lshl_b32 s63, s36, 5
    s_add_u32 s63, s63, s32
    s_sub_u32 s64, 13, s62
    s_sub_u32 s65, 14, s62
    s_cmp_eq_u32 s65, 7
    s_cselect_b32 s65, 0, s65
    s_sub_u32 s66, 64, s63
    s_and_b32 s66, s66, 63
    s_cmp_ge_u32 s62, 7
    s_cselect_b32 s38, 1, 0
    s_cselect_b32 s64, s64, s62
    s_cselect_b32 s65, s65, s62
    s_cselect_b32 s66, s66, s63
    s_mov_b32 s67, 0x3a000000
    s_cselect_b32 s67, 0xba000000, s67
    s_and_b32 s7, s66, 31
    s_lshl_b32 s7, s7, 20
    s_lshr_b32 s66, s66, 5
    s_lshl_b32 s66, s66, 12
    s_add_u32 s66, s66, s7
    s_add_u32 s66, s66, 688128
    s_lshl_b32 s39, s64, 14
    s_add_u32 m0, s61, 106496
    s_bfe_u32 s60, s3, 0x40004
    s_lshl_b32 s60, s60, 7
    buffer_load_dwordx4 v126, s[8:11], s60 offen  lds
    s_add_u32 m0, s51, 32768
    s_mul_i32 s59, s60, 1792
    buffer_load_dwordx4 v112, s[12:15], s59 offen offset:0  lds
    buffer_load_dwordx4 v113, s[12:15], s59 offen offset:1024  lds
    buffer_load_dwordx4 v114, s[12:15], s59 offen offset:2048  lds
    buffer_load_dwordx4 v115, s[12:15], s59 offen offset:3072  lds
    s_add_u32 m0, s61, 110592
    s_nop 0
    buffer_load_dwordx4 v127, s[8:11], s60 offen  lds
    s_add_u32 m0, s51, 49152
    s_add_u32 s59, s59, 114688
    buffer_load_dwordx4 v112, s[12:15], s59 offen offset:0  lds
    buffer_load_dwordx4 v113, s[12:15], s59 offen offset:1024  lds
    buffer_load_dwordx4 v114, s[12:15], s59 offen offset:2048  lds
    buffer_load_dwordx4 v115, s[12:15], s59 offen offset:3072  lds
    s_lshl_b32 s4, s65, 14
    s_add_u32 s39, s39, s66
    s_add_u32 s4, s4, s66
    s_cmp_eq_u32 s38, 1
    s_cselect_b32 s4, s4, 2146435072
    v_and_b32 v123, 15, v2
    v_lshlrev_b32 v123, 4, v123
    s_lshl_b32 s7, s36, 3
    v_add_u32 v123, s7, v123
    s_lshl_b32 s7, s32, 20
    s_add_u32 s43, s7, 807424
    s_add_u32 s7, s7, 802816
    s_mul_i32 s40, s34, 256
    s_add_u32 s40, s40, s7
    s_add_u32 s7, s7, 2048
    s_mul_i32 s41, s64, 256
    s_add_u32 s41, s41, s7
    s_mul_i32 s42, s65, 256
    s_add_u32 s42, s42, s7
    v_lshlrev_b32 v103, 4, v2
    s_mul_i32 s64, s32, 1048576
    s_mul_i32 s65, s34, 16384
    s_add_u32 s64, s64, s65
    s_mul_i32 s65, s37, 4096
    s_add_u32 s64, s64, s65
    s_mul_i32 s65, s36, 1024
    s_add_u32 s64, s64, s65
    v_mad_u32_u24 v102, v2, 16, s64
    v_and_b32 v3, 3, v2
    v_cmp_eq_u32 vcc, 0, v3
    s_cmp_eq_u32 s62, 0
    s_cselect_b32 s64, 1, s38
    s_mul_i32 s64, s64, 0xffff
    v_mov_b32 v3, s64
    v_lshrrev_b32 v105, 2, v2
    v_lshlrev_b32 v105, 6, v105
    v_cndmask_b32 v104, 0, v3, vcc
    v_mov_b32 v48, 0
    v_mov_b32 v49, 0
    v_mov_b32 v50, 0
    v_mov_b32 v51, 0
    s_lshl_b32 s66, s37, 1
    s_lshl_b32 s66, 3, s66
    v_and_b32 v3, 15, v2
    v_lshl_add_u32 v3, v3, 6, s63
    v_lshrrev_b32 v4, 4, v2
    v_lshlrev_b32 v4, 2, v4
    v_mul_u32_u24 v4, v4, v3
    v_cvt_f32_u32 v3, v3
    v_cvt_f32_u32 v4, v4
    v_mul_f32 v3, s67, v3
    v_mul_f32 v4, s67, v4
    v_fract_f32 v8, v4
    v_cos_f32 v16, v8
    v_sin_f32 v24, v8
    v_add_f32 v4, v4, v3
    v_fract_f32 v8, v4
    v_cos_f32 v17, v8
    v_sin_f32 v25, v8
    v_add_f32 v4, v4, v3
    v_fract_f32 v8, v4
    v_cos_f32 v18, v8
    s_waitcnt vmcnt(10)
    s_barrier
    s_add_u32 m0, s61, 114688
    s_bfe_u32 s60, s3, 0x40008
    s_lshl_b32 s60, s60, 7
    buffer_load_dwordx4 v126, s[8:11], s60 offen  lds
    s_add_u32 m0, s51, 65536
    s_mul_i32 s59, s60, 1792
    buffer_load_dwordx4 v112, s[12:15], s59 offen offset:0  lds
    buffer_load_dwordx4 v113, s[12:15], s59 offen offset:1024  lds
    buffer_load_dwordx4 v114, s[12:15], s59 offen offset:2048  lds
    buffer_load_dwordx4 v115, s[12:15], s59 offen offset:3072  lds
    s_add_u32 m0, s61, 118784
    s_nop 0
    buffer_load_dwordx4 v127, s[8:11], s60 offen  lds
    s_add_u32 m0, s51, 81920
    s_add_u32 s59, s59, 114688
    buffer_load_dwordx4 v112, s[12:15], s59 offen offset:0  lds
    buffer_load_dwordx4 v113, s[12:15], s59 offen offset:1024  lds
    buffer_load_dwordx4 v114, s[12:15], s59 offen offset:2048  lds
    buffer_load_dwordx4 v115, s[12:15], s59 offen offset:3072  lds
    s_waitcnt vmcnt(10)
    s_barrier
    s_add_u32 m0, s61, 122880
    s_bfe_u32 s60, s3, 0x4000c
    s_lshl_b32 s60, s60, 7
    buffer_load_dwordx4 v126, s[8:11], s60 offen  lds
    s_add_u32 m0, s51, 0
    s_mul_i32 s59, s60, 1792
    buffer_load_dwordx4 v112, s[12:15], s59 offen offset:0  lds
    buffer_load_dwordx4 v113, s[12:15], s59 offen offset:1024  lds
    buffer_load_dwordx4 v114, s[12:15], s59 offen offset:2048  lds
    buffer_load_dwordx4 v115, s[12:15], s59 offen offset:3072  lds
    s_add_u32 m0, s61, 126976
    s_nop 0
    buffer_load_dwordx4 v127, s[8:11], s60 offen  lds
    s_add_u32 m0, s51, 16384
    s_add_u32 s59, s59, 114688
    buffer_load_dwordx4 v112, s[12:15], s59 offen offset:0  lds
    buffer_load_dwordx4 v113, s[12:15], s59 offen offset:1024  lds
    buffer_load_dwordx4 v114, s[12:15], s59 offen offset:2048  lds
    buffer_load_dwordx4 v115, s[12:15], s59 offen offset:3072  lds
    s_waitcnt vmcnt(10)
    s_barrier
    s_add_u32 m0, s61, 131072
    s_bfe_u32 s60, s3, 0x40010
    s_lshl_b32 s60, s60, 7
    buffer_load_dwordx4 v126, s[8:11], s60 offen  lds
    s_add_u32 m0, s51, 32768
    s_mul_i32 s59, s60, 1792
    buffer_load_dwordx4 v112, s[12:15], s59 offen offset:0  lds
    buffer_load_dwordx4 v113, s[12:15], s59 offen offset:1024  lds
    buffer_load_dwordx4 v114, s[12:15], s59 offen offset:2048  lds
    buffer_load_dwordx4 v115, s[12:15], s59 offen offset:3072  lds
    s_add_u32 m0, s61, 135168
    s_nop 0
    buffer_load_dwordx4 v127, s[8:11], s60 offen  lds
    s_add_u32 m0, s51, 49152
    s_add_u32 s59, s59, 114688
    buffer_load_dwordx4 v112, s[12:15], s59 offen offset:0  lds
    buffer_load_dwordx4 v113, s[12:15], s59 offen offset:1024  lds
    buffer_load_dwordx4 v114, s[12:15], s59 offen offset:2048  lds
    buffer_load_dwordx4 v115, s[12:15], s59 offen offset:3072  lds
    s_waitcnt vmcnt(10)
    s_barrier
    s_add_u32 m0, s61, 139264
    s_bfe_u32 s60, s3, 0x40014
    s_lshl_b32 s60, s60, 7
    buffer_load_dwordx4 v126, s[8:11], s60 offen  lds
    s_add_u32 m0, s51, 65536
    s_mul_i32 s59, s60, 1792
    buffer_load_dwordx4 v112, s[12:15], s59 offen offset:0  lds
    buffer_load_dwordx4 v113, s[12:15], s59 offen offset:1024  lds
    buffer_load_dwordx4 v114, s[12:15], s59 offen offset:2048  lds
    buffer_load_dwordx4 v115, s[12:15], s59 offen offset:3072  lds
    s_add_u32 m0, s61, 143360
    s_nop 0
    buffer_load_dwordx4 v127, s[8:11], s60 offen  lds
    s_add_u32 m0, s51, 81920
    s_add_u32 s59, s59, 114688
    buffer_load_dwordx4 v112, s[12:15], s59 offen offset:0  lds
    buffer_load_dwordx4 v113, s[12:15], s59 offen offset:1024  lds
    buffer_load_dwordx4 v114, s[12:15], s59 offen offset:2048  lds
    buffer_load_dwordx4 v115, s[12:15], s59 offen offset:3072  lds
    s_waitcnt vmcnt(10)
    s_barrier
    s_load_dword s30, s[46:47], s68
    s_load_dword s28, s[46:47], s69
    s_add_u32 m0, s61, 147456
    s_bfe_u32 s60, s3, 0x40018
    s_lshl_b32 s60, s60, 7
    buffer_load_dwordx4 v126, s[8:11], s60 offen  lds
    s_add_u32 m0, s51, 0
    s_mul_i32 s59, s60, 1792
    buffer_load_dwordx4 v112, s[12:15], s59 offen offset:0  lds
    buffer_load_dwordx4 v113, s[12:15], s59 offen offset:1024  lds
    buffer_load_dwordx4 v114, s[12:15], s59 offen offset:2048  lds
    buffer_load_dwordx4 v115, s[12:15], s59 offen offset:3072  lds
    s_add_u32 m0, s61, 151552
    s_nop 0
    buffer_load_dwordx4 v127, s[8:11], s60 offen  lds
    s_add_u32 m0, s51, 16384
    s_add_u32 s59, s59, 114688
    buffer_load_dwordx4 v112, s[12:15], s59 offen offset:0  lds
    buffer_load_dwordx4 v113, s[12:15], s59 offen offset:1024  lds
    buffer_load_dwordx4 v114, s[12:15], s59 offen offset:2048  lds
    buffer_load_dwordx4 v115, s[12:15], s59 offen offset:3072  lds
L_rdy4:
    s_waitcnt lgkmcnt(0)
    s_min_u32 s6, s30, s28
    s_cmp_ge_u32 s6, 7
    s_cbranch_scc1 L_rdy4_ok
    s_load_dword s30, s[46:47], s68 glc
    s_load_dword s28, s[46:47], s69 glc
    s_add_u32 s5, s5, 1
    s_cmp_lt_u32 s5, 20000
    s_cbranch_scc1 L_rdy4
    s_waitcnt lgkmcnt(0)
L_rdy4_ok:
    s_waitcnt vmcnt(10)
    s_barrier
    s_add_u32 m0, s51, 32768
    s_add_u32 s59, s53, 0
    buffer_load_dwordx4 v116, s[16:19], s59 offen offset:0  lds
    buffer_load_dwordx4 v117, s[16:19], s59 offen offset:1024  lds
    buffer_load_dwordx4 v118, s[16:19], s59 offen offset:2048  lds
    buffer_load_dwordx4 v119, s[16:19], s59 offen offset:3072  lds
    s_load_dword s30, s[48:49], s31
    s_add_u32 m0, s51, 49152
    s_add_u32 s59, s53, 114688
    buffer_load_dwordx4 v116, s[16:19], s59 offen offset:0  lds
    buffer_load_dwordx4 v117, s[16:19], s59 offen offset:1024  lds
    buffer_load_dwordx4 v118, s[16:19], s59 offen offset:2048  lds
    buffer_load_dwordx4 v119, s[16:19], s59 offen offset:3072  lds
L_rdy5:
    s_waitcnt lgkmcnt(0)
    s_min_u32 s6, s30, s28
    s_cmp_ge_u32 s6, 7
    s_cbranch_scc1 L_rdy5_ok
    s_load_dword s30, s[48:49], s31 glc
    s_add_u32 s5, s5, 1
    s_cmp_lt_u32 s5, 20000
    s_cbranch_scc1 L_rdy5
    s_waitcnt lgkmcnt(0)
L_rdy5_ok:
    s_waitcnt vmcnt(8)
    s_barrier
    ds_read_b64 v[192:193], v98 offset:0
    ds_read_b64 v[194:195], v98 offset:2048
    ds_read_b64 v[196:197], v99 offset:0
    ds_read_b64 v[198:199], v99 offset:2048
    s_add_u32 m0, s51, 65536
    s_add_u32 s59, s54, 0
    buffer_load_dwordx4 v116, s[16:19], s59 offen offset:0  lds
    buffer_load_dwordx4 v117, s[16:19], s59 offen offset:1024  lds
    buffer_load_dwordx4 v118, s[16:19], s59 offen offset:2048  lds
    buffer_load_dwordx4 v119, s[16:19], s59 offen offset:3072  lds
    s_add_u32 m0, s51, 81920
    s_add_u32 s59, s54, 114688
    buffer_load_dwordx4 v116, s[16:19], s59 offen offset:0  lds
    buffer_load_dwordx4 v117, s[16:19], s59 offen offset:1024  lds
    buffer_load_dwordx4 v118, s[16:19], s59 offen offset:2048  lds
    buffer_load_dwordx4 v119, s[16:19], s59 offen offset:3072  lds
    s_waitcnt vmcnt(8) lgkmcnt(0)
    s_barrier
    s_add_u32 m0, s51, 98304
    s_add_u32 s59, s55, 0
    buffer_load_dwordx4 v116, s[16:19], s59 offen offset:0  lds
    buffer_load_dwordx4 v117, s[16:19], s59 offen offset:1024  lds
    buffer_load_dwordx4 v118, s[16:19], s59 offen offset:2048  lds
    buffer_load_dwordx4 v119, s[16:19], s59 offen offset:3072  lds
    s_add_u32 m0, s51, 114688
    s_add_u32 s59, s55, 114688
    buffer_load_dwordx4 v116, s[16:19], s59 offen offset:0  lds
    buffer_load_dwordx4 v117, s[16:19], s59 offen offset:1024  lds
    buffer_load_dwordx4 v118, s[16:19], s59 offen offset:2048  lds
    buffer_load_dwordx4 v119, s[16:19], s59 offen offset:3072  lds
    v_sin_f32 v26, v8
    v_add_f32 v4, v4, v3
    v_fract_f32 v8, v4
    v_cos_f32 v19, v8
    v_sin_f32 v27, v8
    v_fmamk_f32 v4, v3, 0x41500000, v4
    v_fract_f32 v8, v4
    v_cos_f32 v20, v8
    v_sin_f32 v28, v8
    v_add_f32 v4, v4, v3
    v_fract_f32 v8, v4
    v_cos_f32 v21, v8
    v_sin_f32 v29, v8
    v_add_f32 v4, v4, v3
    v_fract_f32 v8, v4
    v_cos_f32 v22, v8
    v_sin_f32 v30, v8
    v_add_f32 v4, v4, v3
    v_fract_f32 v8, v4
    v_cos_f32 v23, v8
    v_sin_f32 v31, v8
    v_mov_b32 v10, 0xbf317218
    v_mov_b32 v11, v10
    v_bfrev_b32 v3, 1
    v_pk_mul_f32 v[16:17], v[16:17], v[10:11]
    v_cvt_pk_bf16_f32 v128, v16, v17
    v_xor_b32 v132, v3, v128
    v_pk_mul_f32 v[18:19], v[18:19], v[10:11]
    v_cvt_pk_bf16_f32 v129, v18, v19
    v_xor_b32 v133, v3, v129
    v_pk_mul_f32 v[20:21], v[20:21], v[10:11]
    v_cvt_pk_bf16_f32 v130, v20, v21
    v_xor_b32 v134, v3, v130
    v_pk_mul_f32 v[22:23], v[22:23], v[10:11]
L_pad0:
L_pad_in0:
    s_cbranch_execz L_pad_ret
    v_cvt_pk_bf16_f32 v131, v22, v23
    v_xor_b32 v135, v3, v131
    v_pk_mul_f32 v[24:25], v[24:25], v[10:11]
    v_cvt_pk_bf16_f32 v136, v24, v25
    v_xor_b32 v140, v3, v136
    v_pk_mul_f32 v[26:27], v[26:27], v[10:11]
    v_cvt_pk_bf16_f32 v137, v26, v27
    v_xor_b32 v141, v3, v137
    v_pk_mul_f32 v[28:29], v[28:29], v[10:11]
    v_cvt_pk_bf16_f32 v138, v28, v29
    v_xor_b32 v142, v3, v138
    v_pk_mul_f32 v[30:31], v[30:31], v[10:11]
    v_cvt_pk_bf16_f32 v139, v30, v31
    v_xor_b32 v143, v3, v139
    s_lshl_b32 s64, s50, 12
    s_add_u32 s64, s64, 98304
    s_mul_i32 s65, s38, 48
    v_lshrrev_b32 v3, 4, v2
    v_lshlrev_b32 v3, 5, v3
    v_xor_b32 v3, v3, v103
    v_xor_b32 v3, s65, v3
    v_add_u32 v106, s64, v3
    v_lshrrev_b32 v3, 2, v2
    v_lshlrev_b32 v3, 7, v3
    v_and_b32 v4, 3, v2
    v_lshl_add_u32 v3, v4, 3, v3
    v_bfe_u32 v4, v2, 3, 2
    v_lshl_add_u32 v3, v4, 5, v3
    v_xor_b32 v4, 0, v3
    v_add_u32 v84, s64, v4
    v_xor_b32 v4, 32, v3
    v_add_u32 v85, s64, v4
    v_xor_b32 v4, 64, v3
    v_add_u32 v86, s64, v4
    v_xor_b32 v4, 96, v3
    v_add_u32 v87, s64, v4
    s_waitcnt vmcnt(0)
    s_barrier
    s_barrier
    s_add_u32 m0, s51, 131072
    s_add_u32 s59, s56, 0
    buffer_load_dwordx4 v116, s[16:19], s59 offen offset:0  lds
    buffer_load_dwordx4 v117, s[16:19], s59 offen offset:1024  lds
    buffer_load_dwordx4 v118, s[16:19], s59 offen offset:2048  lds
    buffer_load_dwordx4 v119, s[16:19], s59 offen offset:3072  lds
    s_barrier
    s_load_dword s30, s[48:49], s31 offset:8192
    s_load_dword s28, s[48:49], s29 offset:8192
    s_add_u32 m0, s51, 147456
    s_add_u32 s59, s56, 114688
    buffer_load_dwordx4 v116, s[16:19], s59 offen offset:0  lds
    buffer_load_dwordx4 v117, s[16:19], s59 offen offset:1024  lds
    buffer_load_dwordx4 v118, s[16:19], s59 offen offset:2048  lds
    buffer_load_dwordx4 v119, s[16:19], s59 offen offset:3072  lds
    s_add_u32 m0, s51, 32768
    s_add_u32 s59, s57, 0
    buffer_load_dwordx4 v116, s[16:19], s59 offen offset:0  lds
    buffer_load_dwordx4 v117, s[16:19], s59 offen offset:1024  lds
    buffer_load_dwordx4 v118, s[16:19], s59 offen offset:2048  lds
    buffer_load_dwordx4 v119, s[16:19], s59 offen offset:3072  lds
L_rdy6:
    s_waitcnt lgkmcnt(0)
    s_min_u32 s6, s30, s28
    s_cmp_ge_u32 s6, 7
    s_cbranch_scc1 L_rdy6_ok
    s_load_dword s30, s[48:49], s31 offset:8192 glc
    s_load_dword s28, s[48:49], s29 offset:8192 glc
    s_add_u32 s5, s5, 1
    s_cmp_lt_u32 s5, 20000
    s_cbranch_scc1 L_rdy6
    s_waitcnt lgkmcnt(0)
L_rdy6_ok:
    s_cmp_eq_u32 s38, 1
    s_cselect_b32 s28, s28, s30
    s_and_b32 s30, s30, 0x2000
    s_and_b32 s28, s28, 0x2000
    s_add_u32 s40, s40, s30
    s_add_u32 s41, s41, s30
    s_add_u32 s42, s42, s30
    s_add_u32 s39, s39, s28
    s_add_u32 s4, s4, s28
    v_add_u32 v102, s30, v102
    s_barrier
    s_add_u32 m0, s51, 49152
    s_add_u32 s59, s57, 114688
    buffer_load_dwordx4 v116, s[16:19], s59 offen offset:0  lds
    buffer_load_dwordx4 v117, s[16:19], s59 offen offset:1024  lds
    buffer_load_dwordx4 v118, s[16:19], s59 offen offset:2048  lds
    buffer_load_dwordx4 v119, s[16:19], s59 offen offset:3072  lds
    s_add_u32 m0, s51, 0
    s_add_u32 s59, s58, 0
    buffer_load_dwordx4 v116, s[16:19], s59 offen offset:0  lds
    buffer_load_dwordx4 v117, s[16:19], s59 offen offset:1024  lds
    buffer_load_dwordx4 v118, s[16:19], s59 offen offset:2048  lds
    buffer_load_dwordx4 v119, s[16:19], s59 offen offset:3072  lds
    s_barrier
    s_add_u32 m0, s51, 16384
    s_add_u32 s59, s58, 114688
    buffer_load_dwordx4 v116, s[16:19], s59 offen offset:0  lds
    buffer_load_dwordx4 v117, s[16:19], s59 offen offset:1024  lds
    buffer_load_dwordx4 v118, s[16:19], s59 offen offset:2048  lds
    buffer_load_dwordx4 v119, s[16:19], s59 offen offset:3072  lds
    s_add_u32 m0, s51, 65536
    s_add_u32 s59, s52, 0
    buffer_load_dwordx4 v116, s[16:19], s59 offen offset:0  lds
    buffer_load_dwordx4 v117, s[16:19], s59 offen offset:1024  lds
    buffer_load_dwordx4 v118, s[16:19], s59 offen offset:2048  lds
    buffer_load_dwordx4 v119, s[16:19], s59 offen offset:3072  lds
    s_add_u32 m0, s51, 81920
    s_add_u32 s59, s52, 114688
    buffer_load_dwordx4 v116, s[16:19], s59 offen offset:0  lds
    buffer_load_dwordx4 v117, s[16:19], s59 offen offset:1024  lds
    buffer_load_dwordx4 v118, s[16:19], s59 offen offset:2048  lds
    buffer_load_dwordx4 v119, s[16:19], s59 offen offset:3072  lds
    s_waitcnt vmcnt(24)
    s_barrier
    s_waitcnt vmcnt(16)
    s_barrier
    s_load_dword s28, s[48:49], s40 glc
    s_load_dword s29, s[48:49], s41 glc
    s_load_dword s30, s[48:49], s42 glc
    s_waitcnt vmcnt(0)
    s_barrier
    s_waitcnt lgkmcnt(0)
    s_mov_b32 s55, s28
    s_and_b32 s28, s29, s30
    s_bitcmp1_b32 s28, 5
    s_cselect_b32 s31, 1, 0
    s_cselect_b32 s28, s39, 2146435072
    s_cselect_b32 s29, s4, 2146435072
    s_cselect_b32 s30, s43, 2146435072
    buffer_load_dwordx4 v[32:35], v103, s[20:23], s28 offen offset:0 sc1
    buffer_load_dwordx4 v[36:39], v103, s[20:23], s28 offen offset:1024 sc1
    buffer_load_dwordx4 v[40:43], v103, s[20:23], s28 offen offset:2048 sc1
    buffer_load_dwordx4 v[44:47], v103, s[20:23], s28 offen offset:3072 sc1
    s_cmp_eq_u32 s38, 0
    s_cbranch_scc1 L_np28
    s_mov_b32 exec_lo, 0x11111111
    s_mov_b32 exec_hi, 0x11111111
    buffer_load_ushort v48, v105, s[20:23], s29 offen offset:0 sc1
    buffer_load_ushort v49, v105, s[20:23], s29 offen offset:1024 sc1
    buffer_load_ushort v50, v105, s[20:23], s29 offen offset:2048 sc1
    buffer_load_ushort v51, v105, s[20:23], s29 offen offset:3072 sc1
    s_mov_b64 exec, -1
L_np28:
    buffer_load_dwordx2 v[124:125], v123, s[20:23], s30 offen sc1
    s_mov_b32 s60, s52
    s_mov_b32 s52, 0
    s_cmp_eq_u32 s31, 1
    s_cbranch_scc1 L_gdone
    s_waitcnt vmcnt(0)
L_gw:
    s_load_dword s52, s[48:49], s40 glc
    s_load_dword s53, s[48:49], s41 glc
    s_load_dword s54, s[48:49], s42 glc
    s_add_u32 s5, s5, 1
    s_waitcnt lgkmcnt(0)
    s_or_b32 s55, s55, s52
    s_cmp_ge_u32 s5, 20000
    s_cbranch_scc1 L_gg
    s_and_b32 s57, s53, s54
    s_bitcmp1_b32 s57, 5
    s_cbranch_scc0 L_gw
L_gg:
    buffer_load_dwordx4 v[32:35], v103, s[20:23], s39 offen offset:0 sc1
    buffer_load_dwordx4 v[36:39], v103, s[20:23], s39 offen offset:1024 sc1
    buffer_load_dwordx4 v[40:43], v103, s[20:23], s39 offen offset:2048 sc1
    buffer_load_dwordx4 v[44:47], v103, s[20:23], s39 offen offset:3072 sc1
    s_cmp_eq_u32 s38, 0
    s_cbranch_scc1 L_np39
    s_mov_b32 exec_lo, 0x11111111
    s_mov_b32 exec_hi, 0x11111111
    buffer_load_ushort v48, v105, s[20:23], s4 offen offset:0 sc1
    buffer_load_ushort v49, v105, s[20:23], s4 offen offset:1024 sc1
    buffer_load_ushort v50, v105, s[20:23], s4 offen offset:2048 sc1
    buffer_load_ushort v51, v105, s[20:23], s4 offen offset:3072 sc1
    s_mov_b64 exec, -1
L_np39:
    buffer_load_dwordx2 v[124:125], v123, s[20:23], s43 offen sc1
L_gdone:
    s_lshl_b32 s56, s66, 0
    s_andn2_b32 s57, s56, s55
    s_cbranch_scc0 L_wf0_ok
L_wf0:
    s_waitcnt lgkmcnt(0)
    s_or_b32 s55, s55, s52
    s_andn2_b32 s57, s56, s55
    s_cbranch_scc0 L_wf0_ok
    s_load_dword s52, s[48:49], s40 glc
    s_add_u32 s5, s5, 1
    s_cmp_lt_u32 s5, 20000
    s_cbranch_scc1 L_wf0
L_wf0_ok:
    s_mov_b32 s57, 0
    buffer_load_dwordx4 v[144:147], v102, s[20:23], s57 offen offset:0 sc1
    buffer_load_dwordx4 v[152:155], v102, s[20:23], s57 offen offset:2048 sc1
    s_lshl_b32 s56, s66, 4
    s_andn2_b32 s57, s56, s55
    s_cbranch_scc0 L_wf1_ok
L_wf1:
    s_waitcnt lgkmcnt(0)
    s_or_b32 s55, s55, s52
    s_andn2_b32 s57, s56, s55
    s_cbranch_scc0 L_wf1_ok
    s_load_dword s52, s[48:49], s40 glc
    s_add_u32 s5, s5, 1
    s_cmp_lt_u32 s5, 20000
    s_cbranch_scc1 L_wf1
L_wf1_ok:
    s_mov_b32 s57, 114688
    buffer_load_dwordx4 v[148:151], v102, s[20:23], s57 offen offset:0 sc1
    buffer_load_dwordx4 v[156:159], v102, s[20:23], s57 offen offset:2048 sc1
    s_lshl_b32 s64, s37, 13
    s_lshl_b32 s65, s36, 11
    s_add_u32 s64, s64, s65
    s_add_u32 s64, s64, 114688
    v_add_u32 v108, s64, v103
    s_lshl_b32 s64, s36, 12
    s_add_u32 s64, s64, 131072
    s_lshl_b32 s65, s37, 2
    v_and_b32 v3, 3, v2
    v_add_u32 v3, s65, v3
    v_bfe_u32 v4, v2, 2, 3
    v_xor_b32 v4, v3, v4
    v_lshrrev_b32 v8, 2, v2
    v_lshlrev_b32 v4, 4, v4
    v_lshl_add_u32 v4, v8, 7, v4
    v_add_u32 v111, s64, v4
    v_lshl_add_u32 v8, v8, 6, s63
    v_mul_u32_u24 v8, 896, v8
    v_lshl_add_u32 v8, v3, 4, v8
    s_lshl_b32 s64, s34, 7
    v_add_u32 v120, s64, v8
    v_and_b32 v3, 1, v2
    v_lshlrev_b32 v3, 4, v3
    v_mov_b32 v4, 0x3f80
    v_lshlrev_b32 v3, v3, v4
    v_mov_b32 v88, 0
    v_mov_b32 v89, 0
    v_mov_b32 v90, 0
    v_mov_b32 v91, 0
    v_mov_b32 v92, 0
    v_mov_b32 v93, 0
    v_mov_b32 v94, 0
    v_mov_b32 v95, 0
    v_mov_b32 v96, 0x4444
    s_mov_b32 exec_lo, 0x0f00000f
    s_mov_b32 exec_hi, 0x0f00000f
    v_mov_b32 v88, v3
    v_mov_b32 v93, v3
    s_mov_b32 exec_lo, 0xf00000f0
    s_mov_b32 exec_hi, 0xf00000f0
    v_mov_b32 v90, v3
    v_mov_b32 v95, v3
    s_mov_b32 exec_lo, 0xcccccccc
    s_mov_b32 exec_hi, 0xcccccccc
    v_mov_b32 v96, 0xeeee
    s_mov_b64 exec, -1
    v_mov_b32 v121, 0xffff
    v_mov_b32 v100, 1.0
    v_mov_b32 v101, 1.0
    s_mov_b32 s62, 0x00003f80
    s_mov_b32 s63, 0x3f800000
    v_lshlrev_b32 v200, 16, v192
    v_and_b32 v201, v12, v192
    v_lshlrev_b32 v202, 16, v193
    v_and_b32 v203, v12, v193
    v_lshlrev_b32 v204, 16, v194
    v_and_b32 v205, v12, v194
    v_lshlrev_b32 v206, 16, v195
    v_and_b32 v207, v12, v195
    v_lshlrev_b32 v208, 16, v196
    v_and_b32 v209, v12, v196
    v_lshlrev_b32 v210, 16, v197
    v_and_b32 v211, v12, v197
    v_lshlrev_b32 v212, 16, v198
    v_and_b32 v213, v12, v198
    v_lshlrev_b32 v214, 16, v199
    v_and_b32 v215, v12, v199
    s_waitcnt vmcnt(4)
    v_bfi_b32 v32, v104, v48, v32
    v_bfi_b32 v36, v104, v49, v36
    v_bfi_b32 v40, v104, v50, v40
    v_bfi_b32 v44, v104, v51, v44
    s_cmp_eq_u32 s38, 0
    s_cbranch_scc1 L_nomir
    v_mov_b32_dpp v3, v32 quad_perm:[1,2,3,0] row_mask:0xf bank_mask:0xf
    v_bfi_b32 v53, v121, v35, v34
    v_bfi_b32 v54, v121, v34, v33
    v_bfi_b32 v55, v121, v33, v32
    v_bfi_b32 v52, v121, v3, v35
    ds_write_b128 v106, v[52:55] offset:0
    v_mov_b32_dpp v3, v36 quad_perm:[1,2,3,0] row_mask:0xf bank_mask:0xf
    v_bfi_b32 v57, v121, v39, v38
    v_bfi_b32 v58, v121, v38, v37
    v_bfi_b32 v59, v121, v37, v36
    v_bfi_b32 v56, v121, v3, v39
    ds_write_b128 v106, v[56:59] offset:1024
    v_mov_b32_dpp v3, v40 quad_perm:[1,2,3,0] row_mask:0xf bank_mask:0xf
    v_bfi_b32 v61, v121, v43, v42
    v_bfi_b32 v62, v121, v42, v41
    v_bfi_b32 v63, v121, v41, v40
    v_bfi_b32 v60, v121, v3, v43
    ds_write_b128 v106, v[60:63] offset:2048
    v_mov_b32_dpp v3, v44 quad_perm:[1,2,3,0] row_mask:0xf bank_mask:0xf
    v_bfi_b32 v65, v121, v47, v46
    v_bfi_b32 v66, v121, v46, v45
    v_bfi_b32 v67, v121, v45, v44
    v_bfi_b32 v64, v121, v3, v47
    ds_write_b128 v106, v[64:67] offset:3072
    s_branch L_mirdone
L_nomir:
    ds_write_b128 v106, v[32:35] offset:0
    ds_write_b128 v106, v[36:39] offset:1024
    ds_write_b128 v106, v[40:43] offset:2048
    ds_write_b128 v106, v[44:47] offset:3072
L_mirdone:
    ds_read_b64_tr_b16 v[32:33], v84 offset:0
    ds_read_b64_tr_b16 v[34:35], v84 offset:2048
    ds_read_b64_tr_b16 v[40:41], v85 offset:0
    ds_read_b64_tr_b16 v[42:43], v85 offset:2048
    ds_read_b64_tr_b16 v[36:37], v86 offset:0
    ds_read_b64_tr_b16 v[38:39], v86 offset:2048
    ds_read_b64_tr_b16 v[44:45], v87 offset:0
    ds_read_b64_tr_b16 v[46:47], v87 offset:2048
    v_mul_f32 v112, 0xbfb8aa3b, v124
    v_mul_f32 v113, 0xbfb8aa3b, v124
    v_mul_f32 v114, 0xbfb8aa3b, v125
    v_mul_f32 v115, 0xbfb8aa3b, v125
    s_waitcnt lgkmcnt(4)
    v_mfma_f32_16x16x32_bf16 v[68:71], v[32:35], v[128:131], 0
    v_mfma_f32_16x16x32_bf16 v[72:75], v[32:35], v[132:135], 0
    v_mfma_f32_16x16x32_bf16 v[76:79], v[40:43], v[128:131], 0
    v_mfma_f32_16x16x32_bf16 v[80:83], v[40:43], v[132:135], 0
    s_waitcnt lgkmcnt(0)
    v_mfma_f32_16x16x32_bf16 v[68:71], v[36:39], v[136:139], v[68:71]
    s_load_dword s52, s[48:49], s40 glc
    v_mfma_f32_16x16x32_bf16 v[72:75], v[36:39], v[140:143], v[72:75]
    v_mfma_f32_16x16x32_bf16 v[76:79], v[44:47], v[136:139], v[76:79]
    v_mfma_f32_16x16x32_bf16 v[80:83], v[44:47], v[140:143], v[80:83]
    s_waitcnt vmcnt(0)
    v_mov_b32 v16, 0
    v_mov_b32 v17, 0
    v_mov_b32 v18, 0
    v_mov_b32 v19, 0
    v_mov_b32 v20, 0
    v_mov_b32 v21, 0
    v_mov_b32 v22, 0
    v_mov_b32 v23, 0
    v_mov_b32 v24, 0
    v_mov_b32 v25, 0
    v_mov_b32 v26, 0
    v_mov_b32 v27, 0
    v_mov_b32 v28, 0
    v_mov_b32 v29, 0
    v_mov_b32 v30, 0
    v_mov_b32 v31, 0
    v_smfmac_f32_16x16x64_bf16 v[16:19], v[88:91], v[144:151], v96
    v_smfmac_f32_16x16x64_bf16 v[24:27], v[88:91], v[152:159], v96
    v_smfmac_f32_16x16x64_bf16 v[20:23], v[92:95], v[144:151], v96
    v_smfmac_f32_16x16x64_bf16 v[28:31], v[92:95], v[152:159], v96
    s_lshl_b32 s56, s66, 8
    s_andn2_b32 s57, s56, s55
    s_cbranch_scc0 L_wf2_ok
L_wf2:
    s_waitcnt lgkmcnt(0)
    s_or_b32 s55, s55, s52
    s_andn2_b32 s57, s56, s55
    s_cbranch_scc0 L_wf2_ok
    s_load_dword s52, s[48:49], s40 glc
    s_add_u32 s5, s5, 1
    s_cmp_lt_u32 s5, 20000
    s_cbranch_scc1 L_wf2
L_wf2_ok:
    s_mov_b32 s57, 229376
    buffer_load_dwordx4 v[160:163], v102, s[20:23], s57 offen offset:0 sc1
    buffer_load_dwordx4 v[168:171], v102, s[20:23], s57 offen offset:2048 sc1
    s_lshl_b32 s56, s66, 12
    s_andn2_b32 s57, s56, s55
    s_cbranch_scc0 L_wf3_ok
L_wf3:
    s_waitcnt lgkmcnt(0)
    s_or_b32 s55, s55, s52
    s_andn2_b32 s57, s56, s55
    s_cbranch_scc0 L_wf3_ok
    s_load_dword s52, s[48:49], s40 glc
    s_add_u32 s5, s5, 1
    s_cmp_lt_u32 s5, 20000
    s_cbranch_scc1 L_wf3
L_wf3_ok:
    s_mov_b32 s57, 344064
    buffer_load_dwordx4 v[164:167], v102, s[20:23], s57 offen offset:0 sc1
    buffer_load_dwordx4 v[172:175], v102, s[20:23], s57 offen offset:2048 sc1
    s_lshl_b32 s56, s66, 16
    s_andn2_b32 s57, s56, s55
    s_cbranch_scc0 L_wf4_ok
L_wf4:
    s_waitcnt lgkmcnt(0)
    s_or_b32 s55, s55, s52
    s_andn2_b32 s57, s56, s55
    s_cbranch_scc0 L_wf4_ok
    s_load_dword s52, s[48:49], s40 glc
    s_add_u32 s5, s5, 1
    s_cmp_lt_u32 s5, 20000
    s_cbranch_scc1 L_wf4
L_wf4_ok:
    s_mov_b32 s57, 458752
    buffer_load_dwordx4 v[176:179], v102, s[20:23], s57 offen offset:0 sc1
    buffer_load_dwordx4 v[184:187], v102, s[20:23], s57 offen offset:2048 sc1
    s_lshl_b32 s56, s66, 20
    s_andn2_b32 s57, s56, s55
    s_cbranch_scc0 L_wf5_ok
L_wf5:
    s_waitcnt lgkmcnt(0)
    s_or_b32 s55, s55, s52
    s_andn2_b32 s57, s56, s55
    s_cbranch_scc0 L_wf5_ok
    s_load_dword s52, s[48:49], s40 glc
    s_add_u32 s5, s5, 1
    s_cmp_lt_u32 s5, 20000
    s_cbranch_scc1 L_wf5
L_wf5_ok:
    s_mov_b32 s57, 573440
    buffer_load_dwordx4 v[180:183], v102, s[20:23], s57 offen offset:0 sc1
    buffer_load_dwordx4 v[188:191], v102, s[20:23], s57 offen offset:2048 sc1
    s_barrier
    ds_read_b128 v[216:219], v108 offset:0
    ds_read_b128 v[220:223], v108 offset:1024
    ds_read_b128 v[224:227], v108 offset:4096
    ds_read_b128 v[228:231], v108 offset:5120
    s_nop 2
    s_waitcnt lgkmcnt(0)
    v_pk_add_f32 v[16:17], v[16:17], v[216:217]
    v_pk_add_f32 v[18:19], v[18:19], v[218:219]
    v_pk_add_f32 v[20:21], v[20:21], v[220:221]
    v_pk_add_f32 v[22:23], v[22:23], v[222:223]
    v_pk_add_f32 v[24:25], v[24:25], v[224:225]
    v_pk_add_f32 v[26:27], v[26:27], v[226:227]
    v_pk_add_f32 v[28:29], v[28:29], v[228:229]
    v_pk_add_f32 v[30:31], v[30:31], v[230:231]
    s_waitcnt vmcnt(4)
    s_nop 1
    v_smfmac_f32_16x16x64_bf16 v[16:19], v[88:91], v[160:167], v96
    v_smfmac_f32_16x16x64_bf16 v[24:27], v[88:91], v[168:175], v96
    v_smfmac_f32_16x16x64_bf16 v[20:23], v[92:95], v[160:167], v96
    v_smfmac_f32_16x16x64_bf16 v[28:31], v[92:95], v[168:175], v96
    s_waitcnt vmcnt(0)
    s_nop 1
    v_smfmac_f32_16x16x64_bf16 v[16:19], v[88:91], v[176:183], v96
    v_smfmac_f32_16x16x64_bf16 v[24:27], v[88:91], v[184:191], v96
    v_smfmac_f32_16x16x64_bf16 v[20:23], v[92:95], v[176:183], v96
    v_smfmac_f32_16x16x64_bf16 v[28:31], v[92:95], v[184:191], v96
    s_nop 7
    s_mov_b32 s57, 917504
    v_pk_mul_f32 v[16:17], v[16:17], v[112:113]
    v_pk_mul_f32 v[18:19], v[18:19], v[112:113]
    v_pk_mul_f32 v[24:25], v[24:25], v[112:113]
    v_pk_mul_f32 v[26:27], v[26:27], v[112:113]
    v_exp_f32 v52, v16
    v_exp_f32 v53, v17
    v_exp_f32 v54, v18
    v_exp_f32 v55, v19
    v_exp_f32 v60, v24
    v_exp_f32 v61, v25
    v_exp_f32 v62, v26
    v_exp_f32 v63, v27
    v_pk_mul_f32 v[68:69], v[68:69], v[16:17]
    v_pk_mul_f32 v[70:71], v[70:71], v[18:19]
    v_pk_mul_f32 v[76:77], v[76:77], v[24:25]
    v_pk_mul_f32 v[78:79], v[78:79], v[26:27]
    v_pk_add_f32 v[52:53], v[52:53], v[100:101]
    v_pk_add_f32 v[54:55], v[54:55], v[100:101]
    v_pk_add_f32 v[60:61], v[60:61], v[100:101]
    v_pk_add_f32 v[62:63], v[62:63], v[100:101]
    v_rcp_f32 v52, v52
    v_rcp_f32 v53, v53
    v_rcp_f32 v54, v54
    v_rcp_f32 v55, v55
    v_rcp_f32 v60, v60
    v_rcp_f32 v61, v61
    v_rcp_f32 v62, v62
    v_rcp_f32 v63, v63
    v_pk_fma_f32 v[68:69], v[68:69], v[52:53], v[200:201]
    v_pk_fma_f32 v[70:71], v[70:71], v[54:55], v[202:203]
    v_pk_fma_f32 v[76:77], v[76:77], v[60:61], v[208:209]
    v_pk_fma_f32 v[78:79], v[78:79], v[62:63], v[210:211]
    v_cvt_pk_bf16_f32 v192, v68, v69
    v_cvt_pk_bf16_f32 v193, v70, v71
    ds_write_b64 v109, v[192:193] offset:0
    v_cvt_pk_bf16_f32 v196, v76, v77
    v_cvt_pk_bf16_f32 v197, v78, v79
    ds_write_b64 v110, v[196:197] offset:0
    ds_read_b128 v[32:35], v111 offset:0
    v_pk_mul_f32 v[20:21], v[20:21], v[114:115]
    v_pk_mul_f32 v[22:23], v[22:23], v[114:115]
    v_pk_mul_f32 v[28:29], v[28:29], v[114:115]
    v_pk_mul_f32 v[30:31], v[30:31], v[114:115]
    v_exp_f32 v56, v20
    v_exp_f32 v57, v21
    v_exp_f32 v58, v22
    v_exp_f32 v59, v23
    v_exp_f32 v64, v28
    v_exp_f32 v65, v29
    v_exp_f32 v66, v30
    v_exp_f32 v67, v31
    v_pk_mul_f32 v[72:73], v[72:73], v[20:21]
    v_pk_mul_f32 v[74:75], v[74:75], v[22:23]
    v_pk_mul_f32 v[80:81], v[80:81], v[28:29]
    v_pk_mul_f32 v[82:83], v[82:83], v[30:31]
    v_pk_add_f32 v[56:57], v[56:57], v[100:101]
    v_pk_add_f32 v[58:59], v[58:59], v[100:101]
    v_pk_add_f32 v[64:65], v[64:65], v[100:101]
    v_pk_add_f32 v[66:67], v[66:67], v[100:101]
    v_rcp_f32 v56, v56
    v_rcp_f32 v57, v57
    v_rcp_f32 v58, v58
    v_rcp_f32 v59, v59
    v_rcp_f32 v64, v64
    v_rcp_f32 v65, v65
    v_rcp_f32 v66, v66
    v_rcp_f32 v67, v67
    s_waitcnt lgkmcnt(0)
    buffer_store_dwordx4 v[32:35], v120, s[24:27], 0 offen sc1
    v_pk_fma_f32 v[72:73], v[72:73], v[56:57], v[204:205]
    v_pk_fma_f32 v[74:75], v[74:75], v[58:59], v[206:207]
    v_pk_fma_f32 v[80:81], v[80:81], v[64:65], v[212:213]
    v_pk_fma_f32 v[82:83], v[82:83], v[66:67], v[214:215]
    v_cvt_pk_bf16_f32 v194, v72, v73
    v_cvt_pk_bf16_f32 v195, v74, v75
    ds_write_b64 v109, v[194:195] offset:2048
    v_cvt_pk_bf16_f32 v198, v80, v81
    v_cvt_pk_bf16_f32 v199, v82, v83
    ds_write_b64 v110, v[198:199] offset:2048
    ds_read_b128 v[36:39], v111 offset:2048
    s_waitcnt lgkmcnt(0)
    buffer_store_dwordx4 v[36:39], v120, s[24:27], s57 offen sc1
    s_endpgm
L_compute:
    s_add_u32 s48, s48, 0x1fffff
    s_addc_u32 s49, s49, 0
    s_and_b32 s48, s48, 0xffe00000
    s_mov_b32 s20, s48
    s_and_b32 s21, s49, 0xffff
    s_mov_b32 s22, 35651584
    s_mov_b32 s23, 0x00020000
    s_mov_b32 s62, 0x6453210
    s_mov_b32 s63, 0x6542301
    s_bitcmp1_b32 s2, 3
    s_cselect_b32 s62, 0x5643120, s62
    s_cselect_b32 s63, 0x6534201, s63
    s_bitcmp1_b32 s2, 4
    s_cselect_b32 s62, s63, s62
    s_mul_i32 s63, s34, 0x1111111
    s_add_u32 s62, s62, s63
    s_add_u32 s63, s62, 0x1111111
    s_and_b32 s63, s63, 0x8888888
    s_lshr_b32 s63, s63, 3
    s_mul_i32 s63, s63, 7
    s_sub_u32 s62, s62, s63
    s_lshr_b32 s34, s62, 24
    s_lshl_b32 s52, s34, 7
    s_bfe_u32 s53, s62, 0x40000
    s_lshl_b32 s53, s53, 7
    s_bfe_u32 s54, s62, 0x40004
    s_lshl_b32 s54, s54, 7
    s_bfe_u32 s55, s62, 0x40008
    s_lshl_b32 s55, s55, 7
    s_bfe_u32 s56, s62, 0x4000c
    s_lshl_b32 s56, s56, 7
    s_bfe_u32 s57, s62, 0x40010
    s_lshl_b32 s57, s57, 7
    s_bfe_u32 s58, s62, 0x40014
    s_lshl_b32 s58, s58, 7
    v_mov_b32 v12, 0xffff0000
    v_mov_b32 v192, 0
    v_mov_b32 v193, 0
    v_mov_b32 v194, 0
    v_mov_b32 v195, 0
    v_mov_b32 v196, 0
    v_mov_b32 v197, 0
    v_mov_b32 v198, 0
    v_mov_b32 v199, 0
    v_mov_b32 v200, 0
    v_mov_b32 v201, 0
    v_mov_b32 v202, 0
    v_mov_b32 v203, 0
    v_mov_b32 v204, 0x4444
    s_mov_b32 exec_lo, 0x00110011
    s_mov_b32 exec_hi, 0x00220022
    v_mov_b32 v200, 0x3f803f80
    v_mov_b32 v201, 0x3f803f80
    v_mov_b32 v202, 0x3f803f80
    v_mov_b32 v203, 0x3f803f80
    s_mov_b32 exec_lo, 0x00f000f0
    s_mov_b32 exec_hi, 0x00f000f0
    v_mov_b32 v204, 0xeeee
    s_mov_b64 exec, -1
    v_lshrrev_b32 v3, 2, v2
    v_lshlrev_b32 v3, 7, v3
    v_and_b32 v4, 3, v2
    v_lshl_add_u32 v3, v4, 3, v3
    v_bfe_u32 v4, v2, 3, 2
    v_lshl_add_u32 v3, v4, 5, v3
    s_lshl_b32 s64, s35, 12
    s_lshl_b32 s65, s35, 5
    v_xor_b32 v112, 0, v3
    v_add_u32 v112, s64, v112
    v_add_u32 v116, 0x10000, v112
    v_xor_b32 v113, 32, v3
    v_add_u32 v113, s64, v113
    v_add_u32 v117, 0x10000, v113
    v_xor_b32 v114, 64, v3
    v_add_u32 v114, s64, v114
    v_add_u32 v118, 0x10000, v114
    v_xor_b32 v115, 96, v3
    v_add_u32 v115, s64, v115
    v_add_u32 v119, 0x10000, v115
    v_xor_b32 v122, s65, v3
    v_add_u32 v123, 0x10000, v122
    v_add_u32 v127, 0x20000, v122
    v_and_b32 v8, 15, v2
    v_lshrrev_b32 v4, 4, v2
    v_xor_b32 v120, v4, v6
    v_lshlrev_b32 v120, 4, v120
    v_lshl_add_u32 v120, v8, 7, v120
    v_add_u32 v120, 98304, v120
    v_xor_b32 v121, 64, v120
    v_lshlrev_b32 v205, 5, v8
    v_lshlrev_b32 v124, 4, v2
    s_lshl_b32 s64, s35, 13
    v_add_u32 v126, s64, v124
    s_mul_i32 s64, s32, 1048576
    s_mul_i32 s65, s35, 2048
    s_add_u32 s64, s64, s65
    v_mad_u32_u24 v125, v2, 16, s64
    s_lshl_b32 s64, s32, 20
    s_add_u32 s59, s64, 806912
    s_add_u32 s64, s64, 802816
    s_add_u32 s62, s64, 12032
    s_mov_b32 s61, 0
    s_mul_i32 s4, s53, 128
    s_add_u32 s4, s4, 0
    s_mul_i32 s5, s54, 128
    s_add_u32 s5, s5, 114688
    s_mul_i32 s6, s55, 128
    s_add_u32 s6, s6, 229376
    s_mul_i32 s7, s56, 128
    s_add_u32 s7, s7, 344064
    s_mul_i32 s8, s57, 128
    s_add_u32 s8, s8, 458752
    s_mul_i32 s9, s58, 128
    s_add_u32 s9, s9, 573440
    s_mul_i32 s50, s53, 2
    s_add_u32 s50, s50, s64
    s_mul_i32 s51, s54, 2
    s_add_u32 s51, s51, s64
    s_mul_i32 s52, s55, 2
    s_add_u32 s52, s52, s64
    s_mul_i32 s53, s56, 2
    s_add_u32 s53, s53, s64
    s_mul_i32 s54, s57, 2
    s_add_u32 s54, s54, s64
    s_mul_i32 s55, s58, 2
    s_add_u32 s55, s55, s64
    v_lshlrev_b32 v13, 26, v2
    s_lshl_b32 s64, 1, s35
    v_lshlrev_b32_e64 v5, 0, s64
    v_lshlrev_b32_e64 v6, 4, s64
    v_lshlrev_b32_e64 v7, 8, s64
    v_lshlrev_b32_e64 v8, 12, s64
    v_lshlrev_b32_e64 v9, 16, s64
    v_lshlrev_b32_e64 v10, 20, s64
    s_waitcnt lgkmcnt(0)
    s_cmp_lg_u32 s35, 0
    s_cbranch_scc1 L_iw1
    s_mov_b64 exec, 0
    s_cbranch_execz L_pad_in0
L_iw1:
    s_cmp_lg_u32 s35, 1
    s_cbranch_scc1 L_iw2
    s_mov_b64 exec, 0
    s_cbranch_execz L_pad_in1
L_iw2:
    s_cmp_lg_u32 s35, 2
    s_cbranch_scc1 L_iw3
    s_mov_b64 exec, 0
    s_cbranch_execz L_pad_in2
L_iw3:
    s_mov_b64 exec, 0
    s_cbranch_execz L_pad_ret
L_pad_ret:
    s_mov_b64 exec, -1
    s_waitcnt vmcnt(0)
    s_barrier
    ds_read_b128 v[48:51], v120 offset:0
    ds_read_b64_tr_b16 v[16:17], v112 offset:0
    ds_read_b64_tr_b16 v[18:19], v112 offset:2048
    ds_read_b128 v[52:55], v120 offset:2048
    ds_read_b128 v[56:59], v120 offset:4096
    ds_read_b128 v[60:63], v120 offset:6144
    ds_read_b64_tr_b16 v[20:21], v113 offset:0
    ds_read_b64_tr_b16 v[22:23], v113 offset:2048
    ds_read_b64_tr_b16 v[24:25], v114 offset:0
    ds_read_b64_tr_b16 v[26:27], v114 offset:2048
    ds_read_b64_tr_b16 v[28:29], v115 offset:0
L_pad1:
L_pad_in1:
    s_cbranch_execz L_pad_ret
    ds_read_b64_tr_b16 v[30:31], v115 offset:2048
    ds_read_b64_tr_b16 v[32:33], v112 offset:16384
    ds_read_b64_tr_b16 v[34:35], v112 offset:18432
    ds_read_b64_tr_b16 v[36:37], v113 offset:16384
    s_waitcnt lgkmcnt(9)
    v_mfma_f32_16x16x32_bf16 v[128:131], v[16:19], v[48:51], 0
    ds_read_b64_tr_b16 v[38:39], v113 offset:18432
    v_mfma_f32_16x16x32_bf16 v[132:135], v[16:19], v[52:55], 0
    ds_read_b128 v[64:67], v121 offset:0
    v_mfma_f32_16x16x32_bf16 v[136:139], v[16:19], v[56:59], 0
    ds_read_b128 v[68:71], v121 offset:2048
    v_mfma_f32_16x16x32_bf16 v[140:143], v[16:19], v[60:63], 0
    ds_read_b128 v[72:75], v121 offset:4096
    s_waitcnt lgkmcnt(11)
    v_mfma_f32_16x16x32_bf16 v[156:159], v[20:23], v[60:63], 0
    ds_read_b128 v[76:79], v121 offset:6144
    v_mfma_f32_16x16x32_bf16 v[152:155], v[20:23], v[56:59], 0
    ds_read_b64_tr_b16 v[40:41], v114 offset:16384
    v_mfma_f32_16x16x32_bf16 v[148:151], v[20:23], v[52:55], 0
    ds_read_b64_tr_b16 v[42:43], v114 offset:18432
    v_mfma_f32_16x16x32_bf16 v[144:147], v[20:23], v[48:51], 0
    ds_read_b64_tr_b16 v[44:45], v115 offset:16384
    s_waitcnt lgkmcnt(13)
    v_mfma_f32_16x16x32_bf16 v[160:163], v[24:27], v[48:51], 0
    ds_read_b64_tr_b16 v[46:47], v115 offset:18432
    v_mfma_f32_16x16x32_bf16 v[164:167], v[24:27], v[52:55], 0
    v_mfma_f32_16x16x32_bf16 v[168:171], v[24:27], v[56:59], 0
    v_mfma_f32_16x16x32_bf16 v[172:175], v[24:27], v[60:63], 0
    s_waitcnt lgkmcnt(12)
    v_mfma_f32_16x16x32_bf16 v[188:191], v[28:31], v[60:63], 0
    v_mfma_f32_16x16x32_bf16 v[184:187], v[28:31], v[56:59], 0
    v_mfma_f32_16x16x32_bf16 v[180:183], v[28:31], v[52:55], 0
    v_mfma_f32_16x16x32_bf16 v[176:179], v[28:31], v[48:51], 0
    v_smfmac_f32_16x16x64_bf16 v[192:195], v[200:203], v[16:23], v204
    v_smfmac_f32_16x16x64_bf16 v[196:199], v[200:203], v[24:31], v204
    s_waitcnt lgkmcnt(0)
    s_barrier
    v_smfmac_f32_16x16x64_bf16 v[192:195], v[200:203], v[32:39], v204
    ds_read_b128 v[48:51], v120 offset:8192
    v_smfmac_f32_16x16x64_bf16 v[196:199], v[200:203], v[40:47], v204
    ds_read_b64_tr_b16 v[16:17], v112 offset:32768
    v_mfma_f32_16x16x32_bf16 v[128:131], v[32:35], v[64:67], v[128:131]
    ds_read_b64_tr_b16 v[18:19], v112 offset:34816
    v_mfma_f32_16x16x32_bf16 v[132:135], v[32:35], v[68:71], v[132:135]
    ds_read_b128 v[52:55], v120 offset:10240
    v_mfma_f32_16x16x32_bf16 v[136:139], v[32:35], v[72:75], v[136:139]
    ds_read_b128 v[56:59], v120 offset:12288
    v_mfma_f32_16x16x32_bf16 v[140:143], v[32:35], v[76:79], v[140:143]
    ds_read_b128 v[60:63], v120 offset:14336
    v_mfma_f32_16x16x32_bf16 v[156:159], v[36:39], v[76:79], v[156:159]
    ds_read_b64_tr_b16 v[20:21], v113 offset:32768
    v_mfma_f32_16x16x32_bf16 v[152:155], v[36:39], v[72:75], v[152:155]
    ds_read_b64_tr_b16 v[22:23], v113 offset:34816
    v_mfma_f32_16x16x32_bf16 v[148:151], v[36:39], v[68:71], v[148:151]
    ds_read_b64_tr_b16 v[24:25], v114 offset:32768
    v_mfma_f32_16x16x32_bf16 v[144:147], v[36:39], v[64:67], v[144:147]
    ds_read_b64_tr_b16 v[26:27], v114 offset:34816
    v_mfma_f32_16x16x32_bf16 v[160:163], v[40:43], v[64:67], v[160:163]
    ds_read_b64_tr_b16 v[28:29], v115 offset:32768
    v_mfma_f32_16x16x32_bf16 v[164:167], v[40:43], v[68:71], v[164:167]
    ds_read_b64_tr_b16 v[30:31], v115 offset:34816
    v_mfma_f32_16x16x32_bf16 v[168:171], v[40:43], v[72:75], v[168:171]
    ds_read_b64_tr_b16 v[32:33], v112 offset:49152
    v_mfma_f32_16x16x32_bf16 v[172:175], v[40:43], v[76:79], v[172:175]
    ds_read_b64_tr_b16 v[34:35], v112 offset:51200
    v_mfma_f32_16x16x32_bf16 v[188:191], v[44:47], v[76:79], v[188:191]
    ds_read_b64_tr_b16 v[36:37], v113 offset:49152
    v_mfma_f32_16x16x32_bf16 v[184:187], v[44:47], v[72:75], v[184:187]
    ds_read_b64_tr_b16 v[38:39], v113 offset:51200
    v_mfma_f32_16x16x32_bf16 v[180:183], v[44:47], v[68:71], v[180:183]
    v_mfma_f32_16x16x32_bf16 v[176:179], v[44:47], v[64:67], v[176:179]
    s_waitcnt lgkmcnt(6)
    v_mfma_f32_16x16x32_bf16 v[128:131], v[16:19], v[48:51], v[128:131]
    ds_read_b128 v[64:67], v121 offset:8192
    v_mfma_f32_16x16x32_bf16 v[132:135], v[16:19], v[52:55], v[132:135]
    ds_read_b128 v[68:71], v121 offset:10240
    v_mfma_f32_16x16x32_bf16 v[136:139], v[16:19], v[56:59], v[136:139]
    ds_read_b128 v[72:75], v121 offset:12288
    v_mfma_f32_16x16x32_bf16 v[140:143], v[16:19], v[60:63], v[140:143]
    ds_read_b128 v[76:79], v121 offset:14336
    v_mfma_f32_16x16x32_bf16 v[156:159], v[20:23], v[60:63], v[156:159]
    ds_read_b64_tr_b16 v[40:41], v114 offset:49152
    v_mfma_f32_16x16x32_bf16 v[152:155], v[20:23], v[56:59], v[152:155]
    ds_read_b64_tr_b16 v[42:43], v114 offset:51200
    v_mfma_f32_16x16x32_bf16 v[148:151], v[20:23], v[52:55], v[148:151]
    ds_read_b64_tr_b16 v[44:45], v115 offset:49152
    v_mfma_f32_16x16x32_bf16 v[144:147], v[20:23], v[48:51], v[144:147]
    ds_read_b64_tr_b16 v[46:47], v115 offset:51200
    v_mfma_f32_16x16x32_bf16 v[160:163], v[24:27], v[48:51], v[160:163]
    v_mfma_f32_16x16x32_bf16 v[164:167], v[24:27], v[52:55], v[164:167]
    v_mfma_f32_16x16x32_bf16 v[168:171], v[24:27], v[56:59], v[168:171]
    v_mfma_f32_16x16x32_bf16 v[172:175], v[24:27], v[60:63], v[172:175]
    s_waitcnt lgkmcnt(12)
    v_mfma_f32_16x16x32_bf16 v[188:191], v[28:31], v[60:63], v[188:191]
    v_mfma_f32_16x16x32_bf16 v[184:187], v[28:31], v[56:59], v[184:187]
    v_mfma_f32_16x16x32_bf16 v[180:183], v[28:31], v[52:55], v[180:183]
    v_mfma_f32_16x16x32_bf16 v[176:179], v[28:31], v[48:51], v[176:179]
    v_smfmac_f32_16x16x64_bf16 v[192:195], v[200:203], v[16:23], v204
    v_smfmac_f32_16x16x64_bf16 v[196:199], v[200:203], v[24:31], v204
    s_waitcnt lgkmcnt(0)
    s_barrier
    v_smfmac_f32_16x16x64_bf16 v[192:195], v[200:203], v[32:39], v204
    ds_read_b128 v[48:51], v120 offset:16384
    v_smfmac_f32_16x16x64_bf16 v[196:199], v[200:203], v[40:47], v204
    ds_read_b64_tr_b16 v[16:17], v116 offset:0
    v_mfma_f32_16x16x32_bf16 v[128:131], v[32:35], v[64:67], v[128:131]
    ds_read_b64_tr_b16 v[18:19], v116 offset:2048
    v_mfma_f32_16x16x32_bf16 v[132:135], v[32:35], v[68:71], v[132:135]
    ds_read_b128 v[52:55], v120 offset:18432
    v_mfma_f32_16x16x32_bf16 v[136:139], v[32:35], v[72:75], v[136:139]
    ds_read_b128 v[56:59], v120 offset:20480
    v_mfma_f32_16x16x32_bf16 v[140:143], v[32:35], v[76:79], v[140:143]
    ds_read_b128 v[60:63], v120 offset:22528
    v_mfma_f32_16x16x32_bf16 v[156:159], v[36:39], v[76:79], v[156:159]
    ds_read_b64_tr_b16 v[20:21], v117 offset:0
    v_mfma_f32_16x16x32_bf16 v[152:155], v[36:39], v[72:75], v[152:155]
    ds_read_b64_tr_b16 v[22:23], v117 offset:2048
    v_mfma_f32_16x16x32_bf16 v[148:151], v[36:39], v[68:71], v[148:151]
    ds_read_b64_tr_b16 v[24:25], v118 offset:0
    v_mfma_f32_16x16x32_bf16 v[144:147], v[36:39], v[64:67], v[144:147]
    ds_read_b64_tr_b16 v[26:27], v118 offset:2048
    v_mfma_f32_16x16x32_bf16 v[160:163], v[40:43], v[64:67], v[160:163]
    ds_read_b64_tr_b16 v[28:29], v119 offset:0
    v_mfma_f32_16x16x32_bf16 v[164:167], v[40:43], v[68:71], v[164:167]
    ds_read_b64_tr_b16 v[30:31], v119 offset:2048
    v_mfma_f32_16x16x32_bf16 v[168:171], v[40:43], v[72:75], v[168:171]
    ds_read_b64_tr_b16 v[32:33], v116 offset:16384
    v_mfma_f32_16x16x32_bf16 v[172:175], v[40:43], v[76:79], v[172:175]
    ds_read_b64_tr_b16 v[34:35], v116 offset:18432
    v_mfma_f32_16x16x32_bf16 v[188:191], v[44:47], v[76:79], v[188:191]
    ds_read_b64_tr_b16 v[36:37], v117 offset:16384
    v_mfma_f32_16x16x32_bf16 v[184:187], v[44:47], v[72:75], v[184:187]
    ds_read_b64_tr_b16 v[38:39], v117 offset:18432
    v_mfma_f32_16x16x32_bf16 v[180:183], v[44:47], v[68:71], v[180:183]
    v_mfma_f32_16x16x32_bf16 v[176:179], v[44:47], v[64:67], v[176:179]
    s_waitcnt lgkmcnt(6)
    v_mfma_f32_16x16x32_bf16 v[128:131], v[16:19], v[48:51], v[128:131]
    ds_read_b128 v[64:67], v121 offset:16384
    v_mfma_f32_16x16x32_bf16 v[132:135], v[16:19], v[52:55], v[132:135]
    ds_read_b128 v[68:71], v121 offset:18432
    v_mfma_f32_16x16x32_bf16 v[136:139], v[16:19], v[56:59], v[136:139]
    ds_read_b128 v[72:75], v121 offset:20480
    v_mfma_f32_16x16x32_bf16 v[140:143], v[16:19], v[60:63], v[140:143]
    ds_read_b128 v[76:79], v121 offset:22528
    v_mfma_f32_16x16x32_bf16 v[156:159], v[20:23], v[60:63], v[156:159]
    ds_read_b64_tr_b16 v[40:41], v118 offset:16384
    v_mfma_f32_16x16x32_bf16 v[152:155], v[20:23], v[56:59], v[152:155]
    ds_read_b64_tr_b16 v[42:43], v118 offset:18432
    v_mfma_f32_16x16x32_bf16 v[148:151], v[20:23], v[52:55], v[148:151]
    ds_read_b64_tr_b16 v[44:45], v119 offset:16384
    v_mfma_f32_16x16x32_bf16 v[144:147], v[20:23], v[48:51], v[144:147]
    ds_read_b64_tr_b16 v[46:47], v119 offset:18432
    v_mfma_f32_16x16x32_bf16 v[160:163], v[24:27], v[48:51], v[160:163]
    v_mfma_f32_16x16x32_bf16 v[164:167], v[24:27], v[52:55], v[164:167]
    v_mfma_f32_16x16x32_bf16 v[168:171], v[24:27], v[56:59], v[168:171]
    v_mfma_f32_16x16x32_bf16 v[172:175], v[24:27], v[60:63], v[172:175]
    s_waitcnt lgkmcnt(12)
    v_mfma_f32_16x16x32_bf16 v[188:191], v[28:31], v[60:63], v[188:191]
    v_mfma_f32_16x16x32_bf16 v[184:187], v[28:31], v[56:59], v[184:187]
    v_mfma_f32_16x16x32_bf16 v[180:183], v[28:31], v[52:55], v[180:183]
    v_mfma_f32_16x16x32_bf16 v[176:179], v[28:31], v[48:51], v[176:179]
    v_smfmac_f32_16x16x64_bf16 v[192:195], v[200:203], v[16:23], v204
    v_smfmac_f32_16x16x64_bf16 v[196:199], v[200:203], v[24:31], v204
    s_waitcnt lgkmcnt(0)
    s_barrier
    v_smfmac_f32_16x16x64_bf16 v[192:195], v[200:203], v[32:39], v204
    ds_read_b128 v[48:51], v120 offset:24576
    v_smfmac_f32_16x16x64_bf16 v[196:199], v[200:203], v[40:47], v204
    ds_read_b64_tr_b16 v[16:17], v112 offset:0
    v_mfma_f32_16x16x32_bf16 v[128:131], v[32:35], v[64:67], v[128:131]
    ds_read_b64_tr_b16 v[18:19], v112 offset:2048
    v_mfma_f32_16x16x32_bf16 v[132:135], v[32:35], v[68:71], v[132:135]
    ds_read_b128 v[52:55], v120 offset:26624
    v_mfma_f32_16x16x32_bf16 v[136:139], v[32:35], v[72:75], v[136:139]
    ds_read_b128 v[56:59], v120 offset:28672
    v_mfma_f32_16x16x32_bf16 v[140:143], v[32:35], v[76:79], v[140:143]
    ds_read_b128 v[60:63], v120 offset:30720
    v_mfma_f32_16x16x32_bf16 v[156:159], v[36:39], v[76:79], v[156:159]
    ds_read_b64_tr_b16 v[20:21], v113 offset:0
    v_mfma_f32_16x16x32_bf16 v[152:155], v[36:39], v[72:75], v[152:155]
    ds_read_b64_tr_b16 v[22:23], v113 offset:2048
    v_mfma_f32_16x16x32_bf16 v[148:151], v[36:39], v[68:71], v[148:151]
    ds_read_b64_tr_b16 v[24:25], v114 offset:0
    v_mfma_f32_16x16x32_bf16 v[144:147], v[36:39], v[64:67], v[144:147]
    ds_read_b64_tr_b16 v[26:27], v114 offset:2048
    v_mfma_f32_16x16x32_bf16 v[160:163], v[40:43], v[64:67], v[160:163]
    ds_read_b64_tr_b16 v[28:29], v115 offset:0
    v_mfma_f32_16x16x32_bf16 v[164:167], v[40:43], v[68:71], v[164:167]
    ds_read_b64_tr_b16 v[30:31], v115 offset:2048
    v_mfma_f32_16x16x32_bf16 v[168:171], v[40:43], v[72:75], v[168:171]
    ds_read_b64_tr_b16 v[32:33], v112 offset:16384
    v_mfma_f32_16x16x32_bf16 v[172:175], v[40:43], v[76:79], v[172:175]
    ds_read_b64_tr_b16 v[34:35], v112 offset:18432
    v_mfma_f32_16x16x32_bf16 v[188:191], v[44:47], v[76:79], v[188:191]
    ds_read_b64_tr_b16 v[36:37], v113 offset:16384
    v_mfma_f32_16x16x32_bf16 v[184:187], v[44:47], v[72:75], v[184:187]
    ds_read_b64_tr_b16 v[38:39], v113 offset:18432
    v_mfma_f32_16x16x32_bf16 v[180:183], v[44:47], v[68:71], v[180:183]
    v_mfma_f32_16x16x32_bf16 v[176:179], v[44:47], v[64:67], v[176:179]
    s_waitcnt lgkmcnt(6)
    v_mfma_f32_16x16x32_bf16 v[128:131], v[16:19], v[48:51], v[128:131]
    ds_read_b128 v[64:67], v121 offset:24576
    v_mfma_f32_16x16x32_bf16 v[132:135], v[16:19], v[52:55], v[132:135]
    ds_read_b128 v[68:71], v121 offset:26624
    v_mfma_f32_16x16x32_bf16 v[136:139], v[16:19], v[56:59], v[136:139]
    ds_read_b128 v[72:75], v121 offset:28672
    v_mfma_f32_16x16x32_bf16 v[140:143], v[16:19], v[60:63], v[140:143]
    ds_read_b128 v[76:79], v121 offset:30720
    v_mfma_f32_16x16x32_bf16 v[156:159], v[20:23], v[60:63], v[156:159]
    ds_read_b64_tr_b16 v[40:41], v114 offset:16384
    v_mfma_f32_16x16x32_bf16 v[152:155], v[20:23], v[56:59], v[152:155]
    ds_read_b64_tr_b16 v[42:43], v114 offset:18432
    v_mfma_f32_16x16x32_bf16 v[148:151], v[20:23], v[52:55], v[148:151]
    ds_read_b64_tr_b16 v[44:45], v115 offset:16384
    v_mfma_f32_16x16x32_bf16 v[144:147], v[20:23], v[48:51], v[144:147]
    ds_read_b64_tr_b16 v[46:47], v115 offset:18432
    v_mfma_f32_16x16x32_bf16 v[160:163], v[24:27], v[48:51], v[160:163]
    v_mfma_f32_16x16x32_bf16 v[164:167], v[24:27], v[52:55], v[164:167]
    v_mfma_f32_16x16x32_bf16 v[168:171], v[24:27], v[56:59], v[168:171]
    v_mfma_f32_16x16x32_bf16 v[172:175], v[24:27], v[60:63], v[172:175]
    s_waitcnt lgkmcnt(12)
    v_mfma_f32_16x16x32_bf16 v[188:191], v[28:31], v[60:63], v[188:191]
    v_mfma_f32_16x16x32_bf16 v[184:187], v[28:31], v[56:59], v[184:187]
    v_mfma_f32_16x16x32_bf16 v[180:183], v[28:31], v[52:55], v[180:183]
    v_mfma_f32_16x16x32_bf16 v[176:179], v[28:31], v[48:51], v[176:179]
    v_smfmac_f32_16x16x64_bf16 v[192:195], v[200:203], v[16:23], v204
    v_smfmac_f32_16x16x64_bf16 v[196:199], v[200:203], v[24:31], v204
    s_waitcnt lgkmcnt(0)
    s_barrier
    v_smfmac_f32_16x16x64_bf16 v[192:195], v[200:203], v[32:39], v204
    ds_read_b128 v[48:51], v120 offset:32768
    v_smfmac_f32_16x16x64_bf16 v[196:199], v[200:203], v[40:47], v204
    ds_read_b64_tr_b16 v[16:17], v112 offset:32768
    v_mfma_f32_16x16x32_bf16 v[128:131], v[32:35], v[64:67], v[128:131]
    ds_read_b64_tr_b16 v[18:19], v112 offset:34816
    v_mfma_f32_16x16x32_bf16 v[132:135], v[32:35], v[68:71], v[132:135]
    ds_read_b128 v[52:55], v120 offset:34816
    v_mfma_f32_16x16x32_bf16 v[136:139], v[32:35], v[72:75], v[136:139]
    ds_read_b128 v[56:59], v120 offset:36864
    v_mfma_f32_16x16x32_bf16 v[140:143], v[32:35], v[76:79], v[140:143]
    ds_read_b128 v[60:63], v120 offset:38912
    v_mfma_f32_16x16x32_bf16 v[156:159], v[36:39], v[76:79], v[156:159]
    ds_read_b64_tr_b16 v[20:21], v113 offset:32768
    v_mfma_f32_16x16x32_bf16 v[152:155], v[36:39], v[72:75], v[152:155]
    ds_read_b64_tr_b16 v[22:23], v113 offset:34816
    v_mfma_f32_16x16x32_bf16 v[148:151], v[36:39], v[68:71], v[148:151]
    ds_read_b64_tr_b16 v[24:25], v114 offset:32768
    v_mfma_f32_16x16x32_bf16 v[144:147], v[36:39], v[64:67], v[144:147]
    ds_read_b64_tr_b16 v[26:27], v114 offset:34816
    v_mfma_f32_16x16x32_bf16 v[160:163], v[40:43], v[64:67], v[160:163]
    ds_read_b64_tr_b16 v[28:29], v115 offset:32768
    v_mfma_f32_16x16x32_bf16 v[164:167], v[40:43], v[68:71], v[164:167]
    ds_read_b64_tr_b16 v[30:31], v115 offset:34816
    v_mfma_f32_16x16x32_bf16 v[168:171], v[40:43], v[72:75], v[168:171]
    ds_read_b64_tr_b16 v[32:33], v112 offset:49152
    v_mfma_f32_16x16x32_bf16 v[172:175], v[40:43], v[76:79], v[172:175]
    ds_read_b64_tr_b16 v[34:35], v112 offset:51200
    v_mfma_f32_16x16x32_bf16 v[188:191], v[44:47], v[76:79], v[188:191]
    ds_read_b64_tr_b16 v[36:37], v113 offset:49152
    v_mfma_f32_16x16x32_bf16 v[184:187], v[44:47], v[72:75], v[184:187]
    ds_read_b64_tr_b16 v[38:39], v113 offset:51200
    v_mfma_f32_16x16x32_bf16 v[180:183], v[44:47], v[68:71], v[180:183]
    v_mfma_f32_16x16x32_bf16 v[176:179], v[44:47], v[64:67], v[176:179]
    s_waitcnt lgkmcnt(6)
    v_mfma_f32_16x16x32_bf16 v[128:131], v[16:19], v[48:51], v[128:131]
    ds_read_b128 v[64:67], v121 offset:32768
    v_mfma_f32_16x16x32_bf16 v[132:135], v[16:19], v[52:55], v[132:135]
    ds_read_b128 v[68:71], v121 offset:34816
    v_mfma_f32_16x16x32_bf16 v[136:139], v[16:19], v[56:59], v[136:139]
    ds_read_b128 v[72:75], v121 offset:36864
    v_mfma_f32_16x16x32_bf16 v[140:143], v[16:19], v[60:63], v[140:143]
    ds_read_b128 v[76:79], v121 offset:38912
    v_mfma_f32_16x16x32_bf16 v[156:159], v[20:23], v[60:63], v[156:159]
    ds_read_b64_tr_b16 v[40:41], v114 offset:49152
    v_mfma_f32_16x16x32_bf16 v[152:155], v[20:23], v[56:59], v[152:155]
    ds_read_b64_tr_b16 v[42:43], v114 offset:51200
    v_mfma_f32_16x16x32_bf16 v[148:151], v[20:23], v[52:55], v[148:151]
    ds_read_b64_tr_b16 v[44:45], v115 offset:49152
    v_mfma_f32_16x16x32_bf16 v[144:147], v[20:23], v[48:51], v[144:147]
    ds_read_b64_tr_b16 v[46:47], v115 offset:51200
    v_mfma_f32_16x16x32_bf16 v[160:163], v[24:27], v[48:51], v[160:163]
    v_mfma_f32_16x16x32_bf16 v[164:167], v[24:27], v[52:55], v[164:167]
    v_mfma_f32_16x16x32_bf16 v[168:171], v[24:27], v[56:59], v[168:171]
    v_mfma_f32_16x16x32_bf16 v[172:175], v[24:27], v[60:63], v[172:175]
    s_waitcnt lgkmcnt(12)
    v_mfma_f32_16x16x32_bf16 v[188:191], v[28:31], v[60:63], v[188:191]
    v_mfma_f32_16x16x32_bf16 v[184:187], v[28:31], v[56:59], v[184:187]
    v_mfma_f32_16x16x32_bf16 v[180:183], v[28:31], v[52:55], v[180:183]
    v_mfma_f32_16x16x32_bf16 v[176:179], v[28:31], v[48:51], v[176:179]
    v_smfmac_f32_16x16x64_bf16 v[192:195], v[200:203], v[16:23], v204
    v_smfmac_f32_16x16x64_bf16 v[196:199], v[200:203], v[24:31], v204
    s_waitcnt lgkmcnt(0)
    s_barrier
    v_smfmac_f32_16x16x64_bf16 v[192:195], v[200:203], v[32:39], v204
    ds_read_b128 v[48:51], v120 offset:40960
    v_smfmac_f32_16x16x64_bf16 v[196:199], v[200:203], v[40:47], v204
    ds_read_b64_tr_b16 v[16:17], v116 offset:0
    v_mfma_f32_16x16x32_bf16 v[128:131], v[32:35], v[64:67], v[128:131]
    ds_read_b64_tr_b16 v[18:19], v116 offset:2048
    v_mfma_f32_16x16x32_bf16 v[132:135], v[32:35], v[68:71], v[132:135]
    ds_read_b128 v[52:55], v120 offset:43008
    v_mfma_f32_16x16x32_bf16 v[136:139], v[32:35], v[72:75], v[136:139]
    ds_read_b128 v[56:59], v120 offset:45056
    v_mfma_f32_16x16x32_bf16 v[140:143], v[32:35], v[76:79], v[140:143]
    ds_read_b128 v[60:63], v120 offset:47104
    v_mfma_f32_16x16x32_bf16 v[156:159], v[36:39], v[76:79], v[156:159]
    ds_read_b64_tr_b16 v[20:21], v117 offset:0
    v_mfma_f32_16x16x32_bf16 v[152:155], v[36:39], v[72:75], v[152:155]
    ds_read_b64_tr_b16 v[22:23], v117 offset:2048
    v_mfma_f32_16x16x32_bf16 v[148:151], v[36:39], v[68:71], v[148:151]
    ds_read_b64_tr_b16 v[24:25], v118 offset:0
    v_mfma_f32_16x16x32_bf16 v[144:147], v[36:39], v[64:67], v[144:147]
    ds_read_b64_tr_b16 v[26:27], v118 offset:2048
    v_mfma_f32_16x16x32_bf16 v[160:163], v[40:43], v[64:67], v[160:163]
    ds_read_b64_tr_b16 v[28:29], v119 offset:0
    v_mfma_f32_16x16x32_bf16 v[164:167], v[40:43], v[68:71], v[164:167]
    ds_read_b64_tr_b16 v[30:31], v119 offset:2048
    v_mfma_f32_16x16x32_bf16 v[168:171], v[40:43], v[72:75], v[168:171]
    ds_read_b64_tr_b16 v[32:33], v116 offset:16384
    v_mfma_f32_16x16x32_bf16 v[172:175], v[40:43], v[76:79], v[172:175]
    ds_read_b64_tr_b16 v[34:35], v116 offset:18432
    v_mfma_f32_16x16x32_bf16 v[188:191], v[44:47], v[76:79], v[188:191]
    ds_read_b64_tr_b16 v[36:37], v117 offset:16384
    v_mfma_f32_16x16x32_bf16 v[184:187], v[44:47], v[72:75], v[184:187]
    ds_read_b64_tr_b16 v[38:39], v117 offset:18432
    v_mfma_f32_16x16x32_bf16 v[180:183], v[44:47], v[68:71], v[180:183]
    v_mfma_f32_16x16x32_bf16 v[176:179], v[44:47], v[64:67], v[176:179]
    s_waitcnt lgkmcnt(6)
    v_mfma_f32_16x16x32_bf16 v[128:131], v[16:19], v[48:51], v[128:131]
    ds_read_b128 v[64:67], v121 offset:40960
    v_mfma_f32_16x16x32_bf16 v[132:135], v[16:19], v[52:55], v[132:135]
    ds_read_b128 v[68:71], v121 offset:43008
    v_mfma_f32_16x16x32_bf16 v[136:139], v[16:19], v[56:59], v[136:139]
    ds_read_b128 v[72:75], v121 offset:45056
    v_mfma_f32_16x16x32_bf16 v[140:143], v[16:19], v[60:63], v[140:143]
    ds_read_b128 v[76:79], v121 offset:47104
    v_mfma_f32_16x16x32_bf16 v[156:159], v[20:23], v[60:63], v[156:159]
    ds_read_b64_tr_b16 v[40:41], v118 offset:16384
    v_mfma_f32_16x16x32_bf16 v[152:155], v[20:23], v[56:59], v[152:155]
    ds_read_b64_tr_b16 v[42:43], v118 offset:18432
    v_mfma_f32_16x16x32_bf16 v[148:151], v[20:23], v[52:55], v[148:151]
    ds_read_b64_tr_b16 v[44:45], v119 offset:16384
    v_mfma_f32_16x16x32_bf16 v[144:147], v[20:23], v[48:51], v[144:147]
    ds_read_b64_tr_b16 v[46:47], v119 offset:18432
    v_mfma_f32_16x16x32_bf16 v[160:163], v[24:27], v[48:51], v[160:163]
    v_mfma_f32_16x16x32_bf16 v[164:167], v[24:27], v[52:55], v[164:167]
    v_mfma_f32_16x16x32_bf16 v[168:171], v[24:27], v[56:59], v[168:171]
    v_mfma_f32_16x16x32_bf16 v[172:175], v[24:27], v[60:63], v[172:175]
    s_waitcnt lgkmcnt(12)
    v_mfma_f32_16x16x32_bf16 v[188:191], v[28:31], v[60:63], v[188:191]
    v_mfma_f32_16x16x32_bf16 v[184:187], v[28:31], v[56:59], v[184:187]
    v_mfma_f32_16x16x32_bf16 v[180:183], v[28:31], v[52:55], v[180:183]
    v_mfma_f32_16x16x32_bf16 v[176:179], v[28:31], v[48:51], v[176:179]
    v_smfmac_f32_16x16x64_bf16 v[192:195], v[200:203], v[16:23], v204
    v_smfmac_f32_16x16x64_bf16 v[196:199], v[200:203], v[24:31], v204
    s_waitcnt lgkmcnt(0)
    s_barrier
    v_smfmac_f32_16x16x64_bf16 v[192:195], v[200:203], v[32:39], v204
    ds_read_b128 v[48:51], v120 offset:49152
    v_smfmac_f32_16x16x64_bf16 v[196:199], v[200:203], v[40:47], v204
    ds_read_b64_tr_b16 v[16:17], v112 offset:0
    buffer_load_dwordx4 v[216:219], v205, s[20:23], s59 offen offset:0 sc1
    v_mfma_f32_16x16x32_bf16 v[128:131], v[32:35], v[64:67], v[128:131]
    ds_read_b64_tr_b16 v[18:19], v112 offset:2048
    v_mfma_f32_16x16x32_bf16 v[132:135], v[32:35], v[68:71], v[132:135]
    ds_read_b128 v[52:55], v120 offset:51200
    buffer_load_dwordx4 v[220:223], v205, s[20:23], s59 offen offset:16 sc1
    v_mfma_f32_16x16x32_bf16 v[136:139], v[32:35], v[72:75], v[136:139]
    ds_read_b128 v[56:59], v120 offset:53248
    v_mfma_f32_16x16x32_bf16 v[140:143], v[32:35], v[76:79], v[140:143]
    ds_read_b128 v[60:63], v120 offset:55296
    v_mfma_f32_16x16x32_bf16 v[156:159], v[36:39], v[76:79], v[156:159]
    ds_read_b64_tr_b16 v[20:21], v113 offset:0
    v_mfma_f32_16x16x32_bf16 v[152:155], v[36:39], v[72:75], v[152:155]
    ds_read_b64_tr_b16 v[22:23], v113 offset:2048
    v_mfma_f32_16x16x32_bf16 v[148:151], v[36:39], v[68:71], v[148:151]
    ds_read_b64_tr_b16 v[24:25], v114 offset:0
    v_mfma_f32_16x16x32_bf16 v[144:147], v[36:39], v[64:67], v[144:147]
    ds_read_b64_tr_b16 v[26:27], v114 offset:2048
    v_mfma_f32_16x16x32_bf16 v[160:163], v[40:43], v[64:67], v[160:163]
    ds_read_b64_tr_b16 v[28:29], v115 offset:0
    v_mfma_f32_16x16x32_bf16 v[164:167], v[40:43], v[68:71], v[164:167]
    ds_read_b64_tr_b16 v[30:31], v115 offset:2048
    v_mfma_f32_16x16x32_bf16 v[168:171], v[40:43], v[72:75], v[168:171]
    ds_read_b64_tr_b16 v[32:33], v112 offset:16384
    v_mfma_f32_16x16x32_bf16 v[172:175], v[40:43], v[76:79], v[172:175]
    ds_read_b64_tr_b16 v[34:35], v112 offset:18432
    v_mfma_f32_16x16x32_bf16 v[188:191], v[44:47], v[76:79], v[188:191]
    ds_read_b64_tr_b16 v[36:37], v113 offset:16384
    v_mfma_f32_16x16x32_bf16 v[184:187], v[44:47], v[72:75], v[184:187]
    ds_read_b64_tr_b16 v[38:39], v113 offset:18432
    v_mfma_f32_16x16x32_bf16 v[180:183], v[44:47], v[68:71], v[180:183]
    v_mfma_f32_16x16x32_bf16 v[176:179], v[44:47], v[64:67], v[176:179]
    s_waitcnt lgkmcnt(10)
    v_mfma_f32_16x16x32_bf16 v[128:131], v[16:19], v[48:51], v[128:131]
    ds_read_b128 v[64:67], v121 offset:49152
    v_mfma_f32_16x16x32_bf16 v[132:135], v[16:19], v[52:55], v[132:135]
    ds_read_b128 v[68:71], v121 offset:51200
    v_mfma_f32_16x16x32_bf16 v[136:139], v[16:19], v[56:59], v[136:139]
    ds_read_b128 v[72:75], v121 offset:53248
    v_mfma_f32_16x16x32_bf16 v[140:143], v[16:19], v[60:63], v[140:143]
    ds_read_b128 v[76:79], v121 offset:55296
    s_waitcnt lgkmcnt(12)
    v_mfma_f32_16x16x32_bf16 v[156:159], v[20:23], v[60:63], v[156:159]
    ds_read_b64_tr_b16 v[40:41], v114 offset:16384
    v_mfma_f32_16x16x32_bf16 v[152:155], v[20:23], v[56:59], v[152:155]
    ds_read_b64_tr_b16 v[42:43], v114 offset:18432
    v_mfma_f32_16x16x32_bf16 v[148:151], v[20:23], v[52:55], v[148:151]
    ds_read_b64_tr_b16 v[44:45], v115 offset:16384
    v_mfma_f32_16x16x32_bf16 v[144:147], v[20:23], v[48:51], v[144:147]
    ds_read_b64_tr_b16 v[46:47], v115 offset:18432
    v_smfmac_f32_16x16x64_bf16 v[192:195], v[200:203], v[16:23], v204
    s_waitcnt lgkmcnt(8)
    v_smfmac_f32_16x16x64_bf16 v[192:195], v[200:203], v[32:39], v204
    v_mfma_f32_16x16x32_bf16 v[160:163], v[24:27], v[48:51], v[160:163]
    v_mfma_f32_16x16x32_bf16 v[164:167], v[24:27], v[52:55], v[164:167]
    v_mfma_f32_16x16x32_bf16 v[168:171], v[24:27], v[56:59], v[168:171]
    v_mfma_f32_16x16x32_bf16 v[172:175], v[24:27], v[60:63], v[172:175]
    s_waitcnt lgkmcnt(4)
    v_mfma_f32_16x16x32_bf16 v[128:131], v[32:35], v[64:67], v[128:131]
    v_mfma_f32_16x16x32_bf16 v[132:135], v[32:35], v[68:71], v[132:135]
    v_mfma_f32_16x16x32_bf16 v[136:139], v[32:35], v[72:75], v[136:139]
    v_mfma_f32_16x16x32_bf16 v[140:143], v[32:35], v[76:79], v[140:143]
    v_mfma_f32_16x16x32_bf16 v[156:159], v[36:39], v[76:79], v[156:159]
    v_mfma_f32_16x16x32_bf16 v[152:155], v[36:39], v[72:75], v[152:155]
    s_nop 1
    v_mfma_f32_16x16x32_bf16 v[148:151], v[36:39], v[68:71], v[148:151]
    v_cvt_pk_bf16_f32 v208, v192, v192
    v_and_b32 v3, v12, v208
    v_mfma_f32_16x16x32_bf16 v[144:147], v[36:39], v[64:67], v[144:147]
    v_sub_f32 v3, v192, v3
    v_cvt_pk_bf16_f32 v209, v3, v3
    v_mfma_f32_16x16x32_bf16 v[188:191], v[28:31], v[60:63], v[188:191]
    s_waitcnt lgkmcnt(0)
    s_barrier
    v_cvt_pk_bf16_f32 v210, v193, v193
    v_and_b32 v3, v12, v210
    v_mfma_f32_16x16x32_bf16 v[184:187], v[28:31], v[56:59], v[184:187]
    v_sub_f32 v3, v193, v3
    v_cvt_pk_bf16_f32 v211, v3, v3
    v_mfma_f32_16x16x32_bf16 v[180:183], v[28:31], v[52:55], v[180:183]
    v_mfma_f32_16x16x32_bf16 v[176:179], v[28:31], v[48:51], v[176:179]
    s_waitcnt vmcnt(0)
    v_mfma_f32_16x16x16_bf16 v[128:131], v[208:209], v[216:217], v[128:131]
    v_mfma_f32_16x16x16_bf16 v[144:147], v[210:211], v[216:217], v[144:147]
    ds_read_b64_tr_b16 v[16:17], v122 offset:32768
    v_mfma_f32_16x16x16_bf16 v[132:135], v[208:209], v[218:219], v[132:135]
    ds_read_b64_tr_b16 v[18:19], v122 offset:34816
    v_mfma_f32_16x16x16_bf16 v[148:151], v[210:211], v[218:219], v[148:151]
    ds_read_b64_tr_b16 v[20:21], v122 offset:40960
    v_mfma_f32_16x16x16_bf16 v[136:139], v[208:209], v[220:221], v[136:139]
    ds_read_b64_tr_b16 v[22:23], v122 offset:43008
    v_mfma_f32_16x16x16_bf16 v[152:155], v[210:211], v[220:221], v[152:155]
    ds_read_b64_tr_b16 v[32:33], v122 offset:36864
    v_mfma_f32_16x16x16_bf16 v[140:143], v[208:209], v[222:223], v[140:143]
    ds_read_b64_tr_b16 v[34:35], v122 offset:38912
    v_cvt_pk_bf16_f32 v80, v128, v129
    v_mfma_f32_16x16x16_bf16 v[156:159], v[210:211], v[222:223], v[156:159]
    ds_read_b64_tr_b16 v[36:37], v122 offset:45056
    v_cvt_pk_bf16_f32 v81, v130, v131
    v_smfmac_f32_16x16x64_bf16 v[196:199], v[200:203], v[24:31], v204
    ds_read_b64_tr_b16 v[38:39], v122 offset:47104
    v_cvt_pk_bf16_f32 v82, v144, v145
    v_smfmac_f32_16x16x64_bf16 v[196:199], v[200:203], v[40:47], v204
    ds_read_b64_tr_b16 v[24:25], v122 offset:49152
    v_cvt_pk_bf16_f32 v83, v146, v147
    v_mfma_f32_16x16x32_bf16 v[160:163], v[40:43], v[64:67], v[160:163]
    ds_read_b64_tr_b16 v[26:27], v122 offset:51200
    v_pk_max_i16 v80, v80, 0
    v_mfma_f32_16x16x32_bf16 v[164:167], v[40:43], v[68:71], v[164:167]
    ds_read_b64_tr_b16 v[28:29], v122 offset:57344
    v_pk_max_i16 v81, v81, 0
    v_mfma_f32_16x16x32_bf16 v[168:171], v[40:43], v[72:75], v[168:171]
    ds_read_b64_tr_b16 v[30:31], v122 offset:59392
    v_pk_max_i16 v82, v82, 0
    v_mfma_f32_16x16x32_bf16 v[172:175], v[40:43], v[76:79], v[172:175]
    v_pk_max_i16 v83, v83, 0
    v_mfma_f32_16x16x32_bf16 v[188:191], v[44:47], v[76:79], v[188:191]
    v_cvt_pk_bf16_f32 v212, v196, v196
    v_and_b32 v3, v12, v212
    v_sub_f32 v3, v196, v3
    v_mfma_f32_16x16x32_bf16 v[184:187], v[44:47], v[72:75], v[184:187]
    v_cvt_pk_bf16_f32 v213, v3, v3
    v_cvt_pk_bf16_f32 v214, v197, v197
    v_and_b32 v3, v12, v214
    v_mfma_f32_16x16x32_bf16 v[180:183], v[44:47], v[68:71], v[180:183]
    v_sub_f32 v3, v197, v3
    v_cvt_pk_bf16_f32 v215, v3, v3
    v_mfma_f32_16x16x32_bf16 v[176:179], v[44:47], v[64:67], v[176:179]
    v_cvt_pk_bf16_f32 v84, v132, v133
    v_cvt_pk_bf16_f32 v85, v134, v135
    v_mfma_f32_16x16x16_bf16 v[160:163], v[212:213], v[216:217], v[160:163]
    ds_read_b64_tr_b16 v[40:41], v122 offset:53248
    v_cvt_pk_bf16_f32 v86, v148, v149
    v_cvt_pk_bf16_f32 v87, v150, v151
    v_mfma_f32_16x16x16_bf16 v[176:179], v[214:215], v[216:217], v[176:179]
    ds_read_b64_tr_b16 v[42:43], v122 offset:55296
    v_pk_max_i16 v84, v84, 0
    v_pk_max_i16 v85, v85, 0
    v_mfma_f32_16x16x16_bf16 v[164:167], v[212:213], v[218:219], v[164:167]
    ds_read_b64_tr_b16 v[44:45], v122 offset:61440
    v_pk_max_i16 v86, v86, 0
    v_pk_max_i16 v87, v87, 0
    v_mfma_f32_16x16x16_bf16 v[180:183], v[214:215], v[218:219], v[180:183]
    ds_read_b64_tr_b16 v[46:47], v122 offset:63488
    v_cvt_pk_bf16_f32 v88, v136, v137
    v_cvt_pk_bf16_f32 v89, v138, v139
    v_mfma_f32_16x16x16_bf16 v[168:171], v[212:213], v[220:221], v[168:171]
    v_cvt_pk_bf16_f32 v90, v152, v153
    v_cvt_pk_bf16_f32 v91, v154, v155
    v_mfma_f32_16x16x16_bf16 v[184:187], v[214:215], v[220:221], v[184:187]
    v_pk_max_i16 v88, v88, 0
    v_pk_max_i16 v89, v89, 0
    v_mfma_f32_16x16x16_bf16 v[172:175], v[212:213], v[222:223], v[172:175]
    v_pk_max_i16 v90, v90, 0
    v_pk_max_i16 v91, v91, 0
    v_mfma_f32_16x16x16_bf16 v[188:191], v[214:215], v[222:223], v[188:191]
    v_cvt_pk_bf16_f32 v92, v140, v141
    v_cvt_pk_bf16_f32 v93, v142, v143
    v_cvt_pk_bf16_f32 v94, v156, v157
    v_cvt_pk_bf16_f32 v95, v158, v159
    v_pk_max_i16 v92, v92, 0
    v_pk_max_i16 v93, v93, 0
    v_pk_max_i16 v94, v94, 0
    v_pk_max_i16 v95, v95, 0
    v_cvt_pk_bf16_f32 v96, v160, v161
    v_cvt_pk_bf16_f32 v97, v162, v163
    v_cvt_pk_bf16_f32 v98, v176, v177
    v_cvt_pk_bf16_f32 v99, v178, v179
    v_pk_max_i16 v96, v96, 0
    v_pk_max_i16 v97, v97, 0
    v_pk_max_i16 v98, v98, 0
    v_pk_max_i16 v99, v99, 0
L_pad2:
L_pad_in2:
    s_cbranch_execz L_pad_ret
    v_cvt_pk_bf16_f32 v100, v164, v165
    v_cvt_pk_bf16_f32 v101, v166, v167
    v_cvt_pk_bf16_f32 v102, v180, v181
    v_cvt_pk_bf16_f32 v103, v182, v183
    v_pk_max_i16 v100, v100, 0
    v_pk_max_i16 v101, v101, 0
    v_pk_max_i16 v102, v102, 0
    v_pk_max_i16 v103, v103, 0
    v_cvt_pk_bf16_f32 v104, v168, v169
    v_cvt_pk_bf16_f32 v105, v170, v171
    v_cvt_pk_bf16_f32 v106, v184, v185
    v_cvt_pk_bf16_f32 v107, v186, v187
    v_pk_max_i16 v104, v104, 0
    v_pk_max_i16 v105, v105, 0
    v_pk_max_i16 v106, v106, 0
    v_pk_max_i16 v107, v107, 0
    v_cvt_pk_bf16_f32 v108, v172, v173
    v_cvt_pk_bf16_f32 v109, v174, v175
    v_cvt_pk_bf16_f32 v110, v188, v189
    v_cvt_pk_bf16_f32 v111, v190, v191
    v_pk_max_i16 v108, v108, 0
    v_pk_max_i16 v109, v109, 0
    v_pk_max_i16 v110, v110, 0
    v_pk_max_i16 v111, v111, 0
    s_barrier
    ds_write_b128 v126, v[80:83] offset:0
    ds_write_b128 v126, v[84:87] offset:1024
    ds_write_b128 v126, v[88:91] offset:2048
    ds_write_b128 v126, v[92:95] offset:3072
    ds_write_b128 v126, v[96:99] offset:4096
    s_barrier
    ds_write_b128 v126, v[100:103] offset:5120
    ds_write_b128 v126, v[104:107] offset:6144
    ds_write_b128 v126, v[108:111] offset:7168
    s_load_dword s63, s[48:49], s62
L_crdy:
    s_waitcnt lgkmcnt(0)
    s_cmp_ge_u32 s63, 7
    s_cbranch_scc0 L_crdy2
L_crdy_ok:
    s_barrier
    ds_read_b128 v[192:195], v124 offset:0
    ds_read_b128 v[196:199], v124 offset:1024
    ds_read_b128 v[200:203], v124 offset:2048
    ds_read_b128 v[204:207], v124 offset:3072
    ds_read_b128 v[208:211], v124 offset:8192
    ds_read_b128 v[212:215], v124 offset:9216
    ds_read_b128 v[216:219], v124 offset:10240
    ds_read_b128 v[220:223], v124 offset:11264
    ds_read_b128 v[224:227], v124 offset:16384
    ds_read_b128 v[228:231], v124 offset:17408
    s_waitcnt lgkmcnt(6)
    v_mfma_f32_16x16x32_bf16 v[48:51], v[16:19], v[192:195], 0
    ds_read_b128 v[232:235], v124 offset:18432
    v_mfma_f32_16x16x32_bf16 v[52:55], v[16:19], v[196:199], 0
    ds_read_b128 v[236:239], v124 offset:19456
    v_mfma_f32_16x16x32_bf16 v[56:59], v[16:19], v[200:203], 0
    ds_read_b128 v[240:243], v124 offset:24576
    v_mfma_f32_16x16x32_bf16 v[60:63], v[16:19], v[204:207], 0
    ds_read_b128 v[244:247], v124 offset:25600
    s_waitcnt lgkmcnt(6)
    v_mfma_f32_16x16x32_bf16 v[48:51], v[20:23], v[208:211], v[48:51]
    ds_read_b128 v[248:251], v124 offset:26624
    v_mfma_f32_16x16x32_bf16 v[52:55], v[20:23], v[212:215], v[52:55]
    ds_read_b128 v[252:255], v124 offset:27648
    v_mfma_f32_16x16x32_bf16 v[56:59], v[20:23], v[216:219], v[56:59]
    ds_read_b128 v[128:131], v124 offset:4096
    v_mfma_f32_16x16x32_bf16 v[60:63], v[20:23], v[220:223], v[60:63]
    ds_read_b128 v[132:135], v124 offset:5120
    s_waitcnt lgkmcnt(6)
    v_mfma_f32_16x16x32_bf16 v[48:51], v[24:27], v[224:227], v[48:51]
    ds_read_b128 v[136:139], v124 offset:6144
    v_mfma_f32_16x16x32_bf16 v[52:55], v[24:27], v[228:231], v[52:55]
    ds_read_b128 v[140:143], v124 offset:7168
    v_mfma_f32_16x16x32_bf16 v[56:59], v[24:27], v[232:235], v[56:59]
    ds_read_b128 v[144:147], v124 offset:12288
    v_mfma_f32_16x16x32_bf16 v[60:63], v[24:27], v[236:239], v[60:63]
    ds_read_b128 v[148:151], v124 offset:13312
    s_waitcnt lgkmcnt(6)
    v_mfma_f32_16x16x32_bf16 v[48:51], v[28:31], v[240:243], v[48:51]
    ds_read_b128 v[152:155], v124 offset:14336
    v_mfma_f32_16x16x32_bf16 v[52:55], v[28:31], v[244:247], v[52:55]
    ds_read_b128 v[156:159], v124 offset:15360
    v_mfma_f32_16x16x32_bf16 v[56:59], v[28:31], v[248:251], v[56:59]
    ds_read_b128 v[160:163], v124 offset:20480
    v_mfma_f32_16x16x32_bf16 v[60:63], v[28:31], v[252:255], v[60:63]
    ds_read_b128 v[164:167], v124 offset:21504
    s_waitcnt lgkmcnt(6)
    v_mfma_f32_16x16x32_bf16 v[48:51], v[32:35], v[128:131], v[48:51]
    ds_read_b128 v[168:171], v124 offset:22528
    v_mfma_f32_16x16x32_bf16 v[52:55], v[32:35], v[132:135], v[52:55]
    ds_read_b128 v[172:175], v124 offset:23552
    v_mfma_f32_16x16x32_bf16 v[56:59], v[32:35], v[136:139], v[56:59]
    ds_read_b128 v[176:179], v124 offset:28672
    v_mfma_f32_16x16x32_bf16 v[60:63], v[32:35], v[140:143], v[60:63]
    ds_read_b128 v[180:183], v124 offset:29696
    s_waitcnt lgkmcnt(6)
    v_mfma_f32_16x16x32_bf16 v[48:51], v[36:39], v[144:147], v[48:51]
    ds_read_b128 v[184:187], v124 offset:30720
    v_mfma_f32_16x16x32_bf16 v[52:55], v[36:39], v[148:151], v[52:55]
    ds_read_b128 v[188:191], v124 offset:31744
    v_mfma_f32_16x16x32_bf16 v[56:59], v[36:39], v[152:155], v[56:59]
    ds_read_b64_tr_b16 v[16:17], v123 offset:0
    v_mfma_f32_16x16x32_bf16 v[60:63], v[36:39], v[156:159], v[60:63]
    ds_read_b64_tr_b16 v[18:19], v123 offset:2048
    s_waitcnt lgkmcnt(6)
    v_mfma_f32_16x16x32_bf16 v[48:51], v[40:43], v[160:163], v[48:51]
    ds_read_b64_tr_b16 v[20:21], v123 offset:8192
    s_and_b32 s63, s63, 0x2000
    v_mfma_f32_16x16x32_bf16 v[52:55], v[40:43], v[164:167], v[52:55]
    ds_read_b64_tr_b16 v[22:23], v123 offset:10240
    v_add_u32 v125, s63, v125
    v_mfma_f32_16x16x32_bf16 v[56:59], v[40:43], v[168:171], v[56:59]
    ds_read_b64_tr_b16 v[24:25], v123 offset:16384
    v_add_u32 v13, s63, v13
    v_mfma_f32_16x16x32_bf16 v[60:63], v[40:43], v[172:175], v[60:63]
    ds_read_b64_tr_b16 v[26:27], v123 offset:18432
    s_waitcnt lgkmcnt(6)
    v_mfma_f32_16x16x32_bf16 v[48:51], v[44:47], v[176:179], v[48:51]
    ds_read_b64_tr_b16 v[28:29], v123 offset:24576
    v_mfma_f32_16x16x32_bf16 v[52:55], v[44:47], v[180:183], v[52:55]
    ds_read_b64_tr_b16 v[30:31], v123 offset:26624
    v_mfma_f32_16x16x32_bf16 v[56:59], v[44:47], v[184:187], v[56:59]
    v_mfma_f32_16x16x32_bf16 v[60:63], v[44:47], v[188:191], v[60:63]
    s_barrier
    s_waitcnt lgkmcnt(4)
    v_mfma_f32_16x16x32_bf16 v[64:67], v[16:19], v[192:195], 0
    ds_read_b64_tr_b16 v[32:33], v123 offset:4096
    v_mfma_f32_16x16x32_bf16 v[68:71], v[16:19], v[196:199], 0
    ds_read_b64_tr_b16 v[34:35], v123 offset:6144
    v_mfma_f32_16x16x32_bf16 v[72:75], v[16:19], v[200:203], 0
    ds_read_b64_tr_b16 v[36:37], v123 offset:12288
    v_cvt_pk_bf16_f32 v80, v48, v49
    v_mfma_f32_16x16x32_bf16 v[76:79], v[16:19], v[204:207], 0
    ds_read_b64_tr_b16 v[38:39], v123 offset:14336
    v_cvt_pk_bf16_f32 v81, v50, v51
    v_mfma_f32_16x16x32_bf16 v[64:67], v[20:23], v[208:211], v[64:67]
    ds_read_b64_tr_b16 v[40:41], v123 offset:20480
    v_cvt_pk_bf16_f32 v82, v52, v53
    v_mfma_f32_16x16x32_bf16 v[68:71], v[20:23], v[212:215], v[68:71]
    ds_read_b64_tr_b16 v[42:43], v123 offset:22528
    v_cvt_pk_bf16_f32 v83, v54, v55
    v_mfma_f32_16x16x32_bf16 v[72:75], v[20:23], v[216:219], v[72:75]
    ds_read_b64_tr_b16 v[44:45], v123 offset:28672
    v_cvt_pk_bf16_f32 v84, v56, v57
    v_mfma_f32_16x16x32_bf16 v[76:79], v[20:23], v[220:223], v[76:79]
    ds_read_b64_tr_b16 v[46:47], v123 offset:30720
    v_cvt_pk_bf16_f32 v85, v58, v59
    s_waitcnt lgkmcnt(8)
    v_mfma_f32_16x16x32_bf16 v[64:67], v[24:27], v[224:227], v[64:67]
    v_cvt_pk_bf16_f32 v86, v60, v61
    v_mfma_f32_16x16x32_bf16 v[68:71], v[24:27], v[228:231], v[68:71]
    v_cvt_pk_bf16_f32 v87, v62, v63
    v_mfma_f32_16x16x32_bf16 v[72:75], v[24:27], v[232:235], v[72:75]
    buffer_store_dwordx4 v[80:83], v125, s[20:23], s4 offen offset:0 sc1
    v_mfma_f32_16x16x32_bf16 v[76:79], v[24:27], v[236:239], v[76:79]
    v_mfma_f32_16x16x32_bf16 v[64:67], v[28:31], v[240:243], v[64:67]
    buffer_store_dwordx4 v[84:87], v125, s[20:23], s4 offen offset:1024 sc1
    v_mfma_f32_16x16x32_bf16 v[68:71], v[28:31], v[244:247], v[68:71]
    v_mfma_f32_16x16x32_bf16 v[72:75], v[28:31], v[248:251], v[72:75]
    v_mfma_f32_16x16x32_bf16 v[76:79], v[28:31], v[252:255], v[76:79]
    s_waitcnt lgkmcnt(0)
    s_barrier
    v_mfma_f32_16x16x32_bf16 v[64:67], v[32:35], v[128:131], v[64:67]
    ds_read_b64_tr_b16 v[16:17], v123 offset:32768
    v_mfma_f32_16x16x32_bf16 v[68:71], v[32:35], v[132:135], v[68:71]
    ds_read_b64_tr_b16 v[18:19], v123 offset:34816
    v_mfma_f32_16x16x32_bf16 v[72:75], v[32:35], v[136:139], v[72:75]
    ds_read_b64_tr_b16 v[20:21], v123 offset:40960
    v_mfma_f32_16x16x32_bf16 v[76:79], v[32:35], v[140:143], v[76:79]
    ds_read_b64_tr_b16 v[22:23], v123 offset:43008
    v_mfma_f32_16x16x32_bf16 v[64:67], v[36:39], v[144:147], v[64:67]
    ds_read_b64_tr_b16 v[24:25], v123 offset:49152
    v_mfma_f32_16x16x32_bf16 v[68:71], v[36:39], v[148:151], v[68:71]
    ds_read_b64_tr_b16 v[26:27], v123 offset:51200
    v_mfma_f32_16x16x32_bf16 v[72:75], v[36:39], v[152:155], v[72:75]
    ds_read_b64_tr_b16 v[28:29], v123 offset:57344
    v_mfma_f32_16x16x32_bf16 v[76:79], v[36:39], v[156:159], v[76:79]
    ds_read_b64_tr_b16 v[30:31], v123 offset:59392
    v_mfma_f32_16x16x32_bf16 v[64:67], v[40:43], v[160:163], v[64:67]
    ds_read_b64_tr_b16 v[32:33], v123 offset:36864
    v_mfma_f32_16x16x32_bf16 v[68:71], v[40:43], v[164:167], v[68:71]
    ds_read_b64_tr_b16 v[34:35], v123 offset:38912
    v_mfma_f32_16x16x32_bf16 v[72:75], v[40:43], v[168:171], v[72:75]
    ds_read_b64_tr_b16 v[36:37], v123 offset:45056
    v_mfma_f32_16x16x32_bf16 v[76:79], v[40:43], v[172:175], v[76:79]
    ds_read_b64_tr_b16 v[38:39], v123 offset:47104
    v_mfma_f32_16x16x32_bf16 v[64:67], v[44:47], v[176:179], v[64:67]
    ds_read_b64_tr_b16 v[40:41], v123 offset:53248
    v_mfma_f32_16x16x32_bf16 v[68:71], v[44:47], v[180:183], v[68:71]
    ds_read_b64_tr_b16 v[42:43], v123 offset:55296
    v_mfma_f32_16x16x32_bf16 v[72:75], v[44:47], v[184:187], v[72:75]
    v_mfma_f32_16x16x32_bf16 v[76:79], v[44:47], v[188:191], v[76:79]
    s_waitcnt lgkmcnt(10)
    v_mfma_f32_16x16x32_bf16 v[48:51], v[16:19], v[192:195], 0
    ds_read_b64_tr_b16 v[44:45], v123 offset:61440
    v_mfma_f32_16x16x32_bf16 v[52:55], v[16:19], v[196:199], 0
    ds_read_b64_tr_b16 v[46:47], v123 offset:63488
    v_mfma_f32_16x16x32_bf16 v[56:59], v[16:19], v[200:203], 0
    v_cvt_pk_bf16_f32 v88, v64, v65
    v_cvt_pk_bf16_f32 v89, v66, v67
    v_mfma_f32_16x16x32_bf16 v[60:63], v[16:19], v[204:207], 0
    v_cvt_pk_bf16_f32 v90, v68, v69
    v_cvt_pk_bf16_f32 v91, v70, v71
    v_mfma_f32_16x16x32_bf16 v[48:51], v[20:23], v[208:211], v[48:51]
    v_cvt_pk_bf16_f32 v92, v72, v73
    v_cvt_pk_bf16_f32 v93, v74, v75
    v_mfma_f32_16x16x32_bf16 v[52:55], v[20:23], v[212:215], v[52:55]
    v_cvt_pk_bf16_f32 v94, v76, v77
    v_cvt_pk_bf16_f32 v95, v78, v79
    v_mfma_f32_16x16x32_bf16 v[56:59], v[20:23], v[216:219], v[56:59]
    buffer_store_dwordx4 v[88:91], v125, s[20:23], s5 offen offset:0 sc1
    v_mfma_f32_16x16x32_bf16 v[60:63], v[20:23], v[220:223], v[60:63]
    s_waitcnt lgkmcnt(8)
    v_mfma_f32_16x16x32_bf16 v[48:51], v[24:27], v[224:227], v[48:51]
    buffer_store_dwordx4 v[92:95], v125, s[20:23], s5 offen offset:1024 sc1
    v_mfma_f32_16x16x32_bf16 v[52:55], v[24:27], v[228:231], v[52:55]
    v_mfma_f32_16x16x32_bf16 v[56:59], v[24:27], v[232:235], v[56:59]
    v_mfma_f32_16x16x32_bf16 v[60:63], v[24:27], v[236:239], v[60:63]
    v_mfma_f32_16x16x32_bf16 v[48:51], v[28:31], v[240:243], v[48:51]
    v_mfma_f32_16x16x32_bf16 v[52:55], v[28:31], v[244:247], v[52:55]
    v_mfma_f32_16x16x32_bf16 v[56:59], v[28:31], v[248:251], v[56:59]
    v_mfma_f32_16x16x32_bf16 v[60:63], v[28:31], v[252:255], v[60:63]
    s_waitcnt lgkmcnt(0)
    s_barrier
    v_mfma_f32_16x16x32_bf16 v[48:51], v[32:35], v[128:131], v[48:51]
    ds_read_b64_tr_b16 v[16:17], v127 offset:0
    v_mfma_f32_16x16x32_bf16 v[52:55], v[32:35], v[132:135], v[52:55]
    ds_read_b64_tr_b16 v[18:19], v127 offset:2048
    v_mfma_f32_16x16x32_bf16 v[56:59], v[32:35], v[136:139], v[56:59]
    ds_read_b64_tr_b16 v[20:21], v127 offset:8192
    s_waitcnt vmcnt(2)
    buffer_atomic_or v5, v13, s[20:23], s50 offen sc1
    v_mfma_f32_16x16x32_bf16 v[60:63], v[32:35], v[140:143], v[60:63]
    ds_read_b64_tr_b16 v[22:23], v127 offset:10240
    v_mfma_f32_16x16x32_bf16 v[48:51], v[36:39], v[144:147], v[48:51]
    ds_read_b64_tr_b16 v[24:25], v127 offset:16384
    v_mfma_f32_16x16x32_bf16 v[52:55], v[36:39], v[148:151], v[52:55]
    ds_read_b64_tr_b16 v[26:27], v127 offset:18432
    v_mfma_f32_16x16x32_bf16 v[56:59], v[36:39], v[152:155], v[56:59]
    ds_read_b64_tr_b16 v[28:29], v127 offset:24576
    v_mfma_f32_16x16x32_bf16 v[60:63], v[36:39], v[156:159], v[60:63]
    ds_read_b64_tr_b16 v[30:31], v127 offset:26624
    v_mfma_f32_16x16x32_bf16 v[48:51], v[40:43], v[160:163], v[48:51]
    ds_read_b64_tr_b16 v[32:33], v127 offset:4096
    v_mfma_f32_16x16x32_bf16 v[52:55], v[40:43], v[164:167], v[52:55]
    ds_read_b64_tr_b16 v[34:35], v127 offset:6144
    v_mfma_f32_16x16x32_bf16 v[56:59], v[40:43], v[168:171], v[56:59]
    ds_read_b64_tr_b16 v[36:37], v127 offset:12288
    v_mfma_f32_16x16x32_bf16 v[60:63], v[40:43], v[172:175], v[60:63]
    ds_read_b64_tr_b16 v[38:39], v127 offset:14336
    v_mfma_f32_16x16x32_bf16 v[48:51], v[44:47], v[176:179], v[48:51]
    ds_read_b64_tr_b16 v[40:41], v127 offset:20480
    v_mfma_f32_16x16x32_bf16 v[52:55], v[44:47], v[180:183], v[52:55]
    ds_read_b64_tr_b16 v[42:43], v127 offset:22528
    v_mfma_f32_16x16x32_bf16 v[56:59], v[44:47], v[184:187], v[56:59]
    v_mfma_f32_16x16x32_bf16 v[60:63], v[44:47], v[188:191], v[60:63]
    s_waitcnt lgkmcnt(10)
    v_mfma_f32_16x16x32_bf16 v[64:67], v[16:19], v[192:195], 0
    ds_read_b64_tr_b16 v[44:45], v127 offset:28672
    v_mfma_f32_16x16x32_bf16 v[68:71], v[16:19], v[196:199], 0
    ds_read_b64_tr_b16 v[46:47], v127 offset:30720
    v_mfma_f32_16x16x32_bf16 v[72:75], v[16:19], v[200:203], 0
    v_cvt_pk_bf16_f32 v96, v48, v49
    v_cvt_pk_bf16_f32 v97, v50, v51
    v_mfma_f32_16x16x32_bf16 v[76:79], v[16:19], v[204:207], 0
    v_cvt_pk_bf16_f32 v98, v52, v53
    v_cvt_pk_bf16_f32 v99, v54, v55
    v_mfma_f32_16x16x32_bf16 v[64:67], v[20:23], v[208:211], v[64:67]
    v_cvt_pk_bf16_f32 v100, v56, v57
    v_cvt_pk_bf16_f32 v101, v58, v59
    v_mfma_f32_16x16x32_bf16 v[68:71], v[20:23], v[212:215], v[68:71]
    v_cvt_pk_bf16_f32 v102, v60, v61
    v_cvt_pk_bf16_f32 v103, v62, v63
    v_mfma_f32_16x16x32_bf16 v[72:75], v[20:23], v[216:219], v[72:75]
    buffer_store_dwordx4 v[96:99], v125, s[20:23], s6 offen offset:0 sc1
    v_mfma_f32_16x16x32_bf16 v[76:79], v[20:23], v[220:223], v[76:79]
    s_waitcnt lgkmcnt(8)
    v_mfma_f32_16x16x32_bf16 v[64:67], v[24:27], v[224:227], v[64:67]
    buffer_store_dwordx4 v[100:103], v125, s[20:23], s6 offen offset:1024 sc1
    v_mfma_f32_16x16x32_bf16 v[68:71], v[24:27], v[228:231], v[68:71]
    v_mfma_f32_16x16x32_bf16 v[72:75], v[24:27], v[232:235], v[72:75]
    v_mfma_f32_16x16x32_bf16 v[76:79], v[24:27], v[236:239], v[76:79]
    v_mfma_f32_16x16x32_bf16 v[64:67], v[28:31], v[240:243], v[64:67]
    v_mfma_f32_16x16x32_bf16 v[68:71], v[28:31], v[244:247], v[68:71]
    v_mfma_f32_16x16x32_bf16 v[72:75], v[28:31], v[248:251], v[72:75]
    s_waitcnt vmcnt(3)
    buffer_atomic_or v6, v13, s[20:23], s51 offen sc1
    v_mfma_f32_16x16x32_bf16 v[76:79], v[28:31], v[252:255], v[76:79]
    s_waitcnt lgkmcnt(0)
    s_barrier
    v_mfma_f32_16x16x32_bf16 v[64:67], v[32:35], v[128:131], v[64:67]
    ds_read_b64_tr_b16 v[16:17], v122 offset:32768
    v_mfma_f32_16x16x32_bf16 v[68:71], v[32:35], v[132:135], v[68:71]
    ds_read_b64_tr_b16 v[18:19], v122 offset:34816
    v_mfma_f32_16x16x32_bf16 v[72:75], v[32:35], v[136:139], v[72:75]
    ds_read_b64_tr_b16 v[20:21], v122 offset:40960
    v_mfma_f32_16x16x32_bf16 v[76:79], v[32:35], v[140:143], v[76:79]
    ds_read_b64_tr_b16 v[22:23], v122 offset:43008
    v_mfma_f32_16x16x32_bf16 v[64:67], v[36:39], v[144:147], v[64:67]
    ds_read_b64_tr_b16 v[24:25], v122 offset:49152
    v_mfma_f32_16x16x32_bf16 v[68:71], v[36:39], v[148:151], v[68:71]
    ds_read_b64_tr_b16 v[26:27], v122 offset:51200
    v_mfma_f32_16x16x32_bf16 v[72:75], v[36:39], v[152:155], v[72:75]
    ds_read_b64_tr_b16 v[28:29], v122 offset:57344
    v_mfma_f32_16x16x32_bf16 v[76:79], v[36:39], v[156:159], v[76:79]
    ds_read_b64_tr_b16 v[30:31], v122 offset:59392
    v_mfma_f32_16x16x32_bf16 v[64:67], v[40:43], v[160:163], v[64:67]
    ds_read_b64_tr_b16 v[32:33], v122 offset:36864
    v_mfma_f32_16x16x32_bf16 v[68:71], v[40:43], v[164:167], v[68:71]
    ds_read_b64_tr_b16 v[34:35], v122 offset:38912
    v_mfma_f32_16x16x32_bf16 v[72:75], v[40:43], v[168:171], v[72:75]
    ds_read_b64_tr_b16 v[36:37], v122 offset:45056
    v_mfma_f32_16x16x32_bf16 v[76:79], v[40:43], v[172:175], v[76:79]
    ds_read_b64_tr_b16 v[38:39], v122 offset:47104
    v_mfma_f32_16x16x32_bf16 v[64:67], v[44:47], v[176:179], v[64:67]
    ds_read_b64_tr_b16 v[40:41], v122 offset:53248
    v_mfma_f32_16x16x32_bf16 v[68:71], v[44:47], v[180:183], v[68:71]
    ds_read_b64_tr_b16 v[42:43], v122 offset:55296
    v_mfma_f32_16x16x32_bf16 v[72:75], v[44:47], v[184:187], v[72:75]
    v_mfma_f32_16x16x32_bf16 v[76:79], v[44:47], v[188:191], v[76:79]
    s_waitcnt lgkmcnt(10)
    v_mfma_f32_16x16x32_bf16 v[48:51], v[16:19], v[192:195], 0
    ds_read_b64_tr_b16 v[44:45], v122 offset:61440
    v_mfma_f32_16x16x32_bf16 v[52:55], v[16:19], v[196:199], 0
    ds_read_b64_tr_b16 v[46:47], v122 offset:63488
    v_mfma_f32_16x16x32_bf16 v[56:59], v[16:19], v[200:203], 0
    v_cvt_pk_bf16_f32 v104, v64, v65
    v_cvt_pk_bf16_f32 v105, v66, v67
    v_mfma_f32_16x16x32_bf16 v[60:63], v[16:19], v[204:207], 0
    v_cvt_pk_bf16_f32 v106, v68, v69
    v_cvt_pk_bf16_f32 v107, v70, v71
    v_mfma_f32_16x16x32_bf16 v[48:51], v[20:23], v[208:211], v[48:51]
    v_cvt_pk_bf16_f32 v108, v72, v73
    v_cvt_pk_bf16_f32 v109, v74, v75
    v_mfma_f32_16x16x32_bf16 v[52:55], v[20:23], v[212:215], v[52:55]
    v_cvt_pk_bf16_f32 v110, v76, v77
    v_cvt_pk_bf16_f32 v111, v78, v79
    v_mfma_f32_16x16x32_bf16 v[56:59], v[20:23], v[216:219], v[56:59]
    buffer_store_dwordx4 v[104:107], v125, s[20:23], s7 offen offset:0 sc1
    v_mfma_f32_16x16x32_bf16 v[60:63], v[20:23], v[220:223], v[60:63]
    s_waitcnt lgkmcnt(8)
    v_mfma_f32_16x16x32_bf16 v[48:51], v[24:27], v[224:227], v[48:51]
    buffer_store_dwordx4 v[108:111], v125, s[20:23], s7 offen offset:1024 sc1
    v_mfma_f32_16x16x32_bf16 v[52:55], v[24:27], v[228:231], v[52:55]
    v_mfma_f32_16x16x32_bf16 v[56:59], v[24:27], v[232:235], v[56:59]
    v_mfma_f32_16x16x32_bf16 v[60:63], v[24:27], v[236:239], v[60:63]
    v_mfma_f32_16x16x32_bf16 v[48:51], v[28:31], v[240:243], v[48:51]
    v_mfma_f32_16x16x32_bf16 v[52:55], v[28:31], v[244:247], v[52:55]
    v_mfma_f32_16x16x32_bf16 v[56:59], v[28:31], v[248:251], v[56:59]
    s_waitcnt vmcnt(3)
    buffer_atomic_or v7, v13, s[20:23], s52 offen sc1
    v_mfma_f32_16x16x32_bf16 v[60:63], v[28:31], v[252:255], v[60:63]
    s_waitcnt lgkmcnt(0)
    s_barrier
    v_mfma_f32_16x16x32_bf16 v[48:51], v[32:35], v[128:131], v[48:51]
    ds_read_b64_tr_b16 v[16:17], v122 offset:0
    v_mfma_f32_16x16x32_bf16 v[52:55], v[32:35], v[132:135], v[52:55]
    ds_read_b64_tr_b16 v[18:19], v122 offset:2048
    v_mfma_f32_16x16x32_bf16 v[56:59], v[32:35], v[136:139], v[56:59]
    ds_read_b64_tr_b16 v[20:21], v122 offset:8192
    v_mfma_f32_16x16x32_bf16 v[60:63], v[32:35], v[140:143], v[60:63]
    ds_read_b64_tr_b16 v[22:23], v122 offset:10240
    v_mfma_f32_16x16x32_bf16 v[48:51], v[36:39], v[144:147], v[48:51]
    ds_read_b64_tr_b16 v[24:25], v122 offset:16384
    v_mfma_f32_16x16x32_bf16 v[52:55], v[36:39], v[148:151], v[52:55]
    ds_read_b64_tr_b16 v[26:27], v122 offset:18432
    v_mfma_f32_16x16x32_bf16 v[56:59], v[36:39], v[152:155], v[56:59]
    ds_read_b64_tr_b16 v[28:29], v122 offset:24576
    v_mfma_f32_16x16x32_bf16 v[60:63], v[36:39], v[156:159], v[60:63]
    ds_read_b64_tr_b16 v[30:31], v122 offset:26624
    v_mfma_f32_16x16x32_bf16 v[48:51], v[40:43], v[160:163], v[48:51]
    ds_read_b64_tr_b16 v[32:33], v122 offset:4096
    v_mfma_f32_16x16x32_bf16 v[52:55], v[40:43], v[164:167], v[52:55]
    ds_read_b64_tr_b16 v[34:35], v122 offset:6144
    v_mfma_f32_16x16x32_bf16 v[56:59], v[40:43], v[168:171], v[56:59]
    ds_read_b64_tr_b16 v[36:37], v122 offset:12288
    v_mfma_f32_16x16x32_bf16 v[60:63], v[40:43], v[172:175], v[60:63]
    ds_read_b64_tr_b16 v[38:39], v122 offset:14336
    v_mfma_f32_16x16x32_bf16 v[48:51], v[44:47], v[176:179], v[48:51]
    ds_read_b64_tr_b16 v[40:41], v122 offset:20480
    v_mfma_f32_16x16x32_bf16 v[52:55], v[44:47], v[180:183], v[52:55]
    ds_read_b64_tr_b16 v[42:43], v122 offset:22528
    v_mfma_f32_16x16x32_bf16 v[56:59], v[44:47], v[184:187], v[56:59]
    v_mfma_f32_16x16x32_bf16 v[60:63], v[44:47], v[188:191], v[60:63]
    s_waitcnt lgkmcnt(10)
    v_mfma_f32_16x16x32_bf16 v[64:67], v[16:19], v[192:195], 0
    ds_read_b64_tr_b16 v[44:45], v122 offset:28672
    v_mfma_f32_16x16x32_bf16 v[68:71], v[16:19], v[196:199], 0
    ds_read_b64_tr_b16 v[46:47], v122 offset:30720
    v_mfma_f32_16x16x32_bf16 v[72:75], v[16:19], v[200:203], 0
    v_cvt_pk_bf16_f32 v80, v48, v49
    v_cvt_pk_bf16_f32 v81, v50, v51
    v_mfma_f32_16x16x32_bf16 v[76:79], v[16:19], v[204:207], 0
    v_cvt_pk_bf16_f32 v82, v52, v53
    v_cvt_pk_bf16_f32 v83, v54, v55
    v_mfma_f32_16x16x32_bf16 v[64:67], v[20:23], v[208:211], v[64:67]
    v_cvt_pk_bf16_f32 v84, v56, v57
    v_cvt_pk_bf16_f32 v85, v58, v59
    v_mfma_f32_16x16x32_bf16 v[68:71], v[20:23], v[212:215], v[68:71]
    v_cvt_pk_bf16_f32 v86, v60, v61
    v_cvt_pk_bf16_f32 v87, v62, v63
    v_mfma_f32_16x16x32_bf16 v[72:75], v[20:23], v[216:219], v[72:75]
    buffer_store_dwordx4 v[80:83], v125, s[20:23], s8 offen offset:0 sc1
    v_mfma_f32_16x16x32_bf16 v[76:79], v[20:23], v[220:223], v[76:79]
    s_waitcnt lgkmcnt(8)
    v_mfma_f32_16x16x32_bf16 v[64:67], v[24:27], v[224:227], v[64:67]
    buffer_store_dwordx4 v[84:87], v125, s[20:23], s8 offen offset:1024 sc1
    v_mfma_f32_16x16x32_bf16 v[68:71], v[24:27], v[228:231], v[68:71]
    v_mfma_f32_16x16x32_bf16 v[72:75], v[24:27], v[232:235], v[72:75]
    v_mfma_f32_16x16x32_bf16 v[76:79], v[24:27], v[236:239], v[76:79]
    v_mfma_f32_16x16x32_bf16 v[64:67], v[28:31], v[240:243], v[64:67]
    v_mfma_f32_16x16x32_bf16 v[68:71], v[28:31], v[244:247], v[68:71]
    v_mfma_f32_16x16x32_bf16 v[72:75], v[28:31], v[248:251], v[72:75]
    s_waitcnt vmcnt(3)
    buffer_atomic_or v8, v13, s[20:23], s53 offen sc1
    v_mfma_f32_16x16x32_bf16 v[76:79], v[28:31], v[252:255], v[76:79]
    s_waitcnt lgkmcnt(4)
    v_mfma_f32_16x16x32_bf16 v[64:67], v[32:35], v[128:131], v[64:67]
    ds_read_b64_tr_b16 v[16:17], v123 offset:0
    v_mfma_f32_16x16x32_bf16 v[68:71], v[32:35], v[132:135], v[68:71]
    ds_read_b64_tr_b16 v[18:19], v123 offset:2048
    v_mfma_f32_16x16x32_bf16 v[72:75], v[32:35], v[136:139], v[72:75]
    ds_read_b64_tr_b16 v[20:21], v123 offset:8192
    v_mfma_f32_16x16x32_bf16 v[76:79], v[32:35], v[140:143], v[76:79]
    ds_read_b64_tr_b16 v[22:23], v123 offset:10240
    v_mfma_f32_16x16x32_bf16 v[64:67], v[36:39], v[144:147], v[64:67]
    ds_read_b64_tr_b16 v[24:25], v123 offset:16384
    v_mfma_f32_16x16x32_bf16 v[68:71], v[36:39], v[148:151], v[68:71]
    ds_read_b64_tr_b16 v[26:27], v123 offset:18432
    v_mfma_f32_16x16x32_bf16 v[72:75], v[36:39], v[152:155], v[72:75]
    ds_read_b64_tr_b16 v[28:29], v123 offset:24576
    s_lshl_b32 s64, s35, 12
    v_mfma_f32_16x16x32_bf16 v[76:79], v[36:39], v[156:159], v[76:79]
    ds_read_b64_tr_b16 v[30:31], v123 offset:26624
    s_add_u32 s64, s64, 114688
    s_waitcnt lgkmcnt(8)
    v_mfma_f32_16x16x32_bf16 v[64:67], v[40:43], v[160:163], v[64:67]
    ds_read_b64_tr_b16 v[32:33], v123 offset:4096
    v_add_u32 v3, s64, v124
    v_mfma_f32_16x16x32_bf16 v[68:71], v[40:43], v[164:167], v[68:71]
    ds_read_b64_tr_b16 v[34:35], v123 offset:6144
    v_mfma_f32_16x16x32_bf16 v[72:75], v[40:43], v[168:171], v[72:75]
    ds_read_b64_tr_b16 v[36:37], v123 offset:12288
    v_mfma_f32_16x16x32_bf16 v[76:79], v[40:43], v[172:175], v[76:79]
    ds_read_b64_tr_b16 v[38:39], v123 offset:14336
    v_mfma_f32_16x16x32_bf16 v[64:67], v[44:47], v[176:179], v[64:67]
    ds_read_b64_tr_b16 v[40:41], v123 offset:20480
    v_mfma_f32_16x16x32_bf16 v[68:71], v[44:47], v[180:183], v[68:71]
    ds_read_b64_tr_b16 v[42:43], v123 offset:22528
    v_mfma_f32_16x16x32_bf16 v[72:75], v[44:47], v[184:187], v[72:75]
    v_mfma_f32_16x16x32_bf16 v[76:79], v[44:47], v[188:191], v[76:79]
    s_waitcnt lgkmcnt(10)
    v_mfma_f32_16x16x32_bf16 v[48:51], v[16:19], v[192:195], 0
    ds_read_b64_tr_b16 v[44:45], v123 offset:28672
    v_mfma_f32_16x16x32_bf16 v[52:55], v[16:19], v[196:199], 0
    ds_read_b64_tr_b16 v[46:47], v123 offset:30720
    v_mfma_f32_16x16x32_bf16 v[56:59], v[16:19], v[200:203], 0
    v_cvt_pk_bf16_f32 v88, v64, v65
    v_cvt_pk_bf16_f32 v89, v66, v67
    v_mfma_f32_16x16x32_bf16 v[60:63], v[16:19], v[204:207], 0
    v_cvt_pk_bf16_f32 v90, v68, v69
    v_cvt_pk_bf16_f32 v91, v70, v71
    v_mfma_f32_16x16x32_bf16 v[48:51], v[20:23], v[208:211], v[48:51]
    v_cvt_pk_bf16_f32 v92, v72, v73
    v_cvt_pk_bf16_f32 v93, v74, v75
    v_mfma_f32_16x16x32_bf16 v[52:55], v[20:23], v[212:215], v[52:55]
    v_cvt_pk_bf16_f32 v94, v76, v77
    v_cvt_pk_bf16_f32 v95, v78, v79
    v_mfma_f32_16x16x32_bf16 v[56:59], v[20:23], v[216:219], v[56:59]
    buffer_store_dwordx4 v[88:91], v125, s[20:23], s9 offen offset:0 sc1
    v_mfma_f32_16x16x32_bf16 v[60:63], v[20:23], v[220:223], v[60:63]
    s_waitcnt lgkmcnt(8)
    v_mfma_f32_16x16x32_bf16 v[48:51], v[24:27], v[224:227], v[48:51]
    buffer_store_dwordx4 v[92:95], v125, s[20:23], s9 offen offset:1024 sc1
    v_mfma_f32_16x16x32_bf16 v[52:55], v[24:27], v[228:231], v[52:55]
    v_mfma_f32_16x16x32_bf16 v[56:59], v[24:27], v[232:235], v[56:59]
    v_mfma_f32_16x16x32_bf16 v[60:63], v[24:27], v[236:239], v[60:63]
    v_mfma_f32_16x16x32_bf16 v[48:51], v[28:31], v[240:243], v[48:51]
    v_mfma_f32_16x16x32_bf16 v[52:55], v[28:31], v[244:247], v[52:55]
    v_mfma_f32_16x16x32_bf16 v[56:59], v[28:31], v[248:251], v[56:59]
    s_waitcnt vmcnt(3)
    buffer_atomic_or v9, v13, s[20:23], s54 offen sc1
    v_mfma_f32_16x16x32_bf16 v[60:63], v[28:31], v[252:255], v[60:63]
    s_waitcnt lgkmcnt(4)
    v_mfma_f32_16x16x32_bf16 v[48:51], v[32:35], v[128:131], v[48:51]
    v_mfma_f32_16x16x32_bf16 v[52:55], v[32:35], v[132:135], v[52:55]
    v_mfma_f32_16x16x32_bf16 v[56:59], v[32:35], v[136:139], v[56:59]
    v_mfma_f32_16x16x32_bf16 v[60:63], v[32:35], v[140:143], v[60:63]
    v_mfma_f32_16x16x32_bf16 v[48:51], v[36:39], v[144:147], v[48:51]
    v_mfma_f32_16x16x32_bf16 v[52:55], v[36:39], v[148:151], v[52:55]
    v_mfma_f32_16x16x32_bf16 v[56:59], v[36:39], v[152:155], v[56:59]
    v_mfma_f32_16x16x32_bf16 v[60:63], v[36:39], v[156:159], v[60:63]
    s_waitcnt lgkmcnt(0)
    v_mfma_f32_16x16x32_bf16 v[48:51], v[40:43], v[160:163], v[48:51]
    v_mfma_f32_16x16x32_bf16 v[52:55], v[40:43], v[164:167], v[52:55]
    v_mfma_f32_16x16x32_bf16 v[56:59], v[40:43], v[168:171], v[56:59]
    v_mfma_f32_16x16x32_bf16 v[60:63], v[40:43], v[172:175], v[60:63]
    v_mfma_f32_16x16x32_bf16 v[48:51], v[44:47], v[176:179], v[48:51]
    v_mfma_f32_16x16x32_bf16 v[52:55], v[44:47], v[180:183], v[52:55]
    v_mfma_f32_16x16x32_bf16 v[56:59], v[44:47], v[184:187], v[56:59]
    v_mfma_f32_16x16x32_bf16 v[60:63], v[44:47], v[188:191], v[60:63]
    s_nop 4
    ds_write_b128 v3, v[48:51] offset:0
    ds_write_b128 v3, v[52:55] offset:1024
    ds_write_b128 v3, v[56:59] offset:2048
    ds_write_b128 v3, v[60:63] offset:3072
    s_waitcnt vmcnt(1)
    buffer_atomic_or v10, v13, s[20:23], s55 offen sc1
    s_waitcnt lgkmcnt(0)
    s_barrier
    s_endpgm
L_crdy2:
    s_load_dword s63, s[48:49], s62 glc
    s_add_u32 s61, s61, 1
    s_cmp_lt_u32 s61, 20000
    s_cbranch_scc1 L_crdy
    s_waitcnt lgkmcnt(0)
    s_branch L_crdy_ok
L_dft2:
    s_mov_b32 s28, s46
    s_and_b32 s29, s47, 0xffff
    s_mov_b32 s30, 256
    s_mov_b32 s31, 0x00020000
    v_mov_b32 v12, 0xffff0000
    v_mov_b32 v244, 0
    v_mov_b32 v245, 0
    v_mov_b32 v15, 0
    v_bfe_u32 v3, v5, 1, 4
    v_and_b32 v4, 1, v5
    v_lshl_add_u32 v3, v3, 1, v4
    v_lshrrev_b32 v4, 5, v5
    v_lshl_add_u32 v3, v3, 1, v4
    v_lshl_or_b32 v3, v6, 24, v3
    v_lshlrev_b32 v254, 2, v3
    v_lshlrev_b32 v255, 3, v3
    s_lshl_b32 s53, s32, 20
    s_add_u32 s53, s53, 806912
    v_lshrrev_b32 v8, 2, v6
    v_and_b32 v11, 3, v6
    v_mad_u32_u24 v9, v8, 12, v11
    v_and_b32 v13, 15, v5
    v_xor_b32 v9, v9, v13
    v_lshlrev_b32 v9, 4, v9
    v_lshl_add_u32 v9, v11, 8, v9
    v_lshl_add_u32 v9, v8, 12, v9
    v_lshrrev_b32 v13, 4, v5
    v_lshl_add_u32 v9, v13, 10, v9
    v_mov_b32 v246, 0
    v_mov_b32 v247, 1.0
    v_mov_b32 v252, 1.0
    s_mov_b32 exec_lo, 0x01010101
    s_mov_b32 exec_hi, 0x01010101
    v_mov_b32 v246, -1
    v_mov_b32 v247, 0.5
    s_mov_b32 exec_lo, 0x40404040
    s_mov_b32 exec_hi, 0x40404040
    v_mov_b32 v252, 0.5
    s_mov_b64 exec, -1
    s_cmp_lt_u32 s35, 4
    s_cbranch_scc1 L_dft_old
    s_setprio 1
L_dft_old:
    s_cmp_eq_u32 s35, 7
    s_cbranch_scc1 L_dft_w7
    s_add_u32 s6, s6, L_tab-L_pc
    s_addc_u32 s7, s7, 0
    s_lshl_b32 s52, s35, 14
    s_add_u32 s52, s52, 8192
    v_lshl_add_u32 v250, v2, 4, s52
    v_add_u32 v251, 8192, v250
    v_lshlrev_b32 v253, 4, v2
    s_lshl_b32 s50, s35, 13
    s_add_u32 s50, s50, 65536
    v_and_b32 v8, 15, v2
    v_lshrrev_b32 v11, 4, v2
    v_xor_b32 v248, v8, v11
    v_lshlrev_b32 v248, 4, v248
    v_lshl_add_u32 v248, v11, 8, v248
    v_xor_b32 v249, 192, v248
    v_add_u32 v249, 4096, v249
    s_waitcnt vmcnt(7)
    v_dot2_f32_bf16 v15, v16, v16, v15
    v_lshlrev_b32 v192, 16, v16
    v_and_b32 v193, v12, v16
    v_dot2_f32_bf16 v15, v17, v17, v15
    v_lshlrev_b32 v194, 16, v17
    v_and_b32 v195, v12, v17
    v_dot2_f32_bf16 v15, v18, v18, v15
    v_lshlrev_b32 v196, 16, v18
    v_and_b32 v197, v12, v18
    v_dot2_f32_bf16 v15, v19, v19, v15
    v_lshlrev_b32 v198, 16, v19
    v_and_b32 v199, v12, v19
    s_waitcnt vmcnt(6)
    v_dot2_f32_bf16 v15, v20, v20, v15
    v_lshlrev_b32 v200, 16, v20
    v_and_b32 v201, v12, v20
    v_dot2_f32_bf16 v15, v21, v21, v15
    v_lshlrev_b32 v202, 16, v21
    v_and_b32 v203, v12, v21
    v_dot2_f32_bf16 v15, v22, v22, v15
    v_lshlrev_b32 v204, 16, v22
    v_and_b32 v205, v12, v22
    v_dot2_f32_bf16 v15, v23, v23, v15
    v_lshlrev_b32 v206, 16, v23
    v_and_b32 v207, v12, v23
    s_waitcnt vmcnt(5)
    v_dot2_f32_bf16 v15, v24, v24, v15
    v_lshlrev_b32 v208, 16, v24
    v_and_b32 v209, v12, v24
    v_dot2_f32_bf16 v15, v25, v25, v15
    v_lshlrev_b32 v210, 16, v25
    v_and_b32 v211, v12, v25
    v_dot2_f32_bf16 v15, v26, v26, v15
    v_lshlrev_b32 v212, 16, v26
    v_and_b32 v213, v12, v26
    v_dot2_f32_bf16 v15, v27, v27, v15
    v_lshlrev_b32 v214, 16, v27
    v_and_b32 v215, v12, v27
    s_waitcnt vmcnt(4)
    v_dot2_f32_bf16 v15, v28, v28, v15
    v_lshlrev_b32 v216, 16, v28
    v_and_b32 v217, v12, v28
    v_dot2_f32_bf16 v15, v29, v29, v15
    v_lshlrev_b32 v218, 16, v29
    v_and_b32 v219, v12, v29
    v_dot2_f32_bf16 v15, v30, v30, v15
    v_lshlrev_b32 v220, 16, v30
    v_and_b32 v221, v12, v30
    v_dot2_f32_bf16 v15, v31, v31, v15
    v_lshlrev_b32 v222, 16, v31
    v_and_b32 v223, v12, v31
    v_mov_b32_dpp v3, v200 row_shr:1 row_mask:0xf bank_mask:0xf bound_ctrl:1
    v_mov_b32_dpp v242, v200 row_shl:7 row_mask:0xf bank_mask:0xf bound_ctrl:1
    v_bfi_b32 v200, v246, 0, v3
    v_mov_b32_dpp v3, v216 row_shr:1 row_mask:0xf bank_mask:0xf bound_ctrl:1
    v_mov_b32_dpp v243, v216 row_shl:7 row_mask:0xf bank_mask:0xf bound_ctrl:1
    v_bfi_b32 v216, v246, 0, v3
    v_add_f32 v224, v192, v216
    v_add_f32 v228, v208, v200
    v_sub_f32 v232, v192, v216
    v_sub_f32 v236, v208, v200
    v_add_f32 v225, v193, v223
    v_add_f32 v229, v209, v207
    v_sub_f32 v233, v193, v223
    v_sub_f32 v237, v209, v207
    v_add_f32 v226, v194, v222
    v_add_f32 v230, v210, v206
    v_sub_f32 v234, v194, v222
    v_sub_f32 v238, v210, v206
    v_add_f32 v227, v195, v221
    v_add_f32 v231, v211, v205
    v_sub_f32 v235, v195, v221
    v_sub_f32 v239, v211, v205
    v_pk_add_f32 v[48:49], v[224:225], v[228:229]
    v_pk_add_f32 v[56:57], v[232:233], v[236:237]
    v_sub_f32 v64, v224, v228
    v_sub_f32 v65, v225, v229
    v_sub_f32 v72, v232, v236
    v_sub_f32 v73, v233, v237
    v_pk_add_f32 v[244:245], v[244:245], v[48:49]
    v_pk_add_f32 v[50:51], v[226:227], v[230:231]
    v_pk_add_f32 v[58:59], v[234:235], v[238:239]
    v_sub_f32 v66, v226, v230
    v_sub_f32 v67, v227, v231
    v_sub_f32 v74, v234, v238
    v_sub_f32 v75, v235, v239
    v_pk_add_f32 v[244:245], v[244:245], v[50:51]
    v_add_f32 v224, v196, v220
    v_add_f32 v228, v212, v204
    v_sub_f32 v232, v196, v220
    v_sub_f32 v236, v212, v204
    v_add_f32 v225, v197, v219
    v_add_f32 v229, v213, v203
    v_sub_f32 v233, v197, v219
    v_sub_f32 v237, v213, v203
    v_add_f32 v226, v198, v218
    v_add_f32 v230, v214, v202
    v_sub_f32 v234, v198, v218
    v_sub_f32 v238, v214, v202
    v_add_f32 v227, v199, v217
    v_add_f32 v231, v215, v201
    v_sub_f32 v235, v199, v217
    v_sub_f32 v239, v215, v201
    v_pk_add_f32 v[52:53], v[224:225], v[228:229]
    v_pk_add_f32 v[60:61], v[232:233], v[236:237]
    v_sub_f32 v68, v224, v228
    v_sub_f32 v69, v225, v229
    v_sub_f32 v76, v232, v236
    v_sub_f32 v77, v233, v237
    v_pk_add_f32 v[244:245], v[244:245], v[52:53]
    v_pk_add_f32 v[54:55], v[226:227], v[230:231]
    v_pk_add_f32 v[62:63], v[234:235], v[238:239]
    v_sub_f32 v70, v226, v230
    v_sub_f32 v71, v227, v231
    v_sub_f32 v78, v234, v238
    v_sub_f32 v79, v235, v239
    v_pk_add_f32 v[244:245], v[244:245], v[54:55]
    s_waitcnt vmcnt(3)
    v_dot2_f32_bf16 v15, v32, v32, v15
    v_lshlrev_b32 v192, 16, v32
    v_and_b32 v193, v12, v32
    v_dot2_f32_bf16 v15, v33, v33, v15
    v_lshlrev_b32 v194, 16, v33
    v_and_b32 v195, v12, v33
    v_dot2_f32_bf16 v15, v34, v34, v15
    v_lshlrev_b32 v196, 16, v34
    v_and_b32 v197, v12, v34
    v_dot2_f32_bf16 v15, v35, v35, v15
    v_lshlrev_b32 v198, 16, v35
    v_and_b32 v199, v12, v35
    s_waitcnt vmcnt(2)
    v_dot2_f32_bf16 v15, v36, v36, v15
    v_lshlrev_b32 v200, 16, v36
    v_and_b32 v201, v12, v36
    v_dot2_f32_bf16 v15, v37, v37, v15
    v_lshlrev_b32 v202, 16, v37
    v_and_b32 v203, v12, v37
    v_dot2_f32_bf16 v15, v38, v38, v15
    v_lshlrev_b32 v204, 16, v38
    v_and_b32 v205, v12, v38
    v_dot2_f32_bf16 v15, v39, v39, v15
    v_lshlrev_b32 v206, 16, v39
    v_and_b32 v207, v12, v39
    s_waitcnt vmcnt(1)
    v_dot2_f32_bf16 v15, v40, v40, v15
    v_lshlrev_b32 v208, 16, v40
    v_and_b32 v209, v12, v40
    v_dot2_f32_bf16 v15, v41, v41, v15
    v_lshlrev_b32 v210, 16, v41
    v_and_b32 v211, v12, v41
    v_dot2_f32_bf16 v15, v42, v42, v15
    v_lshlrev_b32 v212, 16, v42
    v_and_b32 v213, v12, v42
    v_dot2_f32_bf16 v15, v43, v43, v15
    v_lshlrev_b32 v214, 16, v43
    v_and_b32 v215, v12, v43
    s_waitcnt vmcnt(0)
    v_dot2_f32_bf16 v15, v44, v44, v15
    v_lshlrev_b32 v216, 16, v44
    v_and_b32 v217, v12, v44
    v_dot2_f32_bf16 v15, v45, v45, v15
    v_lshlrev_b32 v218, 16, v45
    v_and_b32 v219, v12, v45
    v_dot2_f32_bf16 v15, v46, v46, v15
    v_lshlrev_b32 v220, 16, v46
    v_and_b32 v221, v12, v46
    v_dot2_f32_bf16 v15, v47, v47, v15
    v_lshlrev_b32 v222, 16, v47
    v_and_b32 v223, v12, v47
    global_load_dwordx4 v[128:131], v250, s[6:7] offset:-4096
    v_mov_b32_dpp v3, v200 row_shr:1 row_mask:0xf bank_mask:0xf bound_ctrl:1
    v_bfi_b32 v200, v246, v242, v3
    v_mov_b32_dpp v3, v216 row_shr:1 row_mask:0xf bank_mask:0xf bound_ctrl:1
    v_bfi_b32 v216, v246, v243, v3
    v_add_f32 v224, v192, v216
    v_add_f32 v228, v208, v200
    v_sub_f32 v232, v192, v216
    v_sub_f32 v236, v208, v200
    v_add_f32 v225, v193, v223
    v_add_f32 v229, v209, v207
    v_sub_f32 v233, v193, v223
    v_sub_f32 v237, v209, v207
    v_add_f32 v226, v194, v222
    v_add_f32 v230, v210, v206
    v_sub_f32 v234, v194, v222
    v_sub_f32 v238, v210, v206
    v_add_f32 v227, v195, v221
    v_add_f32 v231, v211, v205
    v_sub_f32 v235, v195, v221
    v_sub_f32 v239, v211, v205
    v_pk_add_f32 v[80:81], v[224:225], v[228:229]
    v_pk_add_f32 v[88:89], v[232:233], v[236:237]
    v_sub_f32 v96, v224, v228
    v_sub_f32 v97, v225, v229
    v_sub_f32 v104, v232, v236
    v_sub_f32 v105, v233, v237
    v_pk_add_f32 v[244:245], v[244:245], v[80:81]
    v_pk_add_f32 v[82:83], v[226:227], v[230:231]
    v_pk_add_f32 v[90:91], v[234:235], v[238:239]
    v_sub_f32 v98, v226, v230
    v_sub_f32 v99, v227, v231
    v_sub_f32 v106, v234, v238
    v_sub_f32 v107, v235, v239
    v_pk_add_f32 v[244:245], v[244:245], v[82:83]
    global_load_dwordx4 v[132:135], v250, s[6:7] offset:-3072
    v_add_f32 v224, v196, v220
    v_add_f32 v228, v212, v204
    v_sub_f32 v232, v196, v220
    v_sub_f32 v236, v212, v204
    v_add_f32 v225, v197, v219
    v_add_f32 v229, v213, v203
    v_sub_f32 v233, v197, v219
    v_sub_f32 v237, v213, v203
    v_add_f32 v226, v198, v218
    v_add_f32 v230, v214, v202
    v_sub_f32 v234, v198, v218
    v_sub_f32 v238, v214, v202
    v_add_f32 v227, v199, v217
    v_add_f32 v231, v215, v201
    v_sub_f32 v235, v199, v217
    v_sub_f32 v239, v215, v201
    v_pk_add_f32 v[84:85], v[224:225], v[228:229]
    v_pk_add_f32 v[92:93], v[232:233], v[236:237]
    v_sub_f32 v100, v224, v228
    v_sub_f32 v101, v225, v229
    v_sub_f32 v108, v232, v236
    v_sub_f32 v109, v233, v237
    v_pk_add_f32 v[244:245], v[244:245], v[84:85]
    v_pk_add_f32 v[86:87], v[226:227], v[230:231]
    v_pk_add_f32 v[94:95], v[234:235], v[238:239]
    v_sub_f32 v102, v226, v230
    v_sub_f32 v103, v227, v231
    v_sub_f32 v110, v234, v238
    v_sub_f32 v111, v235, v239
    v_pk_add_f32 v[244:245], v[244:245], v[86:87]
    global_load_dwordx4 v[136:139], v250, s[6:7] offset:-2048
    v_add_f32 v14, v244, v245
    s_nop 1
    v_add_f32_dpp v14, v14, v14 quad_perm:[1,0,3,2] row_mask:0xf bank_mask:0xf
    v_add_f32_dpp v15, v15, v15 quad_perm:[1,0,3,2] row_mask:0xf bank_mask:0xf
    s_nop 0
    v_add_f32_dpp v14, v14, v14 quad_perm:[2,3,0,1] row_mask:0xf bank_mask:0xf
    v_add_f32_dpp v15, v15, v15 quad_perm:[2,3,0,1] row_mask:0xf bank_mask:0xf
    s_nop 0
    v_add_f32_dpp v14, v14, v14 row_half_mirror row_mask:0xf bank_mask:0xf
    v_add_f32_dpp v15, v15, v15 row_half_mirror row_mask:0xf bank_mask:0xf
    s_nop 0
    v_mul_f32 v13, 0xbb124925, v14
    v_mul_f32 v15, 0x3b124925, v15
    v_fma_f32 v15, -v13, v13, v15
    v_max_f32 v15, 0, v15
    v_add_f32 v15, 0x3727c5ac, v15
    v_rsq_f32 v14, v15
    v_cvt_pk_bf16_f32 v224, v13, v13
    v_and_b32 v3, v12, v224
    v_sub_f32 v3, v13, v3
    v_cvt_pk_bf16_f32 v224, v13, v3
    v_mov_b32 v225, v224
    buffer_store_dwordx2 v[224:225], v255, s[20:23], s53 offen sc1
    buffer_store_dword v14, v254, s[20:23], s53 offen offset:512 sc1
    v_mul_f32 v13, 4.0, v13
    v_mov_b32 v15, v14
    v_mul_f32 v240, v13, v14
    v_mul_f32 v241, v13, v14
    v_mul_f32 v242, v240, v247
    v_mov_b32 v243, v240
    v_mul_f32 v244, v240, v252
    v_mov_b32 v245, v240
    v_pk_fma_f32 v[48:49], v[48:49], v[14:15], v[242:243]
    v_cvt_pk_bf16_f32 v16, v48, v49
    v_pk_fma_f32 v[50:51], v[50:51], v[14:15], v[240:241]
    v_cvt_pk_bf16_f32 v17, v50, v51
    v_pk_fma_f32 v[52:53], v[52:53], v[14:15], v[240:241]
    v_cvt_pk_bf16_f32 v18, v52, v53
    v_pk_fma_f32 v[54:55], v[54:55], v[14:15], v[240:241]
    v_cvt_pk_bf16_f32 v19, v54, v55
    ds_write_b128 v9, v[16:19] offset:0
    global_load_dwordx4 v[140:143], v250, s[6:7] offset:-1024
    v_pk_fma_f32 v[80:81], v[80:81], v[14:15], v[244:245]
    v_cvt_pk_bf16_f32 v20, v80, v81
    v_pk_fma_f32 v[82:83], v[82:83], v[14:15], v[240:241]
    v_cvt_pk_bf16_f32 v21, v82, v83
    v_pk_fma_f32 v[84:85], v[84:85], v[14:15], v[240:241]
    v_cvt_pk_bf16_f32 v22, v84, v85
    v_pk_fma_f32 v[86:87], v[86:87], v[14:15], v[240:241]
    v_cvt_pk_bf16_f32 v23, v86, v87
    ds_write_b128 v9, v[20:23] offset:8192
    global_load_dwordx4 v[144:147], v250, s[6:7] offset:0
    v_pk_mul_f32 v[56:57], v[56:57], v[14:15]
    v_cvt_pk_bf16_f32 v24, v56, v57
    v_pk_mul_f32 v[58:59], v[58:59], v[14:15]
    v_cvt_pk_bf16_f32 v25, v58, v59
    v_pk_mul_f32 v[60:61], v[60:61], v[14:15]
    v_cvt_pk_bf16_f32 v26, v60, v61
    v_pk_mul_f32 v[62:63], v[62:63], v[14:15]
    v_cvt_pk_bf16_f32 v27, v62, v63
    ds_write_b128 v9, v[24:27] offset:16384
    global_load_dwordx4 v[148:151], v250, s[6:7] offset:1024
    v_pk_mul_f32 v[88:89], v[88:89], v[14:15]
    v_cvt_pk_bf16_f32 v28, v88, v89
    v_pk_mul_f32 v[90:91], v[90:91], v[14:15]
    v_cvt_pk_bf16_f32 v29, v90, v91
    v_pk_mul_f32 v[92:93], v[92:93], v[14:15]
    v_cvt_pk_bf16_f32 v30, v92, v93
    v_pk_mul_f32 v[94:95], v[94:95], v[14:15]
    v_cvt_pk_bf16_f32 v31, v94, v95
    ds_write_b128 v9, v[28:31] offset:24576
    global_load_dwordx4 v[152:155], v250, s[6:7] offset:2048
    v_pk_mul_f32 v[64:65], v[64:65], v[14:15]
    v_cvt_pk_bf16_f32 v32, v64, v65
    v_pk_mul_f32 v[66:67], v[66:67], v[14:15]
    v_cvt_pk_bf16_f32 v33, v66, v67
    v_pk_mul_f32 v[68:69], v[68:69], v[14:15]
    v_cvt_pk_bf16_f32 v34, v68, v69
    v_pk_mul_f32 v[70:71], v[70:71], v[14:15]
    v_cvt_pk_bf16_f32 v35, v70, v71
    ds_write_b128 v9, v[32:35] offset:32768
    v_pk_mul_f32 v[96:97], v[96:97], v[14:15]
    v_cvt_pk_bf16_f32 v36, v96, v97
    v_pk_mul_f32 v[98:99], v[98:99], v[14:15]
    v_cvt_pk_bf16_f32 v37, v98, v99
    v_pk_mul_f32 v[100:101], v[100:101], v[14:15]
    v_cvt_pk_bf16_f32 v38, v100, v101
    v_pk_mul_f32 v[102:103], v[102:103], v[14:15]
    v_cvt_pk_bf16_f32 v39, v102, v103
    ds_write_b128 v9, v[36:39] offset:40960
    v_pk_mul_f32 v[72:73], v[72:73], v[14:15]
    v_cvt_pk_bf16_f32 v40, v72, v73
    v_pk_mul_f32 v[74:75], v[74:75], v[14:15]
    v_cvt_pk_bf16_f32 v41, v74, v75
    v_pk_mul_f32 v[76:77], v[76:77], v[14:15]
    v_cvt_pk_bf16_f32 v42, v76, v77
    v_pk_mul_f32 v[78:79], v[78:79], v[14:15]
    v_cvt_pk_bf16_f32 v43, v78, v79
    ds_write_b128 v9, v[40:43] offset:49152
    v_pk_mul_f32 v[104:105], v[104:105], v[14:15]
    v_cvt_pk_bf16_f32 v44, v104, v105
    v_pk_mul_f32 v[106:107], v[106:107], v[14:15]
    v_cvt_pk_bf16_f32 v45, v106, v107
    v_pk_mul_f32 v[108:109], v[108:109], v[14:15]
    v_cvt_pk_bf16_f32 v46, v108, v109
    v_pk_mul_f32 v[110:111], v[110:111], v[14:15]
    v_cvt_pk_bf16_f32 v47, v110, v111
    ds_write_b128 v9, v[44:47] offset:57344
    s_waitcnt vmcnt(4) lgkmcnt(0)
    s_barrier
    s_cmp_ge_u32 s35, 4
    s_cbranch_scc1 L_dft_lo
    s_setprio 2
L_dft_lo:
    ds_read_b128 v[16:19], v248 offset:0
    ds_read_b128 v[20:23], v248 offset:1024
    ds_read_b128 v[24:27], v248 offset:2048
    ds_read_b128 v[28:31], v248 offset:3072
    ds_read_b128 v[32:35], v249 offset:0
    ds_read_b128 v[36:39], v249 offset:1024
    ds_read_b128 v[40:43], v249 offset:2048
    ds_read_b128 v[44:47], v249 offset:3072
    global_load_dwordx4 v[156:159], v250, s[6:7] offset:3072
    global_load_dwordx4 v[160:163], v251, s[6:7] offset:-4096
    global_load_dwordx4 v[164:167], v251, s[6:7] offset:-3072
    global_load_dwordx4 v[168:171], v251, s[6:7] offset:-2048
    global_load_dwordx4 v[172:175], v251, s[6:7] offset:-1024
    global_load_dwordx4 v[176:179], v251, s[6:7] offset:0
    global_load_dwordx4 v[180:183], v251, s[6:7] offset:1024
    global_load_dwordx4 v[184:187], v251, s[6:7] offset:2048
    global_load_dwordx4 v[188:191], v251, s[6:7] offset:3072
    global_load_dwordx4 v[112:115], v253, s[6:7] offset:0
    global_load_dwordx4 v[116:119], v253, s[6:7] offset:1024
    global_load_dwordx4 v[120:123], v253, s[6:7] offset:2048
    global_load_dwordx4 v[124:127], v253, s[6:7] offset:3072
    v_and_b32 v5, 7, v2
    v_xor_b32 v5, v5, v11
    v_lshlrev_b32 v5, 4, v5
    v_lshl_add_u32 v5, v8, 7, v5
    v_xor_b32 v6, 64, v5
    v_add_u32 v9, s50, v5
    v_add_u32 v7, s50, v6
    v_lshrrev_b32 v5, 3, v2
    v_and_b32 v6, 7, v2
    v_xor_b32 v14, v5, v6
    v_lshlrev_b32 v14, 4, v14
    v_lshl_add_u32 v14, v5, 7, v14
    v_add_u32 v14, s50, v14
    v_lshlrev_b32 v15, 21, v5
    v_lshl_add_u32 v15, v6, 4, v15
    s_lshl_b32 s56, s35, 14
    s_lshl_b32 s57, s32, 7
    s_add_u32 s56, s56, s57
    s_add_u32 s56, s56, 688128
    v_add_u32 v15, s56, v15
    s_waitcnt lgkmcnt(4)
    v_mfma_f32_16x16x32_bf16 v[64:67], v[16:19], v[128:131], 0
    ds_read_b128 v[48:51], v248 offset:8192
    v_lshlrev_b32 v246, 1, v5
    v_mfma_f32_16x16x32_bf16 v[68:71], v[20:23], v[128:131], 0
    ds_read_b128 v[52:55], v248 offset:9216
    v_lshlrev_b32 v5, 2, v2
    v_mfma_f32_16x16x32_bf16 v[72:75], v[24:27], v[128:131], 0
    ds_read_b128 v[56:59], v248 offset:10240
    v_add_u32 v5, 163328, v5
    v_mfma_f32_16x16x32_bf16 v[76:79], v[28:31], v[128:131], 0
    ds_read_b128 v[60:63], v248 offset:11264
    v_mov_b32 v240, 0x80008000
    s_waitcnt lgkmcnt(4)
    v_mfma_f32_16x16x32_bf16 v[64:67], v[32:35], v[132:135], v[64:67]
    ds_read_b128 v[16:19], v249 offset:8192
    v_mov_b32 v241, 0x80000000
    v_mfma_f32_16x16x32_bf16 v[68:71], v[36:39], v[132:135], v[68:71]
    ds_read_b128 v[20:23], v249 offset:9216
    v_mfma_f32_16x16x32_bf16 v[72:75], v[40:43], v[132:135], v[72:75]
    ds_read_b128 v[24:27], v249 offset:10240
    v_mfma_f32_16x16x32_bf16 v[76:79], v[44:47], v[132:135], v[76:79]
    ds_read_b128 v[28:31], v249 offset:11264
    s_waitcnt vmcnt(16)
    s_waitcnt lgkmcnt(4)
    v_mfma_f32_16x16x32_bf16 v[64:67], v[48:51], v[136:139], v[64:67]
    ds_read_b128 v[32:35], v248 offset:16384
    v_mfma_f32_16x16x32_bf16 v[68:71], v[52:55], v[136:139], v[68:71]
    ds_read_b128 v[36:39], v248 offset:17408
    v_mfma_f32_16x16x32_bf16 v[72:75], v[56:59], v[136:139], v[72:75]
    ds_read_b128 v[40:43], v248 offset:18432
    v_mfma_f32_16x16x32_bf16 v[76:79], v[60:63], v[136:139], v[76:79]
    ds_read_b128 v[44:47], v248 offset:19456
    s_waitcnt lgkmcnt(4)
    v_mfma_f32_16x16x32_bf16 v[64:67], v[16:19], v[140:143], v[64:67]
    ds_read_b128 v[48:51], v249 offset:16384
    v_mfma_f32_16x16x32_bf16 v[68:71], v[20:23], v[140:143], v[68:71]
    ds_read_b128 v[52:55], v249 offset:17408
    v_mfma_f32_16x16x32_bf16 v[72:75], v[24:27], v[140:143], v[72:75]
    ds_read_b128 v[56:59], v249 offset:18432
    v_mfma_f32_16x16x32_bf16 v[76:79], v[28:31], v[140:143], v[76:79]
    ds_read_b128 v[60:63], v249 offset:19456
    s_waitcnt vmcnt(14)
    s_waitcnt lgkmcnt(4)
    v_mfma_f32_16x16x32_bf16 v[80:83], v[32:35], v[144:147], 0
    ds_read_b128 v[16:19], v248 offset:24576
    v_mfma_f32_16x16x32_bf16 v[84:87], v[36:39], v[144:147], 0
    ds_read_b128 v[20:23], v248 offset:25600
    v_mfma_f32_16x16x32_bf16 v[88:91], v[40:43], v[144:147], 0
    ds_read_b128 v[24:27], v248 offset:26624
    v_mfma_f32_16x16x32_bf16 v[92:95], v[44:47], v[144:147], 0
    ds_read_b128 v[28:31], v248 offset:27648
    v_add_f32 v3, v64, v72
    v_add_f32 v4, v65, v73
    s_waitcnt lgkmcnt(4)
    v_mfma_f32_16x16x32_bf16 v[80:83], v[48:51], v[148:151], v[80:83]
    ds_read_b128 v[32:35], v249 offset:24576
    v_sub_f32 v10, v64, v72
    v_sub_f32 v13, v65, v73
    v_mfma_f32_16x16x32_bf16 v[84:87], v[52:55], v[148:151], v[84:87]
    ds_read_b128 v[36:39], v249 offset:25600
    v_cvt_pk_bf16_f32 v192, v3, v4
    v_mfma_f32_16x16x32_bf16 v[88:91], v[56:59], v[148:151], v[88:91]
    ds_read_b128 v[40:43], v249 offset:26624
    v_cvt_pk_bf16_f32 v196, v10, v13
    v_mfma_f32_16x16x32_bf16 v[92:95], v[60:63], v[148:151], v[92:95]
    ds_read_b128 v[44:47], v249 offset:27648
    s_waitcnt vmcnt(12)
    v_add_f32 v3, v66, v74
    v_add_f32 v4, v67, v75
    s_waitcnt lgkmcnt(4)
    v_mfma_f32_16x16x32_bf16 v[80:83], v[16:19], v[152:155], v[80:83]
    ds_read_b128 v[48:51], v248 offset:32768
    v_sub_f32 v10, v66, v74
    v_sub_f32 v13, v67, v75
    v_mfma_f32_16x16x32_bf16 v[84:87], v[20:23], v[152:155], v[84:87]
    ds_read_b128 v[52:55], v248 offset:33792
    v_cvt_pk_bf16_f32 v193, v3, v4
    v_mfma_f32_16x16x32_bf16 v[88:91], v[24:27], v[152:155], v[88:91]
    ds_read_b128 v[56:59], v248 offset:34816
    v_cvt_pk_bf16_f32 v197, v10, v13
    v_mfma_f32_16x16x32_bf16 v[92:95], v[28:31], v[152:155], v[92:95]
    ds_read_b128 v[60:63], v248 offset:35840
    v_add_f32 v3, v68, v76
    v_add_f32 v4, v69, v77
    v_sub_f32 v10, v68, v76
    v_sub_f32 v13, v69, v77
    s_waitcnt lgkmcnt(4)
    v_mfma_f32_16x16x32_bf16 v[80:83], v[32:35], v[156:159], v[80:83]
    ds_read_b128 v[16:19], v249 offset:32768
    v_cvt_pk_bf16_f32 v194, v3, v4
    v_cvt_pk_bf16_f32 v198, v10, v13
    v_mfma_f32_16x16x32_bf16 v[84:87], v[36:39], v[156:159], v[84:87]
    ds_read_b128 v[20:23], v249 offset:33792
    v_add_f32 v3, v70, v78
    v_add_f32 v4, v71, v79
    v_sub_f32 v10, v70, v78
    v_sub_f32 v13, v71, v79
    v_mfma_f32_16x16x32_bf16 v[88:91], v[40:43], v[156:159], v[88:91]
    ds_read_b128 v[24:27], v249 offset:34816
    v_cvt_pk_bf16_f32 v195, v3, v4
    v_cvt_pk_bf16_f32 v199, v10, v13
    v_mfma_f32_16x16x32_bf16 v[92:95], v[44:47], v[156:159], v[92:95]
    ds_read_b128 v[28:31], v249 offset:35840
    s_waitcnt vmcnt(10)
    s_waitcnt lgkmcnt(4)
    v_mfma_f32_16x16x32_bf16 v[64:67], v[48:51], v[160:163], 0
    ds_read_b128 v[32:35], v248 offset:40960
    v_mfma_f32_16x16x32_bf16 v[68:71], v[52:55], v[160:163], 0
    ds_read_b128 v[36:39], v248 offset:41984
    v_mfma_f32_16x16x32_bf16 v[72:75], v[56:59], v[160:163], 0
    ds_read_b128 v[40:43], v248 offset:43008
    v_mfma_f32_16x16x32_bf16 v[76:79], v[60:63], v[160:163], 0
    ds_read_b128 v[44:47], v248 offset:44032
    v_add_f32 v3, v80, v88
    v_add_f32 v4, v81, v89
    s_waitcnt lgkmcnt(4)
    v_mfma_f32_16x16x32_bf16 v[64:67], v[16:19], v[164:167], v[64:67]
    ds_read_b128 v[48:51], v249 offset:40960
    v_sub_f32 v10, v80, v88
    v_sub_f32 v13, v81, v89
    v_mfma_f32_16x16x32_bf16 v[68:71], v[20:23], v[164:167], v[68:71]
    ds_read_b128 v[52:55], v249 offset:41984
    v_cvt_pk_bf16_f32 v200, v3, v4
    v_mfma_f32_16x16x32_bf16 v[72:75], v[24:27], v[164:167], v[72:75]
    ds_read_b128 v[56:59], v249 offset:43008
    v_cvt_pk_bf16_f32 v204, v10, v13
    v_mfma_f32_16x16x32_bf16 v[76:79], v[28:31], v[164:167], v[76:79]
    ds_read_b128 v[60:63], v249 offset:44032
    s_waitcnt vmcnt(8)
    v_add_f32 v3, v82, v90
    v_add_f32 v4, v83, v91
    s_waitcnt lgkmcnt(4)
    v_mfma_f32_16x16x32_bf16 v[64:67], v[32:35], v[168:171], v[64:67]
    ds_read_b128 v[16:19], v248 offset:49152
    v_sub_f32 v10, v82, v90
    v_sub_f32 v13, v83, v91
    v_mfma_f32_16x16x32_bf16 v[68:71], v[36:39], v[168:171], v[68:71]
    ds_read_b128 v[20:23], v248 offset:50176
    v_cvt_pk_bf16_f32 v201, v3, v4
    v_mfma_f32_16x16x32_bf16 v[72:75], v[40:43], v[168:171], v[72:75]
    ds_read_b128 v[24:27], v248 offset:51200
    v_cvt_pk_bf16_f32 v205, v10, v13
    v_mfma_f32_16x16x32_bf16 v[76:79], v[44:47], v[168:171], v[76:79]
    ds_read_b128 v[28:31], v248 offset:52224
    v_add_f32 v3, v84, v92
    v_add_f32 v4, v85, v93
    v_sub_f32 v10, v84, v92
    v_sub_f32 v13, v85, v93
    s_waitcnt lgkmcnt(4)
    v_mfma_f32_16x16x32_bf16 v[64:67], v[48:51], v[172:175], v[64:67]
    ds_read_b128 v[32:35], v249 offset:49152
    v_cvt_pk_bf16_f32 v202, v3, v4
    v_cvt_pk_bf16_f32 v206, v10, v13
    v_mfma_f32_16x16x32_bf16 v[68:71], v[52:55], v[172:175], v[68:71]
    ds_read_b128 v[36:39], v249 offset:50176
    v_add_f32 v3, v86, v94
    v_add_f32 v4, v87, v95
    v_sub_f32 v10, v86, v94
    v_sub_f32 v13, v87, v95
    v_mfma_f32_16x16x32_bf16 v[72:75], v[56:59], v[172:175], v[72:75]
    ds_read_b128 v[40:43], v249 offset:51200
    v_cvt_pk_bf16_f32 v203, v3, v4
    v_cvt_pk_bf16_f32 v207, v10, v13
    v_mfma_f32_16x16x32_bf16 v[76:79], v[60:63], v[172:175], v[76:79]
    ds_read_b128 v[44:47], v249 offset:52224
    s_waitcnt vmcnt(6)
    s_waitcnt vmcnt(0)
    s_waitcnt lgkmcnt(4)
    v_mfma_f32_16x16x32_bf16 v[80:83], v[16:19], v[176:179], 0
    ds_read_b128 v[48:51], v248 offset:57344
    v_xor_b32 v224, v240, v200
    v_mfma_f32_16x16x32_bf16 v[84:87], v[20:23], v[176:179], 0
    ds_read_b128 v[52:55], v248 offset:58368
    v_xor_b32 v225, v240, v201
    v_mfma_f32_16x16x32_bf16 v[88:91], v[24:27], v[176:179], 0
    ds_read_b128 v[56:59], v248 offset:59392
    v_xor_b32 v226, v240, v202
    v_mfma_f32_16x16x32_bf16 v[92:95], v[28:31], v[176:179], 0
    ds_read_b128 v[60:63], v248 offset:60416
    v_add_f32 v3, v64, v72
    v_add_f32 v4, v65, v73
    v_xor_b32 v227, v240, v203
    s_waitcnt lgkmcnt(4)
    v_mfma_f32_16x16x32_bf16 v[80:83], v[32:35], v[180:183], v[80:83]
    ds_read_b128 v[16:19], v249 offset:57344
    v_sub_f32 v10, v64, v72
    v_sub_f32 v13, v65, v73
    v_xor_b32 v228, v240, v204
    v_mfma_f32_16x16x32_bf16 v[84:87], v[36:39], v[180:183], v[84:87]
    ds_read_b128 v[20:23], v249 offset:58368
    v_cvt_pk_bf16_f32 v208, v3, v4
    v_xor_b32 v229, v240, v205
    v_mfma_f32_16x16x32_bf16 v[88:91], v[40:43], v[180:183], v[88:91]
    ds_read_b128 v[24:27], v249 offset:59392
    v_cvt_pk_bf16_f32 v212, v10, v13
    v_xor_b32 v230, v240, v206
    v_mfma_f32_16x16x32_bf16 v[92:95], v[44:47], v[180:183], v[92:95]
    ds_read_b128 v[28:31], v249 offset:60416
    v_add_f32 v3, v66, v74
    v_add_f32 v4, v67, v75
    v_xor_b32 v231, v240, v207
    s_waitcnt lgkmcnt(4)
    v_mfma_f32_16x16x32_bf16 v[80:83], v[48:51], v[184:187], v[80:83]
    v_sub_f32 v10, v66, v74
    v_sub_f32 v13, v67, v75
    v_xor_b32 v96, v241, v112
    v_xor_b32 v97, v241, v113
    v_mfma_f32_16x16x32_bf16 v[84:87], v[52:55], v[184:187], v[84:87]
    v_cvt_pk_bf16_f32 v209, v3, v4
    v_xor_b32 v98, v241, v114
    v_xor_b32 v99, v241, v115
    v_mfma_f32_16x16x32_bf16 v[88:91], v[56:59], v[184:187], v[88:91]
    v_cvt_pk_bf16_f32 v213, v10, v13
    v_xor_b32 v100, v241, v116
    v_xor_b32 v101, v241, v117
    v_mfma_f32_16x16x32_bf16 v[92:95], v[60:63], v[184:187], v[92:95]
    v_add_f32 v3, v68, v76
    v_add_f32 v4, v69, v77
    v_sub_f32 v10, v68, v76
    v_sub_f32 v13, v69, v77
    v_xor_b32 v102, v241, v118
    v_xor_b32 v103, v241, v119
    s_waitcnt lgkmcnt(0)
    v_mfma_f32_16x16x32_bf16 v[80:83], v[16:19], v[188:191], v[80:83]
    v_cvt_pk_bf16_f32 v210, v3, v4
    v_cvt_pk_bf16_f32 v214, v10, v13
    v_mfma_f32_16x16x32_bf16 v[84:87], v[20:23], v[188:191], v[84:87]
    v_add_f32 v3, v70, v78
    v_add_f32 v4, v71, v79
    v_sub_f32 v10, v70, v78
    v_sub_f32 v13, v71, v79
    v_mfma_f32_16x16x32_bf16 v[88:91], v[24:27], v[188:191], v[88:91]
    v_cvt_pk_bf16_f32 v211, v3, v4
    v_cvt_pk_bf16_f32 v215, v10, v13
    v_mfma_f32_16x16x32_bf16 v[92:95], v[28:31], v[188:191], v[92:95]
    v_xor_b32 v104, v241, v120
    v_xor_b32 v105, v241, v121
    v_mfma_f32_16x16x32_bf16 v[128:131], v[192:195], v[112:115], 0
    v_xor_b32 v106, v241, v122
    v_xor_b32 v107, v241, v123
    v_mfma_f32_16x16x32_bf16 v[136:139], v[200:203], v[112:115], 0
    v_xor_b32 v108, v241, v124
    v_xor_b32 v109, v241, v125
    v_mfma_f32_16x16x32_bf16 v[128:131], v[224:227], v[116:119], v[128:131]
    v_xor_b32 v110, v241, v126
    v_xor_b32 v111, v241, v127
    v_mfma_f32_16x16x32_bf16 v[136:139], v[192:195], v[116:119], v[136:139]
    v_add_f32 v3, v80, v88
    v_add_f32 v4, v81, v89
    v_sub_f32 v10, v80, v88
    v_sub_f32 v13, v81, v89
    v_mfma_f32_16x16x32_bf16 v[144:147], v[192:195], v[96:99], 0
    v_cvt_pk_bf16_f32 v216, v3, v4
    v_cvt_pk_bf16_f32 v220, v10, v13
    v_mfma_f32_16x16x32_bf16 v[152:155], v[200:203], v[96:99], 0
    v_add_f32 v3, v82, v90
    v_add_f32 v4, v83, v91
    v_sub_f32 v10, v82, v90
    v_sub_f32 v13, v83, v91
    v_mfma_f32_16x16x32_bf16 v[144:147], v[224:227], v[100:103], v[144:147]
    v_cvt_pk_bf16_f32 v217, v3, v4
    v_cvt_pk_bf16_f32 v221, v10, v13
    v_mfma_f32_16x16x32_bf16 v[152:155], v[192:195], v[100:103], v[152:155]
    v_add_f32 v3, v84, v92
    v_add_f32 v4, v85, v93
    v_sub_f32 v10, v84, v92
    v_sub_f32 v13, v85, v93
    v_mfma_f32_16x16x32_bf16 v[160:163], v[196:199], v[120:123], 0
    v_cvt_pk_bf16_f32 v218, v3, v4
    v_cvt_pk_bf16_f32 v222, v10, v13
    v_mfma_f32_16x16x32_bf16 v[168:171], v[204:207], v[120:123], 0
    v_add_f32 v3, v86, v94
    v_add_f32 v4, v87, v95
    v_sub_f32 v10, v86, v94
    v_sub_f32 v13, v87, v95
    v_mfma_f32_16x16x32_bf16 v[160:163], v[228:231], v[124:127], v[160:163]
    v_cvt_pk_bf16_f32 v219, v3, v4
    v_cvt_pk_bf16_f32 v223, v10, v13
    v_mfma_f32_16x16x32_bf16 v[168:171], v[196:199], v[124:127], v[168:171]
    v_xor_b32 v232, v240, v216
    v_xor_b32 v233, v240, v217
    v_mfma_f32_16x16x32_bf16 v[176:179], v[196:199], v[104:107], 0
    v_xor_b32 v234, v240, v218
    v_xor_b32 v235, v240, v219
    v_mfma_f32_16x16x32_bf16 v[184:187], v[204:207], v[104:107], 0
    v_xor_b32 v236, v240, v220
    v_xor_b32 v237, v240, v221
    v_mfma_f32_16x16x32_bf16 v[176:179], v[228:231], v[108:111], v[176:179]
    v_xor_b32 v238, v240, v222
    v_xor_b32 v239, v240, v223
    v_mfma_f32_16x16x32_bf16 v[184:187], v[196:199], v[108:111], v[184:187]
    v_mfma_f32_16x16x32_bf16 v[132:135], v[208:211], v[112:115], 0
    v_mfma_f32_16x16x32_bf16 v[140:143], v[216:219], v[112:115], 0
    v_mfma_f32_16x16x32_bf16 v[132:135], v[232:235], v[116:119], v[132:135]
    v_mfma_f32_16x16x32_bf16 v[140:143], v[208:211], v[116:119], v[140:143]
    v_mfma_f32_16x16x32_bf16 v[148:151], v[208:211], v[96:99], 0
    v_mfma_f32_16x16x32_bf16 v[156:159], v[216:219], v[96:99], 0
    v_mfma_f32_16x16x32_bf16 v[148:151], v[232:235], v[100:103], v[148:151]
    v_mfma_f32_16x16x32_bf16 v[156:159], v[208:211], v[100:103], v[156:159]
    v_mfma_f32_16x16x32_bf16 v[164:167], v[212:215], v[120:123], 0
    v_mfma_f32_16x16x32_bf16 v[172:175], v[220:223], v[120:123], 0
    v_mfma_f32_16x16x32_bf16 v[164:167], v[236:239], v[124:127], v[164:167]
    v_cvt_pk_bf16_f32 v16, v128, v132
    v_cvt_pk_bf16_f32 v17, v129, v133
    v_mfma_f32_16x16x32_bf16 v[172:175], v[212:215], v[124:127], v[172:175]
    v_cvt_pk_bf16_f32 v18, v130, v134
    v_cvt_pk_bf16_f32 v19, v131, v135
    v_mfma_f32_16x16x32_bf16 v[180:183], v[212:215], v[104:107], 0
    ds_write_b128 v9, v[16:19] offset:0
    v_cvt_pk_bf16_f32 v20, v136, v140
    v_mfma_f32_16x16x32_bf16 v[188:191], v[220:223], v[104:107], 0
    v_cvt_pk_bf16_f32 v21, v137, v141
    v_cvt_pk_bf16_f32 v22, v138, v142
    v_mfma_f32_16x16x32_bf16 v[180:183], v[236:239], v[108:111], v[180:183]
    v_cvt_pk_bf16_f32 v23, v139, v143
    ds_write_b128 v7, v[20:23] offset:0
    v_mfma_f32_16x16x32_bf16 v[188:191], v[212:215], v[108:111], v[188:191]
    ds_read_b128 v[48:51], v14 offset:0
    ds_read_b128 v[52:55], v14 offset:1024
    v_cvt_pk_bf16_f32 v24, v144, v148
    v_cvt_pk_bf16_f32 v25, v145, v149
    v_cvt_pk_bf16_f32 v26, v146, v150
    v_cvt_pk_bf16_f32 v27, v147, v151
    ds_write_b128 v9, v[24:27] offset:2048
    v_cvt_pk_bf16_f32 v28, v152, v156
    v_cvt_pk_bf16_f32 v29, v153, v157
    v_cvt_pk_bf16_f32 v30, v154, v158
    v_cvt_pk_bf16_f32 v31, v155, v159
    ds_write_b128 v7, v[28:31] offset:2048
    ds_read_b128 v[56:59], v14 offset:2048
    ds_read_b128 v[60:63], v14 offset:3072
    ds_read_b32 v6, v5
    v_cvt_pk_bf16_f32 v32, v160, v164
    v_cvt_pk_bf16_f32 v33, v161, v165
    v_cvt_pk_bf16_f32 v34, v162, v166
    v_cvt_pk_bf16_f32 v35, v163, v167
    s_mov_b32 s54, 0
L_drdy:
    s_waitcnt lgkmcnt(0)
    v_cmp_le_u32 vcc, 7, v6
    v_cmp_le_u32 s[58:59], 8, v6
    s_add_u32 s54, s54, 1
    s_cmp_ge_u32 s54, 320000
    s_cbranch_scc1 L_dgo
    s_cmp_eq_u32 vcc_lo, -1
    s_cbranch_scc1 L_dgo
    ds_read_b32 v6, v5
    s_branch L_drdy
L_dgo:
    v_lshrrev_b32_e64 v246, v246, s58
    v_bfe_u32 v3, v246, 0, 1
    v_lshl_add_u32 v242, v3, 13, v15
    v_bfe_u32 v3, v246, 16, 1
    v_lshl_add_u32 v243, v3, 13, v15
    v_bfe_u32 v3, v246, 1, 1
    v_lshl_add_u32 v244, v3, 13, v15
    v_bfe_u32 v3, v246, 17, 1
    v_lshl_add_u32 v245, v3, 13, v15
    s_mov_b32 s56, 0
    buffer_store_dwordx4 v[48:51], v242, s[20:23], s56 offen sc1
    s_mov_b32 s56, 16777216
    buffer_store_dwordx4 v[52:55], v243, s[20:23], s56 offen sc1
    ds_write_b128 v9, v[32:35] offset:4096
    v_cvt_pk_bf16_f32 v36, v168, v172
    v_cvt_pk_bf16_f32 v37, v169, v173
    v_cvt_pk_bf16_f32 v38, v170, v174
    v_cvt_pk_bf16_f32 v39, v171, v175
    ds_write_b128 v7, v[36:39] offset:4096
    ds_read_b128 v[64:67], v14 offset:4096
    ds_read_b128 v[68:71], v14 offset:5120
    s_mov_b32 s56, 4096
    buffer_store_dwordx4 v[56:59], v242, s[20:23], s56 offen sc1
    s_mov_b32 s56, 16781312
    buffer_store_dwordx4 v[60:63], v243, s[20:23], s56 offen sc1
    v_cvt_pk_bf16_f32 v40, v176, v180
    v_cvt_pk_bf16_f32 v41, v177, v181
    v_cvt_pk_bf16_f32 v42, v178, v182
    v_cvt_pk_bf16_f32 v43, v179, v183
    ds_write_b128 v9, v[40:43] offset:6144
    v_cvt_pk_bf16_f32 v44, v184, v188
    v_cvt_pk_bf16_f32 v45, v185, v189
    v_cvt_pk_bf16_f32 v46, v186, v190
    v_cvt_pk_bf16_f32 v47, v187, v191
    ds_write_b128 v7, v[44:47] offset:6144
    ds_read_b128 v[72:75], v14 offset:6144
    ds_read_b128 v[76:79], v14 offset:7168
    s_mov_b32 s56, 1048576
    s_waitcnt lgkmcnt(5)
    buffer_store_dwordx4 v[64:67], v244, s[20:23], s56 offen sc1
    s_mov_b32 s56, 17825792
    s_waitcnt lgkmcnt(4)
    buffer_store_dwordx4 v[68:71], v245, s[20:23], s56 offen sc1
    s_mov_b32 s56, 1052672
    s_waitcnt lgkmcnt(1)
    buffer_store_dwordx4 v[72:75], v244, s[20:23], s56 offen sc1
    s_mov_b32 s56, 17829888
    s_waitcnt lgkmcnt(0)
    buffer_store_dwordx4 v[76:79], v245, s[20:23], s56 offen sc1
    s_lshl_b32 s56, s35, 8
    s_add_u32 s56, s56, 804864
    v_and_b32 v6, 0x2000, v6
    v_lshl_add_u32 v3, v2, 20, v6
    v_add_u32 v3, s56, v3
    v_mov_b32 v4, 1
    s_waitcnt vmcnt(0)
    s_mov_b32 exec_hi, 0
    buffer_atomic_add v4, v3, s[20:23], 0 offen sc1
    s_mov_b64 exec, -1
    s_branch L_dft_end
L_dft_w7:
    s_lshl_b32 s56, s32, 2
    s_add_u32 s57, s58, 12032
    s_add_u32 s60, s58, 1792
    s_add_u32 s61, s60, 8192
    s_add_u32 s64, s60, 2048
    v_lshlrev_b32 v5, 2, v2
    v_add_u32 v253, 163328, v5
    ds_write_b32 v253, v15
    s_mov_b32 s65, 7
    s_mov_b32 s59, 0
    s_waitcnt vmcnt(8)
    s_atomic_or s65, s[46:47], s56
    s_waitcnt vmcnt(7)
    v_dot2_f32_bf16 v15, v16, v16, v15
    v_lshlrev_b32 v192, 16, v16
    v_and_b32 v193, v12, v16
    v_dot2_f32_bf16 v15, v17, v17, v15
    v_lshlrev_b32 v194, 16, v17
    v_and_b32 v195, v12, v17
    v_dot2_f32_bf16 v15, v18, v18, v15
    v_lshlrev_b32 v196, 16, v18
    v_and_b32 v197, v12, v18
    v_dot2_f32_bf16 v15, v19, v19, v15
    v_lshlrev_b32 v198, 16, v19
    v_and_b32 v199, v12, v19
    s_waitcnt vmcnt(6)
    v_dot2_f32_bf16 v15, v20, v20, v15
    v_lshlrev_b32 v200, 16, v20
    v_and_b32 v201, v12, v20
    v_dot2_f32_bf16 v15, v21, v21, v15
    v_lshlrev_b32 v202, 16, v21
    v_and_b32 v203, v12, v21
    v_dot2_f32_bf16 v15, v22, v22, v15
    v_lshlrev_b32 v204, 16, v22
    v_and_b32 v205, v12, v22
    v_dot2_f32_bf16 v15, v23, v23, v15
    v_lshlrev_b32 v206, 16, v23
    v_and_b32 v207, v12, v23
    s_waitcnt vmcnt(5)
    v_dot2_f32_bf16 v15, v24, v24, v15
    v_lshlrev_b32 v208, 16, v24
    v_and_b32 v209, v12, v24
    v_dot2_f32_bf16 v15, v25, v25, v15
    v_lshlrev_b32 v210, 16, v25
    v_and_b32 v211, v12, v25
    v_dot2_f32_bf16 v15, v26, v26, v15
    v_lshlrev_b32 v212, 16, v26
    v_and_b32 v213, v12, v26
    v_dot2_f32_bf16 v15, v27, v27, v15
    v_lshlrev_b32 v214, 16, v27
    v_and_b32 v215, v12, v27
    s_waitcnt vmcnt(4)
    v_dot2_f32_bf16 v15, v28, v28, v15
    v_lshlrev_b32 v216, 16, v28
    v_and_b32 v217, v12, v28
    v_dot2_f32_bf16 v15, v29, v29, v15
    v_lshlrev_b32 v218, 16, v29
    v_and_b32 v219, v12, v29
    v_dot2_f32_bf16 v15, v30, v30, v15
    v_lshlrev_b32 v220, 16, v30
    v_and_b32 v221, v12, v30
    v_dot2_f32_bf16 v15, v31, v31, v15
    v_lshlrev_b32 v222, 16, v31
    v_and_b32 v223, v12, v31
    v_mov_b32_dpp v3, v200 row_shr:1 row_mask:0xf bank_mask:0xf bound_ctrl:1
    v_mov_b32_dpp v242, v200 row_shl:7 row_mask:0xf bank_mask:0xf bound_ctrl:1
    v_bfi_b32 v200, v246, 0, v3
    v_mov_b32_dpp v3, v216 row_shr:1 row_mask:0xf bank_mask:0xf bound_ctrl:1
    v_mov_b32_dpp v243, v216 row_shl:7 row_mask:0xf bank_mask:0xf bound_ctrl:1
    v_bfi_b32 v216, v246, 0, v3
    v_add_f32 v224, v192, v216
    v_add_f32 v228, v208, v200
    v_sub_f32 v232, v192, v216
    v_sub_f32 v236, v208, v200
    v_add_f32 v225, v193, v223
    v_add_f32 v229, v209, v207
    v_sub_f32 v233, v193, v223
    v_sub_f32 v237, v209, v207
    v_add_f32 v226, v194, v222
    v_add_f32 v230, v210, v206
    v_sub_f32 v234, v194, v222
    v_sub_f32 v238, v210, v206
    v_add_f32 v227, v195, v221
    v_add_f32 v231, v211, v205
    v_sub_f32 v235, v195, v221
    v_sub_f32 v239, v211, v205
    v_pk_add_f32 v[48:49], v[224:225], v[228:229]
    v_pk_add_f32 v[56:57], v[232:233], v[236:237]
    v_sub_f32 v64, v224, v228
    v_sub_f32 v65, v225, v229
    v_sub_f32 v72, v232, v236
    v_sub_f32 v73, v233, v237
    v_pk_add_f32 v[244:245], v[244:245], v[48:49]
    v_pk_add_f32 v[50:51], v[226:227], v[230:231]
    v_pk_add_f32 v[58:59], v[234:235], v[238:239]
    v_sub_f32 v66, v226, v230
    v_sub_f32 v67, v227, v231
    v_sub_f32 v74, v234, v238
    v_sub_f32 v75, v235, v239
    v_pk_add_f32 v[244:245], v[244:245], v[50:51]
    v_add_f32 v224, v196, v220
    v_add_f32 v228, v212, v204
    v_sub_f32 v232, v196, v220
    v_sub_f32 v236, v212, v204
    v_add_f32 v225, v197, v219
    v_add_f32 v229, v213, v203
    v_sub_f32 v233, v197, v219
    v_sub_f32 v237, v213, v203
    v_add_f32 v226, v198, v218
    v_add_f32 v230, v214, v202
    v_sub_f32 v234, v198, v218
    v_sub_f32 v238, v214, v202
    v_add_f32 v227, v199, v217
    v_add_f32 v231, v215, v201
    v_sub_f32 v235, v199, v217
    v_sub_f32 v239, v215, v201
    v_pk_add_f32 v[52:53], v[224:225], v[228:229]
    v_pk_add_f32 v[60:61], v[232:233], v[236:237]
    v_sub_f32 v68, v224, v228
    v_sub_f32 v69, v225, v229
    v_sub_f32 v76, v232, v236
    v_sub_f32 v77, v233, v237
    v_pk_add_f32 v[244:245], v[244:245], v[52:53]
    v_pk_add_f32 v[54:55], v[226:227], v[230:231]
    v_pk_add_f32 v[62:63], v[234:235], v[238:239]
    v_sub_f32 v70, v226, v230
    v_sub_f32 v71, v227, v231
    v_sub_f32 v78, v234, v238
    v_sub_f32 v79, v235, v239
    v_pk_add_f32 v[244:245], v[244:245], v[54:55]
    s_waitcnt vmcnt(3)
    v_dot2_f32_bf16 v15, v32, v32, v15
    v_lshlrev_b32 v192, 16, v32
    v_and_b32 v193, v12, v32
    v_dot2_f32_bf16 v15, v33, v33, v15
    v_lshlrev_b32 v194, 16, v33
    v_and_b32 v195, v12, v33
    v_dot2_f32_bf16 v15, v34, v34, v15
    v_lshlrev_b32 v196, 16, v34
    v_and_b32 v197, v12, v34
    v_dot2_f32_bf16 v15, v35, v35, v15
    v_lshlrev_b32 v198, 16, v35
    v_and_b32 v199, v12, v35
    s_waitcnt vmcnt(2)
    v_dot2_f32_bf16 v15, v36, v36, v15
    v_lshlrev_b32 v200, 16, v36
    v_and_b32 v201, v12, v36
    v_dot2_f32_bf16 v15, v37, v37, v15
    v_lshlrev_b32 v202, 16, v37
    v_and_b32 v203, v12, v37
    v_dot2_f32_bf16 v15, v38, v38, v15
    v_lshlrev_b32 v204, 16, v38
    v_and_b32 v205, v12, v38
    v_dot2_f32_bf16 v15, v39, v39, v15
    v_lshlrev_b32 v206, 16, v39
    v_and_b32 v207, v12, v39
    s_waitcnt vmcnt(1)
    v_dot2_f32_bf16 v15, v40, v40, v15
    v_lshlrev_b32 v208, 16, v40
    v_and_b32 v209, v12, v40
    v_dot2_f32_bf16 v15, v41, v41, v15
    v_lshlrev_b32 v210, 16, v41
    v_and_b32 v211, v12, v41
    v_dot2_f32_bf16 v15, v42, v42, v15
    v_lshlrev_b32 v212, 16, v42
    v_and_b32 v213, v12, v42
    v_dot2_f32_bf16 v15, v43, v43, v15
    v_lshlrev_b32 v214, 16, v43
    v_and_b32 v215, v12, v43
    s_waitcnt vmcnt(0)
    v_dot2_f32_bf16 v15, v44, v44, v15
    v_lshlrev_b32 v216, 16, v44
    v_and_b32 v217, v12, v44
    v_dot2_f32_bf16 v15, v45, v45, v15
    v_lshlrev_b32 v218, 16, v45
    v_and_b32 v219, v12, v45
    v_dot2_f32_bf16 v15, v46, v46, v15
    v_lshlrev_b32 v220, 16, v46
    v_and_b32 v221, v12, v46
    v_dot2_f32_bf16 v15, v47, v47, v15
    v_lshlrev_b32 v222, 16, v47
    v_and_b32 v223, v12, v47
    v_mov_b32_dpp v3, v200 row_shr:1 row_mask:0xf bank_mask:0xf bound_ctrl:1
    v_bfi_b32 v200, v246, v242, v3
    v_mov_b32_dpp v3, v216 row_shr:1 row_mask:0xf bank_mask:0xf bound_ctrl:1
    v_bfi_b32 v216, v246, v243, v3
    v_add_f32 v224, v192, v216
    v_add_f32 v228, v208, v200
    v_sub_f32 v232, v192, v216
    v_sub_f32 v236, v208, v200
    v_add_f32 v225, v193, v223
    v_add_f32 v229, v209, v207
    v_sub_f32 v233, v193, v223
    v_sub_f32 v237, v209, v207
    v_add_f32 v226, v194, v222
    v_add_f32 v230, v210, v206
    v_sub_f32 v234, v194, v222
    v_sub_f32 v238, v210, v206
    v_add_f32 v227, v195, v221
    v_add_f32 v231, v211, v205
    v_sub_f32 v235, v195, v221
    v_sub_f32 v239, v211, v205
    v_pk_add_f32 v[80:81], v[224:225], v[228:229]
    v_pk_add_f32 v[88:89], v[232:233], v[236:237]
    v_sub_f32 v96, v224, v228
    v_sub_f32 v97, v225, v229
    v_sub_f32 v104, v232, v236
    v_sub_f32 v105, v233, v237
    v_pk_add_f32 v[244:245], v[244:245], v[80:81]
    v_pk_add_f32 v[82:83], v[226:227], v[230:231]
    v_pk_add_f32 v[90:91], v[234:235], v[238:239]
    v_sub_f32 v98, v226, v230
    v_sub_f32 v99, v227, v231
    v_sub_f32 v106, v234, v238
    v_sub_f32 v107, v235, v239
    v_pk_add_f32 v[244:245], v[244:245], v[82:83]
    v_add_f32 v224, v196, v220
    v_add_f32 v228, v212, v204
    v_sub_f32 v232, v196, v220
    v_sub_f32 v236, v212, v204
    v_add_f32 v225, v197, v219
    v_add_f32 v229, v213, v203
    v_sub_f32 v233, v197, v219
    v_sub_f32 v237, v213, v203
    v_add_f32 v226, v198, v218
    v_add_f32 v230, v214, v202
    v_sub_f32 v234, v198, v218
    v_sub_f32 v238, v214, v202
    v_add_f32 v227, v199, v217
    v_add_f32 v231, v215, v201
    v_sub_f32 v235, v199, v217
    v_sub_f32 v239, v215, v201
    v_pk_add_f32 v[84:85], v[224:225], v[228:229]
    v_pk_add_f32 v[92:93], v[232:233], v[236:237]
    v_sub_f32 v100, v224, v228
    v_sub_f32 v101, v225, v229
    v_sub_f32 v108, v232, v236
    v_sub_f32 v109, v233, v237
    v_pk_add_f32 v[244:245], v[244:245], v[84:85]
    v_pk_add_f32 v[86:87], v[226:227], v[230:231]
    v_pk_add_f32 v[94:95], v[234:235], v[238:239]
    v_sub_f32 v102, v226, v230
    v_sub_f32 v103, v227, v231
    v_sub_f32 v110, v234, v238
    v_sub_f32 v111, v235, v239
    v_pk_add_f32 v[244:245], v[244:245], v[86:87]
    v_add_f32 v14, v244, v245
    s_nop 1
    v_add_f32_dpp v14, v14, v14 quad_perm:[1,0,3,2] row_mask:0xf bank_mask:0xf
    v_add_f32_dpp v15, v15, v15 quad_perm:[1,0,3,2] row_mask:0xf bank_mask:0xf
    s_nop 0
    v_add_f32_dpp v14, v14, v14 quad_perm:[2,3,0,1] row_mask:0xf bank_mask:0xf
    v_add_f32_dpp v15, v15, v15 quad_perm:[2,3,0,1] row_mask:0xf bank_mask:0xf
    s_nop 0
    v_add_f32_dpp v14, v14, v14 row_half_mirror row_mask:0xf bank_mask:0xf
    v_add_f32_dpp v15, v15, v15 row_half_mirror row_mask:0xf bank_mask:0xf
    s_nop 0
    v_mul_f32 v13, 0xbb124925, v14
    v_mul_f32 v15, 0x3b124925, v15
    v_fma_f32 v15, -v13, v13, v15
    v_max_f32 v15, 0, v15
    v_add_f32 v15, 0x3727c5ac, v15
    v_rsq_f32 v14, v15
    v_cvt_pk_bf16_f32 v224, v13, v13
    v_and_b32 v3, v12, v224
    v_sub_f32 v3, v13, v3
    v_cvt_pk_bf16_f32 v224, v13, v3
    v_mov_b32 v225, v224
    buffer_store_dwordx2 v[224:225], v255, s[20:23], s53 offen sc1
    buffer_store_dword v14, v254, s[20:23], s53 offen offset:512 sc1
    v_mul_f32 v13, 4.0, v13
    v_mov_b32 v15, v14
    v_mul_f32 v240, v13, v14
    v_mul_f32 v241, v13, v14
    v_mul_f32 v242, v240, v247
    v_mov_b32 v243, v240
    v_mul_f32 v244, v240, v252
    v_mov_b32 v245, v240
    v_pk_fma_f32 v[48:49], v[48:49], v[14:15], v[242:243]
    v_cvt_pk_bf16_f32 v16, v48, v49
    v_pk_fma_f32 v[50:51], v[50:51], v[14:15], v[240:241]
    v_cvt_pk_bf16_f32 v17, v50, v51
    v_pk_fma_f32 v[52:53], v[52:53], v[14:15], v[240:241]
    v_cvt_pk_bf16_f32 v18, v52, v53
    v_pk_fma_f32 v[54:55], v[54:55], v[14:15], v[240:241]
    v_cvt_pk_bf16_f32 v19, v54, v55
    ds_write_b128 v9, v[16:19] offset:0
    v_pk_fma_f32 v[80:81], v[80:81], v[14:15], v[244:245]
    v_cvt_pk_bf16_f32 v20, v80, v81
    v_pk_fma_f32 v[82:83], v[82:83], v[14:15], v[240:241]
    v_cvt_pk_bf16_f32 v21, v82, v83
    v_pk_fma_f32 v[84:85], v[84:85], v[14:15], v[240:241]
    v_cvt_pk_bf16_f32 v22, v84, v85
    v_pk_fma_f32 v[86:87], v[86:87], v[14:15], v[240:241]
    v_cvt_pk_bf16_f32 v23, v86, v87
    ds_write_b128 v9, v[20:23] offset:8192
    v_pk_mul_f32 v[56:57], v[56:57], v[14:15]
    v_cvt_pk_bf16_f32 v24, v56, v57
    v_pk_mul_f32 v[58:59], v[58:59], v[14:15]
    v_cvt_pk_bf16_f32 v25, v58, v59
    v_pk_mul_f32 v[60:61], v[60:61], v[14:15]
    v_cvt_pk_bf16_f32 v26, v60, v61
    v_pk_mul_f32 v[62:63], v[62:63], v[14:15]
    v_cvt_pk_bf16_f32 v27, v62, v63
    ds_write_b128 v9, v[24:27] offset:16384
    v_pk_mul_f32 v[88:89], v[88:89], v[14:15]
    v_cvt_pk_bf16_f32 v28, v88, v89
    v_pk_mul_f32 v[90:91], v[90:91], v[14:15]
    v_cvt_pk_bf16_f32 v29, v90, v91
    v_pk_mul_f32 v[92:93], v[92:93], v[14:15]
    v_cvt_pk_bf16_f32 v30, v92, v93
    v_pk_mul_f32 v[94:95], v[94:95], v[14:15]
    v_cvt_pk_bf16_f32 v31, v94, v95
    ds_write_b128 v9, v[28:31] offset:24576
    v_pk_mul_f32 v[64:65], v[64:65], v[14:15]
    v_cvt_pk_bf16_f32 v32, v64, v65
    v_pk_mul_f32 v[66:67], v[66:67], v[14:15]
    v_cvt_pk_bf16_f32 v33, v66, v67
    v_pk_mul_f32 v[68:69], v[68:69], v[14:15]
    v_cvt_pk_bf16_f32 v34, v68, v69
    v_pk_mul_f32 v[70:71], v[70:71], v[14:15]
    v_cvt_pk_bf16_f32 v35, v70, v71
    ds_write_b128 v9, v[32:35] offset:32768
    v_pk_mul_f32 v[96:97], v[96:97], v[14:15]
    v_cvt_pk_bf16_f32 v36, v96, v97
    v_pk_mul_f32 v[98:99], v[98:99], v[14:15]
    v_cvt_pk_bf16_f32 v37, v98, v99
    v_pk_mul_f32 v[100:101], v[100:101], v[14:15]
    v_cvt_pk_bf16_f32 v38, v100, v101
    v_pk_mul_f32 v[102:103], v[102:103], v[14:15]
    v_cvt_pk_bf16_f32 v39, v102, v103
    ds_write_b128 v9, v[36:39] offset:40960
    v_pk_mul_f32 v[72:73], v[72:73], v[14:15]
    v_cvt_pk_bf16_f32 v40, v72, v73
    v_pk_mul_f32 v[74:75], v[74:75], v[14:15]
    v_cvt_pk_bf16_f32 v41, v74, v75
    v_pk_mul_f32 v[76:77], v[76:77], v[14:15]
    v_cvt_pk_bf16_f32 v42, v76, v77
    v_pk_mul_f32 v[78:79], v[78:79], v[14:15]
    v_cvt_pk_bf16_f32 v43, v78, v79
    ds_write_b128 v9, v[40:43] offset:49152
    v_pk_mul_f32 v[104:105], v[104:105], v[14:15]
    v_cvt_pk_bf16_f32 v44, v104, v105
    v_pk_mul_f32 v[106:107], v[106:107], v[14:15]
    v_cvt_pk_bf16_f32 v45, v106, v107
    v_pk_mul_f32 v[108:109], v[108:109], v[14:15]
    v_cvt_pk_bf16_f32 v46, v108, v109
    v_pk_mul_f32 v[110:111], v[110:111], v[14:15]
    v_cvt_pk_bf16_f32 v47, v110, v111
    ds_write_b128 v9, v[44:47] offset:57344
    s_waitcnt vmcnt(0) lgkmcnt(0)
    s_barrier
    v_mov_b32 v4, 7
    s_mov_b64 exec, 1
    buffer_atomic_or v4, off, s[20:23], s64 sc1
    s_mov_b64 exec, -1
    buffer_load_dword v6, v5, s[28:31], 0 offen sc1
    s_waitcnt lgkmcnt(0)
    s_mov_b32 s63, 1
    s_load_dword s62, s[48:49], s60 glc
    s_load_dword s63, s[48:49], s61 glc
    s_waitcnt lgkmcnt(1)
    s_nop 7
    s_cmp_eq_u32 s63, 0
    s_addc_u32 s59, s59, 0
    s_waitcnt lgkmcnt(0)
    s_mov_b32 s63, 1
    s_load_dword s62, s[48:49], s60 glc
    s_load_dword s63, s[48:49], s61 glc
    s_waitcnt lgkmcnt(1)
    s_nop 7
    s_cmp_eq_u32 s63, 0
    s_addc_u32 s59, s59, 0
    s_cmp_gt_u32 s59, 1
    s_cselect_b32 s65, 0x2007, 7
    s_atomic_or s65, s[48:49], s57
    v_lshlrev_b32 v3, 20, v2
    s_mov_b32 s56, 814848
    s_mov_b32 s54, 0
    s_mov_b32 exec_hi, 0
    s_branch L_w7in
L_w7all0:
    buffer_load_dword v6, v5, s[28:31], 0 offen sc1
L_w7in:
    s_add_u32 s54, s54, 1
    s_waitcnt vmcnt(0) lgkmcnt(0)
    v_cmp_le_u32 vcc, 7, v6
    s_cmp_ge_u32 s54, 20000
    s_cbranch_scc1 L_w7out
    s_cmp_eq_u32 vcc_lo, -1
    s_cbranch_scc0 L_w7all0
L_w7all1:
    buffer_load_dword v6, v3, s[20:23], s56 offen sc1
    s_add_u32 s54, s54, 1
    s_waitcnt vmcnt(0) lgkmcnt(0)
    v_cmp_le_u32 vcc, 7, v6
    s_cmp_ge_u32 s54, 20000
    s_cbranch_scc1 L_w7out
    s_cmp_eq_u32 vcc_lo, -1
    s_cbranch_scc0 L_w7all1
    ds_write_b32 v253, v6
L_w7out:
    s_mov_b64 exec, -1
L_dft_end:
L_end:
    s_endpgm
.p2align 8
.type L_tab,@object
L_tab:
.quad 0x3f803f803f803f80,0x3f803f803f803f80
.quad 0x3f553f6d3f7b3f80,0xbf55bf6dbf7bbf80
.quad 0x3ec43f353f6d3f80,0x3ec43f353f6d3f80
.quad 0xbe483ec43f553f80,0x3e48bec4bf55bf80
.quad 0xbf35248d3f353f80,0xbf35248d3f353f80
.quad 0xbf7bbec43f0e3f80,0x3f7b3ec4bf0ebf80
.quad 0xbf6dbf353ec43f80,0xbf6dbf353ec43f80
.quad 0xbf0ebf6d3e483f80,0x3f0e3f6dbe48bf80
.quad 0xa554bf80248d3f80,0xa554bf80248d3f80
.quad 0x3f0ebf6dbe483f80,0xbf0e3f6d3e48bf80
.quad 0x3f6dbf35bec43f80,0x3f6dbf35bec43f80
.quad 0x3f7bbec4bf0e3f80,0xbf7b3ec43f0ebf80
.quad 0x3f35a554bf353f80,0x3f35a554bf353f80
.quad 0x3e483ec4bf553f80,0xbe48bec43f55bf80
.quad 0xbec43f35bf6d3f80,0xbec43f35bf6d3f80
.quad 0xbf553f6dbf7b3f80,0x3f55bf6d3f7bbf80
.quad 0x3f803f803f803f80,0x3f803f803f803f80
.quad 0x3e483ec43f0e3f35,0xbe48bec4bf0ebf35
.quad 0xbf6dbf35bec4248d,0xbf6dbf35bec4248d
.quad 0xbf0ebf6dbf7bbf35,0x3f0e3f6d3f7b3f35
.quad 0x3f35a554bf35bf80,0x3f35a554bf35bf80
.quad 0x3f553f6d3e48bf35,0xbf55bf6dbe483f35
.quad 0xbec43f353f6da554,0xbec43f353f6da554
.quad 0xbf7bbec43f553f35,0x3f7b3ec4bf55bf35
.quad 0xa554bf80248d3f80,0xa554bf80248d3f80
.quad 0x3f7bbec4bf553f35,0xbf7b3ec43f55bf35
.quad 0x3ec43f35bf6d248d,0x3ec43f35bf6d248d
.quad 0xbf553f6dbe48bf35,0x3f55bf6d3e483f35
.quad 0xbf35248d3f35bf80,0xbf35248d3f35bf80
.quad 0x3f0ebf6d3f7bbf35,0xbf0e3f6dbf7b3f35
.quad 0x3f6dbf353ec4a554,0x3f6dbf353ec4a554
.quad 0xbe483ec4bf0e3f35,0x3e48bec43f0ebf35
.quad 0x3f803f803f803f80,0x3f803f803f803f80
.quad 0xbf0ebec4be48248d,0x3f0e3ec43e48a554
.quad 0xbec4bf35bf6dbf80,0xbec4bf35bf6dbf80
.quad 0x3f7b3f6d3f0ea554,0xbf7bbf6dbf0e248d
.quad 0xbf35248d3f353f80,0xbf35248d3f353f80
.quad 0xbe48bf6dbf55248d,0x3e483f6d3f55a554
.quad 0x3f6d3f35bec4bf80,0x3f6d3f35bec4bf80
.quad 0xbf553ec43f7ba554,0x3f55bec4bf7b248d
.quad 0xa554bf80248d3f80,0xa554bf80248d3f80
.quad 0x3f553ec4bf7b248d,0xbf55bec43f7ba554
.quad 0xbf6d3f353ec4bf80,0xbf6d3f353ec4bf80
.quad 0x3e48bf6d3f55a554,0xbe483f6dbf55248d
.quad 0x3f35a554bf353f80,0x3f35a554bf353f80
.quad 0xbf7b3f6dbf0e248d,0x3f7bbf6d3f0ea554
.quad 0x3ec4bf353f6dbf80,0x3ec4bf353f6dbf80
.quad 0x3f0ebec43e48a554,0xbf0e3ec4be48248d
.quad 0x3f803f803f803f80,0x3f803f803f803f80
.quad 0xbf7bbf6dbf55bf35,0x3f7b3f6d3f553f35
.quad 0x3f6d3f353ec4a554,0x3f6d3f353ec4a554
.quad 0xbf55bec43e483f35,0x3f553ec4be48bf35
.quad 0x3f35a554bf35bf80,0x3f35a554bf35bf80
.quad 0xbf0e3ec43f7b3f35,0x3f0ebec4bf7bbf35
.quad 0x3ec4bf35bf6d248d,0x3ec4bf35bf6d248d
.quad 0xbe483f6d3f0ebf35,0x3e48bf6dbf0e3f35
.quad 0xa554bf80248d3f80,0xa554bf80248d3f80
.quad 0x3e483f6dbf0ebf35,0xbe48bf6d3f0e3f35
.quad 0xbec4bf353f6da554,0xbec4bf353f6da554
.quad 0x3f0e3ec4bf7b3f35,0xbf0ebec43f7bbf35
.quad 0xbf35248d3f35bf80,0xbf35248d3f35bf80
.quad 0x3f55bec4be483f35,0xbf553ec43e48bf35
.quad 0xbf6d3f35bec4248d,0xbf6d3f35bec4248d
.quad 0x3f7bbf6d3f55bf35,0xbf7b3f6dbf553f35
.quad 0x8000800080008000,0x8000800080008000
.quad 0xbf0ebec4be488000,0x3f0e3ec43e48a50d
.quad 0xbf6dbf35bec48000,0xbf6dbf35bec48000
.quad 0xbf7bbf6dbf0e8000,0x3f7b3f6d3f0ea50d
.quad 0xbf35bf80bf358000,0xbf35bf80bf358000
.quad 0xbe48bf6dbf558000,0x3e483f6d3f55a50d
.quad 0x3ec4bf35bf6d8000,0x3ec4bf35bf6d8000
.quad 0x3f55bec4bf7b8000,0xbf553ec43f7ba50d
.quad 0x3f80a50dbf808000,0x3f80a50dbf808000
.quad 0x3f553ec4bf7b8000,0xbf55bec43f7ba50d
.quad 0x3ec43f35bf6d8000,0x3ec43f35bf6d8000
.quad 0xbe483f6dbf558000,0x3e48bf6d3f55a50d
.quad 0xbf353f80bf358000,0xbf353f80bf358000
.quad 0xbf7b3f6dbf0e8000,0x3f7bbf6d3f0ea50d
.quad 0xbf6d3f35bec48000,0xbf6d3f35bec48000
.quad 0xbf0e3ec4be488000,0x3f0ebec43e48a50d
.quad 0x8000800080008000,0x8000800080008000
.quad 0xbf7bbf6dbf55bf35,0x3f7b3f6d3f553f35
.quad 0xbec4bf35bf6dbf80,0xbec4bf35bf6dbf80
.quad 0x3f553ec4be48bf35,0xbf55bec43e483f35
.quad 0x3f353f803f35a50d,0x3f353f803f35a50d
.quad 0xbf0e3ec43f7b3f35,0x3f0ebec4bf7bbf35
.quad 0xbf6dbf353ec43f80,0xbf6dbf353ec43f80
.quad 0x3e48bf6dbf0e3f35,0xbe483f6d3f0ebf35
.quad 0x3f80a50dbf808000,0x3f80a50dbf808000
.quad 0x3e483f6dbf0ebf35,0xbe48bf6d3f0e3f35
.quad 0xbf6d3f353ec4bf80,0xbf6d3f353ec4bf80
.quad 0xbf0ebec43f7bbf35,0x3f0e3ec4bf7b3f35
.quad 0x3f35bf803f35a50d,0x3f35bf803f35a50d
.quad 0x3f55bec4be483f35,0xbf553ec43e48bf35
.quad 0xbec43f35bf6d3f80,0xbec43f35bf6d3f80
.quad 0xbf7b3f6dbf553f35,0x3f7bbf6d3f55bf35
.quad 0x8000800080008000,0x8000800080008000
.quad 0xbf55bf6dbf7bbf80,0x3f553f6d3f7b3f80
.quad 0x3f6d3f353ec4a50d,0x3f6d3f353ec4a50d
.quad 0xbe483ec43f553f80,0x3e48bec4bf55bf80
.quad 0xbf35bf80bf358000,0xbf35bf80bf358000
.quad 0x3f7b3ec4bf0ebf80,0xbf7bbec43f0e3f80
.quad 0xbec43f353f6da50d,0xbec43f353f6da50d
.quad 0xbf0ebf6d3e483f80,0x3f0e3f6dbe48bf80
.quad 0x3f80a50dbf808000,0x3f80a50dbf808000
.quad 0xbf0e3f6d3e48bf80,0x3f0ebf6dbe483f80
.quad 0xbec4bf353f6da50d,0xbec4bf353f6da50d
.quad 0x3f7bbec4bf0e3f80,0xbf7b3ec43f0ebf80
.quad 0xbf353f80bf358000,0xbf353f80bf358000
.quad 0xbe48bec43f55bf80,0x3e483ec4bf553f80
.quad 0x3f6dbf353ec4a50d,0x3f6dbf353ec4a50d
.quad 0xbf553f6dbf7b3f80,0x3f55bf6d3f7bbf80
.quad 0x8000800080008000,0x8000800080008000
.quad 0xbe48bec4bf0ebf35,0x3e483ec43f0e3f35
.quad 0x3ec43f353f6d3f80,0x3ec43f353f6d3f80
.quad 0xbf0ebf6dbf7bbf35,0x3f0e3f6d3f7b3f35
.quad 0x3f353f803f35a50d,0x3f353f803f35a50d
.quad 0xbf55bf6dbe483f35,0x3f553f6d3e48bf35
.quad 0x3f6d3f35bec4bf80,0x3f6d3f35bec4bf80
.quad 0xbf7bbec43f553f35,0x3f7b3ec4bf55bf35
.quad 0x3f80a50dbf808000,0x3f80a50dbf808000
.quad 0xbf7b3ec43f55bf35,0x3f7bbec4bf553f35
.quad 0x3f6dbf35bec43f80,0x3f6dbf35bec43f80
.quad 0xbf553f6dbe48bf35,0x3f55bf6d3e483f35
.quad 0x3f35bf803f35a50d,0x3f35bf803f35a50d
.quad 0xbf0e3f6dbf7b3f35,0x3f0ebf6d3f7bbf35
.quad 0x3ec4bf353f6dbf80,0x3ec4bf353f6dbf80
.quad 0xbe483ec4bf0e3f35,0x3e48bec43f0ebf35
.quad 0x3f753f7b3f7f3f80,0xbe95be48bdc9248d
.quad 0x3f223f553f753f80,0x3f463f0e3e95a554
.quad 0x3dc93f0e3f623f80,0xbf7fbf55bef1248d
.quad 0xbef13e483f463f80,0x3f623f7b3f22a554
.quad 0xbf62be483f223f80,0xbef1bf7bbf46248d
.quad 0xbf7fbf0e3ef13f80,0xbdc93f553f62a554
.quad 0xbf46bf553e953f80,0x3f22bf0ebf75248d
.quad 0xbe95bf7b3dc93f80,0xbf753e483f7fa554
.quad 0x3e95bf7bbdc93f80,0x3f753e48bf7f248d
.quad 0x3f46bf55be953f80,0xbf22bf0e3f75a554
.quad 0x3f7fbf0ebef13f80,0x3dc93f55bf62248d
.quad 0x3f62be48bf223f80,0x3ef1bf7b3f46a554
.quad 0x3ef13e48bf463f80,0xbf623f7bbf22248d
.quad 0xbdc93f0ebf623f80,0x3f7fbf553ef1a554
.quad 0xbf223f55bf753f80,0xbf463f0ebe95248d
.quad 0xbf753f7bbf7f3f80,0x3e95be483dc9a554
.quad 0x3f463f553f623f6d,0xbf22bf0ebef1bec4
.quad 0xbef1be483dc93ec4,0x3f623f7b3f7f3f6d
.quad 0xbf75bf7bbf46bec4,0x3e95be48bf22bf6d
.quad 0x3dc9bf0ebf75bf6d,0xbf7fbf55be953ec4
.quad 0x3f7f3f0ebe95bf6d,0x3dc93f553f753ec4
.quad 0x3e953f7b3f22bec4,0x3f753e48bf46bf6d
.quad 0xbf623e483f7f3ec4,0xbef1bf7bbdc93f6d
.quad 0xbf22bf553ef13f6d,0xbf463f0e3f62bec4
.quad 0x3f22bf55bef13f6d,0x3f463f0ebf62bec4
.quad 0x3f623e48bf7f3ec4,0x3ef1bf7b3dc93f6d
.quad 0xbe953f7bbf22bec4,0xbf753e483f46bf6d
.quad 0xbf7f3f0e3e95bf6d,0xbdc93f55bf753ec4
.quad 0xbdc9bf0e3f75bf6d,0x3f7fbf553e953ec4
.quad 0x3f75bf7b3f46bec4,0xbe95be483f22bf6d
.quad 0x3ef1be48bdc93ec4,0xbf623f7bbf7f3f6d
.quad 0xbf463f55bf623f6d,0x3f22bf0e3ef1bec4
.quad 0x3ef13f0e3f223f35,0xbf62bf55bf46bf35
.quad 0xbf7fbf7bbf62bf35,0xbdc93e483ef13f35
.quad 0x3f223e48be95bf35,0x3f463f7b3f753f35
.quad 0x3e953f553f7f3f35,0x3f753f0ebdc9bf35
.quad 0xbf75bf55bdc93f35,0x3e95bf0ebf7fbf35
.quad 0x3f46be48bf75bf35,0xbf22bf7bbe953f35
.quad 0x3dc93f7b3ef1bf35,0xbf7fbe483f623f35
.quad 0xbf62bf0e3f463f35,0xbef13f553f22bf35
.quad 0x3f62bf0ebf463f35,0x3ef13f55bf22bf35
.quad 0xbdc93f7bbef1bf35,0x3f7fbe48bf623f35
.quad 0xbf46be483f75bf35,0x3f22bf7b3e953f35
.quad 0x3f75bf553dc93f35,0xbe95bf0e3f7fbf35
.quad 0xbe953f55bf7f3f35,0xbf753f0e3dc9bf35
.quad 0xbf223e483e95bf35,0xbf463f7bbf753f35
.quad 0x3f7fbf7b3f62bf35,0x3dc93e48bef13f35
.quad 0xbef13f0ebf223f35,0x3f62bf553f46bf35
.quad 0x3dc93e483e953ec4,0xbf7fbf7bbf75bf6d
.quad 0xbe95bf0ebf46bf6d,0xbf75bf55bf22bec4
.quad 0x3ef13f553f7f3f6d,0xbf62bf0ebdc93ec4
.quad 0xbf22bf7bbf62bec4,0xbf46be483ef13f6d
.quad 0x3f463f7b3ef1bec4,0xbf223e483f623f6d
.quad 0xbf62bf553dc93f6d,0xbef13f0e3f7f3ec4
.quad 0x3f753f0ebf22bf6d,0xbe953f553f46bec4
.quad 0xbf7fbe483f753ec4,0xbdc93f7b3e95bf6d
.quad 0x3f7fbe48bf753ec4,0x3dc93f7bbe95bf6d
.quad 0xbf753f0e3f22bf6d,0x3e953f55bf46bec4
.quad 0x3f62bf55bdc93f6d,0x3ef13f0ebf7f3ec4
.quad 0xbf463f7bbef1bec4,0x3f223e48bf623f6d
.quad 0x3f22bf7b3f62bec4,0x3f46be48bef13f6d
.quad 0xbef13f55bf7f3f6d,0x3f62bf0e3dc93ec4
.quad 0x3e95bf0e3f46bf6d,0x3f75bf553f22bec4
.quad 0xbdc93e48be953ec4,0x3f7fbf7b3f75bf6d
.quad 0xbe95be48bdc98000,0xbf75bf7bbf7fbf80
.quad 0xbf46bf0ebe958000,0x3f223f553f753f80
.quad 0xbf7fbf55bef18000,0xbdc9bf0ebf62bf80
.quad 0xbf62bf7bbf228000,0xbef13e483f463f80
.quad 0xbef1bf7bbf468000,0x3f623e48bf22bf80
.quad 0x3dc9bf55bf628000,0xbf7fbf0e3ef13f80
.quad 0x3f22bf0ebf758000,0x3f463f55be95bf80
.quad 0x3f75be48bf7f8000,0xbe95bf7b3dc93f80
.quad 0x3f753e48bf7f8000,0xbe953f7b3dc9bf80
.quad 0x3f223f0ebf758000,0x3f46bf55be953f80
.quad 0x3dc93f55bf628000,0xbf7f3f0e3ef1bf80
.quad 0xbef13f7bbf468000,0x3f62be48bf223f80
.quad 0xbf623f7bbf228000,0xbef1be483f46bf80
.quad 0xbf7f3f55bef18000,0xbdc93f0ebf623f80
.quad 0xbf463f0ebe958000,0x3f22bf553f75bf80
.quad 0xbe953e48bdc98000,0xbf753f7bbf7f3f80
.quad 0xbf22bf0ebef1bec4,0xbf46bf55bf62bf6d
.quad 0xbf62bf7bbf7fbf6d,0xbef1be483dc93ec4
.quad 0x3e95be48bf22bf6d,0x3f753f7b3f463ec4
.quad 0x3f7f3f553e95bec4,0x3dc9bf0ebf75bf6d
.quad 0x3dc93f553f753ec4,0xbf7fbf0e3e953f6d
.quad 0xbf75be483f463f6d,0x3e953f7b3f22bec4
.quad 0xbef1bf7bbdc93f6d,0x3f62be48bf7fbec4
.quad 0x3f46bf0ebf623ec4,0xbf22bf553ef13f6d
.quad 0x3f463f0ebf62bec4,0xbf223f553ef1bf6d
.quad 0xbef13f7bbdc9bf6d,0x3f623e48bf7f3ec4
.quad 0xbf753e483f46bf6d,0x3e95bf7b3f223ec4
.quad 0x3dc9bf553f75bec4,0xbf7f3f0e3e95bf6d
.quad 0x3f7fbf553e953ec4,0x3dc93f0ebf753f6d
.quad 0x3e953e48bf223f6d,0x3f75bf7b3f46bec4
.quad 0xbf623f7bbf7f3f6d,0xbef13e483dc9bec4
.quad 0xbf223f0ebef13ec4,0xbf463f55bf623f6d
.quad 0xbf62bf55bf46bf35,0xbef1bf0ebf22bf35
.quad 0x3dc9be48bef1bf35,0xbf7fbf7bbf62bf35
.quad 0x3f463f7b3f753f35,0xbf22be483e953f35
.quad 0xbf75bf0e3dc93f35,0x3e953f553f7f3f35
.quad 0x3e95bf0ebf7fbf35,0x3f753f553dc9bf35
.quad 0x3f223f7b3e95bf35,0x3f46be48bf75bf35
.quad 0xbf7fbe483f623f35,0xbdc9bf7bbef13f35
.quad 0x3ef1bf55bf223f35,0xbf62bf0e3f463f35
.quad 0x3ef13f55bf22bf35,0xbf623f0e3f46bf35
.quad 0xbf7f3e483f62bf35,0xbdc93f7bbef1bf35
.quad 0x3f22bf7b3e953f35,0x3f463e48bf753f35
.quad 0x3e953f0ebf7f3f35,0x3f75bf553dc93f35
.quad 0xbf753f0e3dc9bf35,0x3e95bf553f7fbf35
.quad 0x3f46bf7b3f75bf35,0xbf223e483e95bf35
.quad 0x3dc93e48bef13f35,0xbf7f3f7bbf623f35
.quad 0xbf623f55bf463f35,0xbef13f0ebf223f35
.quad 0xbf7fbf7bbf75bf6d,0xbdc9be48be95bec4
.quad 0x3f753f553f223ec4,0xbe95bf0ebf46bf6d
.quad 0xbf62bf0ebdc93ec4,0xbef1bf55bf7fbf6d
.quad 0x3f463e48bef1bf6d,0xbf22bf7bbf62bec4
.quad 0xbf223e483f623f6d,0xbf46bf7bbef13ec4
.quad 0x3ef1bf0ebf7fbec4,0xbf62bf553dc93f6d
.quad 0xbe953f553f46bec4,0xbf75bf0e3f223f6d
.quad 0x3dc9bf7bbe953f6d,0xbf7fbe483f753ec4
.quad 0x3dc93f7bbe95bf6d,0xbf7f3e483f75bec4
.quad 0xbe95bf553f463ec4,0xbf753f0e3f22bf6d
.quad 0x3ef13f0ebf7f3ec4,0xbf623f553dc9bf6d
.quad 0xbf22be483f62bf6d,0xbf463f7bbef1bec4
.quad 0x3f46be48bef13f6d,0xbf223f7bbf623ec4
.quad 0xbf623f0ebdc9bec4,0xbef13f55bf7f3f6d
.quad 0x3f75bf553f22bec4,0xbe953f0ebf463f6d
.quad 0xbf7f3f7bbf753f6d,0xbdc93e48be953ec4
.quad 0xbf803f80bf803f80,0xbf803f80bf803f80,0x3f7f3f803f803f80,0x3f7b3f7c3f7d3f7e,0x3f7c3f7e3f803f80,0x3f6d3f723f763f7a,0x3f783f7c3f7f3f80,0x3f553f603f6a3f72,0x3f723f7a3f7e3f80,0x3f353f483f593f67,0x3f6a3f763f7d3f80,0x3f0e3f2b3f443f59,0x3f603f723f7c3f80,0x3ec43f083f2b3f48,0x3f553f6d3f7b3f80,0x3e483ec43f0e3f35
.quad 0x3f483f673f7a3f80,0x3e643ede3f20,0x3f3a3f603f783f80,0xbe483d663e9b3f08,0x3f2b3f593f763f80,0xbec4bde53e2c3ede,0x3f1a3f513f743f80,0xbf0ebe8e3ce63ea9,0x3f083f483f723f80,0xbf35bedebde53e64,0x3eeb3f3f3f6f3f80,0xbf55bf14be803de5,0x3ec43f353f6d3f80,0xbf6dbf35bec40000,0x3e9b3f2b3f6a3f80,0xbf7bbf51bf02bde5
.quad 0xbf803f80bf803f80,0xbf803f80bf803f80,0x3f743f763f783f7a,0x3f6a3f6d3f6f3f72,0x3f513f593f603f67,0x3f2b3f353f3f3f48,0x3f1a3f2b3f3a3f48,0x3e9b3ec43eeb3f08,0x3ea93ede3f083f20,0xbde500003de53e64,0x3ce63e2c3e9b3ede,0xbf02bec4be80bde5,0xbe8ebde53d663e64,0xbf51bf35bf14bede,0xbf0ebec4be480000,0xbf7bbf6dbf55bf35
.quad 0xbf48bf20bedebe64,0xbf7abf80bf7abf67,0xbf6fbf51bf25bede,0xbf4dbf6dbf7dbf7e,0xbf80bf72bf51bf20,0xbef8bf35bf60bf7a,0xbf78bf80bf6fbf48,0xbdacbec4bf25bf59,0xbf59bf7abf7ebf67,0x3ea98000bea9bf20,0xbf25bf60bf7dbf7a,0x3f303ec43ce6bea9,0xbec4bf35bf6dbf80,0x3f6d3f353ec48000,0xbdacbef8bf4dbf7a,0x3f803f6d3f303ea9
.quad 0xbf803f80bf803f80,0xbf803f80bf803f80,0x3f5c3f603f633f67,0x3f4d3f513f553f59,0x3ef83f083f143f20,0x3e8e3ea93ec43ede,0xbce63d663e0f3e64,0xbeb7be8ebe48bde5,0xbf08bedebea9be64,0xbf59bf48bf35bf20,0xbf63bf51bf3abf20,0xbf7fbf80bf7bbf72,0xbf80bf7ebf76bf67,0xbf3fbf59bf6dbf7a,0xbf55bf6dbf7bbf80,0xbe48bec4bf0ebf35
.quad 0xbedebf20bf48bf67,0x3ede3e648000be64,0x3dacbe2cbed1bf20,0x3f633f3f3f0e3ea9,0x3f143ea93d66be64,0x3f7c3f7e3f6d3f48,0x3f6a3f3f3f023e64,0x3f303f603f7b3f7e,0x3f7e3f7a3f593f20,0x3de53ede3f353f67,0x3f4d3f763f7f3f67,0xbf02be2c3e483f08,0x3ec43f353f6d3f80,0xbf6dbf35bec40000,0xbe0f3e8e3f253f67,0xbf78bf7cbf55bf08
.quad 0xbf803f80bf803f80,0xbf803f80bf803f80,0x3f3a3f3f3f443f48,0x3f253f2b3f303f35,0x3d663de53e2c3e64,0xbe2cbde5bd660000,0xbf25bf14bf02bede,0xbf5cbf51bf44bf35,0xbf7ebf7abf72bf67,0xbf72bf7abf7ebf80,0xbf4dbf60bf6fbf7a,0xbeb7bef8bf1abf35,0xbe2cbea9bef8bf20,0x3ef83ea93e2c8000,0x3f0e3ec43e488000,0x3f7b3f6d3f553f35
.quad 0x3f7a3f673f483f20,0x3f483f673f7a3f80,0x3f5c3f763f803f7a,0x3ce63e8e3f023f35,0x3e8e3f083f3f3f67,0xbf3fbf08be8e0000,0xbeebbe2c3e0f3ede,0xbf7dbf7cbf63bf35,0xbf72bf48bf08be64,0xbf08bf48bf72bf80,0xbf6abf80bf74bf48,0x3e9bbd66bed1bf35,0xbec4bf35bf6dbf80,0x3f6d3f353ec48000,0x3eb7bd66beebbf48,0x3f633f803f6f3f35
.quad 0xbf803f80bf803f80,0xbf803f80bf803f80,0x3f0e3f143f1a3f20,0x3eeb3ef83f023f08,0xbec4bea9be8ebe64,0xbf14bf08bef8bede,0xbf7bbf76bf6fbf67,0xbf7dbf80bf80bf7e,0xbf35bf48bf59bf67,0xbea9bedebf08bf20,0x3e483d66bdacbe64,0x3f303f143eeb3ea9,0x3f6d3f593f3f3f20,0x3f763f7e3f803f7a,0x3f553f6d3f7b3f80,0x3e483ec43f0e3f35
.quad 0x3e643ede3f20,0xbf48bf20bedebe64,0xbf55bf2bbeebbe64,0xbf6abf7cbf7fbf72,0xbf6dbf7ebf7cbf67,0xbd66bea9bf14bf48,0xbe48bef8bf3abf67,0x3f5c3f2b3ed13de5,0x3f353ede3de5be64,0x3f593f7a3f7e3f67,0x3f7b3f7c3f5c3f20,0xbdac3e8e3f1a3f59,0x3ec43f353f6d3f80,0xbf6dbf35bec40000,0xbf0ebe2c3e803f20,0xbf44bf76bf7dbf59
.quad 0xbf803f80bf803f80,0xbf803f80bf803f80,0x3eb73ec43ed13ede,0x3e803e8e3e9b3ea9,0xbf3fbf35bf2bbf20,0xbf60bf59bf51bf48,0xbf63bf6dbf74bf7a,0xbf30bf3fbf4dbf59,0x3de58000bde5be64,0x3f083ede3ea93e64,0x3f783f6d3f5c3f48,0x3f743f7c3f803f7e,0x3f143f353f513f67,0xbd663de53e8e3ede,0xbf0ebec4be480000,0xbf7bbf6dbf55bf35
.quad 0xbf7abf80bf7abf67,0xbedebf20bf48bf67,0xbe0fbec4bf1abf48,0x3f443f143eb73de5,0x3f603f353ef83e64,0x3f513f723f803f7a,0x3f443f6d3f7f3f7a,0xbeb7bd663e803f08,0xbea900003ea93f20,0xbf7ebf7abf59bf20,0xbf80bf6dbf3abede,0xbe0fbef8bf44bf72,0xbec4bf35bf6dbf80,0x3f6d3f353ec48000,0x3f3a3ec4bce6bede,0x3f1a3f603f7f3f72
.quad 0xbf803f80bf803f80,0xbf803f80bf803f80,0x3e0f3e2c3e483e64,0x3ce63d663dac3de5,0xbf76bf72bf6dbf67,0xbf80bf7ebf7cbf7a,0xbed1bef8bf0ebf20,0xbdacbe2cbe80bea9,0x3f593f483f353f20,0x3f7e3f7a3f723f67,0x3f253f3f3f553f67,0x3e0f3e8e3ed13f08,0xbf2bbf08bec4be64,0xbf7cbf72bf60bf48,0xbf55bf6dbf7bbf80,0xbe48bec4bf0ebf35
.quad 0x3ede3e648000be64,0x3f7a3f673f483f20,0x3f743f803f7b3f67,0x3e803ef83f303f59,0xbe2c3de53ec43f20,0xbf76bf59bf2bbede,0xbf80bf76bf55bf20,0xbe9bbf14bf4dbf72,0xbde5bedebf35bf67,0x3f723f483f083e64,0x3f783f513f0e3e64,0x3eb73f2b3f633f7e,0x3ec43f353f6d3f80,0xbf6dbf35bec40000,0xbf5cbf14be483e64,0xbed1bf3fbf74bf7e
.quad 0xbf803f80bf803f80,0xbf803f80bf803f80,0xbdacbd66bce60000,0xbe48be2cbe0fbde5,0xbf7cbf7ebf80bf80,0xbf6dbf72bf76bf7a,0x3e803e2c3dac8000,0x3f0e3ef83ed13ea9,0x3f723f7a3f7e3f80,0x3f353f483f593f67,0xbed1be8ebe0f0000,0xbf55bf3fbf25bf08,0xbf60bf72bf7cbf80,0xbec4bf08bf2bbf48,0x3f0e3ec43e488000,0x3f7b3f6d3f553f35
.quad 0x3f483f673f7a3f80,0x3e643ede3f20,0xbf30bef8be800000,0xbf7bbf80bf74bf59,0xbf2bbf59bf76bf80,0x3ec43de5be2cbede,0x3f4d3f143e9b8000,0x3f553f763f803f72,0x3f083f483f723f80,0xbf35bedebde53e64,0xbf63bf2bbeb70000,0xbf0ebf51bf78bf7e,0xbec4bf35bf6dbf80,0x3f6d3f353ec48000,0x3f743f3f3ed18000,0x3e483f143f5c3f7e
.quad 0xbf803f80bf803f80,0xbf803f80bf803f80,0xbe9bbe8ebe80be64,0xbed1bec4beb7bea9,0xbf51bf59bf60bf67,0xbf2bbf35bf3fbf48,0x3f4d3f3f3f303f20,0x3f743f6d3f633f59,0x3ea93ede3f083f20,0xbde500003de53e64,0xbf80bf7cbf74bf67,0xbf5cbf6dbf78bf7e,0x3e8e3de5bd66be64,0x3f513f353f143ede,0x3f553f6d3f7b3f80,0x3e483ec43f0e3f35
.quad 0xbf48bf20bedebe64,0xbf7abf80bf7abf67,0xbeb7bf14bf44bf67,0x3f1a3ec43e0fbde5,0x3f803f723f513f20,0x3ef83f353f603f7a,0xbe803d663eb73f20,0xbf7fbf6dbf44bf08,0xbf59bf7abf7ebf67,0x3ea98000bea9bf20,0x3f443ef83e0fbe64,0x3f3a3f6d3f803f72,0x3ec43f353f6d3f80,0xbf6dbf35bec40000,0xbf7fbf60bf1abe64,0x3ce6bec4bf3abf72
.quad 0xbf803f80bf803f80,0xbf803f80bf803f80,0xbf02bef8beebbede,0xbf1abf14bf0ebf08,0xbef8bf08bf14bf20,0xbe8ebea9bec4bede,0x3f803f803f7d3f7a,0x3f6f3f763f7b3f7e,0xbf08bedebea9be64,0xbf59bf48bf35bf20,0xbeebbf14bf30bf48,0x3dacbd66be48bea9,0x3f803f7e3f763f67,0x3f3f3f593f6d3f7a,0xbf0ebec4be480000,0xbf7bbf6dbf55bf35
.quad 0xbedebf20bf48bf67,0x3ede3e648000be64,0x3f7f3f7c3f6a3f48,0x3eeb3f2b3f553f72,0xbf14bea9bd663e64,0xbf7cbf7ebf6dbf48,0xbed1bf2bbf5cbf7a,0x3f3a3ef83e48bde5,0x3f7e3f7a3f593f20,0x3de53ede3f353f67,0xbf1abe8e3dac3ede,0xbf5cbf7cbf7bbf59,0xbec4bf35bf6dbf80,0x3f6d3f353ec48000,0x3f7d3f763f443ede,0xbe803e2c3f0e3f59
.quad 0xbf803f80bf803f80,0xbf803f80bf803f80,0xbf30bf2bbf25bf20,0xbf44bf3fbf3abf35,0xbd66bde5be2cbe64,0x3e2c3de53d668000,0x3f443f513f5c3f67,0x3f023f143f253f35,0xbf7ebf7abf72bf67,0xbf72bf7abf7ebf80,0x3f1a3ef83eb73e64,0x3f6f3f603f4d3f35,0x3e2c3ea93ef83f20,0xbef8bea9be2c0000,0xbf55bf6dbf7bbf80,0xbe48bec4bf0ebf35
.quad 0x3f7a3f673f483f20,0x3f483f673f7a3f80,0xbf02be8ebce63e64,0xbf80bf76bf5cbf35,0xbe8ebf08bf3fbf67,0x3f3f3f083e8e8000,0x3f633f7c3f7d3f67,0xbe0f3e2c3eeb3f35,0xbf72bf48bf08be64,0xbf08bf48bf72bf80,0x3ed13d66be9bbf20,0x3f743f803f6a3f35,0x3ec43f353f6d3f80,0xbf6dbf35bec40000,0xbf6fbf80bf63bf20,0x3eeb3d66beb7bf35
.quad 0xbf803f80bf803f80,0xbf803f80bf803f80,0xbf55bf51bf4dbf48,0xbf63bf60bf5cbf59,0x3ec43ea93e8e3e64,0x3f143f083ef83ede,0x3e483e8e3eb73ede,0xbe0fbd663ce63de5,0xbf35bf48bf59bf67,0xbea9bedebf08bf20,0x3f7b3f803f7f3f7a,0x3f3a3f513f633f72,0xbf6dbf59bf3fbf20,0xbf76bf7ebf80bf7a,0x3f0e3ec43e488000,0x3f7b3f6d3f553f35
.quad 0x3e643ede3f20,0xbf48bf20bedebe64,0xbf0ebf3fbf63bf7a,0x3ed13e2cbdacbea9,0x3f6d3f7e3f7c3f67,0x3d663ea93f143f48,0xbf7bbf60bf30bede,0xbf02bf3fbf6abf7e,0x3f353ede3de5be64,0x3f593f7a3f7e3f67,0xbe483e2c3f023f48,0xbf7fbf76bf4dbf08,0xbec4bf35bf6dbf80,0x3f6d3f353ec48000,0x3f553f7c3f783f48,0xbf25be8e3e0f3f08
.quad 0xbf803f80bf803f80,0xbf803f80bf803f80,0xbf6fbf6dbf6abf67,0xbf78bf76bf74bf72,0x3f3f3f353f2b3f20,0x3f603f593f513f48,0xbeebbec4be9bbe64,0xbf3abf2bbf1abf08,0x3de58000bde5be64,0x3f083ede3ea93e64,0x3e803ec43f023f20,0xbe9bbe2cbce63de5,0xbf14bf35bf51bf67,0x3d66bde5be8ebede,0x3f553f6d3f7b3f80,0x3e483ec43f0e3f35
.quad 0xbf7abf80bf7abf67,0xbedebf20bf48bf67,0x3f7d3f6d3f4d3f20,0x3f253f513f6f3f7e,0xbf60bf35bef8be64,0xbf51bf72bf80bf7a,0x3f253ec43dacbe64,0x3f6f3f803f783f59,0xbea900003ea93f20,0xbf7ebf7abf59bf20,0xbce6bec4bf30bf67,0x3f7d3f603f253ea9,0x3ec43f353f6d3f80,0xbf6dbf35bec40000,0xbf30bf6dbf80bf67,0x3f4d3ef83dacbea9
.quad 0xbf803f80bf803f80,0xbf803f80bf803f80,0xbf7dbf7cbf7bbf7a,0xbf80bf80bf7fbf7e,0x3f763f723f6d3f67,0x3f803f7e3f7c3f7a,0xbf6abf60bf55bf48,0xbf7fbf7cbf78bf72,0x3f593f483f353f20,0x3f7e3f7a3f723f67,0xbf44bf2bbf0ebede,0xbf7dbf76bf6abf59,0x3f2b3f083ec43e64,0x3f7c3f723f603f48,0xbf0ebec4be480000,0xbf7bbf6dbf55bf35
.quad 0x3ede3e648000be64,0x3f7a3f673f483f20,0xbe9bbd663e483ede,0xbf78bf60bf3abf08,0x3e2cbde5bec4bf20,0x3f763f593f2b3ede,0xbce63e8e3f0e3f48,0xbf74bf51bf1abea9,0xbde5bedebf35bf67,0x3f723f483f083e64,0x3e803f143f553f7a,0xbf6fbf3fbeebbde5,0xbec4bf35bf6dbf80,0x3f6d3f353ec48000,0x3f023f513f7b3f7a,0xbf6abf2bbe9b3de5
.quad 0x3f80,0x0,0xbf80,0x0,0x3f80,0x0,0xbf80,0x0,0x3f80,0x0,0xbf80,0x0,0x3f80,0x0,0xbf80,0x0
.quad 0x3f80,0x0,0xbf80,0x0,0x3f80,0x0,0xbf80,0x0,0x3f80,0x0,0xbf80,0x0,0x3f80,0x0,0xbf80,0x0
.quad 0x0,0x0,0x0,0x0,0x0,0x0,0x0,0x0,0x0,0x0,0x0,0x0,0x0,0x0,0x0,0x0
.quad 0x0,0x0,0x0,0x0,0x0,0x0,0x0,0x0,0x0,0x0,0x0,0x0,0x0,0x0,0x0,0x0
.quad 0x8000800080008000,0x8000800080008000,0xbdacbd66bce68000,0xbe48be2cbe0fbde5,0xbe2cbde5bd668000,0xbec4bea9be8ebe64,0xbe80be2cbdac8000,0xbf0ebef8bed1bea9,0xbea9be64bde58000,0xbf35bf20bf08bede,0xbed1be8ebe0f8000,0xbf55bf3fbf25bf08,0xbef8bea9be2c8000,0xbf6dbf59bf3fbf20,0xbf0ebec4be488000,0xbf7bbf6dbf55bf35
.quad 0xbf20bedebe648000,0xbf80bf7abf67bf48,0xbf30bef8be808000,0xbf7bbf80bf74bf59,0xbf3fbf08be8e8000,0xbf6dbf7ebf7cbf67,0xbf4dbf14be9b8000,0xbf55bf76bf80bf72,0xbf59bf20bea98000,0xbf35bf67bf7ebf7a,0xbf63bf2bbeb78000,0xbf0ebf51bf78bf7e,0xbf6dbf35bec48000,0xbec4bf35bf6dbf80,0xbf74bf3fbed18000,0xbe48bf14bf5cbf7e
.quad 0x8000800080008000,0x8000800080008000,0xbe9bbe8ebe80be64,0xbed1bec4beb7bea9,0xbf14bf08bef8bede,0xbf3fbf35bf2bbf20,0xbf4dbf3fbf30bf20,0xbf74bf6dbf63bf59,0xbf72bf67bf59bf48,0xbf7ebf80bf7ebf7a,0xbf80bf7cbf74bf67,0xbf5cbf6dbf78bf7e,0xbf76bf7ebf80bf7a,0xbf14bf35bf51bf67,0xbf55bf6dbf7bbf80,0xbe48bec4bf0ebf35
.quad 0xbf20bf48bf67bf7a,0x3e648000be64bede,0xbeb7bf14bf44bf67,0x3f1a3ec43e0fbde5,0xbd66bea9bf14bf48,0x3f603f353ef83e64,0x3e80bd66beb7bf20,0x3f7f3f6d3f443f08,0x3f083e64bde5bede,0x3f723f803f723f48,0x3f443ef83e0fbe64,0x3f3a3f6d3f803f72,0x3f6d3f353ec48000,0x3ec43f353f6d3f80,0x3f7f3f603f1a3e64,0xbce63ec43f3a3f72
.quad 0x8000800080008000,0x8000800080008000,0xbf02bef8beebbede,0xbf1abf14bf0ebf08,0xbf60bf59bf51bf48,0xbf76bf72bf6dbf67,0xbf80bf80bf7dbf7a,0xbf6fbf76bf7bbf7e,0xbf59bf67bf72bf7a,0xbf08bf20bf35bf48,0xbeebbf14bf30bf48,0x3dacbd66be48bea9,0x3d66bde5be8ebede,0x3f2b3f083ec43e64,0x3f0e3ec43e488000,0x3f7b3f6d3f553f35
.quad 0x3f673f483f203ede,0x3f673f7a3f803f7a,0x3f7f3f7c3f6a3f48,0x3eeb3f2b3f553f72,0x3f513f723f803f7a,0xbe2c3de53ec43f20,0x3ed13f2b3f5c3f7a,0xbf3abef8be483de5,0xbde53e643f083f48,0xbf7ebf67bf35bede,0xbf1abe8e3dac3ede,0xbf5cbf7cbf7bbf59,0xbf6dbf35bec48000,0xbec4bf35bf6dbf80,0xbf7dbf76bf44bede,0x3e80be2cbf0ebf59
.quad 0x8000800080008000,0x8000800080008000,0xbf30bf2bbf25bf20,0xbf44bf3fbf3abf35,0xbf80bf7ebf7cbf7a,0xbf7cbf7ebf80bf80,0xbf44bf51bf5cbf67,0xbf02bf14bf25bf35,0xbde5be64bea9bede,0x3ea93e643de58000,0x3f1a3ef83eb73e64,0x3f6f3f603f4d3f35,0x3f7c3f723f603f48,0x3f603f723f7c3f80,0x3f553f6d3f7b3f80,0x3e483ec43f0e3f35
.quad 0x3e643ede3f203f48,0xbf20bedebe648000,0xbf02be8ebce63e64,0xbf80bf76bf5cbf35,0xbf76bf59bf2bbede,0xbf2bbf59bf76bf80,0xbf63bf7cbf7dbf67,0x3e0fbe2cbeebbf35,0xbea9bf20bf59bf7a,0x3f593f203ea98000,0x3ed13d66be9bbf20,0x3f743f803f6a3f35,0x3f6d3f353ec48000,0x3ec43f353f6d3f80,0x3f6f3f803f633f20,0xbeebbd663eb73f35
.quad 0x8000800080008000,0x8000800080008000,0xbf55bf51bf4dbf48,0xbf63bf60bf5cbf59,0xbf6dbf72bf76bf7a,0xbf51bf59bf60bf67,0xbe48be8ebeb7bede,0x3e0f3d66bce6bde5,0x3f353f203f083ede,0x3f723f673f593f48,0x3f7b3f803f7f3f7a,0x3f3a3f513f633f72,0x3ec43f083f2b3f48,0xbe8ebde53d663e64,0xbf0ebec4be488000,0xbf7bbf6dbf55bf35
.quad 0xbf80bf7abf67bf48,0xbf20bf48bf67bf7a,0xbf0ebf3fbf63bf7a,0x3ed13e2cbdacbea9,0x3ec43de5be2cbede,0x3f803f723f513f20,0x3f7b3f603f303ede,0x3f023f3f3f6a3f7e,0x3f353f673f7e3f7a,0xbf08be643de53ede,0xbe483e2c3f023f48,0xbf7fbf76bf4dbf08,0xbf6dbf35bec48000,0xbec4bf35bf6dbf80,0xbf55bf7cbf78bf48,0x3f253e8ebe0fbf08
.quad 0x8000800080008000,0x8000800080008000,0xbf6fbf6dbf6abf67,0xbf78bf76bf74bf72,0xbf2bbf35bf3fbf48,0xbef8bf08bf14bf20,0x3eeb3ec43e9b3e64,0x3f3a3f2b3f1a3f08,0x3f7e3f803f7e3f7a,0x3f593f673f723f7a,0x3e803ec43f023f20,0xbe9bbe2cbce63de5,0xbf51bf35bf14bede,0xbf80bf7ebf76bf67,0xbf55bf6dbf7bbf80,0xbe48bec4bf0ebf35
.quad 0x3e648000be64bede,0x3f673f483f203ede,0x3f7d3f6d3f4d3f20,0x3f253f513f6f3f7e,0x3ef83f353f603f7a,0xbf14bea9bd663e64,0xbf25bec4bdac3e64,0xbf6fbf80bf78bf59,0xbf72bf80bf72bf48,0x3de5be64bf08bf48,0xbce6bec4bf30bf67,0x3f7d3f603f253ea9,0x3f6d3f353ec48000,0x3ec43f353f6d3f80,0x3f303f6d3f803f67,0xbf4dbef8bdac3ea9
.quad 0x8000800080008000,0x8000800080008000,0xbf7dbf7cbf7bbf7a,0xbf80bf80bf7fbf7e,0xbe8ebea9bec4bede,0xbd66bde5be2cbe64,0x3f6a3f603f553f48,0x3f7f3f7c3f783f72,0x3f083f203f353f48,0x3de53e643ea93ede,0xbf44bf2bbf0ebede,0xbf7dbf76bf6abf59,0xbf3fbf59bf6dbf7a,0xbe2cbea9bef8bf20,0x3f0e3ec43e488000,0x3f7b3f6d3f553f35
.quad 0x3f673f7a3f803f7a,0x3e643ede3f203f48,0xbe9bbd663e483ede,0xbf78bf60bf3abf08,0xbf7cbf7ebf6dbf48,0xbe8ebf08bf3fbf67,0x3ce6be8ebf0ebf48,0x3f743f513f1a3ea9,0x3f7e3f673f353ede,0x3ea93f203f593f7a,0x3e803f143f553f7a,0xbf6fbf3fbeebbde5,0xbf6dbf35bec48000,0xbec4bf35bf6dbf80,0xbf02bf51bf7bbf7a,0x3f6a3f2b3e9bbde5
.quad 0x8000800080008000,0x8000800080008000,0xbf7fbf80bf80bf80,0xbf7bbf7cbf7dbf7e,0x3e2c3de53d668000,0x3ec43ea93e8e3e64,0x3f783f7c3f7f3f80,0x3f553f603f6a3f72,0xbea9be64bde58000,0xbf35bf20bf08bede,0xbf6abf76bf7dbf80,0xbf0ebf2bbf44bf59,0x3ef83ea93e2c8000,0x3f6d3f593f3f3f20,0x3f553f6d3f7b3f80,0x3e483ec43f0e3f35
.quad 0xbf20bedebe648000,0xbf80bf7abf67bf48,0xbf3abf60bf78bf80,0x3e48bd66be9bbf08,0x3f3f3f083e8e8000,0x3f6d3f7e3f7c3f67,0x3f1a3f513f743f80,0xbf0ebe8e3ce63ea9,0xbf59bf20bea98000,0xbf35bf67bf7ebf7a,0xbeebbf3fbf6fbf80,0x3f553f143e80bde5,0x3f6d3f353ec48000,0x3ec43f353f6d3f80,0x3e9b3f2b3f6a3f80,0xbf7bbf51bf02bde5
.quad 0x8000800080008000,0x8000800080008000,0xbf74bf76bf78bf7a,0xbf6abf6dbf6fbf72,0x3f143f083ef83ede,0x3f3f3f353f2b3f20,0x3f1a3f2b3f3a3f48,0x3e9b3ec43eeb3f08,0xbf72bf67bf59bf48,0xbf7ebf80bf7ebf7a,0xbce6be2cbe9bbede,0x3f023ec43e803de5,0x3f763f7e3f803f7a,0x3f143f353f513f67,0xbf0ebec4be488000,0xbf7bbf6dbf55bf35
.quad 0xbf20bf48bf67bf7a,0x3e648000be64bede,0x3f6f3f513f253ede,0x3f4d3f6d3f7d3f7e,0x3d663ea93f143f48,0xbf60bf35bef8be64,0xbf78bf80bf6fbf48,0xbdacbec4bf25bf59,0x3f083e64bde5bede,0x3f723f803f723f48,0x3f253f603f7d3f7a,0xbf30bec4bce63ea9,0xbf6dbf35bec48000,0xbec4bf35bf6dbf80,0xbdacbef8bf4dbf7a,0x3f803f6d3f303ea9
.quad 0x8000800080008000,0x8000800080008000,0xbf5cbf60bf63bf67,0xbf4dbf51bf55bf59,0x3f603f593f513f48,0x3f763f723f6d3f67,0xbce63d663e0f3e64,0xbeb7be8ebe48bde5,0xbf59bf67bf72bf7a,0xbf08bf20bf35bf48,0x3f633f513f3a3f20,0x3f7f3f803f7b3f72,0xbd663de53e8e3ede,0xbf2bbf08bec4be64,0xbf55bf6dbf7bbf80,0xbe48bec4bf0ebf35
.quad 0x3f673f483f203ede,0x3f673f7a3f803f7a,0xbdac3e2c3ed13f20,0xbf63bf3fbf0ebea9,0xbf51bf72bf80bf7a,0x3e2cbde5bec4bf20,0x3f6a3f3f3f023e64,0x3f303f603f7b3f7e,0xbde53e643f083f48,0xbf7ebf67bf35bede,0xbf4dbf76bf7fbf67,0x3f023e2cbe48bf08,0x3f6d3f353ec48000,0x3ec43f353f6d3f80,0xbe0f3e8e3f253f67,0xbf78bf7cbf55bf08
.quad 0x8000800080008000,0x8000800080008000,0xbf3abf3fbf44bf48,0xbf25bf2bbf30bf35,0x3f803f7e3f7c3f7a,0x3f7c3f7e3f803f80,0xbf25bf14bf02bede,0xbf5cbf51bf44bf35,0xbde5be64bea9bede,0x3ea93e643de58000,0x3f4d3f603f6f3f7a,0x3eb73ef83f1a3f35,0xbf7cbf72bf60bf48,0xbf60bf72bf7cbf80,0x3f0e3ec43e488000,0x3f7b3f6d3f553f35
.quad 0x3e643ede3f203f48,0xbf20bedebe648000,0xbf5cbf76bf80bf7a,0xbce6be8ebf02bf35,0x3f763f593f2b3ede,0x3f2b3f593f763f80,0xbeebbe2c3e0f3ede,0xbf7dbf7cbf63bf35,0xbea9bf20bf59bf7a,0x3f593f203ea98000,0x3f6a3f803f743f48,0xbe9b3d663ed13f35,0xbf6dbf35bec48000,0xbec4bf35bf6dbf80,0x3eb7bd66beebbf48,0x3f633f803f6f3f35
.quad 0x8000800080008000,0x8000800080008000,0xbf0ebf14bf1abf20,0xbeebbef8bf02bf08,0x3f6d3f723f763f7a,0x3f513f593f603f67,0xbf7bbf76bf6fbf67,0xbf7dbf80bf80bf7e,0x3f353f203f083ede,0x3f723f673f593f48,0xbe48bd663dac3e64,0xbf30bf14beebbea9,0xbec4bf08bf2bbf48,0x3e8e3de5bd66be64,0x3f553f6d3f7b3f80,0x3e483ec43f0e3f35
.quad 0xbf80bf7abf67bf48,0xbf20bf48bf67bf7a,0x3f553f2b3eeb3e64,0x3f6a3f7c3f7f3f72,0xbec4bde53e2c3ede,0xbf80bf72bf51bf20,0xbe48bef8bf3abf67,0x3f5c3f2b3ed13de5,0x3f353f673f7e3f7a,0xbf08be643de53ede,0xbf7bbf7cbf5cbf20,0x3dacbe8ebf1abf59,0x3f6d3f353ec48000,0x3ec43f353f6d3f80,0xbf0ebe2c3e803f20,0xbf44bf76bf7dbf59
.quad 0x8000800080008000,0x8000800080008000,0xbeb7bec4bed1bede,0xbe80be8ebe9bbea9,0x3f2b3f353f3f3f48,0x3ef83f083f143f20,0xbf63bf6dbf74bf7a,0xbf30bf3fbf4dbf59,0x3f7e3f803f7e3f7a,0x3f593f673f723f7a,0xbf78bf6dbf5cbf48,0xbf74bf7cbf80bf7e,0x3f513f353f143ede,0x3f803f7e3f763f67,0xbf0ebec4be488000,0xbf7bbf6dbf55bf35
.quad 0x3e648000be64bede,0x3f673f483f203ede,0x3e0f3ec43f1a3f48,0xbf44bf14beb7bde5,0xbef8bf35bf60bf7a,0x3f143ea93d66be64,0x3f443f6d3f7f3f7a,0xbeb7bd663e803f08,0xbf72bf80bf72bf48,0x3de5be64bf08bf48,0x3f803f6d3f3a3ede,0x3e0f3ef83f443f72,0xbf6dbf35bec48000,0xbec4bf35bf6dbf80,0x3f3a3ec4bce6bede,0x3f1a3f603f7f3f72
.quad 0x8000800080008000,0x8000800080008000,0xbe0fbe2cbe48be64,0xbce6bd66bdacbde5,0x3e8e3ea93ec43ede,0x3d663de53e2c3e64,0xbed1bef8bf0ebf20,0xbdacbe2cbe80bea9,0x3f083f203f353f48,0x3de53e643ea93ede,0xbf25bf3fbf55bf67,0xbe0fbe8ebed1bf08,0x3f3f3f593f6d3f7a,0x3e2c3ea93ef83f20,0xbf55bf6dbf7bbf80,0xbe48bec4bf0ebf35
.quad 0x3f673f7a3f803f7a,0x3e643ede3f203f48,0xbf74bf80bf7bbf67,0xbe80bef8bf30bf59,0x3f7c3f7e3f6d3f48,0x3e8e3f083f3f3f67,0xbf80bf76bf55bf20,0xbe9bbf14bf4dbf72,0x3f7e3f673f353ede,0x3ea93f203f593f7a,0xbf78bf51bf0ebe64,0xbeb7bf2bbf63bf7e,0x3f6d3f353ec48000,0x3ec43f353f6d3f80,0xbf5cbf14be483e64,0xbed1bf3fbf74bf7e
.quad 0x8000,0x0,0x8000,0x0,0x8000,0x0,0x8000,0x0,0x8000,0x0,0x8000,0x0,0x8000,0x0,0x8000,0x0
.quad 0x8000,0x0,0x8000,0x0,0x8000,0x0,0x8000,0x0,0x8000,0x0,0x8000,0x0,0x8000,0x0,0x8000,0x0
.quad 0x0,0x0,0x0,0x0,0x0,0x0,0x0,0x0,0x0,0x0,0x0,0x0,0x0,0x0,0x0,0x0
.quad 0x0,0x0,0x0,0x0,0x0,0x0,0x0,0x0,0x0,0x0,0x0,0x0,0x0,0x0,0x0,0x0
.quad 0x3f803f803f803f80,0x3f7f3f7f3f7f3f80,0x3f7e3f7f3f803f80,0x3f753f783f7a3f7c,0x3f7a3f7d3f7f3f80,0x3f623f6a3f703f76,0x3f753f7b3f7f3f80,0x3f463f553f623f6d,0x3f6e3f783f7e3f80,0x3f223f3a3f4f3f60,0x3f653f743f7d3f80,0x3ef13f1a3f383f51,0x3f5b3f6f3f7c3f80,0x3e953eeb3f1d3f3f,0x3f4f3f6a3f7a3f80,0x3dc93e9b3efe3f2b
.quad 0x3f413f633f793f80,0xbdc93e0f3ebd3f14,0x3f323f5c3f773f80,0xbe95bce63e723ef8,0x3f223f553f753f80,0xbef1be483dc93ec4,0x3f113f4d3f733f80,0xbf22beb7bd2c3e8e,0x3efe3f443f703f80,0xbf46bf02be3a3e2c,0x3ed83f3a3f6e3f80,0xbf62bf25bea23d66,0x3eb03f303f6b3f80,0xbf75bf44bee5bd66,0x3e873f253f683f80,0xbf7fbf5cbf11be2c
.quad 0x3f7d3f7d3f7e3f7e,0x3f7a3f7b3f7c3f7c,0x3f653f6a3f6e3f72,0x3f4f3f553f5b3f60,0x3f383f443f4f3f59,0x3efe3f0e3f1d3f2b,0x3ef13f0e3f223f35,0x3dc93e483e953ec4,0x3e3a3e9b3ed83f08,0xbea2be48bd8f3d66,0xbe013ce63e3a3ea9,0xbf2dbf0ebed8be8e,0xbed8be80bd8f3de5,0xbf6bbf55bf38bf14,0xbf2dbf02bea2bde5,0xbf80bf7bbf6bbf51
.quad 0xbf5ebf3abf0bbea9,0xbf68bf7bbf80bf76,0xbf7abf63bf3cbf08,0xbf28bf55bf73bf80,0xbf7fbf7bbf62bf35,0xbe95bf0ebf46bf6d,0xbf6bbf7fbf79bf59,0x3e01be48befebf3f,0xbf41bf6fbf80bf72,0x3f053e48be1dbef8,0xbf05bf4dbf77bf7e,0x3f533f0e3e56be2c,0xbe72bf1abf5ebf7e,0x3f7c3f553f0b3e2c,0x3d8fbeb7bf38bf72,0x3f793f7b3f4f3ef8
.quad 0x3f773f783f793f7a,0x3f733f743f753f76,0x3f323f3a3f413f48,0x3f113f1a3f223f2b,0x3e723e9b3ebd3ede,0xbd2c3ce63dc93e2c,0xbe95be48bdc90000,0xbf22bf0ebef1bec4,0xbf3cbf25bf0bbede,0xbf79bf6fbf62bf51,0xbf7abf6fbf5ebf48,0xbf6bbf78bf7fbf80,0xbf73bf7dbf80bf7a,0xbefebf25bf46bf60,0xbf28bf4dbf68bf7a,0x3e01bdacbe95bef8
.quad 0xbe3abed1bf1dbf48,0x3f323f023e953d66,0x3eb03dacbe3abede,0x3f7d3f6a3f463f14,0x3f463f0e3e958000,0x3f623f7b3f7f3f6d,0x3f7d3f633f323ede,0x3ed83f303f623f7c,0x3f6e3f803f733f48,0xbe563e0f3ef13f3f,0x3f1d3f5c3f7d3f7a,0xbf41beebbdc93e8e,0x3e013f023f4f3f7a,0xbf7fbf63bf22be8e,0xbecb3ce63ee53f48,0xbf57bf7dbf75bf3f
.quad 0x3f6e3f6f3f703f72,0x3f683f6a3f6b3f6d,0x3ed83eeb3efe3f08,0x3e873e9b3eb03ec4,0xbea2be80be3abde5,0xbf11bf02bee5bec4,0xbf62bf55bf46bf35,0xbf7fbf7bbf75bf6d,0xbf77bf7dbf80bf7e,0xbf38bf4dbf5ebf6d,0xbf05bf25bf41bf59,0x3d8fbdacbe72bec4,0x3e563ce6be1dbea9,0x3f4f3f303f0b3ec4,0x3f533f303f053ea9,0x3f793f803f7c3f6d
.quad 0x3f7d3f7f3f733f59,0x3ee53f253f4f3f6d,0x3f1d3f4d3f6e3f7e,0xbecbbe0f3e013ec4,0xbdc93e483ef13f35,0xbf75bf55bf22bec4,0xbf41bf02be563de5,0xbf57bf78bf7fbf6d,0xbf80bf74bf4abf08,0xbe01beebbf3cbf6d,0xbf32bf6abf80bf72,0x3f2d3eb7bc66bec4,0xbc66bed1bf3cbf72,0x3f803f6f3f383ec4,0x3f2d3e9bbe01bf08,0x3f1d3f633f803f6d
.quad 0x3f623f633f653f67,0x3f5b3f5c3f5e3f60,0x3dc93e0f3e3a3e64,0xbd8fbce63c663d66,0xbf46bf3abf2dbf20,0xbf6bbf63bf5bbf51,0xbf75bf7bbf7fbf80,0xbf46bf55bf62bf6d,0xbe95bed1bf05bf20,0x3e563dacbd2cbe2c,0x3f223f023ebd3e64,0x3f773f6a3f573f3f,0x3f7f3f7f3f773f67,0x3f2d3f4d3f653f76,0x3ef13f253f4a3f67,0xbeb0be0f3d8f3e8e
.quad 0xbef1be80bc663e64,0xbf7ebf6fbf53bf2b,0xbf7fbf6fbf4fbf20,0xbf11bf44bf68bf7c,0xbf22bf55bf75bf80,0x3ef13e48bdc9bec4,0x3e95bce6beb0bf20,0x3f803f743f4f3f14,0x3f753f4d3f0b3e64,0x3ee53f3a3f6b3f80,0x3f463f743f7f3f67,0xbf17be803e013ef8,0xbdc93e9b3f283f67,0xbf7dbf78bf4abef8,0xbf62bf1abe563e64,0xbea2bf30bf6ebf80
.quad 0x3f533f553f573f59,0x3f4a3f4d3f4f3f51,0xbe72be48be1dbde5,0xbecbbeb7bea2be8e,0xbf7ebf7bbf77bf72,0xbf7dbf7fbf80bf80,0xbef1bf0ebf22bf35,0xbdc9be48be95bec4,0x3f283f0e3ee53ea9,0x3f703f633f533f3f,0x3f703f7b3f803f7e,0x3f113f303f4a3f60,0x3c663e483ebd3f08,0xbf28bf02beb0be2c,0xbf6ebf55bf32bf08,0xbf65bf78bf80bf7c
.quad 0xbf2dbf55bf70bf7e,0x3e56bce6be87bef8,0x3ee53e48bd8fbea9,0x3f803f743f573f2b,0x3f7f3f7b3f623f35,0x3e953f0e3f463f6d,0x3e873f0e3f4a3f72,0xbf5bbf25bebdbd66,0xbf4fbf0ebe723de5,0xbf38bf6abf7fbf76,0xbf57bf7bbf7cbf59,0x3efe3e0fbe72bf14,0x3e56be48bf11bf59,0x3f773f7d3f5b3f14,0x3f7d3f553f053de5,0xbc663ed13f413f76
.quad 0x3f413f443f463f48,0x3f383f3a3f3c3f3f,0xbf0bbf02bef1bede,0xbf2dbf25bf1dbf14,0xbf68bf6fbf75bf7a,0xbf41bf4dbf57bf60,0x3e953e483dc98000,0x3f223f0e3ef13ec4,0x3f7d3f803f7f3f7a,0x3f4a3f5c3f6b3f76,0xbc663e0f3e953ede,0xbf17beebbea2be2c,0xbf7ebf74bf62bf48,0xbf53bf6abf79bf80,0xbe87beebbf22bf48,0x3f0b3eb73e1dbd66
.quad 0x3f6b3f4d3f223ede,0x3f5b3f743f7f3f7c,0x3f053f3a3f623f7a,0xbefebe803c663e8e,0xbf46bf0ebe950000,0xbf62bf7bbf7fbf6d,0xbf3cbf6abf7fbf7a,0x3ee53e0fbe3abef8,0x3f113e80bdc9bede,0x3f683f7f3f773f51,0x3f653f7f3f753f48,0xbecbbce63eb03f2b,0xbea23dac3ef13f48,0xbf6ebf80bf68bf2b,0xbf7cbf78bf46bede,0x3eb0bdacbefebf51
.quad 0x3f2d3f303f323f35,0x3f223f253f283f2b,0xbf4abf44bf3cbf35,0xbf62bf5cbf57bf51,0xbf0bbf1abf28bf35,0xbe95beb7bed8bef8,0x3f623f553f463f35,0x3f7f3f7b3f753f6d,0x3ecb3f023f1d3f35,0xbdc93ce63e1d3e8e,0xbf73bf63bf4fbf35,0xbf75bf7dbf80bf7c,0xbe72bed1bf11bf35,0x3ef13e9b3e01bd66,0x3f7d3f6f3f573f35,0x3f463f633f773f80
.quad 0x3d8f3e9b3f053f35,0xbf46bf1abecbbe2c,0xbf80bf78bf5ebf35,0xbef1bf30bf5bbf76,0x3dc9be48bef1bf35,0x3f753f553f223ec4,0x3f7c3f7d3f653f35,0x3dc93ed13f2d3f60,0xbe873dac3ed83f35,0xbf7fbf78bf53bf14,0xbf70bf80bf6bbf35,0x3e95bdacbee5bf3f,0x3ed83ce6bebdbf35,0x3f623f7f3f733f3f,0x3f5e3f7f3f703f35,0xbf22be803e3a3f14
.quad 0x3f173f1a3f1d3f20,0x3f0b3f0e3f113f14,0xbf73bf6fbf6bbf67,0xbf7dbf7bbf79bf76,0xbc66bdacbe1dbe64,0x3e873e483e013d66,0x3f753f7b3f7f3f80,0x3f463f553f623f6d,0xbf11beebbeb0be64,0xbf65bf55bf41bf2b,0xbf1dbf3abf53bf67,0xbd2cbe48beb0bef8,0x3f703f5c3f413f20,0x3f6e3f7b3f803f7c,0x3d2c3e803ee53f20,0xbf38bf0ebebdbe2c
.quad 0xbf77bf80bf7abf67,0xbeb0bf0ebf3cbf60,0x3f0b3e9b3d2cbe64,0x3f7f3f7b3f653f3f,0x3f223f553f753f80,0xbef1be483dc93ec4,0xbf6ebf44bf05be64,0xbf1dbf55bf77bf80,0xbd8fbed1bf32bf67,0x3f793f553f173e8e,0x3f793f7d3f5e3f20,0xbe3a3e483f0b3f51,0xbf05be0f3e873f20,0xbf53bf7bbf7abf51,0xbf28bf6abf80bf67,0x3f5b3f0e3e1dbe8e
.quad 0x3efe3f023f053f08,0x3ee53eeb3ef13ef8,0xbf80bf80bf7fbf7e,0xbf7cbf7dbf7fbf80,0x3f053eeb3ecb3ea9,0x3f3c3f303f223f14,0x3ef13f0e3f223f35,0x3dc93e483e953ec4,0xbf80bf7fbf7abf72,0xbf5bbf6abf75bf7c,0x3f0b3ed13e873de5,0x3f6e3f5c3f463f2b,0x3ee53f1a3f3c3f59,0xbe87bdac3dc93e8e,0xbf7fbf7dbf70bf59,0xbf1dbf44bf62bf76
.quad 0x3f113eb73e01bde5,0x3f803f783f623f3f,0x3ed83f253f533f72,0xbf17beb7bdc93e2c,0xbf7fbf7bbf62bf35,0xbe95bf0ebf46bf6d,0x3f173e9bbc66bea9,0x3f703f803f753f51,0x3ecb3f303f653f7e,0xbf57bf1abe953d66,0xbf7ebf78bf4fbf08,0x3d8fbe9bbf22bf60,0x3f1d3e80be1dbf08,0x3f413f743f7f3f60,0x3ebd3f3a3f733f7e,0xbf7abf4dbef1bd66
.quad 0x3ecb3ed13ed83ede,0x3eb03eb73ebd3ec4,0xbf70bf74bf77bf7a,0xbf5ebf63bf68bf6d,0x3f653f5c3f533f48,0x3f7c3f783f733f6d,0xbe95be48bdc90000,0xbf22bf0ebef1bec4,0xbefebf1abf32bf48,0xbc66be0fbe87bec4,0x3f793f7f3f7f3f7a,0x3f283f443f5b3f6d,0xbf57bf3abf17bede,0xbf7dbf80bf7abf6d,0x3e3abce6be72bede,0x3f5b3f3a3f113ec4
.quad 0x3f173f443f653f7a,0xbea2bdac3e1d3ec4,0xbf7ebf7dbf6bbf48,0xbebdbf1abf4abf6d,0x3f463f0e3e958000,0x3f623f7b3f7f3f6d,0xbd8f3e803f0b3f48,0xbf7abf5cbf28bec4,0xbf2dbf63bf7ebf7a,0x3f1d3e9bbd2cbec4,0x3f803f6f3f3c3ede,0x3d2c3ed13f383f6d,0xbf32beb73d2c3ede,0xbf2dbf6abf80bf6d,0xbd2cbeebbf4abf7a,0x3f7e3f743f3c3ec4
.quad 0x3e953e9b3ea23ea9,0x3e723e803e873e8e,0xbf46bf4dbf53bf59,0xbf28bf30bf38bf3f,0x3f7f3f803f803f7e,0x3f6e3f743f793f7c,0xbf62bf55bf46bf35,0xbf7fbf7bbf75bf6d,0x3ef13eb73e723de5,0x3f573f443f2d3f14,0x3dc93e803ecb3f08,0xbefebeb7be56bd66,0xbf22bf44bf5ebf72,0x3d2cbe0fbea2bef8,0x3f753f7f3f7e3f72,0x3ed83f1a3f413f60
.quad 0xbf75bf5cbf38bf08,0xbf4abf6abf7cbf80,0x3f223ed13e1dbde5,0x3f7c3f7f3f703f51,0xbdc93e483ef13f35,0xbf75bf55bf22bec4,0xbef1bf3abf68bf7e,0x3f383eeb3e1dbe2c,0x3f623f7d3f7a3f59,0xbea23ce63ebd3f2b,0xbf7fbf63bf28bea9,0xbe1dbf02bf4abf76,0x3f463eeb3d8fbea9,0x3f173f5c3f7e3f76,0xbe953e0f3f0b3f59,0xbf65bf80bf6bbf2b
.quad 0x3e3a3e483e563e64,0x3e013e0f3e1d3e2c,0xbf05bf0ebf17bf20,0xbebdbed1bee5bef8,0x3f4a3f553f5e3f67,0x3f173f253f323f3f,0xbf75bf7bbf7fbf80,0xbf46bf55bf62bf6d,0x3f7f3f7b3f733f67,0x3f683f743f7c3f80,0xbf68bf55bf3cbf20,0xbf7cbf80bf7ebf76,0x3f323f0e3ecb3e64,0x3f7f3f783f683f51,0xbecbbe483c663e64,0xbf73bf5cbf3cbf14
.quad 0x3d2cbe48bed8bf20,0x3f573f303efe3e8e,0x3ea23f0e3f413f67,0xbf2dbeebbe563d66,0xbf22bf55bf75bf80,0x3ef13e48bdc9bec4,0x3f5e3f7b3f7e3f67,0xbe723dac3ecb3f2b,0xbf7dbf7bbf5bbf20,0xbc66beb7bf28bf60,0x3f7a3f553f113e64,0x3e873f1a3f5b3f7c,0xbf57bf0ebe3a3e64,0xbefebf4dbf79bf7c,0x3f173e48be72bf20,0x3f323f6f3f7f3f60
.quad 0x3d8f3dac3dc93de5,0x3c663ce63d2c3d66,0xbe56be80be95bea9,0xbd2cbdacbe01be2c,0x3eb03ed13ef13f08,0x3d8f3e0f3e563e8e,0xbef1bf0ebf22bf35,0xbdc9be48be95bec4,0x3f173f303f463f59,0x3e013e803ebd3ef8,0xbf32bf4dbf62bf72,0xbe1dbe9bbee5bf14,0x3f4a3f633f753f7e,0x3e3a3eb73f053f2b,0xbf5ebf74bf7fbf7e,0xbe56bed1bf17bf3f
.quad 0x3f6e3f7d3f7f3f72,0x3e723eeb3f283f51,0xbf79bf80bf75bf59,0xbe87bf02bf38bf60,0x3f7f3f7b3f623f35,0x3e953f0e3f463f6d,0xbf80bf6fbf46bf08,0xbea2bf1abf53bf76,0x3f7c3f5c3f223ea9,0x3eb03f253f5e3f7c,0xbf73bf44bef1bde5,0xbebdbf30bf68bf80,0x3f653f253e95bde5,0x3ecb3f3a3f703f80,0xbf53bf02bdc93ea9,0xbed8bf44bf77bf7c
.quad 0x0,0x0,0x8000,0x0,0x0,0x0,0x8000,0x0,0x0,0x0,0x8000,0x0,0x0,0x0,0x8000,0x0
.quad 0x0,0x0,0x8000,0x0,0x0,0x0,0x8000,0x0,0x0,0x0,0x8000,0x0,0x0,0x0,0x8000,0x0
.quad 0x0,0x0,0x0,0x0,0x0,0x0,0x0,0x0,0x0,0x0,0x0,0x0,0x0,0x0,0x0,0x0
.quad 0x0,0x0,0x0,0x0,0x0,0x0,0x0,0x0,0x0,0x0,0x0,0x0,0x0,0x0,0x0,0x0
.quad 0xbd2cbce6bc668000,0xbdc9bdacbd8fbd66,0xbe01bdacbd2c8000,0xbe95be80be56be2c,0xbe56be0fbd8f8000,0xbef1bed1beb0be8e,0xbe95be48bdc98000,0xbf22bf0ebef1bec4,0xbebdbe80be018000,0xbf46bf30bf17bef8,0xbee5be9bbe1d8000,0xbf62bf4dbf32bf14,0xbf05beb7be3a8000,0xbf75bf63bf4abf2b,0xbf17bed1be568000,0xbf7fbf74bf5ebf3f
.quad 0xbf28beebbe728000,0xbf7fbf7dbf6ebf51,0xbf38bf02be878000,0xbf75bf80bf79bf60,0xbf46bf0ebe958000,0xbf62bf7bbf7fbf6d,0xbf53bf1abea28000,0xbf46bf6fbf80bf76,0xbf5ebf25beb08000,0xbf22bf5cbf7cbf7c,0xbf68bf30bebd8000,0xbef1bf44bf73bf80,0xbf70bf3abecb8000,0xbe95bf25bf65bf80,0xbf77bf44bed88000,0xbdc9bf02bf53bf7c
.quad 0xbe1dbe0fbe01bde5,0xbe56be48be3abe2c,0xbee5bed1bebdbea9,0xbf17bf0ebf05bef8,0xbf32bf25bf17bf08,0xbf5ebf55bf4abf3f,0xbf62bf55bf46bf35,0xbf7fbf7bbf75bf6d,0xbf7cbf74bf68bf59,0xbf73bf7bbf7fbf80,0xbf7ebf80bf7cbf72,0xbf3cbf55bf68bf76,0xbf68bf78bf7fbf7e,0xbecbbf0ebf32bf51,0xbf3cbf5cbf73bf7e,0x3c66be48becbbf14
.quad 0xbefebf30bf57bf72,0x3ed83e48bd2cbe8e,0xbe56beebbf2dbf59,0x3f413f0e3ea23d66,0x3dc9be48bef1bf35,0x3f753f553f223ec4,0x3ecb3dacbe72bf08,0x3f7e3f7b3f5e3f2b,0x3f283eb73c66bea9,0x3f5b3f7b3f7d3f60,0x3f5b3f1a3e87bde5,0x3f113f553f7a3f7c,0x3f793f4d3efe3de5,0x3e3a3f0e3f573f7c,0x3f7f3f6f3f323ea9,0xbe723e483f173f60
.quad 0xbe87be80be72be64,0xbea2be9bbe95be8e,0xbf38bf30bf28bf20,0xbf53bf4dbf46bf3f,0xbf79bf74bf6ebf67,0xbf80bf80bf7fbf7c,0xbf75bf7bbf7fbf80,0xbf46bf55bf62bf6d,0xbf2dbf44bf57bf67,0xbe72beb7bef1bf14,0xbe56beb7befebf20,0x3ecb3e803dc9bd66,0x3ea23e0fbd2cbe64,0x3f5e3f443f223ef8,0x3f413f1a3ed83e64,0x3f7e3f7f3f753f60
.quad 0x3f7c3f6a3f4a3f20,0x3f383f5c3f753f80,0x3f703f7f3f7c3f67,0x3e1d3ed13f223f51,0x3f223f553f753f80,0xbef1be483dc93ec4,0x3e1d3eeb3f383f67,0xbf68bf3abef1be2c,0xbebdbce63ea23f20,0xbf7abf7dbf62bf2b,0xbf4abf02be1d3e64,0xbf28bf63bf7fbf76,0xbf7ebf5cbf17be64,0xbd8fbeebbf46bf76,0xbf6bbf80bf65bf20,0x3f0b3e0fbe95bf2b
.quad 0xbebdbeb7beb0bea9,0xbed8bed1becbbec4,0xbf68bf63bf5ebf59,0xbf77bf74bf70bf6d,0xbf73bf78bf7cbf7e,0xbf53bf5cbf65bf6d,0xbef1bf0ebf22bf35,0xbdc9be48be95bec4,0x3e873e0f3c66bde5,0x3f323f1a3efe3ec4,0x3f5b3f443f283f08,0x3f7f3f7f3f793f6d,0x3f7a3f803f7d3f72,0x3f173f3a3f573f6d,0x3f113f3a3f5b3f72,0xbe72bce63e3a3ec4
.quad 0xbe1d3dac3ea23f08,0xbf65bf44bf17bec4,0xbf4abf1abebdbde5,0xbf6bbf7dbf7ebf6d,0xbf7fbf7bbf62bf35,0xbe95bf0ebf46bf6d,0xbf28bf5cbf7abf7e,0x3f0b3e80bd8fbec4,0x3d2cbe9bbf1dbf59,0x3f7e3f633f2d3ec4,0x3f383ed13d2cbea9,0x3f3c3f6f3f803f6d,0x3f803f6a3f2d3ea9,0xbd2c3eb73f323f6d,0x3f3c3f743f7e3f59,0xbf4abeebbd2c3ec4
.quad 0xbef1beebbee5bede,0xbf05bf02befebef8,0xbf7fbf7dbf7cbf7a,0xbf7fbf80bf80bf80,0xbf22bf30bf3cbf48,0xbecbbeebbf05bf14,0x3e953e483dc98000,0x3f223f0e3ef13ec4,0x3f753f6a3f5b3f48,0x3f7a3f7f3f803f7c,0x3f463f5c3f6e3f7a,0x3e873ed13f0b3f2b,0xbdc93dac3e873ede,0xbf3cbf1abee5be8e,0xbf62bf44bf1dbede,0xbf70bf7dbf7fbf76
.quad 0xbf62bf78bf80bf7a,0xbe01beb7bf11bf3f,0xbdc9beb7bf17bf48,0x3f533f253ed83e2c,0x3f463f0e3e958000,0x3f623f7b3f7f3f6d,0x3f753f803f703f48,0xbc663e9b3f173f51,0x3e953f1a3f573f7a,0xbf65bf30becbbd66,0xbf22be9b3d8f3ede,0xbf4fbf78bf7ebf60,0xbf7fbf74bf41bede,0x3e1dbe80bf1dbf60,0xbef1bf4dbf7abf7a,0x3f733f3a3ebdbd66
.quad 0xbf11bf0ebf0bbf08,0xbf1dbf1abf17bf14,0xbf79bf7bbf7dbf7e,0xbf6bbf6fbf73bf76,0xbe01be48be87bea9,0x3e1d3dac3c66bd66,0x3f623f553f463f35,0x3f7f3f7b3f753f6d,0x3f413f553f653f72,0x3eb03eeb3f113f2b,0xbeb0be48bd2c3de5,0xbf53bf3abf1dbef8,0xbf80bf7bbf6ebf59,0xbf41bf5cbf70bf7c,0xbebdbf0ebf38bf59,0x3ee53e803d2cbe2c
.quad 0x3f3c3f0e3eb03de5,0x3f7a3f803f773f60,0x3f653f7b3f7f3f72,0x3d2c3e9b3f0b3f3f,0xbdc93e483ef13f35,0xbf75bf55bf22bec4,0xbf77bf55bf1dbea9,0xbf05bf44bf6ebf80,0xbf17bf55bf79bf7e,0x3f323ed13d8fbe8e,0x3f0b3e48be3abf08,0x3f5e3f7d3f793f51,0x3f7a3f7b3f533f08,0xbe873e0f3f053f51,0x3e1d3f0e3f5b3f7e,0xbf80bf6abf28be8e
.quad 0xbf28bf25bf22bf20,0xbf32bf30bf2dbf2b,0xbf57bf5cbf62bf67,0xbf3cbf44bf4abf51,0x3ed83eb73e953e64,0x3f283f1a3f0b3ef8,0x3f753f7b3f7f3f80,0x3f463f553f623f6d,0xbe1dbce63dc93e64,0xbf1dbf02becbbe8e,0xbf80bf7dbf75bf67,0xbf4fbf63bf73bf7c,0xbe01be9bbef1bf20,0x3f113ed13e723d66,0x3f773f633f463f20,0x3f573f6f3f7d3f80
.quad 0x3ecb3f1a3f463f67,0xbf05be9bbd8f3e2c,0xbf5bbf30bef1be64,0xbf5ebf78bf80bf76,0xbf22bf55bf75bf80,0x3ef13e48bdc9bec4,0x3f2d3ed13dc9be64,0x3f653f7d3f7c3f60,0x3f533f783f7f3f67,0xbed8bdac3e873f14,0xbee5bdac3e953f20,0xbf6bbf80bf70bf3f,0xbf73bf7fbf62bf20,0x3ebdbce6bed8bf3f,0x3e3abe80bf22bf67,0x3f703f7f3f5e3f14
.quad 0xbf3cbf3abf38bf35,0xbf46bf44bf41bf3f,0xbf1dbf25bf2dbf35,0xbef1bf02bf0bbf14,0x3f573f4d3f413f35,0x3f753f6f3f683f60,0x3ef13f0e3f223f35,0x3dc93e483e953ec4,0xbf6bbf5cbf4abf35,0xbf7fbf80bf7dbf76,0xbea2beebbf17bf35,0x3e953e0fbc66be2c,0x3f793f6a3f533f35,0x3f623f743f7e3f80,0x3e1d3eb73f0b3f35,0xbf22beebbe87bd66
.quad 0xbf7fbf74bf5bbf35,0xbf22bf4dbf6bbf7c,0x3c66be80befebf35,0x3f623f3a3f053e8e,0x3f7f3f7b3f623f35,0x3e953f0e3f463f6d,0xbe3a3e0f3ee53f35,0xbf7fbf6abf3cbef8,0xbf77bf7fbf68bf35,0x3dc9be80bf11bf51,0x3eb0bce6becbbf35,0x3f753f7f3f653f2b,0x3f683f803f6e3f35,0xbef1bdac3ea23f2b,0xbefebdac3eb03f35,0xbf46bf78bf7cbf51
.quad 0xbf4fbf4dbf4abf48,0xbf57bf55bf53bf51,0xbea2beb7becbbede,0xbe1dbe48be72be8e,0x3f803f7f3f7d3f7a,0x3f773f7b3f7e3f80,0xbe95be48bdc98000,0xbf22bf0ebef1bec4,0xbf53bf63bf70bf7a,0xbee5bf0ebf28bf3f,0x3f4a3f303f113ede,0x3f803f7b3f703f60,0x3eb03f023f283f48,0xbebdbe48bc663e2c,0xbf80bf78bf65bf48,0xbf32bf55bf6ebf7c
.quad 0x3e873ce6be56bede,0x3f703f553f2d3ef8,0x3f573f743f803f7a,0xbd8f3e483ee53f2b,0xbf46bf0ebe958000,0xbf62bf7bbf7fbf6d,0xbebdbf25bf5bbf7a,0x3f4a3f0e3e87bd66,0x3f7f3f6a3f383ede,0x3e723f0e3f4f3f76,0xbe723e0f3efe3f48,0xbf7cbf7bbf57bf14,0xbf5bbf7dbf77bf48,0x3f113e48be56bf14,0x3f413ed1bc66bede,0x3f053f553f7d3f76
.quad 0xbf5ebf5cbf5bbf59,0xbf65bf63bf62bf60,0x3c66bce6bd8fbde5,0x3e3a3e0f3dc93d66,0x3f5b3f633f6b3f72,0x3f2d3f3a3f463f51,0xbf62bf55bf46bf35,0xbf7fbf7bbf75bf6d,0x3d2cbdacbe56bea9,0x3f053ed13e953e2c,0x3f573f6a3f773f7e,0x3ebd3f023f223f3f,0xbf65bf4dbf2dbf08,0xbf77bf7fbf7fbf76,0x3d8fbe0fbeb0bf08,0x3f4a3f253ef13e8e
.quad 0x3f533f6f3f7e3f7e,0x3c663e803ef13f2b,0xbf68bf44bf11bea9,0xbf4fbf6fbf7fbf7c,0x3dc9be48bef1bf35,0x3f753f553f223ec4,0x3f4f3f743f803f72,0xbeb0bce63e953f14,0xbf6bbf3abee5bde5,0xbf0bbf4dbf75bf80,0x3e01be80bf17bf59,0x3f7f3f743f463ef8,0x3f4a3f783f7d3f59,0xbf28be9b3dc93ef8,0xbf6ebf30bea23de5,0xbe56bf1abf62bf80
.quad 0xbf6bbf6abf68bf67,0xbf70bf6fbf6ebf6d,0x3eb03e9b3e873e64,0x3efe3eeb3ed83ec4,0x3ee53f023f113f20,0x3e3a3e803ea23ec4,0xbf75bf7bbf7fbf80,0xbf46bf55bf62bf6d,0x3f5e3f4d3f383f20,0x3f803f7d3f773f6d,0xbe72bdac3d8f3e64,0xbf41bf25bf05bec4,0xbf0bbf30bf4fbf67,0x3e1dbce6be56bec4,0x3f7c3f803f793f67,0x3f053f303f533f6d
.quad 0xbf4fbf25bee5be64,0xbf73bf7fbf7dbf6d,0x3e01be0fbecbbf20,0x3f6e3f4d3f1d3ec4,0x3f223f553f753f80,0xbef1be483dc93ec4,0xbf7fbf78bf57bf20,0xbe56bf02bf41bf6d,0x3f3c3eeb3e01be64,0x3f4a3f743f803f6d,0xbc663eb73f2d3f67,0xbf80bf6abf32bec4,0xbf38bf6fbf80bf67,0x3f3c3ed13c66bec4,0x3f803f633f1d3e64,0xbe013e9b3f2d3f6d
.quad 0xbf75bf74bf73bf72,0xbf79bf78bf77bf76,0x3f223f1a3f113f08,0x3f413f3a3f323f2b,0xbdc9bce63d2c3de5,0xbebdbe9bbe72be2c,0xbef1bf0ebf22bf35,0xbdc9be48be95bec4,0x3f623f6f3f793f7e,0x3f0b3f253f3c3f51,0xbf7fbf78bf6bbf59,0xbf5ebf6fbf7abf80,0x3f463f253efe3ea9,0x3f803f7d3f733f60,0xbe95bdac3e013ea9,0xbf68bf4dbf28bef8
.quad 0xbe95bf02bf32bf59,0x3f1d3ed13e3abd66,0x3f463f6a3f7d3f7e,0xbe3a3dac3eb03f14,0xbf7fbf7bbf62bf35,0xbe95bf0ebf46bf6d,0x3f623f303ed83de5,0x3f323f633f7d3f7c,0xbef1be0f3e563f08,0xbf73bf80bf6ebf3f,0xbdc9beebbf41bf72,0x3f7d3f5c3f1d3e8e,0x3f223f633f7f3f72,0xbf4fbf02be013e8e,0xbf75bf7dbf57bf08,0x3ee53ce6becbbf3f
.quad 0xbf7cbf7bbf7abf7a,0xbf7ebf7dbf7dbf7c,0x3f5b3f553f4f3f48,0x3f6e3f6a3f653f60,0xbf1dbf0ebefebede,0xbf4fbf44bf38bf2b,0x3e953e483dc98000,0x3f223f0e3ef13ec4,0x3d8f3e483ea23ede,0xbed8be9bbe3abd66,0xbed8bf0ebf2dbf48,0x3e3a3ce6be01be8e,0x3f383f553f6b3f7a,0x3d8f3e803ed83f14,0xbf6bbf7bbf80bf7a,0xbea2bf02bf2dbf51
.quad 0x3f803f7b3f683f48,0x3f0b3f3a3f5e3f76,0xbf73bf55bf28bede,0xbf3cbf63bf7abf80,0x3f463f0e3e958000,0x3f623f7b3f7f3f6d,0xbefebe483e013ede,0xbf79bf7fbf6bbf3f,0x3e1dbe48bf05bf48,0x3f803f6f3f413ef8,0x3e563f0e3f533f7a,0xbf77bf4dbf05be2c,0xbf0bbf55bf7cbf7a,0x3f5e3f1a3e72be2c,0x3f4f3f7b3f793f48,0xbf38beb73d8f3ef8
.quad 0xbf7fbf7fbf7fbf7e,0xbf80bf80bf80bf80,0x3f7a3f783f753f72,0x3f803f7f3f7e3f7c,0xbf70bf6abf62bf59,0xbf7fbf7dbf7abf76,0x3f623f553f463f35,0x3f7f3f7b3f753f6d,0xbf4fbf3abf22bf08,0xbf7ebf78bf6ebf60,0x3f383f1a3ef13ea9,0x3f7d3f743f653f51,0xbf1dbeebbe95bde5,0xbf7cbf6fbf5bbf3f,0x3efe3e9b3dc9bde5,0x3f7a3f6a3f4f3f2b
.quad 0xbebdbe0f3dc93ea9,0xbf79bf63bf41bf14,0x3e72bce6be95bf08,0x3f773f5c3f323ef8,0xbdc93e483ef13f35,0xbf75bf55bf22bec4,0xbd2cbeb7bf22bf59,0x3f733f4d3f113e8e,0x3e3a3f023f463f72,0xbf70bf44befebe2c,0xbea2bf25bf62bf7e,0x3f6e3f3a3ed83d66,0x3ee53f443f753f7e,0xbf6bbf30beb03d66,0xbf11bf5cbf7fbf72,0x3f683f253e87be2c
.quad 0xbf80,0x0,0x3f80,0x0,0xbf80,0x0,0x3f80,0x0,0xbf80,0x0,0x3f80,0x0,0xbf80,0x0,0x3f80,0x0
.quad 0xbf80,0x0,0x3f80,0x0,0xbf80,0x0,0x3f80,0x0,0xbf80,0x0,0x3f80,0x0,0xbf80,0x0,0x3f80,0x0
.quad 0x0,0x0,0x0,0x0,0x0,0x0,0x0,0x0,0x0,0x0,0x0,0x0,0x0,0x0,0x0,0x0
.quad 0x0,0x0,0x0,0x0,0x0,0x0,0x0,0x0,0x0,0x0,0x0,0x0,0x0,0x0,0x0,0x0
.quad 0x3e643f203f673f80,0xbf80bf67bf20be64,0x3e0f3f143f633f80,0xbf7bbf76bf3abea9,0x3d663f083f603f80,0xbf6dbf7ebf51bede,0xbce63ef83f5c3f80,0xbf55bf80bf63bf08,0xbde53ede3f593f80,0xbf35bf7abf72bf20,0xbe483ec43f553f80,0xbf0ebf6dbf7bbf35,0xbe8e3ea93f513f80,0xbec4bf59bf80bf48,0xbeb73e8e3f4d3f80,0xbe48bf3fbf7fbf59
.quad 0xbede3e643f483f80,0x8000bf20bf7abf67,0xbf023e2c3f443f80,0x3e48bef8bf6fbf72,0xbf143de53f3f3f80,0x3ec4bea9bf60bf7a,0xbf253d663f3a3f80,0x3f0ebe2cbf4dbf7e,0xbf3500003f353f80,0x3f358000bf35bf80,0xbf44bd663f303f80,0x3f553e2cbf1abf7e,0xbf51bde53f2b3f80,0x3f6d3ea9bef8bf7a,0xbf5cbe2c3f253f80,0x3f7b3ef8beb7bf72
.quad 0x3e64be64bf20bf67,0x3f673f803f673f20,0x3f023d66bed1bf48,0x3f253f6d3f7f3f59,0x3f3f3ea9be2cbf20,0x3e8e3f353f763f7a,0x3f6a3f143dacbede,0xbe0f3ec43f4d3f7e,0x3f7e3f483ea9be64,0xbf0800003f083f67,0x3f7b3f6d3f0e8000,0xbf55bec43e483f35,0x3f603f7e3f3f3e64,0xbf7cbf35be2c3ede,0x3f303f7c3f633ede,0xbf78bf6dbf023de5
.quad 0x3ede3f673f7a3f20,0xbf48bf80bf48be64,0x3e0f3f3f3f803f48,0xbeebbf6dbf74bf08,0xbe2c3f083f763f67,0xbd66bf35bf80bf48,0xbeeb3e8e3f5c3f7a,0x3eb7bec4bf6abf72,0xbf3500003f353f80,0x3f358000bf35bf80,0xbf63be8e3f023f7a,0x3f6f3ec4bed1bf72,0xbf7cbf083e8e3f67,0x3f803f35bd66bf48,0xbf7dbf3f3ce63f48,0x3f633f6d3e9bbf08
.quad 0xbf20be643e643f20,0xbf20bf67bf80bf67,0xbf6fbf2bbe803e64,0xbce6bef8bf55bf7e,0xbf7cbf72bf2bbe64,0x3f143de5bec4bf48,0xbf44bf7cbf6fbf20,0x3f743f2b3e48bea9,0xbea9bf48bf7ebf67,0x3f723f7a3f353e64,0x3e48bec4bf55bf80,0x3f0e3f6d3f7b3f35,0x3f2b3de5bef8bf67,0xbd663f083f6d3f7a,0x3f743f14bce6bf20,0xbf25bd663f0e3f72
.quad 0x3f7a3f673edebe64,0xbf7abf2000003f20,0x3f3a3f803f4d3e64,0xbf6abf76bf0e3de5,0x3e8e3f593f7c3f20,0xbef8bf72bf6dbede,0xbe803ef83f743f67,0x3e0fbf14bf7bbf59,0xbf3500003f353f80,0x3f358000bf35bf80,0xbf78bef83e9b3f67,0x3f7d3f14be48bf59,0xbf76bf59be2c3f20,0x3f603f723ec4bede,0xbf30bf80bf1a3e64,0x3ed13f763f553de5
.quad 0x3f673f203e64be64,0x3e643f203f673f80,0x3f743f7c3f4d3ede,0xbf1abe2c3e9b3f35,0x3ef83f593f803f67,0xbf80bf59bef80000,0xbe803e8e3f3a3f7a,0xbf30bf76bf78bf35,0xbf59bede3de53f20,0x3de5bedebf59bf80,0xbf7bbf6dbf0e0000,0x3f553ec4be48bf35,0xbf14bf72bf76bf20,0x3f763f723f148000,0x3e0fbef8bf6abf7a,0x3ed13f603f7d3f35
.quad 0x3f483e64bedebf67,0xbede3e643f483f80,0x3f7f3f513e80bede,0xbf78bf143dac3f35,0x3f2b3f7e3f513e64,0xbf51bf7ebf2b0000,0xbce63f2b3f7f3f48,0xbdacbf3fbf80bf35,0xbf3500003f353f80,0x3f358000bf35bf80,0xbf80bf2b3dac3f48,0x3f7f3f3f3ce6bf35,0xbf3fbf7ebf143e64,0x3f143f7e3f3f8000,0xbdacbf51bf78bede,0xbe803f143f7f3f35
.quad 0xbf80bf67bf20be64,0x3e64be64bf20bf67,0xbf0ebf60bf80bf67,0x3f783f3f3eb7bde5,0x3ec4bde5bf14bf67,0x3f2b3f723f7c3f48,0x3f7b3f3f3e9bbe64,0xbeb73e2c3f253f72,0x3f353f7a3f723f20,0xbf7ebf48bea93e64,0xbe483ec43f553f80,0xbf0ebf6dbf7bbf35,0xbf6dbf083d663f20,0x3ef8bde5bf2bbf7a,0xbf55bf80bf44be64,0x3f803f513e9bbea9
.quad 0x8000bf20bf7abf67,0x3ede3f673f7a3f20,0x3f553e8ebed1bf67,0xbf1a3d663f303f7e,0x3f6d3f723ef8be64,0xbf7cbf59be8e3ede,0x3e483f513f7d3f20,0xbe9bbf60bf78bf08,0xbf3500003f353f80,0x3f358000bf35bf80,0xbf7bbf51be0f3f20,0x3f743f603e80bf08,0xbec4bf72bf60be64,0x3e2c3f593f763ede,0x3f0ebe8ebf6abf67,0xbf4dbd663f3a3f7e
.quad 0x3f673f803f673f20,0xbf20be643e643f20,0xbdac3ec43f443f7a,0xbf6abf80bf5cbf08,0xbf76bf35be8e3e64,0x3e2cbea9bf3fbf7a,0xbf1abf6dbf7dbf48,0x3f7f3f513ed1bde5,0x3f088000bf08bf67,0x3ea93f483f7e3f67,0x3f7b3f6d3f0e8000,0xbf55bec43e483f35,0x3e2c3f353f7c3f67,0xbf3fbf7ebf60bede,0xbf5cbec43e803f48,0x3eebbe2cbf3abf7e
.quad 0xbf48bf80bf48be64,0x3f7a3f673edebe64,0x3e9bbec4bf63bf7a,0x3ce63f2b3f7d3f59,0x3f803f353d66bf20,0xbf76bf083e2c3f48,0x3ed13f6d3f6f3ede,0xbf02bf76bf63bea9,0xbf3500003f353f80,0x3f358000bf35bf80,0xbf6abf6dbeb73ede,0x3f5c3f763eebbea9,0x3d66bf35bf80bf20,0xbe8e3f083f7c3f48,0x3f743ec4beebbf7a,0xbf80bf2b3e0f3f59
.quad 0xbf20bf67bf80bf67,0x3f673f203e64be64,0x3f303e8ebe48bf20,0x3eeb3f513f7d3f72,0x3f513f7e3f6d3f20,0xbf60bf08bd663ede,0xbeeb3d663f0e3f67,0xbf02bf60bf80bf59,0xbf72bf7abf35be64,0x3f593edebde5bf20,0x3e48bec4bf55bf80,0x3f0e3f6d3f7b3f35,0x3f803f593ec4be64,0xbf51bea93e8e3f48,0x3dac3f2b3f7b3f67,0xbf1abf76bf6fbf08
.quad 0xbf7abf2000003f20,0x3f483e64bedebf67,0xbeb7bf60bf7bbf20,0x3f253f7c3f5c3ea9,0x3f603ea9bec4bf67,0xbf3fbde53f143f7a,0x3f1a3f7c3f553e64,0xbf30bf80bf44bde5,0xbf3500003f353f80,0x3f358000bf35bf80,0xbf4dbf7cbf0e3e64,0x3f3a3f803f25bde5,0x3ef8bea9bf6dbf67,0xbf2b3de53f513f7a,0x3f6f3f603e48bf20,0xbf44bf7cbf023ea9
.quad 0x3e643f203f673f80,0xbf80bf67bf20be64,0xbf7dbf51beeb0000,0x3e48be8ebf30bf72,0xbd66bf08bf60bf80,0x3f6d3f7e3f513ede,0x3f803f603f028000,0xbf0ebd663eeb3f59,0xbde53ede3f593f80,0xbf35bf7abf72bf20,0xbf7bbf6dbf0e0000,0x3f553ec4be48bf35,0x3e8ebea9bf51bf80,0x3ec43f593f803f48,0x3f6f3f763f1a8000,0xbf7bbf2bbdac3f08
.quad 0xbede3e643f483f80,0x8000bf20bf7abf67,0xbf5cbf7cbf250000,0x3f7b3f603eb7bea9,0x3f14bde5bf3fbf80,0xbec43ea93f603f7a,0x3f443f803f308000,0xbf55bf7cbf1a3de5,0xbf3500003f353f80,0x3f358000bf35bf80,0xbf25bf80bf3a0000,0x3f0e3f7c3f4d3de5,0x3f513de5bf2bbf80,0xbf6dbea93ef83f7a,0x3f023f7c3f448000,0xbe48bf60bf6fbea9
.quad 0x3e64be64bf20bf67,0x3f673f803f673f20,0x3f5c3f803f6a3f20,0xbf44bec43dac3f08,0xbf3fbea93e2c3f20,0xbe8ebf35bf76bf7a,0xbed1bf51bf7fbf67,0x3f7d3f6d3f1a3de5,0x3f7e3f483ea9be64,0xbf0800003f083f67,0xbe483ec43f553f80,0xbf0ebf6dbf7bbf35,0xbf60bf7ebf3fbe64,0x3f7c3f353e2cbede,0x3f3a3e2cbeebbf67,0xbe803ec43f5c3f7e
.quad 0x3ede3f673f7a3f20,0xbf48bf80bf48be64,0xbf7dbf2bbce63f20,0x3f633ec4be9bbf59,0x3e2cbf08bf76bf67,0x3d663f353f803f48,0x3f633f763f02be64,0xbf6fbf6dbed13ea9,0xbf3500003f353f80,0x3f358000bf35bf80,0xbeebbf76bf5cbe64,0x3eb73f6d3f6a3ea9,0x3f7c3f08be8ebf67,0xbf80bf353d663f48,0xbe0f3f2b3f803f20,0x3eebbec4bf74bf59
.quad 0xbf20be643e643f20,0xbf20bf67bf80bf67,0xbeb7bf3fbf78bf7a,0x3f803f603f0e3de5,0x3f7c3f723f2b3e64,0xbf14bde53ec43f48,0xbf25be2c3eb73f48,0xbe9bbf3fbf7bbf72,0xbea9bf48bf7ebf67,0x3f723f7a3f353e64,0x3f7b3f6d3f0e8000,0xbf55bec43e483f35,0xbf2bbde53ef83f67,0x3d66bf08bf6dbf7a,0xbe9bbf51bf80bf48,0x3f443f803f553ea9
.quad 0x3f7a3f673edebe64,0xbf7abf2000003f20,0xbf30bd663f1a3f7a,0x3ed1be8ebf55bf7e,0xbe8ebf59bf7cbf20,0x3ef83f723f6d3ede,0x3f783f603e9bbede,0xbf7dbf51be483f08,0xbf3500003f353f80,0x3f358000bf35bf80,0xbe80bf60bf74bede,0x3e0f3f513f7b3f08,0x3f763f593e2cbf20,0xbf60bf72bec43ede,0xbf3a3d663f4d3f7a,0x3f6a3e8ebf0ebf7e
.quad 0x3f673f203e64be64,0x3e643f203f673f80,0xbe9b3e2c3f1a3f67,0xbf4dbf7cbf74bf35,0xbef8bf59bf80bf67,0x3f803f593ef88000,0x3f783f763f303e64,0xbf3abe8e3e803f35,0xbf59bede3de53f20,0x3de5bedebf59bf80,0x3e48bec4bf55bf80,0x3f0e3f6d3f7b3f35,0x3f143f723f763f20,0xbf76bf72bf140000,0xbf7dbf60bed13e64,0x3f6a3ef8be0fbf35
.quad 0x3f483e64bedebf67,0xbede3e643f483f80,0xbdac3f143f783f67,0xbe80bf51bf7fbf35,0xbf2bbf7ebf51be64,0x3f513f7e3f2b8000,0x3f803f3f3dacbf20,0xbf7fbf2b3ce63f35,0xbf3500003f353f80,0x3f358000bf35bf80,0xbce6bf3fbf7fbf20,0xbdac3f2b3f803f35,0x3f3f3f7e3f14be64,0xbf14bf7ebf3f0000,0xbf7fbf143e803f67,0x3f783f513dacbf35
.quad 0xbf80bf67bf20be64,0x3e64be64bf20bf67,0x3f553ef83ce6bede,0x3e803f2b3f6f3f7e,0xbec43de53f143f67,0xbf2bbf72bf7cbf48,0xbe48bf2bbf74bf7a,0x3f6f3f7c3f443ea9,0x3f353f7a3f723f20,0xbf7ebf48bea93e64,0xbf7bbf6dbf0e0000,0x3f553ec4be48bf35,0x3f6d3f08bd66bf20,0xbef83de53f2b3f7a,0xbf0e3d663f253f7a,0x3ce6bf14bf74bf72
.quad 0x8000bf20bf7abf67,0x3ede3f673f7a3f20,0x3f0e3f763f6a3ede,0xbf4dbf80bf3abde5,0xbf6dbf72bef83e64,0x3f7c3f593e8ebede,0x3f7b3f14be0fbf48,0xbf74bef83e803f59,0xbf3500003f353f80,0x3f358000bf35bf80,0x3e48bf14bf7dbf48,0xbe9b3ef83f783f59,0x3ec43f723f603e64,0xbe2cbf59bf76bede,0xbf55bf76bed13ede,0x3f1a3f803f30bde5
.quad 0x3f673f803f673f20,0xbf20be643e643f20,0xbf7fbf6dbf25be64,0x3ed1bd66bf02bf59,0x3f763f353e8ebe64,0xbe2c3ea93f3f3f7a,0xbf4dbec43e0f3f20,0xbdacbf14bf6abf7e,0x3f088000bf08bf67,0x3ea93f483f7e3f67,0xbe483ec43f553f80,0xbf0ebf6dbf7bbf35,0xbe2cbf35bf7cbf67,0x3f3f3f7e3f603ede,0x3f023f6d3f783f20,0xbf63bf7cbf30bde5
.quad 0xbf48bf80bf48be64,0x3f7a3f673edebe64,0x3f743f6d3eebbe64,0xbf80bf3fbe0f3f08,0xbf80bf35bd663f20,0x3f763f08be2cbf48,0x3f6a3ec4beb7bf67,0xbf5cbe8e3eeb3f72,0xbf3500003f353f80,0x3f358000bf35bf80,0x3ed1bec4bf6fbf67,0xbf023e8e3f633f72,0xbd663f353f803f20,0x3e8ebf08bf7cbf48,0xbe9bbf6dbf63be64,0xbce63f3f3f7d3f08
.quad 0xbf20bf67bf80bf67,0x3f673f203e64be64,0x3f3a3f763f7b3f48,0xbf63bf14be0f3ea9,0xbf51bf7ebf6dbf20,0x3f603f083d66bede,0x3f633f803f553ede,0xbf5cbef83ce63f08,0xbf72bf7abf35be64,0x3f593edebde5bf20,0x3f7b3f6d3f0e8000,0xbf55bec43e483f35,0xbf80bf59bec43e64,0x3f513ea9be8ebf48,0x3f7f3f3f3e48bede,0xbf4dbe8e3eb73f59
.quad 0xbf7abf2000003f20,0x3f483e64bedebf67,0x3f6f3ef8be48bf48,0xbf44be2c3f023f72,0xbf60bea93ec43f67,0x3f3f3de5bf14bf7a,0x3f4d3e2cbf0ebf7a,0xbf3abd663f253f7e,0xbf3500003f353f80,0x3f358000bf35bf80,0x3f1abe2cbf55bf7a,0xbf303d663f443f7e,0xbef83ea93f6d3f67,0x3f2bbde5bf51bf7a,0x3eb7bef8bf7bbf48,0xbf253e2c3f5c3f72
.quad 0x3f80,0x0,0xbf80,0x0,0x3f80,0x0,0xbf80,0x0,0x3f80,0x0,0xbf80,0x0,0x3f80,0x0,0xbf80,0x0
.quad 0x3f80,0x0,0xbf80,0x0,0x3f80,0x0,0xbf80,0x0,0x3f80,0x0,0xbf80,0x0,0x3f80,0x0,0xbf80,0x0
.quad 0x0,0x0,0x0,0x0,0x0,0x0,0x0,0x0,0x0,0x0,0x0,0x0,0x0,0x0,0x0,0x0
.quad 0x0,0x0,0x0,0x0,0x0,0x0,0x0,0x0,0x0,0x0,0x0,0x0,0x0,0x0,0x0,0x0
.quad 0xbf7abf48bede8000,0x8000bedebf48bf7a,0xbf7dbf51beeb8000,0x3e48be8ebf30bf72,0xbf80bf59bef88000,0x3ec4bde5bf14bf67,0xbf80bf60bf028000,0x3f0e3d66beebbf59,0xbf7ebf67bf088000,0x3f353e64bea9bf48,0xbf7bbf6dbf0e8000,0x3f553ec4be48bf35,0xbf76bf72bf148000,0x3f6d3f08bd66bf20,0xbf6fbf76bf1a8000,0x3f7b3f2b3dacbf08
.quad 0xbf67bf7abf208000,0x3f803f483e64bede,0xbf5cbf7cbf258000,0x3f7b3f603eb7bea9,0xbf51bf7ebf2b8000,0x3f6d3f723ef8be64,0xbf44bf80bf308000,0x3f553f7c3f1abde5,0xbf35bf80bf358000,0x3f353f803f358000,0xbf25bf80bf3a8000,0x3f0e3f7c3f4d3de5,0xbf14bf7ebf3f8000,0x3ec43f723f603e64,0xbf02bf7cbf448000,0x3e483f603f6f3ea9
.quad 0x3f7a3f7a3f483ede,0xbede80003ede3f48,0x3f5c3f803f6a3f20,0xbf44bec43dac3f08,0x3f2b3f723f7c3f48,0xbf76bf35be8e3e64,0x3ed13f513f7f3f67,0xbf7dbf6dbf1abde5,0x3de53f203f723f7a,0xbf59bf80bf59bede,0xbe483ec43f553f80,0xbf0ebf6dbf7bbf35,0xbef83de53f2b3f7a,0xbe2cbf35bf7cbf67,0xbf3abe2c3eeb3f67,0x3e80bec4bf5cbf7e
.quad 0xbf67bede3e643f48,0x3f208000bf20bf7a,0xbf7dbf2bbce63f20,0x3f633ec4be9bbf59,0xbf7cbf59be8e3ede,0x3f803f353d66bf20,0xbf63bf76bf023e64,0x3f6f3f6d3ed1bea9,0xbf35bf80bf358000,0x3f353f803f358000,0xbeebbf76bf5cbe64,0x3eb73f6d3f6a3ea9,0xbe2cbf59bf76bede,0xbd663f353f803f20,0x3e0fbf2bbf80bf20,0xbeeb3ec43f743f59
.quad 0xbf48bf7abf7abf48,0x3f483ede8000bede,0xbeb7bf3fbf78bf7a,0x3f803f603f0e3de5,0x3e2cbea9bf3fbf7a,0x3f513f7e3f6d3f20,0x3f253e2cbeb7bf48,0x3e9b3f3f3f7b3f72,0x3f723f203de5bede,0xbea93e643f353f7a,0x3f7b3f6d3f0e8000,0xbf55bec43e483f35,0x3f3f3f7e3f603ede,0xbf80bf59bec43e64,0x3e9b3f513f803f48,0xbf44bf80bf55bea9
.quad 0xbe643ede3f673f7a,0xbe64bf48bf80bf48,0xbf30bd663f1a3f7a,0x3ed1be8ebf55bf7e,0xbf76bf083e2c3f48,0x3f603ea9bec4bf67,0xbf78bf60be9b3ede,0x3f7d3f513e48bf08,0xbf35bf80bf358000,0x3f353f803f358000,0xbe80bf60bf74bede,0x3e0f3f513f7b3f08,0x3e8ebf08bf7cbf48,0xbef83ea93f6d3f67,0x3f3abd66bf4dbf7a,0xbf6abe8e3f0e3f7e
.quad 0x3ede3f483f7a3f7a,0xbf7abf48bede8000,0xbe9b3e2c3f1a3f67,0xbf4dbf7cbf74bf35,0xbf60bf08bd663ede,0xbd66bf08bf60bf80,0xbf78bf76bf30be64,0x3f3a3e8ebe80bf35,0xbf08bf67bf7ebf48,0x3f7e3f673f088000,0x3e48bec4bf55bf80,0x3f0e3f6d3f7b3f35,0x3f513ea9be8ebf48,0xbe8e3ea93f513f80,0x3f7d3f603ed1be64,0xbf6abef83e0f3f35
.quad 0x3f203f7a3f673ede,0xbf67bf7abf208000,0xbdac3f143f783f67,0xbe80bf51bf7fbf35,0xbf3fbde53f143f7a,0x3f14bde5bf3fbf80,0xbf80bf3fbdac3f20,0x3f7f3f2bbce6bf35,0xbf35bf80bf358000,0x3f353f803f358000,0xbce6bf3fbf7fbf20,0xbdac3f2b3f803f35,0x3f2bbde5bf51bf7a,0xbf51bde53f2b3f80,0x3f7f3f14be80bf67,0xbf78bf51bdac3f35
.quad 0x8000bedebf48bf7a,0x3f7a3f7a3f483ede,0x3f553ef83ce6bede,0x3e803f2b3f6f3f7e,0x3f6d3f7e3f513ede,0xbf3fbea93e2c3f20,0x3e483f2b3f743f7a,0xbf6fbf7cbf44bea9,0xbf35be643ea93f48,0xbde5bf20bf72bf7a,0xbf7bbf6dbf0e8000,0x3f553ec4be48bf35,0xbec4bf59bf80bf48,0x3f603f7e3f3f3e64,0x3f0ebd66bf25bf7a,0xbce63f143f743f72
.quad 0x3f803f483e64bede,0xbf67bede3e643f48,0x3f0e3f763f6a3ede,0xbf4dbf80bf3abde5,0xbec43ea93f603f7a,0x3e2cbf08bf76bf67,0xbf7bbf143e0f3f48,0x3f743ef8be80bf59,0xbf35bf80bf358000,0x3f353f803f358000,0x3e48bf14bf7dbf48,0xbe9b3ef83f783f59,0x3f6d3ea9bef8bf7a,0xbf7cbf083e8e3f67,0x3f553f763ed1bede,0xbf1abf80bf303de5
.quad 0xbede80003ede3f48,0xbf48bf7abf7abf48,0xbf7fbf6dbf25be64,0x3ed1bd66bf02bf59,0xbe8ebf35bf76bf7a,0x3f7c3f723f2b3e64,0x3f4d3ec4be0fbf20,0x3dac3f143f6a3f7e,0x3f593f803f593ede,0xbf72bf20bde53ede,0xbe483ec43f553f80,0xbf0ebf6dbf7bbf35,0xbf7cbf35be2c3ede,0x3f2b3de5bef8bf67,0xbf02bf6dbf78bf20,0x3f633f7c3f303de5
.quad 0x3f208000bf20bf7a,0xbe643ede3f673f7a,0x3f743f6d3eebbe64,0xbf80bf3fbe0f3f08,0x3d663f353f803f48,0xbe8ebf59bf7cbf20,0xbf6abec43eb73f67,0x3f5c3e8ebeebbf72,0xbf35bf80bf358000,0x3f353f803f358000,0x3ed1bec4bf6fbf67,0xbf023e8e3f633f72,0x3f803f35bd66bf48,0xbf76bf59be2c3f20,0x3e9b3f6d3f633e64,0x3ce6bf3fbf7dbf08
.quad 0x3f483ede8000bede,0x3ede3f483f7a3f7a,0x3f3a3f763f7b3f48,0xbf63bf14be0f3ea9,0xbf14bde53ec43f48,0xbef8bf59bf80bf67,0xbf63bf80bf55bede,0x3f5c3ef8bce6bf08,0x3ea9be64bf35bf7a,0x3f083f673f7e3f48,0x3f7b3f6d3f0e8000,0xbf55bec43e483f35,0xbd663f083f6d3f7a,0xbf14bf72bf76bf20,0xbf7fbf3fbe483ede,0x3f4d3e8ebeb7bf59
.quad 0xbe64bf48bf80bf48,0x3f203f7a3f673ede,0x3f6f3ef8be48bf48,0xbf44be2c3f023f72,0x3ef83f723f6d3ede,0xbf2bbf7ebf51be64,0xbf4dbe2c3f0e3f7a,0x3f3a3d66bf25bf7e,0xbf35bf80bf358000,0x3f353f803f358000,0x3f1abe2cbf55bf7a,0xbf303d663f443f7e,0x3f603f723ec4bede,0xbf3fbf7ebf143e64,0xbeb73ef83f7b3f48,0x3f25be2cbf5cbf72
.quad 0xbf7abf48bede8000,0x8000bedebf48bf7a,0xbe0fbf14bf63bf80,0x3f7b3f763f3a3ea9,0x3f803f593ef88000,0xbec43de53f143f67,0xbce63ef83f5c3f80,0xbf55bf80bf63bf08,0xbf7ebf67bf088000,0x3f353e64bea9bf48,0x3e48bec4bf55bf80,0x3f0e3f6d3f7b3f35,0x3f763f723f148000,0xbf6dbf083d663f20,0xbeb73e8e3f4d3f80,0xbe48bf3fbf7fbf59
.quad 0xbf67bf7abf208000,0x3f803f483e64bede,0x3f02be2cbf44bf80,0xbe483ef83f6f3f72,0x3f513f7e3f2b8000,0xbf6dbf72bef83e64,0xbf253d663f3a3f80,0x3f0ebe2cbf4dbf7e,0xbf35bf80bf358000,0x3f353f803f358000,0x3f443d66bf30bf80,0xbf55be2c3f1a3f7e,0x3f143f7e3f3f8000,0xbec4bf72bf60be64,0xbf5cbe2c3f253f80,0x3f7b3ef8beb7bf72
.quad 0x3f7a3f7a3f483ede,0xbede80003ede3f48,0xbf02bd663ed13f48,0xbf25bf6dbf7fbf59,0xbf2bbf72bf7cbf48,0x3f763f353e8ebe64,0x3f6a3f143dacbede,0xbe0f3ec43f4d3f7e,0x3de53f203f723f7a,0xbf59bf80bf59bede,0xbf7bbf6dbf0e8000,0x3f553ec4be48bf35,0x3ef8bde5bf2bbf7a,0x3e2c3f353f7c3f67,0x3f303f7c3f633ede,0xbf78bf6dbf023de5
.quad 0xbf67bede3e643f48,0x3f208000bf20bf7a,0xbe0fbf3fbf80bf48,0x3eeb3f6d3f743f08,0x3f7c3f593e8ebede,0xbf80bf35bd663f20,0xbeeb3e8e3f5c3f7a,0x3eb7bec4bf6abf72,0xbf35bf80bf358000,0x3f353f803f358000,0x3f633e8ebf02bf7a,0xbf6fbec43ed13f72,0x3e2c3f593f763ede,0x3d66bf35bf80bf20,0xbf7dbf3f3ce63f48,0x3f633f6d3e9bbf08
.quad 0xbf48bf7abf7abf48,0x3f483ede8000bede,0x3f6f3f2b3e80be64,0x3ce63ef83f553f7e,0xbe2c3ea93f3f3f7a,0xbf51bf7ebf6dbf20,0xbf44bf7cbf6fbf20,0x3f743f2b3e48bea9,0x3f723f203de5bede,0xbea93e643f353f7a,0xbe483ec43f553f80,0xbf0ebf6dbf7bbf35,0xbf3fbf7ebf60bede,0x3f803f593ec4be64,0x3f743f14bce6bf20,0xbf25bd663f0e3f72
.quad 0xbe643ede3f673f7a,0xbe64bf48bf80bf48,0xbf3abf80bf4dbe64,0x3f6a3f763f0ebde5,0x3f763f08be2cbf48,0xbf60bea93ec43f67,0xbe803ef83f743f67,0x3e0fbf14bf7bbf59,0xbf35bf80bf358000,0x3f353f803f358000,0x3f783ef8be9bbf67,0xbf7dbf143e483f59,0xbe8e3f083f7c3f48,0x3ef8bea9bf6dbf67,0xbf30bf80bf1a3e64,0x3ed13f763f553de5
.quad 0x3ede3f483f7a3f7a,0xbf7abf48bede8000,0xbf74bf7cbf4dbede,0x3f1a3e2cbe9bbf35,0x3f603f083d66bede,0x3d663f083f603f80,0xbe803e8e3f3a3f7a,0xbf30bf76bf78bf35,0xbf08bf67bf7ebf48,0x3f7e3f673f088000,0x3f7b3f6d3f0e8000,0xbf55bec43e483f35,0xbf51bea93e8e3f48,0x3e8ebea9bf51bf80,0x3e0fbef8bf6abf7a,0x3ed13f603f7d3f35
.quad 0x3f203f7a3f673ede,0xbf67bf7abf208000,0xbf7fbf51be803ede,0x3f783f14bdacbf35,0x3f3f3de5bf14bf7a,0xbf143de53f3f3f80,0xbce63f2b3f7f3f48,0xbdacbf3fbf80bf35,0xbf35bf80bf358000,0x3f353f803f358000,0x3f803f2bbdacbf48,0xbf7fbf3fbce63f35,0xbf2b3de53f513f7a,0x3f513de5bf2bbf80,0xbdacbf51bf78bede,0xbe803f143f7f3f35
.quad 0x8000bedebf48bf7a,0x3f7a3f7a3f483ede,0x3f0e3f603f803f67,0xbf78bf3fbeb73de5,0xbf6dbf7ebf51bede,0x3f3f3ea9be2cbf20,0x3f7b3f3f3e9bbe64,0xbeb73e2c3f253f72,0xbf35be643ea93f48,0xbde5bf20bf72bf7a,0x3e48bec4bf55bf80,0x3f0e3f6d3f7b3f35,0x3ec43f593f803f48,0xbf60bf7ebf3fbe64,0xbf55bf80bf44be64,0x3f803f513e9bbea9
.quad 0x3f803f483e64bede,0xbf67bede3e643f48,0xbf55be8e3ed13f67,0x3f1abd66bf30bf7e,0x3ec4bea9bf60bf7a,0xbe2c3f083f763f67,0x3e483f513f7d3f20,0xbe9bbf60bf78bf08,0xbf35bf80bf358000,0x3f353f803f358000,0x3f7b3f513e0fbf20,0xbf74bf60be803f08,0xbf6dbea93ef83f7a,0x3f7c3f08be8ebf67,0x3f0ebe8ebf6abf67,0xbf4dbd663f3a3f7e
.quad 0xbede80003ede3f48,0xbf48bf7abf7abf48,0x3dacbec4bf44bf7a,0x3f6a3f803f5c3f08,0x3e8e3f353f763f7a,0xbf7cbf72bf2bbe64,0xbf1abf6dbf7dbf48,0x3f7f3f513ed1bde5,0x3f593f803f593ede,0xbf72bf20bde53ede,0xbf7bbf6dbf0e8000,0x3f553ec4be48bf35,0x3f7c3f353e2cbede,0xbf2bbde53ef83f67,0xbf5cbec43e803f48,0x3eebbe2cbf3abf7e
.quad 0x3f208000bf20bf7a,0xbe643ede3f673f7a,0xbe9b3ec43f633f7a,0xbce6bf2bbf7dbf59,0xbd66bf35bf80bf48,0x3e8e3f593f7c3f20,0x3ed13f6d3f6f3ede,0xbf02bf76bf63bea9,0xbf35bf80bf358000,0x3f353f803f358000,0x3f6a3f6d3eb7bede,0xbf5cbf76beeb3ea9,0xbf80bf353d663f48,0x3f763f593e2cbf20,0x3f743ec4beebbf7a,0xbf80bf2b3e0f3f59
.quad 0x3f483ede8000bede,0x3ede3f483f7a3f7a,0xbf30be8e3e483f20,0xbeebbf51bf7dbf72,0x3f143de5bec4bf48,0x3ef83f593f803f67,0xbeeb3d663f0e3f67,0xbf02bf60bf80bf59,0x3ea9be64bf35bf7a,0x3f083f673f7e3f48,0xbe483ec43f553f80,0xbf0ebf6dbf7bbf35,0x3d66bf08bf6dbf7a,0x3f143f723f763f20,0x3dac3f2b3f7b3f67,0xbf1abf76bf6fbf08
.quad 0xbe64bf48bf80bf48,0x3f203f7a3f673ede,0x3eb73f603f7b3f20,0xbf25bf7cbf5cbea9,0xbef8bf72bf6dbede,0x3f2b3f7e3f513e64,0x3f1a3f7c3f553e64,0xbf30bf80bf44bde5,0xbf35bf80bf358000,0x3f353f803f358000,0x3f4d3f7c3f0ebe64,0xbf3abf80bf253de5,0xbf60bf72bec43ede,0x3f3f3f7e3f14be64,0x3f6f3f603e48bf20,0xbf44bf7cbf023ea9
.quad 0x8000,0x0,0x8000,0x0,0x8000,0x0,0x8000,0x0,0x8000,0x0,0x8000,0x0,0x8000,0x0,0x8000,0x0
.quad 0x8000,0x0,0x8000,0x0,0x8000,0x0,0x8000,0x0,0x8000,0x0,0x8000,0x0,0x8000,0x0,0x8000,0x0
.quad 0x0,0x0,0x0,0x0,0x0,0x0,0x0,0x0,0x0,0x0,0x0,0x0,0x0,0x0,0x0,0x0
.quad 0x0,0x0,0x0,0x0,0x0,0x0,0x0,0x0,0x0,0x0,0x0,0x0,0x0,0x0,0x0,0x0
.quad 0x3e3a3f1a3f653f80,0xbf7fbf6fbf2dbe8e,0x3dc93f0e3f623f80,0xbf75bf7bbf46bec4,0x3c663f023f5e3f80,0xbf62bf80bf5bbef8,0xbd8f3eeb3f5b3f80,0xbf46bf7dbf6bbf14,0xbe1d3ed13f573f80,0xbf22bf74bf77bf2b,0xbe723eb73f533f80,0xbef1bf63bf7ebf3f,0xbea23e9b3f4f3f80,0xbe95bf4dbf80bf51,0xbecb3e803f4a3f80,0xbdc9bf30bf7dbf60
.quad 0xbef13e483f463f80,0x3dc9bf0ebf75bf6d,0xbf0b3e0f3f413f80,0x3e95bed1bf68bf76,0xbf1d3dac3f3c3f80,0x3ef1be80bf57bf7c,0xbf2d3ce63f383f80,0x3f22bdacbf41bf80,0xbf3cbce63f323f80,0x3f463dacbf28bf80,0xbf4abdac3f2d3f80,0x3f623e80bf0bbf7c,0xbf57be0f3f283f80,0x3f753ed1bed8bf76,0xbf62be483f223f80,0x3f7f3f0ebe95bf6d
.quad 0x3ebdbdacbf05bf59,0x3f4a3f7b3f773f3f,0x3f223e48be95bf35,0x3ef13f553f7f3f6d,0x3f573eebbd2cbf08,0x3d8f3f0e3f653f80,0x3f773f303e56bea9,0xbeb03e483f2d3f76,0x3f803f5c3ee5bde5,0xbf32be483ebd3f51,0x3f703f783f283de5,0xbf6ebf0e3c663f14,0x3f4a3f803f533ea9,0xbf80bf55beb03e8e,0x3f113f743f703f08,0xbf65bf7bbf28bd66
.quad 0x3e953f553f7f3f35,0xbf22bf7bbf62bec4,0xbc663f253f7d3f59,0xbe87bf55bf7ebf2b,0xbea23ed13f6b3f72,0x3e1dbf0ebf79bf60,0xbf173e0f3f4a3f7e,0x3f0bbe48bf53bf7c,0xbf4fbe0f3f1d3f7e,0x3f573e48bf11bf7c,0xbf73bed13ecb3f72,0x3f7d3f0ebe72bf60,0xbf80bf253e1d3f59,0x3f773f553e01bf2b,0xbf75bf55bdc93f35,0x3f463f7b3ef1bec4
.quad 0xbf4fbeebbc663ede,0xbeb0bf3abf75bf7c,0xbf7fbf55bef10000,0x3e95be48bf22bf6d,0xbf68bf7fbf53bede,0x3f4f3ed1bdc9bf14,0xbf11bf6abf7ebf48,0x3f803f5c3ef1bd66,0xbd8fbf1abf70bf7a,0x3f4a3f7f3f623ef8,0x3ee5be0fbf2dbf7a,0x3e873f443f7f3f60,0x3f573eb7be87bf48,0xbebd3e803f463f80,0x3f803f443e56bede,0xbf5bbeb73e953f51
.quad 0x3f623f7b3f228000,0xbf7fbf55be953ec4,0x3f053f743f6b3ede,0xbf3cbf80bf46be2c,0x3c663f303f7f3f48,0xbe3abf4dbf7fbf2b,0xbefe3e803f5b3f7a,0x3ee5be9bbf62bf76,0xbf5ebe803f053f7a,0x3f653e9bbef1bf76,0xbf80bf303d8f3f48,0x3f7c3f4d3dc9bf2b,0xbf5bbf74becb3ede,0x3f2d3f803f22be2c,0xbef1bf7bbf460000,0x3dc93f553f753ec4
.quad 0x3f7f3f5c3f0b3de5,0xbe563e803f283f6d,0x3f463f7b3f753f35,0xbf62bf0ebdc93ec4,0x3e013f1a3f6b3f7e,0xbf6ebf7dbf4abec4,0xbf17bdac3ee53f59,0xbea2bf44bf7dbf6d,0xbf7cbf3abe723ea9,0x3f05bce6bf11bf6d,0xbf57bf80bf4fbea9,0x3f7d3f3a3e56bec4,0xbe72bf44bf7fbf59,0x3f413f7f3f5b3ec4,0x3efebe0fbf38bf7e,0xbc663f1a3f773f6d
.quad 0x3f753f0ebdc9bf35,0xbf46be483ef13f6d,0x3f653f783f11bde5,0xbf7cbf5cbea23ec4,0x3eb03f633f773f08,0xbefebf74bf68bec4,0xbecb3eb73f683f72,0x3eb0bed1bf6ebf6d,0xbf6bbeb73ed83f72,0x3f703ed1bebdbf6d,0xbf70bf63be873f08,0x3f5e3f743ed8bec4,0xbee5bf78bf53bde5,0x3e3a3f5c3f733ec4,0x3e95bf0ebf7fbf35,0xbf223e483f623f6d
.quad 0xbf62bf80bf68bf20,0x3f323e9bbe1dbf14,0xbdc9bf0ebf62bf80,0x3f753f7b3f463ec4,0x3f463eb7be1dbf20,0x3e3a3f253f703f7c,0x3f753f783f323e64,0xbf4abeb73e3a3f2b,0x3e953f443f7e3f67,0xbf68bf7dbf41be8e,0xbf22bdac3efe3f67,0xbd2cbf1abf73bf76,0xbf7fbf5cbecb3e64,0x3f5e3ed1be56bf3f,0xbef1bf6abf79bf20,0x3f573f7f3f3c3e2c
.quad 0x3ef1be48bf46bf80,0xbdc93f0e3f753f6d,0x3f7f3f303d2cbf20,0xbf6ebeeb3e723f51,0x3f223f7d3f533e64,0xbf41bf80bf38bd66,0xbe953eeb3f733f67,0x3e72bf02bf77bf60,0xbf75beeb3ea23f67,0x3f793f02be87bf60,0xbf46bf7dbf113e64,0x3f283f803f32bd66,0x3dc9bf30bf80bf20,0xbebd3eeb3f793f51,0x3f623e48bf22bf80,0xbf7fbf0e3e953f6d
.quad 0x3efe3f553f7e3f72,0xbf79bf44becb3d66,0xbf22be483e953f35,0xbef1bf55bf7fbf6d,0xbf73bf7bbf41bea9,0x3f3c3e9bbe56bf2b,0xbd2cbf0ebf68bf7e,0x3f573f803f5e3ef8,0x3f6b3f0e3c66bf08,0xbea23e803f3c3f7c,0x3f323f7b3f6b3f08,0xbf7fbf5cbed83e2c,0xbed83e483f3c3f7e,0xbe3abf3abf7ebf60,0xbf7fbf55bea23ea9,0x3f683eebbe3abf3f
.quad 0xbe95bf55bf7fbf35,0x3f223f7b3f623ec4,0x3f4a3e48befebf72,0xbf173dac3f383f80,0x3f5b3f7b3f17bde5,0xbf6ebf6fbee53e8e,0xbe3a3f0e3f7a3f59,0x3e01bf1abf7dbf51,0xbf7cbf0e3e563f59,0x3f7e3f1abe1dbf51,0xbf05bf7bbf4fbde5,0x3ebd3f6f3f653e8e,0x3f1dbe48bf5ebf72,0xbf4fbdac3f323f80,0x3f753f553dc9bf35,0xbf46bf7bbef13ec4
.quad 0x3d2cbed1bf46bf7a,0x3f733f7d3f533ef8,0x3f7f3f553ef18000,0xbe953e483f223f6d,0x3e723f303f753f7a,0xbf77bf78bf38be8e,0xbf6ebf1abdc93ede,0x3e72be9bbf41bf7c,0xbefebf63bf7fbf48,0x3f7a3f6f3f173d66,0x3f4a3e9bbe95bf48,0xbe3a3ed13f5b3f80,0x3f383f7d3f623ede,0xbf7dbf63bee53e2c,0xbf173ce63f223f7a,0x3e01bf02bf6ebf76
.quad 0xbf62bf7bbf220000,0x3f7f3f553e95bec4,0x3eb0beb7bf62bf7a,0xbd8f3f1a3f7a3f60,0x3f7a3f5c3e95bede,0xbf80bf44be013f14,0xbd8f3f253f7f3f48,0x3c66bf30bf80bf3f,0xbf7fbf253dc93f48,0x3f803f30bd2cbf3f,0xbe56bf5cbf75bede,0x3d2c3f443f7e3f14,0x3f703eb7bef1bf7a,0xbf7fbf1a3e563f60,0x3ef13f7b3f468000,0xbdc9bf55bf75bec4
.quad 0xbf11be0f3ea23f35,0xbf22bf6abf80bf60,0xbf46bf7bbf75bf35,0x3f623f0e3dc9bec4,0x3f323e80be87bf35,0x3e953f3a3f793f76,0x3f283f743f793f35,0xbf7fbf4dbebd3e2c,0xbf4fbeb73e563f35,0x3dc9beebbf5ebf80,0xbf05bf6abf7cbf35,0x3f753f743f1d3d66,0x3f653eebbe1dbf35,0xbef13e0f3f323f7c,0x3ebd3f5c3f7e3f35,0xbf46bf80bf4fbe8e
.quad 0xbf75bf0e3dc93f35,0x3f463e48bef1bf6d,0xbe56bf4dbf7fbf35,0x3ef13f6f3f703ef8,0x3f7e3f25bd2cbf35,0xbf75bf023e563f51,0x3d2c3f3a3f803f35,0xbdc9bf44bf7fbf2b,0xbf80bf3abc663f35,0x3f7f3f443d8fbf2b,0x3e01bf25bf80bf35,0xbe953f023f7a3f51,0x3f7a3f4d3d8fbf35,0xbf62bf6fbeb03ef8,0xbe953f0e3f7f3f35,0x3f22be48bf62bf6d
.quad 0x3f6b3f253e72be64,0x3e013f0e3f5e3f80,0x3dc93f0e3f623f80,0xbf75bf7bbf46bec4,0xbf7abf74bf2dbe64,0x3f283e48bea2bf3f,0x3efebce6bf0bbf67,0x3ed83f553f803f60,0x3f2d3f783f733f20,0xbf80bf55becb3e2c,0xbf68bf023d8f3f20,0x3ecbbe48bf38bf7c,0xbe01bf30bf7cbf67,0x3f2d3f7b3f683ef8,0x3f7c3f633ed8be64,0xbf73bf0e3d8f3f2b
.quad 0xbef13e483f463f80,0x3dc9bf0ebf75bf6d,0xbf32bf7fbf4fbe64,0x3f5e3f7b3f1dbd66,0x3f653eb7bebdbf67,0xbf4fbe483f053f76,0x3e1d3f4d3f7e3f20,0xbe56bf55bf7cbf14,0xbf7dbf4dbe013f20,0x3f7a3f553e3abf14,0x3ee5beb7bf6ebf67,0xbf173e483f5b3f76,0x3f383f7f3f17be64,0xbefebf7bbf4abd66,0xbf62be483f223f80,0x3f7f3f0ebe95bf6d
.quad 0xbf7dbf74bf38bea9,0x3ed8bce6bef1bf51,0x3f223e48be95bf35,0x3ef13f553f7f3f6d,0x3eb03f443f7c3f72,0xbf7dbf6fbf22be2c,0xbf7cbf6fbf1dbde5,0x3f383e80be95bf3f,0x3f283e0fbed8bf59,0x3e013f253f753f76,0x3ea23f4d3f803f59,0xbf5ebf7fbf46be8e,0xbf7abf6abefe3de5,0x3f6b3f02bdc9bf2b,0x3f2d3dacbf0bbf72,0xbe723ed13f623f7c
.quad 0x3e953f553f7f3f35,0xbf22bf7bbf62bec4,0xbf79bf63bebd3ea9,0x3f803f3a3dc9bf14,0x3f323ce6bf28bf7e,0xbf113e0f3f463f80,0x3e873f5c3f793f08,0xbea2bf63bf75bef8,0xbf77bf5cbe723f08,0x3f733f633e95bef8,0x3f38bce6bf41bf7e,0xbf53be0f3f223f80,0x3e723f633f6e3ea9,0x3d2cbf3abf7fbf14,0xbf75bf55bdc93f35,0x3f463f7b3ef1bec4
.quad 0x3f413f783f7a3f48,0xbf57bf02bd8f3ec4,0xbf7fbf55bef10000,0x3e95be48bf22bf6d,0x3f1d3e0fbebdbf48,0x3ecb3f4d3f7e3f6d,0x3e1d3f253f733f7a,0xbf65bf7fbf4fbec4,0xbf53bf80bf5bbede,0x3f793f303e3abec4,0x3f7a3f303e1dbede,0xbf17bce63f0b3f6d,0xbf053dac3f283f7a,0xbd8fbf25bf79bf6d,0xbe87bf4dbf80bf48,0x3f323f7d3f5e3ec4
.quad 0x3f623f7b3f228000,0xbf7fbf55be953ec4,0xbf73bf023e3a3f48,0x3f533e80bee5bf6d,0x3ed8be9bbf5ebf7a,0xbe873eeb3f703f6d,0x3ebd3f6a3f703ede,0xbed8bf6fbf6bbec4,0xbf6ebf6abeb03ede,0x3f683f6f3ecbbec4,0x3f683e9bbefebf7a,0xbf77beeb3eb03f6d,0xbea23f023f7c3f48,0x3f11be80bf65bf6d,0xbef1bf7bbf460000,0x3dc93f553f753ec4
.quad 0xbe95bf30bf70bf7e,0x3f803f633f173e2c,0x3f463f7b3f753f35,0xbf62bf0ebdc93ec4,0xbf7fbf6abf17bde5,0x3f113dacbed8bf51,0x3f623f02bc66bf08,0xbe013ed13f533f80,0xbef13dac3f1d3f72,0xbeb0bf4dbf7fbf60,0xbdc9bf25bf77bf72,0x3f3c3f7d3f653ef8,0x3f223f783f6e3f08,0xbf77bf6fbf0b3d66,0xbf75bf6fbf053de5,0x3f7a3f253d2cbf14
.quad 0x3f753f0ebdc9bf35,0xbf46be483ef13f6d,0xbf223ce63f2d3f7e,0x3ecbbe9bbf5bbf7c,0x3dc9bf1abf7cbf59,0x3d8f3f3a3f803f3f,0x3ef13f743f653ea9,0xbf05bf78bf5ebe8e,0xbf62bf74bee53ea9,0x3f5b3f783efebe8e,0x3f7f3f1abe3abf59,0xbf7fbf3a3c663f3f,0xbf46bce63f3c3f7e,0x3f6b3e9bbf05bf7c,0x3e95bf0ebf7fbf35,0xbf223e483f623f6d
.quad 0xbe873e483f1d3f67,0xbf5bbf7fbf6ebf2b,0xbdc9bf0ebf62bf80,0x3f753f7b3f463ec4,0x3ee53f553f7f3f67,0xbf80bf63bf0bbd66,0xbf3cbf7bbf70bf20,0x3f7a3f3a3e87be8e,0x3f6e3f7b3f383e64,0xbf65bf023d2c3f14,0xbf80bf55bebd3e64,0x3f413e80beb0bf51,0x3f703f0ebd2cbf20,0xbf113ce63f1d3f76,0xbf41be483ee53f67,0x3eb0be9bbf53bf80
.quad 0x3ef1be48bf46bf80,0xbdc93f0e3f753f6d,0xbe013f0e3f773f67,0xbe1dbf44bf80bf3f,0xbe72bf55bf7dbf20,0x3ecb3f6a3f733ef8,0x3f113f7b3f573e64,0xbf1dbf7dbf4fbe2c,0xbf53bf7bbf0b3e64,0x3f4a3f7d3f17be2c,0x3f793f553e1dbf20,0xbf6bbf6abea23ef8,0xbf7ebf0e3e873f67,0x3f7d3f443c66bf3f,0x3f623e48bf22bf80,0xbf7fbf0e3e953f6d
.quad 0x3f3c3eb7bdc9bf08,0x3ee53f4d3f7c3f76,0xbf22be483e953f35,0xbef1bf55bf7fbf6d,0x3f053ce6bef1bf59,0x3efe3f5c3f803f60,0xbecb3e0f3f223f72,0xbf05bf63bf7fbf51,0x3e87be9bbf46bf7e,0x3f0b3f6a3f7d3f3f,0xbe013eeb3f623f7e,0xbf11bf6fbf79bf2b,0xbc66bf1abf75bf72,0x3f173f743f733f14,0x3e1d3f3a3f7f3f59,0xbf1dbf78bf6bbef8
.quad 0xbe95bf55bf7fbf35,0x3f223f7b3f623ec4,0x3ed83f6a3f753f08,0xbf28bf7dbf57be8e,0xbf0bbf78bf62bea9,0x3f2d3f7f3f4a3e2c,0x3f283f7f3f463de5,0xbf32bf80bf3cbd66,0xbf41bf7fbf223de5,0x3f383f803f2dbd66,0x3f573f783ef1bea9,0xbf3cbf7fbf1d3e2c,0xbf68bf6abe953f08,0x3f413f7d3f0bbe8e,0x3f753f553dc9bf35,0xbf46bf7bbef13ec4
.quad 0x0,0x0,0x8000,0x0,0x0,0x0,0x8000,0x0,0x0,0x0,0x8000,0x0,0x0,0x0,0x8000,0x0
.quad 0x0,0x0,0x8000,0x0,0x0,0x0,0x8000,0x0,0x0,0x0,0x8000,0x0,0x0,0x0,0x8000,0x0
.quad 0x0,0x0,0x0,0x0,0x0,0x0,0x0,0x0,0x0,0x0,0x0,0x0,0x0,0x0,0x0,0x0
.quad 0x0,0x0,0x0,0x0,0x0,0x0,0x0,0x0,0x0,0x0,0x0,0x0,0x0,0x0,0x0,0x0
.quad 0xbf7cbf4dbee58000,0x3dc9beb7bf3cbf76,0xbf7fbf55bef18000,0x3e95be48bf22bf6d,0xbf80bf5cbefe8000,0x3ef1bce6bf05bf60,0xbf7fbf63bf058000,0x3f223e0fbecbbf51,0xbf7dbf6abf0b8000,0x3f463e9bbe87bf3f,0xbf79bf6fbf118000,0x3f623eebbe01bf2b,0xbf73bf74bf178000,0x3f753f1a3c66bf14,0xbf6bbf78bf1d8000,0x3f7f3f3a3e1dbef8
.quad 0xbf62bf7bbf228000,0x3f7f3f553e95bec4,0xbf57bf7dbf288000,0x3f753f6a3ed8be8e,0xbf4abf7fbf2d8000,0x3f623f783f0bbe2c,0xbf3cbf80bf328000,0x3f463f7f3f28bd66,0xbf2dbf80bf388000,0x3f223f7f3f413d66,0xbf1dbf7fbf3c8000,0x3ef13f783f573e2c,0xbf0bbf7dbf418000,0x3e953f6a3f683e8e,0xbef1bf7bbf468000,0x3dc93f553f753ec4
.quad 0x3f6e3f7f3f5b3f08,0xbf1dbe483e873f2b,0x3f463f7b3f753f35,0xbf62bf0ebdc93ec4,0x3f0b3f633f803f59,0xbf7fbf55bee53d66,0x3e873f3a3f7a3f72,0xbf70bf7bbf3cbe8e,0xbd2c3f023f653f7e,0xbf38bf7bbf6ebf14,0xbeb03e803f413f7e,0xbebdbf55bf80bf51,0xbf1dbce63f113f72,0x3d2cbf0ebf70bf76,0xbf53be9b3eb03f59,0x3ee5be48bf41bf80
.quad 0xbf75bf0e3dc93f35,0x3f463e48bef1bf6d,0xbf80bf44be1d3f08,0x3f773f0ebe01bf3f,0xbf73bf6abecb3ea9,0x3f7d3f553e72bef8,0xbf4fbf7dbf1d3de5,0x3f573f7b3f11be2c,0xbf17bf7dbf4abde5,0x3f0b3f7b3f533e2c,0xbea2bf6abf6bbea9,0x3e1d3f553f793ef8,0xbc66bf44bf7dbf08,0xbe873f0e3f7e3f3f,0x3e95bf0ebf7fbf35,0xbf223e483f623f6d
.quad 0xbf17bf63bf80bf67,0x3f703f303e95be2c,0xbdc9bf0ebf62bf80,0x3f753f7b3f463ec4,0x3ed8bdacbf11bf67,0x3f173f6a3f7f3f51,0x3f533ed1be01bf20,0xbc663f023f623f80,0x3f7f3f4d3eb0be64,0xbf1dbdac3ef13f60,0x3f653f7d3f3c3e64,0xbf77bf25bdc93ef8,0x3f0b3f6f3f773f20,0xbf6ebf78bf22bd66,0x3d2c3f253f7a3f67,0xbf05bf6fbf75bf14
.quad 0xbef13e483f463f80,0x3dc9bf0ebf75bf6d,0xbf5bbe9b3ecb3f67,0x3f2d3ce6bf22bf7c,0xbf80bf3abd8f3f20,0x3f7c3f1abdc9bf3f,0xbf5ebf78bf053e64,0x3f653f743ef1be8e,0xbefebf78bf5bbe64,0x3ee53f743f623e8e,0x3c66bf3abf7fbf20,0xbe3a3f1a3f7f3f3f,0x3f05be9bbf6bbf67,0xbf3c3ce63f463f7c,0x3f623e48bf22bf80,0xbf7fbf0e3e953f6d
.quad 0x3d8f3f023f573f7e,0xbf7abf78bf41bec4,0xbf22be483e953f35,0xbef1bf55bf7fbf6d,0xbf7ebf4dbecb3de5,0x3ebdbe0fbf1dbf6d,0xbf4fbf7fbf65bf08,0x3f733f253e1dbec4,0xbe3abf30bf79bf72,0x3f5b3f803f533ec4,0x3f0bbce6bf17bf72,0x3e1d3f303f7a3f6d,0x3f793f253d8fbf08,0xbf28bdac3f053f6d,0x3f5e3f7d3f323de5,0xbf80bf4dbe873ec4
.quad 0x3e953f553f7f3f35,0xbf22bf7bbf62bec4,0xbee53e803f533f7e,0x3e3abf02bf73bf6d,0xbf70beeb3e873f59,0x3f5e3e9bbed8bf6d,0xbf6bbf6fbed83ea9,0x3f703f6a3ebdbec4,0xbecbbf6fbf68bea9,0x3eb03f6a3f6e3ec4,0x3eb0beebbf77bf59,0xbefe3e9b3f683f6d,0x3f653e80bf11bf7e,0xbf7cbf023ea23f6d,0x3f753f553dc9bf35,0xbf46bf7bbef13ec4
.quad 0x3ef13ce6bed8bf48,0x3f383f743f7d3f51,0x3f7f3f553ef18000,0xbe953e483f223f6d,0x3f223f6f3f7d3f48,0xbf7cbf44beb03e2c,0xbe953e803f383f7a,0xbf1dbf6fbf7cbf3f,0xbf75bf25be013ede,0x3ed8be0fbf28bf76,0xbf46bf7fbf5ebede,0x3f803f4d3ea2be8e,0x3dc9bf02bf6bbf7a,0x3efe3f6a3f7a3f2b,0x3f623ed1be72bf48,0xbf0b3dac3f2d3f7c
.quad 0x3f623f7b3f228000,0xbf7fbf55be953ec4,0x3dc93f3a3f803f48,0xbebdbf63bf79bf14,0xbf46be0f3f113f7a,0x3f28bce6bf32bf80,0xbf75bf63bea23ede,0x3f793f5c3e87bef8,0xbe95bf63bf73bede,0x3e723f5c3f773ef8,0x3f22be0fbf53bf7a,0xbf41bce63f383f80,0x3f7f3f3abd2cbf48,0xbf6ebf63be723f14,0x3ef13f7b3f468000,0xbdc9bf55bf75bec4
.quad 0xbf5ebf0ebe013ea9,0xbe72bf25bf6bbf80,0xbf46bf7bbf75bf35,0x3f623f0e3dc9bec4,0x3ea2be48bf28bf72,0x3f2d3f743f7a3f3f,0x3f803f553ed8bde5,0xbf0bbce63efe3f60,0x3ecb3f553f803f59,0xbf73bf78bf2dbe2c,0xbf38be483ecb3f59,0x3d8fbf02bf68bf7c,0xbf68bf7bbf2dbde5,0x3f7c3f303e01bef8,0x3d8fbf0ebf73bf72,0x3ed83f633f7c3f2b
.quad 0x3f753f0ebdc9bf35,0xbf46be483ef13f6d,0x3f1d3f7b3f5e3ea9,0xbf4fbf7fbf32bd66,0xbf053e483f4f3f7e,0x3ebdbeb7bf65bf76,0xbf7cbf55be563f08,0x3f7e3f4d3e1dbf14,0xbe3abf55bf7abf08,0x3e013f4d3f7d3f14,0x3f5b3e48bf17bf7e,0xbf6ebeb73ee53f76,0x3f4a3f7b3efebea9,0xbf17bf7fbf383d66,0xbe953f0e3f7f3f35,0x3f22be48bf62bf6d
.quad 0x3f803f6a3f223e64,0xbea23e0f3f113f60,0x3dc93f0e3f623f80,0xbf75bf7bbf46bec4,0xbf79bf3abe953e64,0x3e87be80bf32bf76,0xbebdbf4dbf7fbf67,0x3f793f743f283e2c,0x3f5e3eebbdc9bf20,0xbe563eb73f4f3f80,0x3f1d3f743f753f20,0xbf7cbf6abf053d66,0xbf32be0f3ef13f67,0x3e1dbeebbf65bf7c,0xbf4fbf80bf46be64,0x3f7e3f5c3ebdbe8e
.quad 0x3ef1be48bf46bf80,0xbdc93f0e3f753f6d,0x3f703f6f3ef1be64,0xbf7fbf4dbe563ef8,0xbe563f023f753f67,0x3d2cbf25bf7ebf51,0xbf7fbf44bdc93f20,0x3f803f3a3d2cbf2b,0xbd8fbf44bf7fbf20,0x3c663f3a3f803f2b,0x3f7a3f02be95bf67,0xbf80bf253e013f51,0x3eb03f6f3f623e64,0xbd8fbf4dbf7abef8,0xbf62be483f223f80,0x3f7f3f0ebe95bf6d
.quad 0xbf53bf7dbf73bf35,0x3f463ed1bd2cbef8,0x3f223e48be95bf35,0x3ef13f553f7f3f6d,0x3f383f783f773f35,0xbf75bf30be723e8e,0xbf41be9b3e723f35,0xbdc9bf1abf6ebf7c,0xbf17bf6fbf7abf35,0x3f7f3f633efebd66,0x3f5b3ed1be3abf35,0xbe953e9b3f4a3f80,0x3ee53f633f7d3f35,0xbf62bf7dbf38be2c,0xbf6ebf023e013f35,0x3f223ce6bf17bf76
.quad 0xbe95bf55bf7fbf35,0x3f223f7b3f623ec4,0x3f7a3f1abd8fbf35,0xbf62beb73eb03f60,0x3e013f443f803f35,0xbe95bf5cbf7abf14,0xbf80bf303c663f35,0x3f7f3f25bd8fbf3f,0x3d2cbf30bf80bf35,0xbdc93f253f7f3f3f,0x3f7e3f443d2cbf35,0xbf75bf5cbe563f14,0xbe563f1a3f7f3f35,0x3ef1beb7bf70bf60,0xbf75bf55bdc93f35,0x3f463f7b3ef1bec4
.quad 0x3ecb3f443f793f7a,0xbf7ebf55befebd66,0xbf7fbf55bef18000,0x3e95be48bf22bf6d,0x3e56be9bbf3cbf7a,0x3f413f7b3f733f2b,0x3f5e3f803f573ede,0xbf68bf0ebd2c3ef8,0xbf3cbe803ea23f48,0xbc66bf0ebf6bbf7c,0xbed8bf5cbf7fbf48,0x3f6b3f7b3f323e2c,0x3f7e3f3a3e3abede,0xbf3cbe483ed83f60,0xbe3a3eeb3f683f7a,0xbea2bf55bf7fbf3f
.quad 0xbf62bf7bbf228000,0x3f7f3f553e95bec4,0x3f383dacbf17bf7a,0xbefe3e483f4a3f80,0x3ee53f6f3f6e3ede,0xbf17bf7bbf5bbe8e,0xbf7dbf1a3e013f48,0x3f7a3f0ebe3abf51,0x3e1dbf1abf7ebf48,0xbe563f0e3f7c3f51,0x3f653f6f3ebdbede,0xbf4fbf7bbf053e8e,0xbf323dac3f4f3f7a,0x3f5e3e48bf1dbf80,0xbef1bf7bbf468000,0x3dc93f553f753ec4
.quad 0x3e1dbe9bbf32bf72,0x3f683f803f623f14,0x3f463f7b3f753f35,0xbf62bf0ebdc93ec4,0xbf70bf25be3a3ea9,0x3e1dbeb7bf46bf7c,0x3e3abeb7bf4abf7e,0x3f323f783f753f2b,0x3f413f7d3f683f08,0xbf7ebf44be953e8e,0xbf73bf1abd2c3f08,0x3efebdacbf22bf76,0x3e56bed1bf5ebf7e,0x3ecb3f5c3f7f3f3f,0x3f3c3f7f3f573ea9,0xbf79bf6abef13e2c
.quad 0xbf75bf0e3dc93f35,0x3f463e48bef1bf6d,0x3e72beebbf6ebf72,0x3d2c3f303f7f3f51,0x3f383f803f413de5,0xbf53bf7dbf223d66,0xbf77bf023e723f59,0x3f733eebbe95bf60,0x3e87bf02bf79bf59,0xbea23eeb3f753f60,0x3f323f803f28bde5,0xbf11bf7dbf46bd66,0xbf79beeb3ebd3f72,0x3f803f30bdc9bf51,0x3e95bf0ebf7fbf35,0xbf223e483f623f6d
.quad 0xbf28be803e563f20,0xbf0bbf5cbf7fbf6d,0xbdc9bf0ebf62bf80,0x3f753f7b3f463ec4,0x3f4a3f7d3f6e3f20,0xbf6bbf1abe013ec4,0xbf7dbf44bea23e64,0x3ee5bdacbf17bf6d,0x3f113ce6bf05bf67,0x3e723f3a3f7c3f6d,0x3e563f3a3f7d3f67,0xbf4fbf80bf57bec4,0xbf5bbf7fbf41be64,0x3f7f3f443e72bec4,0x3f773f1abc66bf20,0xbf38be0f3efe3f6d
.quad 0xbef13e483f463f80,0x3dc9bf0ebf75bf6d,0xbea2bf5cbf7cbf20,0x3f113f783f653ec4,0x3f683f743efebe64,0xbf77bf63beb03ec4,0xbf6ebed13eb03f67,0x3f683eb7becbbf6d,0x3ebdbed1bf70bf67,0xbed83eb73f6b3f6d,0x3ed83f743f5e3e64,0xbe87bf63bf70bec4,0xbf73bf5cbe3a3f20,0x3f533f783ee5bec4,0x3f623e48bf22bf80,0xbf7fbf0e3e953f6d
.quad 0x3f753f3a3eb0bde5,0x3c663eeb3f4f3f7c,0xbf22be483e953f35,0xbef1bf55bf7fbf6d,0x3dc9bed1bf4fbf7e,0x3f533f7f3f683f14,0x3ef13f5c3f803f59,0xbf7ebf6abf11bd66,0xbf62bf7fbf4abea9,0x3f703f1a3d8fbef8,0x3f7f3f443e87bea9,0xbf2dbe0f3ee53f60,0xbf46be803ebd3f59,0x3e87beb7bf57bf80,0x3e95beb7bf5bbf7e,0x3e563f443f803f51
.quad 0x3e953f553f7f3f35,0xbf22bf7bbf62bec4,0xbf46bf80bf3cbde5,0x3f6b3f743f05be2c,0x3f7f3f4d3e3abf08,0xbf7fbf30bc663f2b,0xbf62be9b3ee53f72,0x3f5b3e80befebf76,0x3ef1be9bbf65bf72,0xbf053e803f5e3f76,0x3dc93f4d3f7c3f08,0x3d8fbf30bf80bf2b,0xbf22bf80bf2d3de5,0x3ecb3f743f5b3e2c,0x3f753f553dc9bf35,0xbf46bf7bbef13ec4
.quad 0xbf77bf7bbf4abede,0x3f053dacbebdbf3f,0x3f7f3f553ef18000,0xbe953e483f223f6d,0xbf65bf0ebd8f3ede,0x3d2cbeebbf57bf80,0x3f2d3e48beb0bf48,0x3e563f303f773f76,0xbebd3e483f323f7a,0xbee5bf5cbf80bf51,0x3c66bf0ebf6ebf7a,0x3f283f783f703f14,0x3eb03f553f803f48,0xbf53bf80bf4abe8e,0xbf28bf7bbf65bede,0x3f703f743f11bd66
.quad 0x3f623f7b3f228000,0xbf7fbf55be953ec4,0xbf7ebf55be873ede,0x3f7d3f25bc66bf2b,0x3f793f0ebe1dbf48,0xbf6bbed13ea23f60,0xbf53be483f0b3f7a,0x3f4a3e0fbf17bf7c,0x3f11be48bf57bf7a,0xbf1d3e0f3f4f3f7c,0xbe723f0e3f7d3f48,0x3ecbbed1bf73bf60,0xbe01bf55bf77bede,0xbe1d3f253f803f2b,0x3ef13f7b3f468000,0xbdc9bf55bf75bec4
.quad 0x3f2d3f6f3f7f3f59,0xbf65bf1abe3a3e8e,0xbf46bf7bbf75bf35,0x3f623f0e3dc9bec4,0x3f5b3f803f623f08,0xbf5ebf02bc663ef8,0xbf6bbf7dbf46bea9,0x3f5b3eebbd8fbf14,0x3f773f743f223de5,0xbf57bed13e1d3f2b,0xbf7ebf63bef13de5,0x3f533eb7be72bf3f,0x3f803f4d3e95bea9,0xbf4fbe9b3ea23f51,0xbf7dbf30bdc93f08,0x3f4a3e80becbbf60
.quad 0x3f753f0ebdc9bf35,0xbf46be483ef13f6d,0xbf68bed13e953f59,0x3f413e0fbf0bbf76,0x3f573e80bef1bf72,0xbf3cbdac3f1d3f7c,0xbf41bdac3f223f7e,0x3f383ce6bf2dbf80,0x3f28bdacbf46bf7e,0xbf323ce63f3c3f80,0xbf0b3e803f623f72,0x3f2dbdacbf4abf7c,0x3ed8bed1bf75bf59,0xbf283e0f3f573f76,0xbe953f0e3f7f3f35,0x3f22be48bf62bf6d
.quad 0xbf80,0x0,0x3f80,0x0,0xbf80,0x0,0x3f80,0x0,0xbf80,0x0,0x3f80,0x0,0xbf80,0x0,0x3f80,0x0
.quad 0xbf80,0x0,0x3f80,0x0,0xbf80,0x0,0x3f80,0x0,0xbf80,0x0,0x3f80,0x0,0xbf80,0x0,0x3f80,0x0
.quad 0x0,0x0,0x0,0x0,0x0,0x0,0x0,0x0,0x0,0x0,0x0,0x0,0x0,0x0,0x0,0x0
.quad 0x0,0x0,0x0,0x0,0x0,0x0,0x0,0x0,0x0,0x0,0x0,0x0,0x0,0x0,0x0,0x0
.quad 0xbf67be643f203f80,0x3f803f20be64bf67,0xbf6fbe8e3f1a3f80,0x3f7b3f3fbdacbf59,0xbf76bea93f143f80,0x3f6d3f593d66bf48,0xbf7bbec43f0e3f80,0x3f553f6d3e48bf35,0xbf7ebede3f083f80,0x3f353f7a3ea9bf20,0xbf80bef83f023f80,0x3f0e3f803eebbf08,0xbf80bf083ef83f80,0x3ec43f7e3f14bede,0xbf7dbf143eeb3f80,0x3e483f763f30bea9
.quad 0xbf7abf203ede3f80,0x3f673f48be64,0xbf74bf2b3ed13f80,0xbe483f513f5cbde5,0xbf6dbf353ec43f80,0xbec43f353f6d8000,0xbf63bf3f3eb73f80,0xbf0e3f143f783de5,0xbf59bf483ea93f80,0xbf353ede3f7e3e64,0xbf4dbf513e9b3f80,0xbf553e8e3f803ea9,0xbf3fbf593e8e3f80,0xbf6d3de53f7c3ede,0xbf30bf603e803f80,0xbf7bbd663f743f08
.quad 0xbf67bf67be643f20,0x3f203f803f20be64,0xbf3abf7cbeeb3ede,0x3e803f6d3f5c3de5,0xbef8bf7ebf2b3e64,0xbe2c3f353f7c3ede,0xbe48bf6dbf550000,0xbf0e3ec43f7b3f35,0x3de5bf48bf72be64,0xbf5900003f593f67,0x3ed1bf14bf7fbede,0xbf7dbec43f1a3f7e,0x3f2bbea9bf7cbf20,0xbf76bf353e8e3f7a,0x3f5cbd66bf6abf48,0xbf44bf6dbdac3f59
.quad 0x3f7a3e64bf48bf67,0xbedebf80bede3f20,0x3f7f3ef8bf1abf7a,0xbce6bf6dbf3a3ea9,0x3f6d3f35bec4bf80,0x3ec4bf35bf6d0000,0x3f443f60be0fbf7a,0x3f3abec4bf80bea9,0x3f083f7a3de5bf67,0x3f728000bf72bf20,0x3e803f803eb7bf48,0x3f7f3ec4bf44bf59,0xbd663f723f14bf20,0x3f603f35bef8bf7a,0xbeb73f513f44bede,0x3f1a3f6dbe0fbf7e
.quad 0xbe64bf67bf67be64,0xbe643f203f803f20,0x3e9bbf14bf80bf20,0xbf443d663f553f72,0x3f3fbde5bf60bf67,0xbf80bf083ec43f7a,0x3f7b3ec4bf0ebf80,0xbf55bf6dbe483f35,0x3f723f48bde5bf67,0xbea9bf7abf353e64,0x3f253f7c3eb7bf20,0x3e9bbf2bbf7bbea9,0x3e2c3f723f3fbe64,0x3f51bde5bf6dbf48,0xbeb73f2b3f783e64,0x3f803ef8bf0ebf7e
.quad 0xbf483e643f7a3f20,0x3f483f678000bf67,0xbf7dbe8e3f443f67,0x3e803f7c3f0ebf08,0xbf6dbf353ec43f80,0xbec43f353f6d8000,0xbf1abf76bdac3f67,0xbf5c3e2c3f7b3f08,0xbde5bf7abf083f20,0xbf7ebede3f353f67,0x3ed1bf3fbf5c3e64,0xbf3abf603e483f7e,0x3f51bea9bf80be64,0xbe2cbf7ebec43f48,0x3f7f3e2cbf6abf20,0x3eebbf3fbf553ea9
.quad 0x3f20be64bf67bf67,0xbf67be643f203f80,0x3f7d3ef8bed1bf7a,0xbf6abf60be0f3f35,0x3f513f723e8ebf20,0xbe8ebf72bf510000,0x3e483f6d3f558000,0x3f0ebec4bf7bbf35,0xbf083ede3f7e3f20,0x3f7e3edebf08bf80,0xbf78be8e3f303f7a,0x3f3a3f763e80bf35,0xbf60bf593d663f67,0xbd663f593f608000,0xbe9bbf7cbf1a3ede,0xbf4d3e2c3f743f35
.quad 0x3edebf20bf7abe64,0xbf7abf203ede3f80,0x3f6f3d66bf63bf48,0xbeebbf80beb73f35,0x3f6d3f35bec4bf80,0x3ec4bf35bf6d0000,0x3ed13f803e9bbf48,0x3f743d66bf6abf35,0xbea93f483f59be64,0x3f593f48bea9bf80,0xbf633e2c3f7d3ede,0x3e0f3f7c3eebbf35,0xbf76bf083f2b3f67,0xbf2b3f083f768000,0xbf02bf763ce63f7a,0xbf80be8e3f5c3f35
.quad 0x3f803f20be64bf67,0xbf67bf67be643f20,0x3f0e3f803f25be64,0xbce6bf51bf74bea9,0xbec43f083f803f20,0x3f603de5bf3fbf7a,0xbf7bbec43f0e3f80,0x3f553f6d3e48bf35,0xbf35bf7abea93f20,0xbde53f483f723e64,0x3e48bf3fbf74be64,0xbf6fbe2c3f443f72,0x3f6d3de5bf51bf67,0xbf3fbf72be2c3f48,0x3f553f60bce6bf67,0x3e80bf3fbf6fbde5
.quad 0x3f673f48be64,0x3f7a3e64bf48bf67,0xbf553e2c3f783f20,0x3f253f763e0fbf59,0xbf6dbf353ec43f80,0xbec43f353f6d8000,0xbe48bf7cbf023f20,0xbf7fbe8e3f4d3f59,0x3f35bedebf7ebe64,0xbf08bf7abde53f67,0x3f7b3ef8bf30bf67,0x3f02bf2bbf6a3de5,0x3ec43f7e3e2cbf67,0x3f803ea9bf51bf48,0xbf0e3f2b3f63be64,0x3ed13f7c3dacbf72
.quad 0x3f203f803f20be64,0xbe64bf67bf67be64,0xbf023ec43f783f48,0x3f633e2cbf30bf7e,0xbf7cbf353e2c3f67,0x3f2b3f7e3ef8bede,0xbe48bf6dbf550000,0xbf0e3ec43f7b3f35,0x3f598000bf59bf67,0xbf72bf483de53f67,0x3f4d3f6d3e0fbf48,0x3dacbf51bf6abde5,0xbe8e3f353f763e64,0x3f7c3ea9bf2bbf7a,0xbf7fbec43f253f7a,0x3ed13f803f02bf08
.quad 0xbedebf80bede3f20,0xbf483e643f7a3f20,0x3f30bec4bf80bede,0xbf4dbf603dac3f72,0x3f6d3f35bec4bf80,0x3ec4bf35bf6d0000,0xbce63f6d3f30bede,0x3f7d3ef8bf25bf72,0xbf7200003f723f20,0x3de53f7a3f08bf20,0xbf25bf6d3dac3f7a,0xbf6f3d663f783f08,0x3ef8bf35bf603e64,0xbf14bf723d663f7a,0x3f7d3ec4bf4dbf48,0x3f25bf14bf6f3de5
.quad 0xbe643f203f803f20,0x3f20be64bf67bf67,0xbf7fbf2b3e483f67,0x3f4d3f763eb7bf08,0xbd66bf59bf6dbe64,0xbf143ea93f763f48,0x3f7b3ec4bf0ebf80,0xbf55bf6dbe483f35,0x3ea93f7a3f35be64,0x3f08bedebf7ebf20,0xbf63bd663f553f67,0x3f5c3f603ce6bf59,0xbf14bf7ebec43f20,0xbef83f083f803ede,0x3f3abe8ebf7bbf20,0xbf63bf513e0f3f72
.quad 0x3f483f678000bf67,0x3edebf20bf7abe64,0xbf023f143f7b3e64,0x3f6a3f3fbe9bbf7e,0xbf6dbf353ec43f80,0xbec43f353f6d8000,0x3e80bf51bf553e64,0xbf6fbf2b3eeb3f7e,0x3f7e3edebf35bf67,0x3ea9bf48bf593e64,0x3ce63f763f0ebf20,0x3f743f14bf1abf72,0xbf7cbde53f6d3f20,0xbe8e3f593f3fbede,0xbe9bbf80be483f67,0xbf78bef83f3a3f59
.quad 0xbf67be643f203f80,0x3f803f20be64bf67,0xbeb7bf76bf4d0000,0xbe483f2b3f7f3f08,0x3f763ea9bf14bf80,0xbf6dbf59bd663f48,0x3e483f6d3f558000,0x3f0ebec4bf7bbf35,0xbf7ebede3f083f80,0x3f353f7a3ea9bf20,0xbce6bf60bf5c0000,0xbf553d663f633f59,0x3f803f08bef8bf80,0xbec4bf7ebf143ede,0xbe0f3f513f638000,0x3f7b3e8ebf3abf72
.quad 0xbf7abf203ede3f80,0x3f673f48be64,0x3e9bbf3fbf6a0000,0xbf7bbf143f023f7e,0x3f6d3f35bec4bf80,0x3ec4bf35bf6d0000,0xbeeb3f2b3f6f8000,0x3f553f51be80bf7e,0xbf59bf483ea93f80,0xbf353ede3f7e3e64,0x3f1abf14bf740000,0xbf0ebf76bce63f72,0x3f3f3f59be8ebf80,0x3f6dbde5bf7cbede,0xbf3a3ef83f788000,0x3e483f803e9bbf59
.quad 0xbf67bf67be643f20,0x3f203f803f20be64,0x3f30be2cbf63bf67,0xbf78bec43f023f7e,0x3ef83f7e3f2bbe64,0x3e2cbf35bf7cbede,0xbf7bbec43f0e3f80,0x3f553f6d3e48bf35,0x3de5bf48bf72be64,0xbf5900003f593f67,0x3f6a3f51bdacbf67,0xbe0fbf6dbf4d3de5,0xbf2b3ea93f7c3f20,0x3f763f35be8ebf7a,0xbf02bf80bed13f20,0xbf253ec43f7f3f08
.quad 0x3f7a3e64bf48bf67,0xbedebf80bede3f20,0xbdac3f603f4dbe64,0x3f803ec4bf30bf72,0xbf6dbf353ec43f80,0xbec43f353f6d8000,0x3f25bef8bf7dbe64,0xbf30bf6d3ce63f72,0x3f083f7a3de5bf67,0x3f728000bf72bf20,0xbf78bd663f6f3f20,0xbdac3f6d3f25bf08,0x3d66bf72bf143f20,0xbf60bf353ef83f7a,0x3f6f3f14bf25bf67,0x3f4dbec4bf7dbde5
.quad 0xbe64bf67bf67be64,0xbe643f203f803f20,0x3f743f513ce6bf48,0xbf25bf80bf0e3ea9,0xbf3f3de53f603f67,0x3f803f08bec4bf7a,0xbe48bf6dbf550000,0xbf0e3ec43f7b3f35,0x3f723f48bde5bf67,0xbea9bf7abf353e64,0xbf443e2c3f6f3f48,0x3f743f3fbe48bf72,0xbe2cbf72bf3f3e64,0xbf513de53f6d3f48,0x3f6f3f3fbe80bf7a,0x3ce6bf60bf553de5
.quad 0xbf483e643f7a3f20,0x3f483f678000bf67,0xbe0fbf76bf253ede,0xbf78be2c3f553f59,0x3f6d3f35bec4bf80,0x3ec4bf35bf6d0000,0xbf4d3e8e3f7f3ede,0x3f023f7c3e48bf59,0xbde5bf7abf083f20,0xbf7ebede3f353f67,0x3f6a3f2bbf02bf7a,0x3f30bef8bf7bbde5,0xbf513ea93f803e64,0x3e2c3f7e3ec4bf48,0xbdacbf7cbed13f48,0xbf63bf2b3f0e3f72
.quad 0x3f20be64bf67bf67,0xbf67be643f203f80,0x3e0f3f603f6a3e64,0x3ed1bef8bf7dbf35,0xbf51bf72be8e3f20,0x3e8e3f723f518000,0x3f7b3ec4bf0ebf80,0xbf55bf6dbe483f35,0xbf083ede3f7e3f20,0x3f7e3edebf08bf80,0xbe80bf76bf3a3e64,0xbf303e8e3f783f35,0x3f603f59bd66bf67,0x3d66bf59bf600000,0xbf74be2c3f4d3f67,0x3f1a3f7c3e9bbf35
.quad 0x3edebf20bf7abe64,0xbf7abf203ede3f80,0x3eb73f803eebbf20,0x3f63bd66bf6fbf35,0xbf6dbf353ec43f80,0xbec43f353f6d8000,0x3f6abd66bf74bf20,0xbe9bbf80bed13f35,0xbea93f483f59be64,0x3f593f48bea9bf80,0xbeebbf7cbe0f3f67,0xbf7dbe2c3f633f35,0x3f763f08bf2bbf67,0x3f2bbf08bf760000,0xbf5c3e8e3f803e64,0xbce63f763f02bf35
.quad 0x3f803f20be64bf67,0xbf67bf67be643f20,0xbf55bd663f443f7a,0x3f803f14be9bbf72,0x3ec4bf08bf80bf20,0xbf60bde53f3f3f7a,0x3e483f6d3f558000,0x3f0ebec4bf7bbf35,0xbf35bf7abea93f20,0xbde53f483f723e64,0x3f7b3f2bbe9bbf7a,0xbeb7bf7cbf253ea9,0xbf6dbde53f513f67,0x3f3f3f723e2cbf48,0x3f0ebef8bf80bede,0xbf78bf2b3eb73f7e
.quad 0x3f673f48be64,0x3f7a3e64bf48bf67,0xbf0ebf7cbe803f48,0xbf443e8e3f7d3f08,0x3f6d3f35bec4bf80,0x3ec4bf35bf6d0000,0xbf7bbe2c3f5c3f48,0x3dac3f763f1abf08,0x3f35bedebf7ebe64,0xbf08bf7abde53f67,0xbe483f603f3abede,0x3f5c3f3fbed1bf7e,0xbec4bf7ebe2c3f67,0xbf80bea93f513f48,0x3f553f3fbeebbf7a,0x3f6abe2cbf7fbea9
.quad 0x3f203f803f20be64,0xbe64bf67bf67be64,0xbf5cbf6dbe803f20,0x3eeb3f7c3f3abde5,0x3f7c3f35be2cbf67,0xbf2bbf7ebef83ede,0xbf7bbec43f0e3f80,0x3f553f6d3e48bf35,0x3f598000bf59bf67,0xbf72bf483de53f67,0xbf1a3ec43f7d3f20,0x3f7f3f14bed1bf7e,0x3e8ebf35bf76be64,0xbf7cbea93f2b3f7a,0x3dac3f6d3f44be64,0x3f6a3d66bf5cbf59
.quad 0xbedebf80bede3f20,0xbf483e643f7a3f20,0x3f3a3f6d3ce6bf67,0x3f1abef8bf7fbea9,0xbf6dbf353ec43f80,0xbec43f353f6d8000,0x3f803ec4bf3abf67,0x3e0fbf60bf443ea9,0xbf7200003f723f20,0x3de53f7a3f08bf20,0x3f44bec4bf7fbe64,0xbeb7bf80be803f59,0xbef83f353f60be64,0x3f143f72bd66bf7a,0x3e0fbf6dbf1a3f20,0xbf44bf513eb73f7e
.quad 0xbe643f203f803f20,0x3f20be64bf67bf67,0x3dacbf3fbf7bbede,0xbf1a3e8e3f6f3f59,0x3d663f593f6d3e64,0x3f14bea9bf76bf48,0xbe48bf6dbf550000,0xbf0e3ec43f7b3f35,0x3ea93f7a3f35be64,0x3f08bedebf7ebf20,0xbeebbf80bf0e3ede,0xbf023ef83f803f08,0x3f143f7e3ec4bf20,0x3ef8bf08bf80bede,0xbf30bf76be483f48,0xbeeb3f143f7d3ea9
.quad 0x3f483f678000bf67,0x3edebf20bf7abe64,0xbf5cbf513e483f7a,0xbed13f2b3f743de5,0x3f6d3f35bec4bf80,0x3ec4bf35bf6d0000,0xbf78bf143f0e3f7a,0xbeb73f3f3f63bde5,0x3f7e3edebf35bf67,0x3ea9bf48bf593e64,0xbf80be8e3f553f48,0xbe9b3f513f4dbea9,0x3f7c3de5bf6dbf20,0x3e8ebf59bf3f3ede,0xbf743d663f7b3ede,0xbe803f603f30bf08
.quad 0x3f80,0x0,0xbf80,0x0,0x3f80,0x0,0xbf80,0x0,0x3f80,0x0,0xbf80,0x0,0x3f80,0x0,0xbf80,0x0
.quad 0x3f80,0x0,0xbf80,0x0,0x3f80,0x0,0xbf80,0x0,0x3f80,0x0,0xbf80,0x0,0x3f80,0x0,0xbf80,0x0
.quad 0x0,0x0,0x0,0x0,0x0,0x0,0x0,0x0,0x0,0x0,0x0,0x0,0x0,0x0,0x0,0x0
.quad 0x0,0x0,0x0,0x0,0x0,0x0,0x0,0x0,0x0,0x0,0x0,0x0,0x0,0x0,0x0,0x0
.quad 0xbedebf7abf488000,0x80003f483f7a3ede,0xbeb7bf76bf4d8000,0xbe483f2b3f7f3f08,0xbe8ebf72bf518000,0xbec43f083f803f20,0xbe48bf6dbf558000,0xbf0e3ec43f7b3f35,0xbde5bf67bf598000,0xbf353e643f723f48,0xbce6bf60bf5c8000,0xbf553d663f633f59,0x3d66bf59bf608000,0xbf6dbde53f513f67,0x3e0fbf51bf638000,0xbf7bbe8e3f3a3f72
.quad 0x3e64bf48bf678000,0xbf80bede3f203f7a,0x3e9bbf3fbf6a8000,0xbf7bbf143f023f7e,0x3ec4bf35bf6d8000,0xbf6dbf353ec43f80,0x3eebbf2bbf6f8000,0xbf55bf513e803f7e,0x3f08bf20bf728000,0xbf35bf673de53f7a,0x3f1abf14bf748000,0xbf0ebf76bce63f72,0x3f2bbf08bf768000,0xbec4bf7ebe2c3f67,0x3f3abef8bf788000,0xbe48bf80be9b3f59
.quad 0x3edebedebf7abf48,0xbf4880003f483f7a,0x3f30be2cbf63bf67,0xbf78bec43f023f7e,0x3f603de5bf3fbf7a,0xbf7cbf353e2c3f67,0x3f7b3ec4bf0ebf80,0xbf55bf6dbe483f35,0x3f7e3f20bea9bf7a,0xbf08bf80bf083ede,0x3f6a3f51bdacbf67,0xbe0fbf6dbf4d3de5,0x3f3f3f723e2cbf48,0x3e8ebf35bf76be64,0x3f023f803ed1bf20,0x3f25bec4bf7fbf08
.quad 0x3e643f7a3f20bede,0x3f678000bf67bf48,0xbdac3f603f4dbe64,0x3f803ec4bf30bf72,0xbec43f353f6d8000,0x3f6d3f35bec4bf80,0xbf253ef83f7d3e64,0x3f303f6dbce6bf72,0xbf593e643f7e3ede,0x3ea93f803ea9bf48,0xbf78bd663f6f3f20,0xbdac3f6d3f25bf08,0xbf80bea93f513f48,0xbef83f353f60be64,0xbf6fbf143f253f67,0xbf4d3ec43f7d3de5
.quad 0x3f7a3edebedebf7a,0xbf7abf4880003f48,0x3f743f513ce6bf48,0xbf25bf80bf0e3ea9,0x3f2b3f7e3ef8bede,0xbd66bf59bf6dbe64,0x3e483f6d3f558000,0x3f0ebec4bf7bbf35,0xbea93f203f7e3ede,0x3f723e64bf35bf7a,0xbf443e2c3f6f3f48,0x3f743f3fbe48bf72,0xbf7cbea93f2b3f7a,0x3f143f7e3ec4bf20,0xbf6fbf3f3e803f7a,0xbce63f603f55bde5
.quad 0xbf20bf7abe643f48,0xbf203ede3f803ede,0xbe0fbf76bf253ede,0xbf78be2c3f553f59,0x3ec4bf35bf6d8000,0xbf6dbf353ec43f80,0x3f4dbe8ebf7fbede,0xbf02bf7cbe483f59,0x3f7e3e64bf59bf48,0x3de5bf67bf353ede,0x3f6a3f2bbf02bf7a,0x3f30bef8bf7bbde5,0x3f143f72bd66bf7a,0x3f7c3de5bf6dbf20,0x3dac3f7c3ed1bf48,0x3f633f2bbf0ebf72
.quad 0x3f483f7a3edebede,0xbedebf7abf488000,0x3e0f3f603f6a3e64,0x3ed1bef8bf7dbf35,0xbf143ea93f763f48,0x3f763ea9bf14bf80,0xbf7bbec43f0e3f80,0x3f553f6d3e48bf35,0xbf59bf67bde53f48,0x3de53f673f598000,0xbe80bf76bf3a3e64,0xbf303e8e3f783f35,0x3ef8bf08bf80bede,0xbf80bf083ef83f80,0x3f743e2cbf4dbf67,0xbf1abf7cbe9b3f35
.quad 0x3f673f48be64bf7a,0x3e64bf48bf678000,0x3eb73f803eebbf20,0x3f63bd66bf6fbf35,0xbec43f353f6d8000,0x3f6d3f35bec4bf80,0xbf6a3d663f743f20,0x3e9b3f803ed1bf35,0xbf72bf203f083f7a,0xbf083f203f728000,0xbeebbf7cbe0f3f67,0xbf7dbe2c3f633f35,0x3e8ebf59bf3f3ede,0xbf3fbf593e8e3f80,0x3f5cbe8ebf80be64,0x3ce6bf76bf023f35
.quad 0x80003f483f7a3ede,0x3edebedebf7abf48,0xbf55bd663f443f7a,0x3f803f14be9bbf72,0xbf6dbf59bd663f48,0x3ef83f7e3f2bbe64,0xbe48bf6dbf558000,0xbf0e3ec43f7b3f35,0x3f35be64bf72bf48,0xbf7ebf203ea93f7a,0x3f7b3f2bbe9bbf7a,0xbeb7bf7cbf253ea9,0x3ec43f7e3f14bede,0x3f2bbea9bf7cbf20,0xbf0e3ef83f803ede,0x3f783f2bbeb7bf7e
.quad 0xbf80bede3f203f7a,0x3e643f7a3f20bede,0xbf0ebf7cbe803f48,0xbf443e8e3f7d3f08,0x3ec4bf35bf6d8000,0xbf6dbf353ec43f80,0x3f7b3e2cbf5cbf48,0xbdacbf76bf1a3f08,0x3f353f67bde5bf7a,0x3f59be64bf7ebede,0xbe483f603f3abede,0x3f5c3f3fbed1bf7e,0xbf6d3de53f7c3ede,0xbd663f723f14bf20,0xbf55bf3f3eeb3f7a,0xbf6a3e2c3f7f3ea9
.quad 0xbf4880003f483f7a,0x3f7a3edebedebf7a,0xbf5cbf6dbe803f20,0x3eeb3f7c3f3abde5,0x3e2cbf35bf7cbede,0xbf3f3de53f603f67,0x3f7b3ec4bf0ebf80,0xbf55bf6dbe483f35,0x3f083f803f08bede,0x3ea9bf20bf7ebede,0xbf1a3ec43f7d3f20,0x3f7f3f14bed1bf7e,0xbf76bf353e8e3f7a,0x3e2c3f723f3fbe64,0xbdacbf6dbf443e64,0xbf6abd663f5c3f59
.quad 0x3f678000bf67bf48,0xbf20bf7abe643f48,0x3f3a3f6d3ce6bf67,0x3f1abef8bf7fbea9,0xbec43f353f6d8000,0x3f6d3f35bec4bf80,0xbf80bec43f3a3f67,0xbe0f3f603f44bea9,0xbea9bf80bea93f48,0xbf7ebe643f593f48,0x3f44bec4bf7fbe64,0xbeb7bf80be803f59,0x3f603f35bef8bf7a,0x3f51bea9bf80be64,0xbe0f3f6d3f1abf20,0x3f443f51beb7bf7e
.quad 0xbf7abf4880003f48,0x3f483f7a3edebede,0x3dacbf3fbf7bbede,0xbf1a3e8e3f6f3f59,0x3f803f08bec4bf7a,0xbf51bf72be8e3f20,0x3e483f6d3f558000,0x3f0ebec4bf7bbf35,0xbf72be643f353f7a,0x3f593f673de5bf48,0xbeebbf80bf0e3ede,0xbf023ef83f803f08,0x3f51bde5bf6dbf48,0xbf60bf593d663f67,0x3f303f763e48bf48,0x3eebbf14bf7dbea9
.quad 0xbf203ede3f803ede,0x3f673f48be64bf7a,0xbf5cbf513e483f7a,0xbed13f2b3f743de5,0x3ec4bf35bf6d8000,0xbf6dbf353ec43f80,0x3f783f14bf0ebf7a,0x3eb7bf3fbf633de5,0xbde53f673f35bede,0x3f723f20bf08bf7a,0xbf80be8e3f553f48,0xbe9b3f513f4dbea9,0xbe2cbf7ebec43f48,0xbf76bf083f2b3f67,0x3f74bd66bf7bbede,0x3e80bf60bf303f08
.quad 0xbedebf7abf488000,0x80003f483f7a3ede,0x3f6f3e8ebf1abf80,0xbf7bbf3f3dac3f59,0x3e8e3f723f518000,0x3ec4bf08bf80bf20,0xbf7bbec43f0e3f80,0x3f553f6d3e48bf35,0xbde5bf67bf598000,0xbf353e643f723f48,0x3f803ef8bf02bf80,0xbf0ebf80beeb3f08,0xbd663f593f608000,0x3f6d3de5bf51bf67,0xbf7dbf143eeb3f80,0x3e483f763f30bea9
.quad 0x3e64bf48bf678000,0xbf80bede3f203f7a,0x3f743f2bbed1bf80,0x3e48bf51bf5c3de5,0xbec43f353f6d8000,0x3f6d3f35bec4bf80,0xbf63bf3f3eb73f80,0xbf0e3f143f783de5,0x3f08bf20bf728000,0xbf35bf673de53f7a,0x3f4d3f51be9bbf80,0x3f55be8ebf80bea9,0xbf2b3f083f768000,0x3ec43f7e3e2cbf67,0xbf30bf603e803f80,0xbf7bbd663f743f08
.quad 0x3edebedebf7abf48,0xbf4880003f483f7a,0x3f3a3f7c3eebbede,0xbe80bf6dbf5cbde5,0xbf60bde53f3f3f7a,0x3f7c3f35be2cbf67,0xbe48bf6dbf558000,0xbf0e3ec43f7b3f35,0x3f7e3f20bea9bf7a,0xbf08bf80bf083ede,0xbed13f143f7f3ede,0x3f7d3ec4bf1abf7e,0xbf3fbf72be2c3f48,0xbe8e3f353f763e64,0x3f5cbd66bf6abf48,0xbf44bf6dbdac3f59
.quad 0x3e643f7a3f20bede,0x3f678000bf67bf48,0xbf7fbef83f1a3f7a,0x3ce63f6d3f3abea9,0x3ec4bf35bf6d8000,0xbf6dbf353ec43f80,0x3f443f60be0fbf7a,0x3f3abec4bf80bea9,0xbf593e643f7e3ede,0x3ea93f803ea9bf48,0xbe80bf80beb73f48,0xbf7fbec43f443f59,0x3f803ea9bf51bf48,0x3ef8bf35bf603e64,0xbeb73f513f44bede,0x3f1a3f6dbe0fbf7e
.quad 0x3f7a3edebedebf7a,0xbf7abf4880003f48,0xbe9b3f143f803f20,0x3f44bd66bf55bf72,0xbf2bbf7ebef83ede,0x3d663f593f6d3e64,0x3f7b3ec4bf0ebf80,0xbf55bf6dbe483f35,0xbea93f203f7e3ede,0x3f723e64bf35bf7a,0xbf25bf7cbeb73f20,0xbe9b3f2b3f7b3ea9,0x3f7c3ea9bf2bbf7a,0xbf14bf7ebec43f20,0xbeb73f2b3f783e64,0x3f803ef8bf0ebf7e
.quad 0xbf20bf7abe643f48,0xbf203ede3f803ede,0x3f7d3e8ebf44bf67,0xbe80bf7cbf0e3f08,0xbec43f353f6d8000,0x3f6d3f35bec4bf80,0xbf1abf76bdac3f67,0xbf5c3e2c3f7b3f08,0x3f7e3e64bf59bf48,0x3de5bf67bf353ede,0xbed13f3f3f5cbe64,0x3f3a3f60be48bf7e,0xbf14bf723d663f7a,0xbf7cbde53f6d3f20,0x3f7f3e2cbf6abf20,0x3eebbf3fbf553ea9
.quad 0x3f483f7a3edebede,0xbedebf7abf488000,0xbf7dbef83ed13f7a,0x3f6a3f603e0fbf35,0x3f14bea9bf76bf48,0xbf76bea93f143f80,0x3e483f6d3f558000,0x3f0ebec4bf7bbf35,0xbf59bf67bde53f48,0x3de53f673f598000,0x3f783e8ebf30bf7a,0xbf3abf76be803f35,0xbef83f083f803ede,0x3f803f08bef8bf80,0xbe9bbf7cbf1a3ede,0xbf4d3e2c3f743f35
.quad 0x3f673f48be64bf7a,0x3e64bf48bf678000,0xbf6fbd663f633f48,0x3eeb3f803eb7bf35,0x3ec4bf35bf6d8000,0xbf6dbf353ec43f80,0x3ed13f803e9bbf48,0x3f743d66bf6abf35,0xbf72bf203f083f7a,0xbf083f203f728000,0x3f63be2cbf7dbede,0xbe0fbf7cbeeb3f35,0xbe8e3f593f3fbede,0x3f3f3f59be8ebf80,0xbf02bf763ce63f7a,0xbf80be8e3f5c3f35
.quad 0x80003f483f7a3ede,0x3edebedebf7abf48,0xbf0ebf80bf253e64,0x3ce63f513f743ea9,0x3f6d3f593d66bf48,0xbef8bf7ebf2b3e64,0xbf7bbec43f0e3f80,0x3f553f6d3e48bf35,0x3f35be64bf72bf48,0xbf7ebf203ea93f7a,0xbe483f3f3f743e64,0x3f6f3e2cbf44bf72,0xbec4bf7ebf143ede,0xbf2b3ea93f7c3f20,0x3f553f60bce6bf67,0x3e80bf3fbf6fbde5
.quad 0xbf80bede3f203f7a,0x3e643f7a3f20bede,0x3f55be2cbf78bf20,0xbf25bf76be0f3f59,0xbec43f353f6d8000,0x3f6d3f35bec4bf80,0xbe48bf7cbf023f20,0xbf7fbe8e3f4d3f59,0x3f353f67bde5bf7a,0x3f59be64bf7ebede,0xbf7bbef83f303f67,0xbf023f2b3f6abde5,0x3f6dbde5bf7cbede,0x3d66bf72bf143f20,0xbf0e3f2b3f63be64,0x3ed13f7c3dacbf72
.quad 0xbf4880003f483f7a,0x3f7a3edebedebf7a,0x3f02bec4bf78bf48,0xbf63be2c3f303f7e,0xbe2c3f353f7c3ede,0x3f3fbde5bf60bf67,0xbe48bf6dbf558000,0xbf0e3ec43f7b3f35,0x3f083f803f08bede,0x3ea9bf20bf7ebede,0xbf4dbf6dbe0f3f48,0xbdac3f513f6a3de5,0x3f763f35be8ebf7a,0xbe2cbf72bf3f3e64,0xbf7fbec43f253f7a,0x3ed13f803f02bf08
.quad 0x3f678000bf67bf48,0xbf20bf7abe643f48,0xbf303ec43f803ede,0x3f4d3f60bdacbf72,0x3ec4bf35bf6d8000,0xbf6dbf353ec43f80,0xbce63f6d3f30bede,0x3f7d3ef8bf25bf72,0xbea9bf80bea93f48,0xbf7ebe643f593f48,0x3f253f6dbdacbf7a,0x3f6fbd66bf78bf08,0xbf60bf353ef83f7a,0xbf513ea93f803e64,0x3f7d3ec4bf4dbf48,0x3f25bf14bf6f3de5
.quad 0xbf7abf4880003f48,0x3f483f7a3edebede,0x3f7f3f2bbe48bf67,0xbf4dbf76beb73f08,0xbf80bf083ec43f7a,0x3f513f723e8ebf20,0x3f7b3ec4bf0ebf80,0xbf55bf6dbe483f35,0xbf72be643f353f7a,0x3f593f673de5bf48,0x3f633d66bf55bf67,0xbf5cbf60bce63f59,0xbf513de53f6d3f48,0x3f603f59bd66bf67,0x3f3abe8ebf7bbf20,0xbf63bf513e0f3f72
.quad 0xbf203ede3f803ede,0x3f673f48be64bf7a,0x3f02bf14bf7bbe64,0xbf6abf3f3e9b3f7e,0xbec43f353f6d8000,0x3f6d3f35bec4bf80,0x3e80bf51bf553e64,0xbf6fbf2b3eeb3f7e,0xbde53f673f35bede,0x3f723f20bf08bf7a,0xbce6bf76bf0e3f20,0xbf74bf143f1a3f72,0x3e2c3f7e3ec4bf48,0x3f763f08bf2bbf67,0xbe9bbf80be483f67,0xbf78bef83f3a3f59
.quad 0x8000,0x0,0x8000,0x0,0x8000,0x0,0x8000,0x0,0x8000,0x0,0x8000,0x0,0x8000,0x0,0x8000,0x0
.quad 0x8000,0x0,0x8000,0x0,0x8000,0x0,0x8000,0x0,0x8000,0x0,0x8000,0x0,0x8000,0x0,0x8000,0x0
.quad 0x0,0x0,0x0,0x0,0x0,0x0,0x0,0x0,0x0,0x0,0x0,0x0,0x0,0x0,0x0,0x0
.quad 0x0,0x0,0x0,0x0,0x0,0x0,0x0,0x0,0x0,0x0,0x0,0x0,0x0,0x0,0x0,0x0
.quad 0xbf6bbe803f1d3f80,0x3f7f3f30be1dbf60,0xbf73be9b3f173f80,0x3f753f4dbc66bf51,0xbf79beb73f113f80,0x3f623f633e01bf3f,0xbf7dbed13f0b3f80,0x3f463f743e87bf2b,0xbf7fbeeb3f053f80,0x3f223f7d3ecbbf14,0xbf80bf023efe3f80,0x3ef13f803f05bef8,0xbf7fbf0e3ef13f80,0x3e953f7b3f22bec4,0xbf7cbf1a3ee53f80,0x3dc93f6f3f3cbe8e
.quad 0xbf77bf253ed83f80,0xbdc93f5c3f53be2c,0xbf70bf303ecb3f80,0xbe953f443f65bd66,0xbf68bf3a3ebd3f80,0xbef13f253f733d66,0xbf5ebf443eb03f80,0xbf223f023f7c3e2c,0xbf53bf4d3ea23f80,0xbf463eb73f803e8e,0xbf46bf553e953f80,0xbf623e483f7f3ec4,0xbf38bf5c3e873f80,0xbf753ce63f793ef8,0xbf28bf633e723f80,0xbf7fbe0f3f6e3f14
.quad 0xbf53bf74beb03f08,0x3ee53f7b3f41bd66,0xbf1dbf80bf113ea9,0x3d2c3f553f703e8e,0xbeb0bf78bf413de5,0xbebd3f0e3f803f14,0xbd2cbf5cbf65bde5,0xbf383e483f6e3f51,0x3e87bf30bf7abea9,0xbf70be483f3c3f76,0x3f0bbeebbf80bf08,0xbf7fbf0e3ee53f80,0x3f46be48bf75bf35,0xbf62bf553dc93f6d,0x3f6e3dacbf5bbf59,0xbf1dbf7bbe873f3f
.quad 0x3f7f3eb7bf32bf72,0xbe72bf7bbf173ef8,0x3f793f1abefebf7e,0x3e3abf55bf573e2c,0x3f5b3f4dbe87bf7e,0x3f11bf0ebf7abe2c,0x3f283f6fbc66bf72,0x3f5bbe48bf7dbef8,0x3ecb3f7f3e72bf59,0x3f7e3e48bf5ebf3f,0x3dc93f7b3ef1bf35,0x3f753f0ebf22bf6d,0xbe563f633f2dbf08,0x3f413f55bea2bf80,0xbefe3f3a3f57bea9,0x3ed83f7b3d2cbf76
.quad 0x3d2cbf44bf7abede,0xbf053eb73f753f51,0x3f0bbeb7bf77bf48,0xbf6ebe803f223f80,0x3f653e0fbf3cbf7a,0xbf77bf443dc93f60,0x3f7f3f1abeb0bf7a,0xbf1dbf7fbef13ef8,0x3f533f6a3e01bf48,0xbc66bf5cbf62bd66,0x3ed83f7f3f11bede,0x3f17bed1bf7fbf14,0xbdc93f553f628000,0x3f753e48bf46bf6d,0xbf173eeb3f803ede,0x3f703f3abe95bf7c
.quad 0xbf6bbce63f653f48,0x3f0b3f7d3e95bf3f,0xbf7ebf023f173f7a,0xbd8f3f633f46be8e,0xbf4abf5c3e1d3f7a,0xbf283eeb3f7f3e8e,0xbebdbf80bea23f48,0xbf7abe0f3f623f3f,0x3e1dbf63bf383ede,0xbf68bf303ef13f7c,0x3f22bf0ebf750000,0xbef1bf7bbdc93f6d,0x3f70bdacbf7cbede,0x3e1dbf6abf223f14,0x3f7c3ed1bf4abf48,0x3f38bf02bf753d66
.quad 0x3f5e3e0fbf32bf7e,0xbf80bf1a3e873f6d,0x3f793f44bd8fbf59,0xbf28bf7fbf053ec4,0x3f0b3f803f17bea9,0x3e1dbf3abf7abec4,0xbe3a3f3a3f793ea9,0x3f5b3ce6bf53bf6d,0xbf4f3dac3f653f59,0x3f733f44be1dbf6d,0xbf7ebf1a3ecb3f7e,0x3ebd3f7d3f1dbec4,0xbf22bf7bbe953f35,0xbef13f0e3f7f3ec4,0x3d8fbf5cbf573de5,0xbf7abe803f413f6d
.quad 0x3f3cbe9bbf7ebf08,0xbf4abf633d2c3f6d,0x3f803ed1bf2dbf72,0xbd2cbf6fbf323ec4,0x3f383f6abd2cbf72,0x3f3cbeb7bf80bec4,0x3d2c3f743f1dbf08,0x3f7e3eebbf2dbf6d,0xbf283f023f7a3de5,0x3f0b3f783d8fbf6d,0xbf7fbe483f623f35,0xbe953f553f46bec4,0xbf4abf4d3ebd3f7e,0xbf6b3e0f3f7e3ec4,0xbe1dbf7fbea23f59,0xbf65bf253f173f6d
.quad 0x3f623f6a3e72bf20,0xbf0bbf7fbf2d3e2c,0x3dc93f5c3f6b3e64,0x3efebed1bf7abf3f,0xbf463dac3f5e3f67,0x3f803f1abea2bf76,0xbf75bf443e013f67,0x3ed83f7d3f28be8e,0xbe95bf78bf383e64,0xbf1d3eb73f7c3f2b,0x3f22beb7bf7dbf20,0xbf7cbf253eb03f7c,0x3f7f3f0ebef1bf80,0xbe95bf7bbf223ec4,0x3ef13f803ed8bf20,0x3f38be9bbf7dbf14
.quad 0xbef13f1a3f7a3e64,0x3f733f30bebdbf80,0xbf7fbe9b3f413f67,0x3e1d3f783f1dbef8,0xbf22bf74bd8f3f67,0xbf4f3e803f7e3ef8,0x3e95bf4dbf573e64,0xbf65bf3a3ecb3f80,0x3f753ce6bf70bf20,0xbc66bf74bf173f14,0x3f463f55be95bf80,0x3f62be48bf7fbec4,0xbdc93f6f3f17bf20,0x3f533f44bed8bf7c,0xbf623e803f803e64,0xbe013f6f3f11bf2b
.quad 0x3d8f3f553f733ea9,0x3ed8beebbf7cbf3f,0xbf68be483f2d3f7e,0x3f7c3f3abe01bf60,0xbf38bf7bbecb3f08,0x3d8f3f5c3f683e2c,0x3ecbbf0ebf80bf08,0xbf73be803f2d3f7c,0x3f803f0ebed8bf7e,0xbf0bbf80befe3ef8,0x3ea23f7b3f28bea9,0x3f2dbe9bbf7abf2b,0xbf463e483f753f35,0x3f623f55bdc9bf6d,0xbf5ebf553e013f72,0xbe723f443f6b3d66
.quad 0x3e1dbf55bf5b3de5,0xbf80bed13f283f76,0x3f7a3e48bf53bf59,0xbe87bf7dbf053f14,0x3f0b3f7b3e3abf59,0x3f5ebe0fbf79bf14,0xbf173f0e3f793de5,0x3f323f6abd8fbf76,0xbf77bf0e3f1d3f72,0xbf053f253f6ebd66,0xbdc9bf7bbef13f35,0xbf75bf0e3f223f6d,0x3f65be48bf7fbea9,0x3d2cbf74bf0b3f2b,0x3f3c3f55beb0bf7e,0x3f7a3ce6bf77bef8
.quad 0xbf4fbce63f463f7a,0x3f7e3f02bebdbf76,0xbf32bf7dbef13ede,0x3e1d3f633f653e2c,0x3f1dbe9bbf75bf48,0xbf7cbed13f053f80,0x3f5e3f633dc9bf48,0xbe56bf6fbf4f3d66,0xbebd3f1a3f7f3ede,0x3f793e9bbf28bf7c,0xbf79bf303e953f7a,0x3e873f783f32be8e,0x3dc9bf55bf620000,0xbf75be483f463f6d,0x3f803ed1bf22bf7a,0xbea2bf7dbf113ef8
.quad 0x3e3a3f783f22bede,0x3f703dacbf5ebf51,0xbf73bdac3f623f48,0x3ebd3f803ed8bf2b,0xbee5bf7fbe953f48,0xbf6b3ce63f703f2b,0x3f53be80bf7fbede,0xbed8bf7fbe873f51,0x3f2d3f6abdc9bf7a,0x3f65be0fbf7cbef8,0xbf223f0e3f758000,0x3ef13f7b3dc9bf6d,0xbf5bbf3a3ef13f7a,0xbf5e3e803f803e8e,0x3ecbbf4dbf463ede,0xbf05bf743d8f3f7c
.quad 0xbf6ebf5cbe013f35,0x3f223f803f17be8e,0x3ee5beebbf7dbf35,0xbf62be0f3f383f7c,0x3f5b3f6a3e3abf35,0xbe95bf74bf4a3d66,0xbf173eb73f7a3f35,0x3f7f3eebbefebf80,0xbf41bf74be723f35,0xbdc93f4d3f6e3e2c,0x3f38be80bf77bf35,0xbf75bf3a3e723f76,0x3f223f7b3e95bf35,0x3ef1bf0ebf7fbec4,0xbf533e0f3f733f35,0x3f463f6a3d2cbf60
.quad 0xbefebf7fbeb03f35,0xbf463e803f7c3f14,0x3f68bce6bf6ebf35,0xbef1bf7fbea23f3f,0x3eb03f803ecbbf35,0x3f753dacbf65bf3f,0xbf77bdac3f683f35,0x3dc93f783f11bf14,0xbe3abf7dbee53f35,0xbf7fbed13f3c3f60,0x3f7f3e48bf62bf35,0x3e95bf55bf463ec4,0x3c663f783efebf35,0x3f623f30bf05bf76,0xbf7fbe9b3f5b3f35,0xbf223f1a3f6bbe2c
.quad 0xbe3abf63bf68be64,0xbea23f0e3f7f3f2b,0x3f7e3f30be3abf67,0xbf3cbf7bbed83ef8,0xbed83f023f7f3f20,0x3f6b3e48bf32bf7c,0xbf3cbf78bea23f20,0xbc663f553f6b3e2c,0x3f5e3ce6bf57bf67,0xbf68bf553d2c3f60,0x3e563f743f3cbe64,0x3f41be48bf73bf3f,0xbf7fbf0e3ef13f80,0x3e953f7b3f22bec4,0x3ecbbf25bf79be64,0xbf7ebf0e3efe3f80
.quad 0x3f413f6a3c66bf67,0x3f05bf0ebf7dbe8e,0xbf5b3e0f3f773f20,0x3f113f7b3e56bf51,0xbe72bf7dbefe3f20,0xbf7cbe483f573f51,0x3f7f3ed1bf38bf67,0x3e72bf55bf4f3e8e,0xbebd3f443f5bbe64,0x3f4a3f55be87bf80,0xbf46bf553e953f80,0xbf623e483f7f3ec4,0x3f57be9bbf80be64,0xbd8fbf7bbee53f3f,0x3e873f803e56bf67,0x3f703f0ebf2dbf60
.quad 0x3f3cbdacbf57bf72,0xbf79bed13ef13f7c,0x3e563f6a3f5e3de5,0x3ecbbf02bf7fbf2b,0xbf73bf4d3d2c3f59,0x3efe3f7f3f22be8e,0x3f41be0fbf68bf59,0xbf7ebf253e953f76,0x3e3a3f6f3f4abde5,0x3f32be80bf75bf3f,0xbf70bf443e3a3f72,0x3e1d3f6f3f46be2c,0x3f46be48bf75bf35,0xbf62bf553dc93f6d,0x3e1d3f743f32bea9,0x3f683ce6bf62bf51
.quad 0xbf6ebf3a3ea23f7e,0xbe563f4d3f62bd66,0x3f4abe80bf7dbf08,0xbf28bf74bdc93f60,0x3e013f783f17bf08,0x3f7f3e9bbf46bf60,0xbf6bbf303ee53f7e,0xbf0b3f1a3f753d66,0x3f4fbe9bbf80bea9,0xbeb0bf80be953f51,0x3dc93f7b3ef1bf35,0x3f753f0ebf22bf6d,0xbf68bf253f113f72,0xbf4f3eb73f7f3e2c,0x3f53beb7bf7ebde5,0x3c66bf78bef13f3f
.quad 0x3f773f4d3c66bf48,0xbf38bf7dbefe3ec4,0xbf5bbdac3f413f7a,0x3f7f3f25be72bf6d,0x3e56bf30bf7dbede,0xbf4f3ce63f573f6d,0x3f113f803f05bede,0x3e72bf30bf7cbec4,0xbf7dbf253ea23f7a,0x3ee53f7f3f17bec4,0x3f4abe0fbf6ebf48,0xbf6bbf4d3e013f6d,0xbdc93f553f628000,0x3f753e48bf46bf6d,0xbf28bf78be563f48,0xbf0b3f023f7f3ec4
.quad 0x3f803eebbf1dbf7a,0xbe01bf74bf2d3ec4,0xbf383eb73f803ede,0x3f3c3f6abc66bf6d,0xbc66bf6fbf2d3ede,0xbf80bed13f323f6d,0x3f3c3f63be01bf7a,0x3f4abe9bbf80bec4,0xbf7fbe803f573f48,0xbe563f5c3f41bec4,0x3f22bf0ebf750000,0xbef1bf7bbdc93f6d,0x3e013f7d3ecbbf48,0x3f6e3f1abf1dbf6d,0xbf4fbf443ee53f7a,0xbf733dac3f7d3ec4
.quad 0x3e953f6f3f5b3de5,0x3e56bf25bf80bf14,0xbf46bf78bebd3f08,0x3e873f6f3f573d66,0x3f7f3f25be87bf72,0xbf2dbf7dbee53ef8,0xbf62bdac3f4a3f72,0x3f703f4dbd8fbf60,0x3ef1bf02bf80bf08,0xbf7ebed13f113f80,0x3dc93f6a3f4fbde5,0x3f53bdacbf68bf51,0xbf22bf7bbe953f35,0xbef13f0e3f7f3ec4,0x3f753f30beb0bf7e,0x3c66bf63bf4f3e2c
.quad 0xbf75be0f3f573f59,0x3ee53f803ecbbf2b,0x3f22beebbf7fbea9,0xbf4fbf5c3e013f76,0xbdc93f633f41bea9,0x3f7d3f02bf1dbf76,0xbef1bf7dbe563f59,0xbf73bce63f6e3f2b,0x3f623f3abed8bf7e,0x3f32beebbf7dbe2c,0xbf7fbe483f623f35,0xbe953f553f46bec4,0x3f46bed1bf7dbde5,0xbe3abf7fbeb03f51,0xbe953f5c3f32bf08,0x3f1d3f6abe3abf80
.quad 0xbf283e483f653f67,0x3f703e9bbf11bf80,0x3eb0bf0ebf80bf20,0xbf53bce63f4a3f76,0x3c663f553f6e3e64,0x3f28be80bf70bf51,0xbebdbf7bbf323e64,0xbee53f023f803f14,0x3f2d3f7b3eb0bf20,0x3e56bf3abf77be8e,0xbf65bf553d8f3f67,0x3d2c3f633f57bd66,0x3f7f3f0ebef1bf80,0xbe95bf7bbf223ec4,0xbf77be483f4a3f67,0x3f053f7f3ebdbf2b
.quad 0x3f4fbe48bf79bf20,0xbf38bf6fbd8f3f60,0xbf0b3f0e3f7c3e64,0x3f5e3f4dbe72bf7c,0x3e56bf55bf533e64,0xbf77bf1a3f053f7c,0x3e1d3f7b3f05bf20,0x3f803eb7bf41bf60,0xbefebf7bbe013f67,0xbf79bdac3f6b3f2b,0x3f463f55be95bf80,0x3f62be48bf7fbec4,0xbf73bf0e3f283f67,0xbf3c3eeb3f7a3d66,0x3f803e48bf68bf20,0x3f0bbf30bf5e3e8e
.quad 0xbf7dbf3a3dc93f59,0x3f4a3f783ecbbef8,0x3f803f1abe95bf72,0xbf4fbf74bea23f14,0xbf7ebeeb3ef13f7e,0x3f533f6f3e72bf2b,0x3f773e9bbf22bf7e,0xbf57bf6abe1d3f3f,0xbf6bbe0f3f463f72,0x3f5b3f633d8fbf51,0x3f5bbce6bf62bf59,0xbf5ebf5c3c663f60,0xbf463e483f753f35,0x3f623f55bdc9bf6d,0x3f2dbeb7bf7fbf08,0xbf65bf4d3e3a3f76
.quad 0xbf113f023f7f3ea9,0x3f683f44be87bf7c,0x3ee5bf25bf75bde5,0xbf6bbf3a3eb03f80,0xbea23f443f62bde5,0x3f6e3f30bed8bf80,0x3e3abf5cbf463ea9,0xbf70bf253efe3f7c,0xbd2c3f6f3f22bf08,0x3f733f1abf11bf76,0xbdc9bf7bbef13f35,0xbf75bf0e3f223f6d,0x3e723f803e95bf59,0x3f773f02bf32bf60,0xbebdbf7dbdc93f72,0xbf79beeb3f413f51
.quad 0x0,0x0,0x8000,0x0,0x0,0x0,0x8000,0x0,0x0,0x0,0x8000,0x0,0x0,0x0,0x8000,0x0
.quad 0x0,0x0,0x8000,0x0,0x0,0x0,0x8000,0x0,0x0,0x0,0x8000,0x0,0x0,0x0,0x8000,0x0
.quad 0x0,0x0,0x0,0x0,0x0,0x0,0x0,0x0,0x0,0x0,0x0,0x0,0x0,0x0,0x0,0x0
.quad 0x0,0x0,0x0,0x0,0x0,0x0,0x0,0x0,0x0,0x0,0x0,0x0,0x0,0x0,0x0,0x0
.quad 0xbecbbf78bf4a8000,0xbdc93f3a3f7d3ef8,0xbea2bf74bf4f8000,0xbe953f1a3f803f14,0xbe72bf6fbf538000,0xbef13eeb3f7e3f2b,0xbe1dbf6abf578000,0xbf223e9b3f773f3f,0xbd8fbf63bf5b8000,0xbf463e0f3f6b3f51,0x3c66bf5cbf5e8000,0xbf62bce63f5b3f60,0x3dc9bf55bf628000,0xbf75be483f463f6d,0x3e3abf4dbf658000,0xbf7fbeb73f2d3f76
.quad 0x3e87bf44bf688000,0xbf7fbf023f113f7c,0x3eb0bf3abf6b8000,0xbf75bf253ee53f80,0x3ed8bf30bf6e8000,0xbf62bf443ea23f80,0x3efebf25bf708000,0xbf46bf5c3e3a3f7c,0x3f11bf1abf738000,0xbf22bf6f3d2c3f76,0x3f22bf0ebf758000,0xbef1bf7bbdc93f6d,0x3f32bf02bf778000,0xbe95bf80be723f60,0x3f41beebbf798000,0xbdc9bf7dbebd3f51
.quad 0x3f11be9bbf70bf59,0xbf65be483f283f80,0x3f4abce6bf53bf72,0xbf80bf0e3eb03f76,0x3f703e80bf28bf7e,0xbf6ebf55bc663f51,0x3f803f02bee5bf7e,0xbf32bf7bbebd3f14,0x3f773f3abe56bf72,0xbeb0bf7bbf2d3e8e,0x3f573f633d2cbf59,0x3d8fbf55bf65bd66,0x3f223f7b3e95bf35,0x3ef1bf0ebf7fbec4,0x3ebd3f7f3f05bf08,0x3f4abe48bf77bf2b
.quad 0x3d8f3f6f3f38bea9,0x3f793e48bf4fbf60,0xbe723f4d3f5ebde5,0x3f7c3f0ebf0bbf7c,0xbf053f1a3f773de5,0x3f533f55be56bf7c,0xbf413eb73f803ea9,0x3f053f7b3e1dbf60,0xbf6b3dac3f793f08,0x3e013f7b3efebf2b,0xbf7fbe483f623f35,0xbe953f553f46bec4,0xbf7abeeb3f3c3f59,0xbf283f0e3f73bd66,0xbf5ebf303f0b3f72,0xbf683e483f803e8e
.quad 0x3f803f25be56bf67,0xbf5bbf6fbe953f14,0x3f573f6f3e87bf20,0xbebdbf78bf463d66,0x3ee53f7d3f2dbe64,0x3e87bf25bf7fbef8,0xbd8f3f4d3f703e64,0x3f4abdacbf62bf60,0xbf113ed13f7e3f20,0x3f803f02bef1bf80,0xbf68bdac3f533f67,0x3f4f3f6a3dc9bf51,0xbf7fbf0e3ef13f80,0x3e953f7b3f22bec4,0xbf4fbf633c663f67,0xbeb03f303f753e2c
.quad 0xbecbbf80bee53f20,0xbf573e0f3f753f2b,0x3e01bf5cbf4f3e64,0xbf7fbeeb3f223f76,0x3f1dbf02bf7dbe64,0xbf41bf633dc93f76,0x3f6ebce6bf73bf20,0xbe56bf7dbef13f2b,0x3f7d3eebbf32bf67,0x3ed8bf3abf623e2c,0x3f463f55be95bf80,0x3f62be48bf7fbec4,0x3eb03f7f3e3abf67,0x3f7d3ed1bf46bf51,0xbe3a3f6a3f1dbf20,0x3f323f5cbe95bf80
.quad 0x3efe3f7d3f38bde5,0xbc66bf4dbf77bec4,0xbe723f253f7f3f08,0x3f41bdacbf5bbf6d,0xbf57bce63f4f3f72,0x3f7d3f30be56bf6d,0xbf7cbf303e723f72,0x3f053f803f11bec4,0xbf17bf7fbee53f08,0xbea23f253f7d3ec4,0x3e01bf4dbf6bbde5,0xbf6ebe0f3f4a3f6d,0x3f46be48bf75bf35,0xbf62bf553dc93f6d,0x3f7f3f02bf0bbf7e,0xbe56bf78bf283ec4
.quad 0x3f2d3f743e01bf59,0x3f1dbeebbf80bec4,0xbc663f6a3f3cbea9,0x3f803eb7bf38bf6d,0xbf323ed13f803ea9,0x3f2d3f6f3c66bf6d,0xbf80be9b3f4a3f59,0xbe013f633f3cbec4,0xbf41bf5c3e563f7e,0xbf573e803f7f3ec4,0xbdc9bf7bbef13f35,0xbf75bf0e3f223f6d,0x3f1dbf1abf6e3de5,0xbecbbf7dbe013f6d,0x3f7d3dacbf73bf08,0x3ee5bf44bf4f3ec4
.quad 0xbef13ed13f793f48,0x3f573dacbf3cbf7c,0xbf7fbf023ecb3f7a,0x3f5e3f6a3e56bf2b,0xbf22bf7fbefe3ede,0xbd2c3f4d3f733e8e,0x3e95bf25bf7ebede,0xbf68be0f3f413f76,0x3f753e80bf32bf7a,0xbf4abf6fbe3a3f3f,0x3f463f6f3e1dbf48,0x3e3abf44bf70be2c,0xbdc93f553f628000,0x3f753e48bf46bf6d,0xbf623ce63f683f48,0x3f323f743e1dbf51
.quad 0xbf62bf4d3e563f7a,0xbea23f3a3f6e3d66,0xbdc9bf74bf283ede,0xbf7dbe803f4a3f60,0x3f46be9bbf7fbede,0xbf17bf78be013f60,0x3f753f1abf0bbf7a,0x3ee5bf30bf6b3d66,0x3e953f803eb0bf48,0x3f803e9bbf4fbf51,0xbf223f0e3f758000,0x3ef13f7b3dc9bf6d,0xbf7fbeb73f4f3f48,0xbf113f253f68be2c,0xbef1bf783c663f7a,0xbf7ebeb73f533f3f
.quad 0xbf7fbf0e3ea23f72,0x3f683f633e3abf2b,0xbed8bf7bbf3c3de5,0xbe3a3f303f7e3ef8,0x3f32be48bf6bbf59,0xbf7fbf023ed83f7c,0x3f6b3f55bc66bf59,0xbea2bf78bf3c3e2c,0xbd2c3f553f683de5,0x3f57bce6bf5ebf60,0xbf73be483f413f72,0x3f3c3f743e56bf3f,0xbf22bf7bbe953f35,0xbef13f0e3f7f3ec4,0x3efebf0ebf7ebea9,0xbf79bf253ecb3f80
.quad 0x3f7d3f0ebf05bf7e,0xbc66bf6abf413e8e,0x3e563f7b3f11bf08,0x3f773e0fbf5bbf51,0xbf573e483f7c3f08,0x3efe3f7d3e72bf51,0xbf4fbf553e723f7e,0xbf383ed13f7f3e8e,0x3e87bf55bf4a3ea9,0xbf5bbf443ebd3f80,0x3f7f3e48bf62bf35,0x3e95bf55bf463ec4,0x3ee53f7b3d8fbf72,0x3f803e9bbf57bf3f,0xbf2d3f0e3f70bde5,0x3e563f803e87bf60
.quad 0xbf17bf80bf223e64,0x3e013f5c3f6e3e8e,0x3f38be0fbf62bf67,0xbf7dbeeb3ee53f7c,0x3f4a3f743e95bf20,0xbe3abf6abf5bbd66,0xbefe3eeb3f7f3f20,0x3f7a3eb7bf17bf80,0xbf6ebf4d3dc93f67,0x3e723f743f41be2c,0x3e72bf3abf75be64,0xbf77be803f383f76,0x3f7f3f0ebef1bf80,0xbe95bf7bbf223ec4,0x3d2c3f6a3f46be64,0x3f733e0fbf53bf60
.quad 0xbf7cbe803f463f67,0x3eb03f7f3efebf14,0xbea2bf7fbef13f20,0xbf6ebce63f683f3f,0x3f65bdacbf75bf20,0xbecbbf80beb03f3f,0x3f113f783dc9bf67,0x3f68bdacbf77bf14,0xbf3c3ed13f7f3e64,0x3ee53f7d3e3abf60,0xbf46bf553e953f80,0xbf623e483f7f3ec4,0x3f05bf30bf623e64,0xbefebf78bc663f76,0x3f6b3f1abf22bf67,0x3f5bbe9bbf7fbe2c
.quad 0x3ebdbf02bf7ebf35,0xbf463ce63f4f3f76,0x3f653f633e1dbf35,0xbef1bf7dbf323e2c,0xbf053ed13f7c3f35,0x3f753e9bbf1dbf80,0xbf4fbf6fbe563f35,0x3dc93f633f5e3d66,0x3f28be9bbf79bf35,0xbf7fbf1a3ebd3f7c,0x3f323f783e87bf35,0x3e95bf30bf79be8e,0xbf463e483f753f35,0x3f623f55bdc9bf6d,0xbf11bf7dbea23f35,0xbf223ed13f803ef8
.quad 0x3f5ebdacbf70bf35,0xbf22bf78be3a3f51,0x3ed83f803ebdbf35,0x3f62bdacbf73bf2b,0xbf70bce63f6b3f35,0x3e953f7f3ee5bf2b,0xbe87bf7fbed83f35,0xbf7fbe803f533f51,0x3f7c3e0fbf65bf35,0x3dc9bf6abf2d3ef8,0x3dc93f7b3ef1bf35,0x3f753f0ebf22bf6d,0xbf80be803f5e3f35,0xbef13f3a3f5bbe8e,0x3d8fbf74bf053f35,0xbf46bf4d3ecb3f7c
.quad 0x3f7c3eebbed8bf7a,0xbf73bf55bd8f3f3f,0xbe013f3a3f7c3ede,0x3f2dbe48bf68bf60,0xbf68bf5cbd8f3f48,0x3ecb3f7b3f38be2c,0x3f2dbe80bf73bf48,0xbf80bf0e3ecb3f7c,0x3efe3f803f0bbede,0x3ed8bf0ebf80bef8,0xbf7abe9b3f2d3f7a,0x3f283f7b3ea2bf2b,0x3dc9bf55bf628000,0xbf75be483f463f6d,0x3f6b3f44be72bf7a,0x3e01bf55bf5e3d66
.quad 0xbf283ed13f803ede,0x3f5b3f55be1dbf76,0xbf05bf7dbe873f48,0xbf533e483f7a3f14,0x3f793e0fbf5ebf48,0xbe3abf7bbf0b3f14,0xbd8f3f6a3f32bede,0x3f793f0ebf17bf76,0xbf6ebf253f053f7a,0xbf1d3f0e3f773d66,0x3f22bf0ebf758000,0xbef1bf7bbdc93f6d,0x3f0b3f74bd2cbf7a,0x3f7f3e48bf65bf2b,0xbf773ce63f7a3ede,0xbeb03f553f3cbef8
.quad 0x3f2d3f7f3f0bbea9,0xbe72bf6abf62be2c,0xbf7abed13efe3f7e,0x3f6b3f5c3dc9bf3f,0x3ea2bf1abf80bf08,0xbf5ebdac3f463f76,0x3f283f7d3ed8bf08,0x3e01bf44bf75be8e,0xbf7cbeb73f1d3f7e,0x3f383f783e95bf2b,0x3eb0bf25bf7cbea9,0xbf7dbeb73f223f7c,0x3f223f7b3e95bf35,0x3ef1bf0ebf7fbec4,0xbf7dbe9b3f383f72,0x3ed83f803ef1bf14
.quad 0x3ebdbf30bf73bde5,0xbf7abf1a3ef13f80,0x3f1d3f783e1dbf59,0x3f41be9bbf7fbef8,0xbf7ebe803f4f3f59,0x3d8f3f743f22bef8,0x3ecbbf3abf653de5,0xbf57bf4d3e953f80,0x3f173f743c66bf72,0x3f70bce6bf75bf14,0xbf7fbe483f623f35,0xbe953f553f46bec4,0x3ed8bf44bf533ea9,0xbf17bf6f3dc93f7c,0x3f113f6fbe01bf7e,0x3f803e80bf62bf2b
.quad 0xbe873f1a3f803f20,0x3f32be0fbf5ebf6d,0xbf05bf7fbf283e64,0xbd8f3f443f793ec4,0x3f7a3f3abe1dbf67,0xbf17bf80bf0b3ec4,0xbf533ce63f5b3f67,0x3f793f3abe3abf6d,0x3e1dbf44bf73be64,0xbf65bdac3f4f3f6d,0x3f1d3f7d3ebdbf20,0x3ecbbf1abf7ebec4,0xbf7fbf0e3ef13f80,0x3e953f7b3f22bec4,0x3f41be80bf7abf20,0xbf57bf5c3d8f3f6d
.quad 0xbd2c3f633f4abe64,0x3f7e3e9bbf3cbf6d,0xbf32bf6fbd2c3f67,0xbf2d3ed13f803ec4,0x3f803eb7bf3cbf67,0x3d2cbf6abf383ec4,0xbf2d3eeb3f7e3e64,0x3f1d3f743d2cbf6d,0xbd8fbf78bf0b3f20,0xbf7abf023f283f6d,0x3f463f55be95bf80,0x3f62be48bf7fbec4,0xbf7ebe0f3f6b3f20,0xbebd3f4d3f4abec4,0x3f17bf25bf653e64,0xbea2bf7fbe1d3f6d
.quad 0xbf75beb73f053f7e,0x3f7a3f44bd2cbf51,0x3f22be80bf6ebf59,0xbf77beb73f0b3f80,0xbdc93f443f773ea9,0x3f3cbe0fbf65bf60,0xbef1bf7fbf1d3ea9,0xbeb03f1a3f7f3ef8,0x3f623f5c3c66bf59,0xbe01bf6abf533d66,0xbf7fbed13f173f7e,0x3f113f7f3ed8bf14,0x3f46be48bf75bf35,0xbf62bf553dc93f6d,0xbe953f3a3f703de5,0x3f803eebbf17bf7c
.quad 0xbe95bf7dbf0b3f08,0xbf653ce63f6b3f3f,0x3f463f63bd8fbf72,0x3f17bf02bf7ebe8e,0xbf7fbeeb3f283f72,0xbe1d3f5c3f4abe8e,0x3f62be0fbf7abf08,0xbea2bf80bebd3f3f,0xbef13f303f68bde5,0x3f383f63be1dbf7c,0xbdc9bf7bbef13f35,0xbf75bf0e3f223f6d,0x3f223f6abe1dbf7e,0x3f7c3dacbf70bf14,0xbf75bf023f383f59,0xbf4a3ed13f7c3d66
.quad 0xbf41bf7bbee53ede,0x3eb03f743f533d66,0x3f703f553d2cbf48,0xbf11bf80bf1d3e8e,0xbf80bf0e3ebd3f7a,0x3f413f783eb0bf14,0x3f6e3e48bf38bf7a,0xbf65bf5cbd2c3f51,0xbf3c3e483f703f48,0x3f7a3f30be87bf76,0x3ee5bf0ebf7fbede,0xbf80beeb3f0b3f80,0xbdc93f553f628000,0x3f753e48bf46bf6d,0xbe87bf7bbf1d3ede,0xbf5b3dac3f6e3f3f
.quad 0x3f173f7b3e72bf48,0x3f32beb7bf7fbef8,0xbf57bf553e3a3f7a,0xbefe3f1a3f793e2c,0x3f7a3f0ebf11bf7a,0x3e87bf4dbf5b3e2c,0xbf7dbe483f5b3f48,0xbc663f6f3f28bef8,0x3f5ebe48bf7ebede,0xbe72bf7fbecb3f3f,0xbf223f0e3f758000,0x3ef13f7b3dc9bf6d,0x3ea2bf55bf413ede,0xbf2dbf633e563f80,0x3d2c3f7b3ed8bf48,0x3f573f3abefebf76
.quad 0x3e1dbf30bf7fbf08,0xbf1d3e803f6b3f60,0xbc663f4d3f753ea9,0x3f17be9bbf73bf51,0xbe01bf63bf62bde5,0xbf113eb73f793f3f,0x3e873f743f46bde5,0x3f0bbed1bf7dbf2b,0xbecbbf7dbf223ea9,0xbf053eeb3f7f3f14,0x3f053f803ef1bf08,0x3efebf02bf80bef8,0xbf22bf7bbe953f35,0xbef13f0e3f7f3ec4,0x3f3c3f6f3dc9bf59,0x3ee5bf1abf7cbe8e
.quad 0xbf53bf5c3dc93f72,0xbed83f253f773e2c,0x3f653f44be95bf7e,0x3ecbbf30bf70bd66,0xbf73bf253ef13f7e,0xbebd3f3a3f68bd66,0x3f7c3f02bf22bf72,0x3eb0bf44bf5e3e2c,0xbf80beb73f463f59,0xbea23f4d3f53be8e,0x3f7f3e48bf62bf35,0x3e95bf55bf463ec4,0xbf79bce63f753f08,0xbe873f5c3f38bef8,0x3f6ebe0fbf7fbea9,0x3e72bf63bf283f14
.quad 0xbf80,0x0,0x3f80,0x0,0xbf80,0x0,0x3f80,0x0,0xbf80,0x0,0x3f80,0x0,0xbf80,0x0,0x3f80,0x0
.quad 0xbf80,0x0,0x3f80,0x0,0xbf80,0x0,0x3f80,0x0,0xbf80,0x0,0x3f80,0x0,0xbf80,0x0,0x3f80,0x0
.quad 0x0,0x0,0x0,0x0,0x0,0x0,0x0,0x0,0x0,0x0,0x0,0x0,0x0,0x0,0x0,0x0
.quad 0x0,0x0,0x0,0x0,0x0,0x0,0x0,0x0,0x0,0x0,0x0,0x0,0x0,0x0,0x0,0x0
.quad 0xbf20bf673e643f80,0xbf80be643f673f20,0xbf0ebf6d3e483f80,0xbf7bbec43f553f35,0xbef8bf723e2c3f80,0xbf6dbf083f3f3f48,0xbed1bf763e0f3f80,0xbf55bf2b3f253f59,0xbea9bf7a3de53f80,0xbf35bf483f083f67,0xbe80bf7c3dac3f80,0xbf0ebf603ed13f72,0xbe2cbf7e3d663f80,0xbec4bf723e8e3f7a,0xbdacbf803ce63f80,0xbe48bf7c3e0f3f7e
.quad 0x8000bf8000003f80,0x8000bf8000003f80,0x3dacbf80bce63f80,0x3e48bf7cbe0f3f7e,0x3e2cbf7ebd663f80,0x3ec4bf72be8e3f7a,0x3e80bf7cbdac3f80,0x3f0ebf60bed13f72,0x3ea9bf7abde53f80,0x3f35bf48bf083f67,0x3ed1bf76be0f3f80,0x3f55bf2bbf253f59,0x3ef8bf72be2c3f80,0x3f6dbf08bf3f3f48,0x3f0ebf6dbe483f80,0x3f7bbec4bf553f35
.quad 0xbf203f203f67be64,0x3e643f803e64bf67,0xbf553ec43f7b8000,0xbe483f6d3f0ebf35,0xbf763de53f803e64,0xbf143f353f51bede,0xbf80be2c3f743ede,0xbf5c3ec43f78bde5,0xbf72bede3f593f20,0xbf7e00003f7e3e64,0xbf4dbf2b3f303f48,0xbf74bec43f633f08,0xbf14bf593ef83f67,0xbf3fbf353f2b3f48,0xbe9bbf763e803f7a,0xbed1bf6d3eb73f72
.quad 0x8000bf8000003f80,0x8000bf8000003f80,0x3e9bbf76be803f7a,0x3ed1bf6dbeb73f72,0x3f14bf59bef83f67,0x3f3fbf35bf2b3f48,0x3f4dbf2bbf303f48,0x3f74bec4bf633f08,0x3f72bedebf593f20,0x3f7e8000bf7e3e64,0x3f80be2cbf743ede,0x3f5c3ec4bf78bde5,0x3f763de5bf803e64,0x3f143f35bf51bede,0x3f553ec4bf7b0000,0x3e483f6dbf0ebf35
.quad 0x3f673f20bf20bf67,0x3f67be64bf80be64,0x3f0e3f6dbe48bf80,0x3f7b3ec4bf55bf35,0x3d663f7e3e8ebf67,0x3f2b3f59bec4bf7a,0xbeeb3f513f30bf20,0x3dac3f803e48bf72,0xbf593ede3f72be64,0xbf083f483f35bf20,0xbf80bd663f7d3e64,0xbf6f3e8e3f7bbde5,0xbf60bf083f513f20,0xbf76bea93f6d3ede,0xbf02bf603eeb3f67,0xbf1abf513f0e3f59
.quad 0x8000bf8000003f80,0x8000bf8000003f80,0x3f02bf60beeb3f67,0x3f1abf51bf0e3f59,0x3f60bf08bf513f20,0x3f76bea9bf6d3ede,0x3f80bd66bf7d3e64,0x3f6f3e8ebf7bbde5,0x3f593edebf72be64,0x3f083f48bf35bf20,0x3eeb3f51bf30bf20,0xbdac3f80be48bf72,0xbd663f7ebe8ebf67,0xbf2b3f593ec4bf7a,0xbf0e3f6d3e48bf80,0xbf7b3ec43f55bf35
.quad 0x3e64bf67bf203f20,0xbf20bf673e643f80,0x3f55bec4bf7b0000,0x3e48bf6dbf0e3f35,0x3f7c3ea9bf60bf20,0x3f60bea9bf7c0000,0x3f1a3f60beb7bf7a,0x3f6f3ef8bf4dbf35,0xbde53f7a3ea9bf67,0x3ea93f7abde5bf80,0xbf443f143f5cbede,0xbf023f513f25bf35,0xbf80bde53f7c3e64,0xbf7c3de53f808000,0xbf30bf3f3f253f48,0xbf44bf2b3f3a3f35
.quad 0x8000bf8000003f80,0x8000bf8000003f80,0x3f30bf3fbf253f48,0x3f44bf2bbf3a3f35,0x3f80bde5bf7c3e64,0x3f7c3de5bf800000,0x3f443f14bf5cbede,0x3f023f51bf25bf35,0x3de53f7abea9bf67,0xbea93f7a3de5bf80,0xbf1a3f603eb7bf7a,0xbf6f3ef83f4dbf35,0xbf7c3ea93f60bf20,0xbf60bea93f7c8000,0xbf55bec43f7b8000,0xbe48bf6d3f0e3f35
.quad 0xbf80be643f673f20,0xbf203f203f67be64,0xbf0ebf6d3e483f80,0xbf7bbec43f553f35,0x3ec4bf59bf2b3f20,0xbe8ebf7ebd663f7a,0x3f7bbd66bf7fbe64,0x3f3abf14bf633ea9,0x3f353f48bf08bf67,0x3f723edebf59bf20,0xbe483f763eb7bf67,0x3e0f3f803ce6bf7e,0xbf6d3ea93f76be64,0xbf513f083f60bede,0xbf55bf143f4d3f20,0xbf63bef83f5c3f08
.quad 0x8000bf8000003f80,0x8000bf8000003f80,0x3f55bf14bf4d3f20,0x3f63bef8bf5c3f08,0x3f6d3ea9bf76be64,0x3f513f08bf60bede,0x3e483f76beb7bf67,0xbe0f3f80bce6bf7e,0xbf353f483f08bf67,0xbf723ede3f59bf20,0xbf7bbd663f7fbe64,0xbf3abf143f633ea9,0xbec4bf593f2b3f20,0x3e8ebf7e3d663f7a,0x3f0ebf6dbe483f80,0x3f7bbec4bf553f35
.quad 0x3e643f803e64bf67,0x3f673f20bf20bf67,0xbf553ec43f7b8000,0xbe483f6d3f0ebf35,0xbf51bf353f143f67,0xbf80bde53f763ede,0x3e80bf6dbf023f48,0xbe9bbf7c3ce63f7e,0x3f7e8000bf7ebe64,0x3f59bedebf723e64,0x3eeb3f6dbe9bbf7a,0x3f3a3f3fbf1abf59,0xbf2b3f353f3fbf20,0xbef83f593f14bf48,0xbf6fbec43f6a3ede,0xbf78be8e3f743ea9
.quad 0x8000bf8000003f80,0x8000bf8000003f80,0x3f6fbec4bf6a3ede,0x3f78be8ebf743ea9,0x3f2b3f35bf3fbf20,0x3ef83f59bf14bf48,0xbeeb3f6d3e9bbf7a,0xbf3a3f3f3f1abf59,0xbf7e00003f7ebe64,0xbf59bede3f723e64,0xbe80bf6d3f023f48,0x3e9bbf7cbce63f7e,0x3f51bf35bf143f67,0x3f80bde5bf763ede,0x3f553ec4bf7b0000,0x3e483f6dbf0ebf35
.quad 0x3f67be64bf80be64,0x3e64bf67bf203f20,0x3f0e3f6dbe48bf80,0x3f7b3ec4bf55bf35,0xbf3f3f083f6dbe64,0xbe2c3f723ef8bf48,0xbf44bf3f3f0e3f67,0xbf7dbe8e3f6a3f08,0x3f08bf48bf353f20,0x3de5bf7abea93f67,0x3f6a3ef8bf55bf20,0x3f7f3e2cbf78bea9,0xbe8e3f723ec4bf67,0xbd663f7e3e2cbf7a,0xbf7dbe2c3f7b3e64,0xbf80bd663f7f3de5
.quad 0x8000bf8000003f80,0x8000bf8000003f80,0x3f7dbe2cbf7b3e64,0x3f80bd66bf7f3de5,0x3e8e3f72bec4bf67,0x3d663f7ebe2cbf7a,0xbf6a3ef83f55bf20,0xbf7f3e2c3f78bea9,0xbf08bf483f353f20,0xbde5bf7a3ea93f67,0x3f44bf3fbf0e3f67,0x3f7dbe8ebf6a3f08,0x3f3f3f08bf6dbe64,0x3e2c3f72bef8bf48,0xbf0e3f6d3e48bf80,0xbf7b3ec43f55bf35
.quad 0xbf20bf673e643f80,0xbf80be643f673f20,0x3f55bec4bf7b0000,0x3e48bf6dbf0e3f35,0x3ef83f72be2cbf80,0x3f6d3f08bf3fbf48,0xbf6a3e8e3f7d8000,0xbf0e3f3f3f44bf08,0xbea9bf7a3de53f80,0xbf35bf483f083f67,0x3f78be2cbf7f0000,0x3f55bef8bf6a3ea9,0x3e2c3f7ebd66bf80,0x3ec43f72be8ebf7a,0xbf7f3d663f808000,0xbf7b3e2c3f7dbde5
.quad 0x8000bf8000003f80,0x8000bf8000003f80,0x3f7f3d66bf800000,0x3f7b3e2cbf7dbde5,0xbe2c3f7e3d66bf80,0xbec43f723e8ebf7a,0xbf78be2c3f7f8000,0xbf55bef83f6a3ea9,0x3ea9bf7abde53f80,0x3f35bf48bf083f67,0x3f6a3e8ebf7d0000,0x3f0e3f3fbf44bf08,0xbef83f723e2cbf80,0xbf6d3f083f3fbf48,0xbf55bec43f7b8000,0xbe48bf6d3f0e3f35
.quad 0xbf203f203f67be64,0x3e643f803e64bf67,0xbf0ebf6d3e483f80,0xbf7bbec43f553f35,0x3f76bde5bf80be64,0x3f14bf35bf513ede,0xbce63f7c3e9bbf67,0x3f023f6dbe80bf7e,0xbf72bede3f593f20,0xbf7e00003f7e3e64,0x3f1abf3fbf3a3f20,0x3e9bbf6dbeeb3f59,0x3f143f59bef8bf67,0x3f3f3f35bf2bbf48,0xbf743e8e3f78be64,0xbf6a3ec43f6fbea9
.quad 0x8000bf8000003f80,0x8000bf8000003f80,0x3f743e8ebf78be64,0x3f6a3ec4bf6fbea9,0xbf143f593ef8bf67,0xbf3f3f353f2bbf48,0xbf1abf3f3f3a3f20,0xbe9bbf6d3eeb3f59,0x3f72bedebf593f20,0x3f7e8000bf7e3e64,0x3ce63f7cbe9bbf67,0xbf023f6d3e80bf7e,0xbf76bde53f80be64,0xbf14bf353f513ede,0x3f0ebf6dbe483f80,0x3f7bbec4bf553f35
.quad 0x3f673f20bf20bf67,0x3f67be64bf80be64,0xbf553ec43f7b8000,0xbe483f6d3f0ebf35,0xbd66bf7ebe8e3f67,0xbf2bbf593ec43f7a,0x3f633f14bf3abf48,0x3f7f3d66bf7bbea9,0xbf593ede3f72be64,0xbf083f483f35bf20,0xbce6bf80be0f3f7a,0xbeb7bf763e483f7e,0x3f603f08bf51bf20,0x3f763ea9bf6dbede,0xbf5c3ef83f63bede,0xbf4d3f143f55bf08
.quad 0x8000bf8000003f80,0x8000bf8000003f80,0x3f5c3ef8bf63bede,0x3f4d3f14bf55bf08,0xbf603f083f51bf20,0xbf763ea93f6dbede,0x3ce6bf803e0f3f7a,0x3eb7bf76be483f7e,0x3f593edebf72be64,0x3f083f48bf35bf20,0xbf633f143f3abf48,0xbf7f3d663f7bbea9,0x3d66bf7e3e8e3f67,0x3f2bbf59bec43f7a,0x3f553ec4bf7b0000,0x3e483f6dbf0ebf35
.quad 0x3e64bf67bf203f20,0xbf20bf673e643f80,0x3f0e3f6dbe48bf80,0x3f7b3ec4bf55bf35,0xbf7cbea93f603f20,0xbf603ea93f7c8000,0x3f4dbef8bf6f3e64,0x3eb7bf60bf1a3f35,0xbde53f7a3ea9bf67,0x3ea93f7abde5bf80,0xbf25bf513f023f67,0xbf5cbf143f443f35,0x3f803de5bf7cbe64,0x3f7cbde5bf800000,0xbf3a3f2b3f44bf20,0xbf253f3f3f30bf35
.quad 0x8000bf8000003f80,0x8000bf8000003f80,0x3f3a3f2bbf44bf20,0x3f253f3fbf30bf35,0xbf803de53f7cbe64,0xbf7cbde53f808000,0x3f25bf51bf023f67,0x3f5cbf14bf443f35,0x3de53f7abea9bf67,0xbea93f7a3de5bf80,0xbf4dbef83f6f3e64,0xbeb7bf603f1a3f35,0x3f7cbea9bf603f20,0x3f603ea9bf7c0000,0xbf0e3f6d3e48bf80,0xbf7b3ec43f55bf35
.quad 0xbf80be643f673f20,0xbf203f203f67be64,0x3f55bec4bf7b0000,0x3e48bf6dbf0e3f35,0xbec43f593f2bbf20,0x3e8e3f7e3d66bf7a,0xbe48bf80bdac3f7a,0xbf30bf513eeb3f72,0x3f353f48bf08bf67,0x3f723edebf59bf20,0xbf7bbe8e3f6f3ede,0xbf7d3d663f803de5,0x3f6dbea9bf763e64,0x3f51bf08bf603ede,0xbf0e3f513f1abf48,0xbeeb3f603f02bf59
.quad 0x8000bf8000003f80,0x8000bf8000003f80,0x3f0e3f51bf1abf48,0x3eeb3f60bf02bf59,0xbf6dbea93f763e64,0xbf51bf083f603ede,0x3f7bbe8ebf6f3ede,0x3f7d3d66bf803de5,0xbf353f483f08bf67,0xbf723ede3f59bf20,0x3e48bf803dac3f7a,0x3f30bf51beeb3f72,0x3ec43f59bf2bbf20,0xbe8e3f7ebd66bf7a,0xbf55bec43f7b8000,0xbe48bf6d3f0e3f35
.quad 0x3e643f803e64bf67,0x3f673f20bf20bf67,0xbf0ebf6d3e483f80,0xbf7bbec43f553f35,0x3f513f35bf14bf67,0x3f803de5bf76bede,0xbf78bec43f5c3f20,0xbf743e2c3f803de5,0x3f7e8000bf7ebe64,0x3f59bedebf723e64,0xbf633ec43f74be64,0xbf303f2b3f4dbf08,0x3f2bbf35bf3f3f20,0x3ef8bf59bf143f48,0xbeb73f6d3ed1bf67,0xbe803f763e9bbf72
.quad 0x8000bf8000003f80,0x8000bf8000003f80,0x3eb73f6dbed1bf67,0x3e803f76be9bbf72,0xbf2bbf353f3f3f20,0xbef8bf593f143f48,0x3f633ec4bf74be64,0x3f303f2bbf4dbf08,0xbf7e00003f7ebe64,0xbf59bede3f723e64,0x3f78bec4bf5c3f20,0x3f743e2cbf803de5,0xbf513f353f14bf67,0xbf803de53f76bede,0x3f0ebf6dbe483f80,0x3f7bbec4bf553f35
.quad 0x3f67be64bf80be64,0x3e64bf67bf203f20,0xbf553ec43f7b8000,0xbe483f6d3f0ebf35,0x3f3fbf08bf6d3e64,0x3e2cbf72bef83f48,0xbf253f2b3f55bede,0xbe0f3f763ed1bf59,0x3f08bf48bf353f20,0x3de5bf7abea93f67,0xbed13f603f0ebf48,0xbdac3f7c3e80bf72,0x3e8ebf72bec43f67,0x3d66bf7ebe2c3f7a,0xbe0f3f7c3e48bf7a,0xbce63f803dacbf7e
.quad 0x8000bf8000003f80,0x8000bf8000003f80,0x3e0f3f7cbe48bf7a,0x3ce63f80bdacbf7e,0xbe8ebf723ec43f67,0xbd66bf7e3e2c3f7a,0x3ed13f60bf0ebf48,0x3dac3f7cbe80bf72,0xbf08bf483f353f20,0xbde5bf7a3ea93f67,0x3f253f2bbf55bede,0x3e0f3f76bed1bf59,0xbf3fbf083f6d3e64,0xbe2cbf723ef83f48,0x3f553ec4bf7b0000,0x3e483f6dbf0ebf35
.quad 0x3f80,0x0,0xbf80,0x0,0x3f80,0x0,0xbf80,0x0,0x3f80,0x0,0xbf80,0x0,0x3f80,0x0,0xbf80,0x0
.quad 0x3f80,0x0,0xbf80,0x0,0x3f80,0x0,0xbf80,0x0,0x3f80,0x0,0xbf80,0x0,0x3f80,0x0,0xbf80,0x0
.quad 0x0,0x0,0x0,0x0,0x0,0x0,0x0,0x0,0x0,0x0,0x0,0x0,0x0,0x0,0x0,0x0
.quad 0x0,0x0,0x0,0x0,0x0,0x0,0x0,0x0,0x0,0x0,0x0,0x0,0x0,0x0,0x0,0x0
.quad 0x3f48bedebf7a8000,0x8000bf7abede3f48,0x3f55bec4bf7b8000,0x3e48bf6dbf0e3f35,0x3f60bea9bf7c8000,0x3ec4bf59bf2b3f20,0x3f6abe8ebf7d8000,0x3f0ebf3fbf443f08,0x3f72be64bf7e8000,0x3f35bf20bf593ede,0x3f78be2cbf7f8000,0x3f55bef8bf6a3ea9,0x3f7cbde5bf808000,0x3f6dbea9bf763e64,0x3f7fbd66bf808000,0x3f7bbe2cbf7d3de5
.quad 0x3f808000bf808000,0x3f808000bf808000,0x3f7f3d66bf808000,0x3f7b3e2cbf7dbde5,0x3f7c3de5bf808000,0x3f6d3ea9bf76be64,0x3f783e2cbf7f8000,0x3f553ef8bf6abea9,0x3f723e64bf7e8000,0x3f353f20bf59bede,0x3f6a3e8ebf7d8000,0x3f0e3f3fbf44bf08,0x3f603ea9bf7c8000,0x3ec43f59bf2bbf20,0x3f553ec4bf7b8000,0x3e483f6dbf0ebf35
.quad 0xbf48bf483ede3f7a,0xbf7a80003f7a3ede,0xbf0ebf6d3e483f80,0xbf7bbec43f553f35,0xbe8ebf7ebd663f7a,0xbf51bf353f143f67,0x3ce6bf7cbe9b3f67,0xbf02bf6d3e803f7e,0x3ea9bf67bf083f48,0xbde5bf80bde53f7a,0x3f1abf3fbf3a3f20,0x3e9bbf6dbeeb3f59,0x3f51bf08bf603ede,0x3f2bbf35bf3f3f20,0x3f74be8ebf783e64,0x3f6abec4bf6f3ea9
.quad 0x3f808000bf808000,0x3f808000bf808000,0x3f743e8ebf78be64,0x3f6a3ec4bf6fbea9,0x3f513f08bf60bede,0x3f2b3f35bf3fbf20,0x3f1a3f3fbf3abf20,0x3e9b3f6dbeebbf59,0x3ea93f67bf08bf48,0xbde53f80bde5bf7a,0x3ce63f7cbe9bbf67,0xbf023f6d3e80bf7e,0xbe8e3f7ebd66bf7a,0xbf513f353f14bf67,0xbf0e3f6d3e48bf80,0xbf7b3ec43f55bf35
.quad 0xbede3f483f48bede,0x3ede3f7a8000bf7a,0xbf553ec43f7b8000,0xbe483f6d3f0ebf35,0xbf80bde53f763ede,0xbf3f3f083f6dbe64,0xbf63bf143f3a3f48,0xbf7fbd663f7b3ea9,0xbf08bf673ea93f7a,0xbf59bf203f353f48,0xbce6bf80be0f3f7a,0xbeb7bf763e483f7e,0x3ef8bf59bf143f48,0x3e8ebf72bec43f67,0x3f5cbef8bf633ede,0x3f4dbf14bf553f08
.quad 0x3f808000bf808000,0x3f808000bf808000,0x3f5c3ef8bf63bede,0x3f4d3f14bf55bf08,0x3ef83f59bf14bf48,0x3e8e3f72bec4bf67,0xbce63f80be0fbf7a,0xbeb73f763e48bf7e,0xbf083f673ea9bf7a,0xbf593f203f35bf48,0xbf633f143f3abf48,0xbf7f3d663f7bbea9,0xbf803de53f76bede,0xbf3fbf083f6d3e64,0xbf55bec43f7b8000,0xbe48bf6d3f0e3f35
.quad 0x3f7a3edebf48bf48,0x3f48bedebf7a8000,0x3f0e3f6dbe48bf80,0x3f7b3ec4bf55bf35,0xbe2c3f723ef8bf48,0x3ef83f72be2cbf80,0xbf4d3ef83f6fbe64,0xbeb73f603f1abf35,0xbf7ebe643f723ede,0xbf723e643f7e8000,0xbf25bf513f023f67,0xbf5cbf143f443f35,0x3d66bf7ebe2c3f7a,0xbe2cbf7e3d663f80,0x3f3abf2bbf443f20,0x3f25bf3fbf303f35
.quad 0x3f808000bf808000,0x3f808000bf808000,0x3f3a3f2bbf44bf20,0x3f253f3fbf30bf35,0x3d663f7ebe2cbf7a,0xbe2c3f7e3d66bf80,0xbf253f513f02bf67,0xbf5c3f143f44bf35,0xbf7e3e643f72bede,0xbf72be643f7e8000,0xbf4dbef83f6f3e64,0xbeb7bf603f1a3f35,0xbe2cbf723ef83f48,0x3ef8bf72be2c3f80,0x3f0ebf6dbe483f80,0x3f7bbec4bf553f35
.quad 0x8000bf7abede3f48,0xbf48bf483ede3f7a,0x3f55bec4bf7b8000,0x3e48bf6dbf0e3f35,0x3f6d3f08bf3fbf48,0x3f76bde5bf80be64,0x3e483f803dacbf7a,0x3f303f51beebbf72,0xbf353f203f59bede,0xbea93f673f08bf48,0xbf7bbe8e3f6f3ede,0xbf7d3d663f803de5,0xbec4bf723e8e3f7a,0xbf14bf593ef83f67,0x3f0ebf51bf1a3f48,0x3eebbf60bf023f59
.quad 0x3f808000bf808000,0x3f808000bf808000,0x3f0e3f51bf1abf48,0x3eeb3f60bf02bf59,0xbec43f723e8ebf7a,0xbf143f593ef8bf67,0xbf7b3e8e3f6fbede,0xbf7dbd663f80bde5,0xbf35bf203f593ede,0xbea9bf673f083f48,0x3e48bf803dac3f7a,0x3f30bf51beeb3f72,0x3f6dbf08bf3f3f48,0x3f763de5bf803e64,0x3f553ec4bf7b8000,0x3e483f6dbf0ebf35
.quad 0xbf7a80003f7a3ede,0xbede3f483f48bede,0xbf0ebf6d3e483f80,0xbf7bbec43f553f35,0x3f14bf35bf513ede,0xbd66bf7ebe8e3f67,0x3f783ec4bf5cbf20,0x3f74be2cbf80bde5,0x3de53f803de5bf7a,0x3f083f67bea9bf7a,0xbf633ec43f74be64,0xbf303f2b3f4dbf08,0xbf3fbf353f2b3f48,0xbf60bf083f513f20,0x3eb7bf6dbed13f67,0x3e80bf76be9b3f72
.quad 0x3f808000bf808000,0x3f808000bf808000,0x3eb73f6dbed1bf67,0x3e803f76be9bbf72,0xbf3f3f353f2bbf48,0xbf603f083f51bf20,0xbf63bec43f743e64,0xbf30bf2b3f4d3f08,0x3de5bf803de53f7a,0x3f08bf67bea93f7a,0x3f78bec4bf5c3f20,0x3f743e2cbf803de5,0x3f143f35bf51bede,0xbd663f7ebe8ebf67,0xbf0e3f6d3e48bf80,0xbf7b3ec43f55bf35
.quad 0x3ede3f7a8000bf7a,0x3f7a3edebf48bf48,0xbf553ec43f7b8000,0xbe483f6d3f0ebf35,0xbf2bbf593ec43f7a,0xbf7cbea93f603f20,0x3f25bf2bbf553ede,0x3e0fbf76bed13f59,0x3f593f20bf35bf48,0x3f7e3e64bf72bede,0xbed13f603f0ebf48,0xbdac3f7c3e80bf72,0xbf76bea93f6d3ede,0xbf80bde53f7c3e64,0x3e0fbf7cbe483f7a,0x3ce6bf80bdac3f7e
.quad 0x3f808000bf808000,0x3f808000bf808000,0x3e0f3f7cbe48bf7a,0x3ce63f80bdacbf7e,0xbf763ea93f6dbede,0xbf803de53f7cbe64,0xbed1bf603f0e3f48,0xbdacbf7c3e803f72,0x3f59bf20bf353f48,0x3f7ebe64bf723ede,0x3f253f2bbf55bede,0x3e0f3f76bed1bf59,0xbf2b3f593ec4bf7a,0xbf7c3ea93f60bf20,0xbf55bec43f7b8000,0xbe48bf6d3f0e3f35
.quad 0x3f48bedebf7a8000,0x8000bf7abede3f48,0x3f0e3f6dbe48bf80,0x3f7b3ec4bf55bf35,0xbf603ea93f7c8000,0xbec43f593f2bbf20,0xbed1bf763e0f3f80,0xbf55bf2b3f253f59,0x3f72be64bf7e8000,0x3f35bf20bf593ede,0x3e803f7cbdacbf80,0x3f0e3f60bed1bf72,0xbf7c3de53f808000,0xbf6d3ea93f76be64,0xbdacbf803ce63f80,0xbe48bf7c3e0f3f7e
.quad 0x3f808000bf808000,0x3f808000bf808000,0xbdac3f803ce6bf80,0xbe483f7c3e0fbf7e,0xbf7cbde53f808000,0xbf6dbea93f763e64,0x3e80bf7cbdac3f80,0x3f0ebf60bed13f72,0x3f723e64bf7e8000,0x3f353f20bf59bede,0xbed13f763e0fbf80,0xbf553f2b3f25bf59,0xbf60bea93f7c8000,0xbec4bf593f2b3f20,0x3f0ebf6dbe483f80,0x3f7bbec4bf553f35
.quad 0xbf48bf483ede3f7a,0xbf7a80003f7a3ede,0x3f55bec4bf7b8000,0x3e48bf6dbf0e3f35,0x3e8e3f7e3d66bf7a,0x3f513f35bf14bf67,0xbf80be2c3f743ede,0xbf5c3ec43f78bde5,0x3ea9bf67bf083f48,0xbde5bf80bde53f7a,0x3f4d3f2bbf30bf48,0x3f743ec4bf63bf08,0xbf513f083f60bede,0xbf2b3f353f3fbf20,0xbe9bbf763e803f7a,0xbed1bf6d3eb73f72
.quad 0x3f808000bf808000,0x3f808000bf808000,0xbe9b3f763e80bf7a,0xbed13f6d3eb7bf72,0xbf51bf083f603ede,0xbf2bbf353f3f3f20,0x3f4dbf2bbf303f48,0x3f74bec4bf633f08,0x3ea93f67bf08bf48,0xbde53f80bde5bf7a,0xbf803e2c3f74bede,0xbf5cbec43f783de5,0x3e8ebf7e3d663f7a,0x3f51bf35bf143f67,0x3f553ec4bf7b8000,0x3e483f6dbf0ebf35
.quad 0xbede3f483f48bede,0x3ede3f7a8000bf7a,0xbf0ebf6d3e483f80,0xbf7bbec43f553f35,0x3f803de5bf76bede,0x3f3fbf08bf6d3e64,0xbeeb3f513f30bf20,0x3dac3f803e48bf72,0xbf08bf673ea93f7a,0xbf59bf203f353f48,0x3f803d66bf7dbe64,0x3f6fbe8ebf7b3de5,0xbef83f593f14bf48,0xbe8e3f723ec4bf67,0xbf02bf603eeb3f67,0xbf1abf513f0e3f59
.quad 0x3f808000bf808000,0x3f808000bf808000,0xbf023f603eebbf67,0xbf1a3f513f0ebf59,0xbef8bf593f143f48,0xbe8ebf723ec43f67,0x3f80bd66bf7d3e64,0x3f6f3e8ebf7bbde5,0xbf083f673ea9bf7a,0xbf593f203f35bf48,0xbeebbf513f303f20,0x3dacbf803e483f72,0x3f80bde5bf763ede,0x3f3f3f08bf6dbe64,0xbf0e3f6d3e48bf80,0xbf7b3ec43f55bf35
.quad 0x3f7a3edebf48bf48,0x3f48bedebf7a8000,0xbf553ec43f7b8000,0xbe483f6d3f0ebf35,0x3e2cbf72bef83f48,0xbef8bf723e2c3f80,0x3f1a3f60beb7bf7a,0x3f6f3ef8bf4dbf35,0xbf7ebe643f723ede,0xbf723e643f7e8000,0x3f44bf14bf5c3ede,0x3f02bf51bf253f35,0xbd663f7e3e2cbf7a,0x3e2c3f7ebd66bf80,0xbf30bf3f3f253f48,0xbf44bf2b3f3a3f35
.quad 0x3f808000bf808000,0x3f808000bf808000,0xbf303f3f3f25bf48,0xbf443f2b3f3abf35,0xbd66bf7e3e2c3f7a,0x3e2cbf7ebd663f80,0x3f443f14bf5cbede,0x3f023f51bf25bf35,0xbf7e3e643f72bede,0xbf72be643f7e8000,0x3f1abf60beb73f7a,0x3f6fbef8bf4d3f35,0x3e2c3f72bef8bf48,0xbef83f723e2cbf80,0xbf55bec43f7b8000,0xbe48bf6d3f0e3f35
.quad 0x8000bf7abede3f48,0xbf48bf483ede3f7a,0x3f0e3f6dbe48bf80,0x3f7b3ec4bf55bf35,0xbf6dbf083f3f3f48,0xbf763de53f803e64,0x3f7bbd66bf7fbe64,0x3f3abf14bf633ea9,0xbf353f203f59bede,0xbea93f673f08bf48,0x3e48bf76beb73f67,0xbe0fbf80bce63f7e,0x3ec43f72be8ebf7a,0x3f143f59bef8bf67,0xbf55bf143f4d3f20,0xbf63bef83f5c3f08
.quad 0x3f808000bf808000,0x3f808000bf808000,0xbf553f143f4dbf20,0xbf633ef83f5cbf08,0x3ec4bf72be8e3f7a,0x3f14bf59bef83f67,0x3e483f76beb7bf67,0xbe0f3f80bce6bf7e,0xbf35bf203f593ede,0xbea9bf673f083f48,0x3f7b3d66bf7f3e64,0x3f3a3f14bf63bea9,0xbf6d3f083f3fbf48,0xbf76bde53f80be64,0x3f0ebf6dbe483f80,0x3f7bbec4bf553f35
.quad 0xbf7a80003f7a3ede,0xbede3f483f48bede,0x3f55bec4bf7b8000,0x3e48bf6dbf0e3f35,0xbf143f353f51bede,0x3d663f7e3e8ebf67,0x3e80bf6dbf023f48,0xbe9bbf7c3ce63f7e,0x3de53f803de5bf7a,0x3f083f67bea9bf7a,0xbeebbf6d3e9b3f7a,0xbf3abf3f3f1a3f59,0x3f3f3f35bf2bbf48,0x3f603f08bf51bf20,0xbf6fbec43f6a3ede,0xbf78be8e3f743ea9
.quad 0x3f808000bf808000,0x3f808000bf808000,0xbf6f3ec43f6abede,0xbf783e8e3f74bea9,0x3f3fbf35bf2b3f48,0x3f60bf08bf513f20,0xbeeb3f6d3e9bbf7a,0xbf3a3f3f3f1abf59,0x3de5bf803de53f7a,0x3f08bf67bea93f7a,0x3e803f6dbf02bf48,0xbe9b3f7c3ce6bf7e,0xbf14bf353f513ede,0x3d66bf7e3e8e3f67,0x3f553ec4bf7b8000,0x3e483f6dbf0ebf35
.quad 0x3ede3f7a8000bf7a,0x3f7a3edebf48bf48,0xbf0ebf6d3e483f80,0xbf7bbec43f553f35,0x3f2b3f59bec4bf7a,0x3f7c3ea9bf60bf20,0xbf44bf3f3f0e3f67,0xbf7dbe8e3f6a3f08,0x3f593f20bf35bf48,0x3f7e3e64bf72bede,0xbf6abef83f553f20,0xbf7fbe2c3f783ea9,0x3f763ea9bf6dbede,0x3f803de5bf7cbe64,0xbf7dbe2c3f7b3e64,0xbf80bd663f7f3de5
.quad 0x3f808000bf808000,0x3f808000bf808000,0xbf7d3e2c3f7bbe64,0xbf803d663f7fbde5,0x3f76bea9bf6d3ede,0x3f80bde5bf7c3e64,0xbf6a3ef83f55bf20,0xbf7f3e2c3f78bea9,0x3f59bf20bf353f48,0x3f7ebe64bf723ede,0xbf443f3f3f0ebf67,0xbf7d3e8e3f6abf08,0x3f2bbf59bec43f7a,0x3f7cbea9bf603f20,0xbf0e3f6d3e48bf80,0xbf7b3ec43f55bf35
.quad 0x8000,0x0,0x8000,0x0,0x8000,0x0,0x8000,0x0,0x8000,0x0,0x8000,0x0,0x8000,0x0,0x8000,0x0
.quad 0x8000,0x0,0x8000,0x0,0x8000,0x0,0x8000,0x0,0x8000,0x0,0x8000,0x0,0x8000,0x0,0x8000,0x0
.quad 0x0,0x0,0x0,0x0,0x0,0x0,0x0,0x0,0x0,0x0,0x0,0x0,0x0,0x0,0x0,0x0
.quad 0x0,0x0,0x0,0x0,0x0,0x0,0x0,0x0,0x0,0x0,0x0,0x0,0x0,0x0,0x0,0x0
.quad 0xbf17bf6a3e563f80,0xbf7fbe9b3f5e3f2b,0xbf05bf6f3e3a3f80,0xbf75beeb3f4a3f3f,0xbee5bf743e1d3f80,0xbf62bf1a3f323f51,0xbebdbf783e013f80,0xbf46bf3a3f173f60,0xbe95bf7b3dc93f80,0xbf22bf553ef13f6d,0xbe56bf7d3d8f3f80,0xbef1bf6a3eb03f76,0xbe01bf7f3d2c3f80,0xbe95bf783e563f7c,0xbd2cbf803c663f80,0xbdc9bf7f3d8f3f80
.quad 0x3d2cbf80bc663f80,0x3dc9bf7fbd8f3f80,0x3e01bf7fbd2c3f80,0x3e95bf78be563f7c,0x3e56bf7dbd8f3f80,0x3ef1bf6abeb03f76,0x3e95bf7bbdc93f80,0x3f22bf55bef13f6d,0x3ebdbf78be013f80,0x3f46bf3abf173f60,0x3ee5bf74be1d3f80,0x3f62bf1abf323f51,0x3f05bf6fbe3a3f80,0x3f75beebbf4a3f3f,0x3f17bf6abe563f80,0x3f7fbe9bbf5e3f2b
.quad 0xbf3c3f023f73bde5,0x3c663f7b3ecbbf51,0xbf683e803f7f3de5,0xbecb3f553f32bf14,0xbf7ebce63f7c3ea9,0xbf3c3f0e3f68be8e,0xbf7cbe9b3f683f08,0xbf733e483f7f3d66,0xbf62bf0e3f463f35,0xbf7fbe483f753ec4,0xbf32bf443f173f59,0xbf5ebf0e3f4a3f2b,0xbee5bf6a3ebd3f72,0xbf17bf553f053f60,0xbe1dbf7d3e013f7e,0xbe56bf7b3e3a3f7c
.quad 0x3e1dbf7dbe013f7e,0x3e56bf7bbe3a3f7c,0x3ee5bf6abebd3f72,0x3f17bf55bf053f60,0x3f32bf44bf173f59,0x3f5ebf0ebf4a3f2b,0x3f62bf0ebf463f35,0x3f7fbe48bf753ec4,0x3f7cbe9bbf683f08,0x3f733e48bf7f3d66,0x3f7ebce6bf7c3ea9,0x3f3c3f0ebf68be8e,0x3f683e80bf7f3de5,0x3ecb3f55bf32bf14,0x3f3c3f02bf73bde5,0xbc663f7bbecbbf51
.quad 0x3f413f4dbed8bf7a,0x3f7e3dacbf75bef8,0x3ea23f7d3d2cbf7a,0x3f5e3f25bf22bf60,0xbe563f6f3efebf48,0x3ecb3f78bdc9bf80,0xbf2d3f253f57bede,0xbe723f6f3ef1bf51,0xbf753e483f7f8000,0xbf463f0e3f62bec4,0xbf79be9b3f6e3ede,0xbf80bce63f7f3e2c,0xbf38bf3a3f283f48,0xbf53bf1a3f463f2b,0xbe87bf783e723f7a,0xbea2bf743e953f76
.quad 0x3e87bf78be723f7a,0x3ea2bf74be953f76,0x3f38bf3abf283f48,0x3f53bf1abf463f2b,0x3f79be9bbf6e3ede,0x3f80bce6bf7f3e2c,0x3f753e48bf7f0000,0x3f463f0ebf62bec4,0x3f2d3f25bf57bede,0x3e723f6fbef1bf51,0x3e563f6fbefebf48,0xbecb3f783dc9bf80,0xbea23f7dbd2cbf7a,0xbf5e3f253f22bf60,0xbf413f4d3ed8bf7a,0xbf7e3dac3f75bef8
.quad 0x3f11bf30bf5b3ea9,0xbe72bf80be3a3f6d,0x3f7abce6bf7dbea9,0x3f17bf30bf573ec4,0x3f5b3f25bf28bf59,0x3f7f3dacbf79bec4,0x3e873f7dbc66bf7e,0x3f323f4dbefebf6d,0xbef13f553f22bf35,0xbdc93f7b3e95bf6d,0xbf733e803f7cbde5,0xbf533f023f65bec4,0xbf68beeb3f5e3f08,0xbf77be9b3f703ec4,0xbebdbf6f3eb03f72,0xbed8bf6a3ecb3f6d
.quad 0x3ebdbf6fbeb03f72,0x3ed8bf6abecb3f6d,0x3f68beebbf5e3f08,0x3f77be9bbf703ec4,0x3f733e80bf7cbde5,0x3f533f02bf65bec4,0x3ef13f55bf22bf35,0x3dc93f7bbe95bf6d,0xbe873f7d3c66bf7e,0xbf323f4d3efebf6d,0xbf5b3f253f28bf59,0xbf7f3dac3f79bec4,0xbf7abce63f7dbea9,0xbf17bf303f573ec4,0xbf11bf303f5b3ea9,0x3e72bf803e3a3f6d
.quad 0xbf62bf253f1d3f67,0xbf703e0f3f7f3e8e,0xbdc9bf7fbe873f67,0xbf3cbf4d3ee53f76,0x3f46bf02bf6e3e64,0x3e87bf6abf0b3f3f,0x3f753ed1bf5bbf20,0x3f7abdacbf80be2c,0x3e953f7bbdc9bf80,0x3f223f55bef1bf6d,0xbf223f3a3f3cbf20,0xbecb3f633f05bf51,0xbf7fbe0f3f7c3e64,0xbf7f3ce63f803d66,0xbef1bf633ee53f67,0xbf05bf5c3efe3f60
.quad 0x3ef1bf63bee53f67,0x3f05bf5cbefe3f60,0x3f7fbe0fbf7c3e64,0x3f7f3ce6bf803d66,0x3f223f3abf3cbf20,0x3ecb3f63bf05bf51,0xbe953f7b3dc9bf80,0xbf223f553ef1bf6d,0xbf753ed13f5bbf20,0xbf7abdac3f80be2c,0xbf46bf023f6e3e64,0xbe87bf6a3f0b3f3f,0x3dc9bf7f3e873f67,0x3f3cbf4dbee53f76,0x3f62bf25bf1d3f67,0x3f703e0fbf7f3e8e
.quad 0xbebd3f553f38bf08,0x3ee53f78bd2cbf7c,0xbf80be483f6e3f08,0xbf413f023f70be2c,0xbeb0bf7b3d2c3f7e,0xbf53bf303f1d3f60,0x3f41bf0ebf653ea9,0x3eb0bf63bf113f3f,0x3f623f0ebf46bf35,0x3f7f3e48bf75bec4,0xbe013f7b3e87bf72,0x3e1d3f7fbc66bf80,0xbf793e483f7dbde5,0xbf6b3eb73f73be8e,0xbf11bf553f0b3f59,0xbf1dbf4d3f173f51
.quad 0x3f11bf55bf0b3f59,0x3f1dbf4dbf173f51,0x3f793e48bf7dbde5,0x3f6b3eb7bf73be8e,0x3e013f7bbe87bf72,0xbe1d3f7f3c66bf80,0xbf623f0e3f46bf35,0xbf7f3e483f75bec4,0xbf41bf0e3f653ea9,0xbeb0bf633f113f3f,0x3eb0bf7bbd2c3f7e,0x3f53bf30bf1d3f60,0x3f80be48bf6e3f08,0x3f413f02bf70be2c,0x3ebd3f55bf38bf08,0xbee53f783d2cbf7c
.quad 0x3f773eebbf46bf48,0x3f57beb7bf7dbd66,0xbe013f743ef1bf48,0x3f113f6abe72bf80,0xbf80be0f3f753ede,0xbf4f3eeb3f73be2c,0xbe1dbf80bdc93f7a,0xbf1dbf5c3ecb3f76,0x3f75be48bf7f0000,0x3f46bf0ebf623ec4,0x3ed83f6fbe95bf7a,0x3f283f4dbf0bbf60,0xbf573f023f62bede,0xbf3c3f253f4abf14,0xbf28bf443f223f48,0xbf32bf3a3f2d3f3f
.quad 0x3f28bf44bf223f48,0x3f32bf3abf2d3f3f,0x3f573f02bf62bede,0x3f3c3f25bf4abf14,0xbed83f6f3e95bf7a,0xbf283f4d3f0bbf60,0xbf75be483f7f8000,0xbf46bf0e3f623ec4,0x3e1dbf803dc93f7a,0x3f1dbf5cbecb3f76,0x3f80be0fbf753ede,0x3f4f3eebbf73be2c,0x3e013f74bef1bf48,0xbf113f6a3e72bf80,0xbf773eeb3f46bf48,0xbf57beb73f7dbd66
.quad 0x3e1dbf6fbf0b3f35,0xbf22bf633e873f80,0x3f793ed1bf53bf35,0x3f62be9bbf7ebd66,0xbea23f633f17bf35,0x3e953f7d3c66bf7c,0xbf6bbf023f4a3f35,0xbf7fbce63f7d3e8e,0x3ef1bf55bf223f35,0x3dc9bf7bbe953f6d,0x3f573f1abf41bf35,0x3f753eb7bf68bef8,0xbf1d3f443f2dbf35,0xbef13f5c3f0bbf51,0xbf3cbf303f383f35,0xbf46bf253f413f2b
.quad 0x3f3cbf30bf383f35,0x3f46bf25bf413f2b,0x3f1d3f44bf2dbf35,0x3ef13f5cbf0bbf51,0xbf573f1a3f41bf35,0xbf753eb73f68bef8,0xbef1bf553f223f35,0xbdc9bf7b3e953f6d,0x3f6bbf02bf4a3f35,0x3f7fbce6bf7d3e8e,0x3ea23f63bf17bf35,0xbe953f7dbc66bf7c,0xbf793ed13f53bf35,0xbf62be9b3f7ebd66,0xbe1dbf6f3f0b3f35,0x3f22bf63be873f80
.quad 0xbf80be803f653f20,0xbf323f0e3f6ebe2c,0x3eb0bf5cbf283f20,0xbebdbf7b3c663f7c,0x3f4a3f3abf11bf67,0x3f803e48bf70bef8,0xbf533eeb3f70be64,0xbee53f553f28bf2b,0xbe95bf7b3dc93f80,0xbf22bf553ef13f6d,0x3f803dacbf7dbe64,0x3f77be48bf7e3d66,0xbea23f6f3ecbbf67,0xbe1d3f7b3e72bf76,0xbf4fbf1a3f4a3f20,0xbf57bf0e3f533f14
.quad 0x3f4fbf1abf4a3f20,0x3f57bf0ebf533f14,0x3ea23f6fbecbbf67,0x3e1d3f7bbe72bf76,0xbf803dac3f7dbe64,0xbf77be483f7e3d66,0x3e95bf7bbdc93f80,0x3f22bf55bef13f6d,0x3f533eebbf70be64,0x3ee53f55bf28bf2b,0xbf4a3f3a3f11bf67,0xbf803e483f70bef8,0xbeb0bf5c3f283f20,0x3ebdbf7bbc663f7c,0x3f80be80bf653f20,0x3f323f0ebf6ebe2c
.quad 0x3d8f3f7d3eb0bf59,0x3f4a3f44bef1bf76,0xbf65bf1a3f2d3f59,0xbf773dac3f7f3e8e,0x3f57bed1bf773de5,0x3ebdbf5cbf223f2b,0x3d2c3f7f3e56bf72,0x3f053f6abe95bf7c,0xbf62bf0e3f463f35,0xbf7fbe483f753ec4,0x3f5bbeebbf6b3ea9,0x3f2dbf30bf463f14,0x3c663f803d8fbf7e,0x3e3a3f7dbdc9bf80,0xbf5ebf023f5b3f08,0xbf65beeb3f623ef8
.quad 0x3f5ebf02bf5b3f08,0x3f65beebbf623ef8,0xbc663f80bd8fbf7e,0xbe3a3f7d3dc9bf80,0xbf5bbeeb3f6b3ea9,0xbf2dbf303f463f14,0x3f62bf0ebf463f35,0x3f7fbe48bf753ec4,0xbd2c3f7fbe56bf72,0xbf053f6a3e95bf7c,0xbf57bed13f773de5,0xbebdbf5c3f223f2b,0x3f65bf1abf2d3f59,0x3f773dacbf7f3e8e,0xbd8f3f7dbeb0bf59,0xbf4a3f443ef1bf76
.quad 0x3f7c3ce6bf79bede,0x3f05bf3abf533ec4,0xbf0b3f3a3f4fbede,0x3e1d3f803e56bf6d,0xbe72bf7fbd8f3f7a,0xbf41bf443f053f6d,0x3f5e3f1abf38bf48,0x3f803e0fbf77bec4,0xbf753e483f7f8000,0xbf463f0e3f62bec4,0x3ee5bf5cbf113f48,0x3e3abf78bea23f6d,0x3eb03f74be87bf7a,0x3efe3f63bed8bf6d,0xbf6bbed13f683ede,0xbf70beb73f6e3ec4
.quad 0x3f6bbed1bf683ede,0x3f70beb7bf6e3ec4,0xbeb03f743e87bf7a,0xbefe3f633ed8bf6d,0xbee5bf5c3f113f48,0xbe3abf783ea23f6d,0x3f753e48bf7f0000,0x3f463f0ebf62bec4,0xbf5e3f1a3f38bf48,0xbf803e0f3f77bec4,0x3e72bf7f3d8f3f7a,0x3f41bf44bf053f6d,0x3f0b3f3abf4fbede,0xbe1d3f80be56bf6d,0xbf7c3ce63f79bede,0xbf05bf3a3f533ec4
.quad 0xbe95bf7fbe013f72,0xbf68bf1a3f283f60,0x3f463f44befebf72,0x3f803e0fbf73bef8,0xbf7fbe803f6b3f08,0xbf5e3eb73f7abd66,0x3f62beb7bf793de5,0x3f0bbf44bf3c3f14,0xbef13f553f22bf35,0xbdc93f7b3e95bf6d,0xbdc9bf80bd2c3f7e,0xbebdbf743e723f7c,0x3f223f4dbf11bf59,0x3f413f30bf32bf3f,0xbf75be9b3f733ea9,0xbf79be803f773e8e
.quad 0x3f75be9bbf733ea9,0x3f79be80bf773e8e,0xbf223f4d3f11bf59,0xbf413f303f32bf3f,0x3dc9bf803d2c3f7e,0x3ebdbf74be723f7c,0x3ef13f55bf22bf35,0x3dc93f7bbe95bf6d,0xbf62beb73f793de5,0xbf0bbf443f3c3f14,0x3f7fbe80bf6b3f08,0x3f5e3eb7bf7abd66,0xbf463f443efebf72,0xbf803e0f3f73bef8,0x3e95bf7f3e013f72,0x3f68bf1abf283f60
.quad 0xbf6b3e483f803e64,0xbea23f5c3f2dbf14,0x3f38bf0ebf6b3e64,0x3d8fbf78bed83f51,0xbed83f553f2dbf20,0x3e3a3f803e01bf76,0x3d8fbf7bbea23f67,0xbed8bf743e3a3f80,0x3e953f7bbdc9bf80,0x3f223f55bef1bf6d,0xbf1dbf553efe3f67,0xbf4fbf253f383f3f,0x3f5b3f0ebf4fbf20,0x3f6e3ed1bf65bef8,0xbf7cbe483f7a3e64,0xbf7ebe0f3f7d3e2c
.quad 0x3f7cbe48bf7a3e64,0x3f7ebe0fbf7d3e2c,0xbf5b3f0e3f4fbf20,0xbf6e3ed13f65bef8,0x3f1dbf55befe3f67,0x3f4fbf25bf383f3f,0xbe953f7b3dc9bf80,0xbf223f553ef1bf6d,0xbd8fbf7b3ea23f67,0x3ed8bf74be3a3f80,0x3ed83f55bf2dbf20,0xbe3a3f80be01bf76,0xbf38bf0e3f6b3e64,0xbd8fbf783ed83f51,0x3f6b3e48bf803e64,0x3ea23f5cbf2dbf14
.quad 0x3efe3f74bdc9bf7e,0x3f7a3ed1bf4fbf3f,0xbf1dbf633e953f7e,0xbf7cbeb73f5b3f2b,0x3f383f4dbef1bf72,0x3f7d3e9bbf65bf14,0xbf4fbf303f223f59,0xbf7ebe803f6e3ef8,0x3f623f0ebf46bf35,0x3f7f3e48bf75bec4,0xbf70bed13f623f08,0xbf7fbe0f3f7a3e8e,0x3f7a3e80bf75bea9,0x3f803dacbf7ebe2c,0xbf7fbdac3f7f3de5,0xbf80bce63f803d66
.quad 0x3f7fbdacbf7f3de5,0x3f80bce6bf803d66,0xbf7a3e803f75bea9,0xbf803dac3f7ebe2c,0x3f70bed1bf623f08,0x3f7fbe0fbf7a3e8e,0xbf623f0e3f46bf35,0xbf7f3e483f75bec4,0x3f4fbf30bf223f59,0x3f7ebe80bf6e3ef8,0xbf383f4d3ef1bf72,0xbf7d3e9b3f65bf14,0x3f1dbf63be953f7e,0x3f7cbeb7bf5b3f2b,0xbefe3f743dc9bf7e,0xbf7a3ed13f4fbf3f
.quad 0x0,0x0,0x8000,0x0,0x0,0x0,0x8000,0x0,0x0,0x0,0x8000,0x0,0x0,0x0,0x8000,0x0
.quad 0x0,0x0,0x8000,0x0,0x0,0x0,0x8000,0x0,0x0,0x0,0x8000,0x0,0x0,0x0,0x8000,0x0
.quad 0x0,0x0,0x0,0x0,0x0,0x0,0x0,0x0,0x0,0x0,0x0,0x0,0x0,0x0,0x0,0x0
.quad 0x0,0x0,0x0,0x0,0x0,0x0,0x0,0x0,0x0,0x0,0x0,0x0,0x0,0x0,0x0,0x0
.quad 0x3f4fbed1bf7a8000,0x3dc9bf74befe3f3f,0x3f5bbeb7bf7c8000,0x3e95bf63bf1d3f2b,0x3f65be9bbf7d8000,0x3ef1bf4dbf383f14,0x3f6ebe80bf7e8000,0x3f22bf30bf4f3ef8,0x3f75be48bf7f8000,0x3f46bf0ebf623ec4,0x3f7abe0fbf7f8000,0x3f62bed1bf703e8e,0x3f7ebdacbf808000,0x3f75be80bf7a3e2c,0x3f80bce6bf808000,0x3f7fbdacbf7f3d66
.quad 0x3f803ce6bf808000,0x3f7f3dacbf7fbd66,0x3f7e3dacbf808000,0x3f753e80bf7abe2c,0x3f7a3e0fbf7f8000,0x3f623ed1bf70be8e,0x3f753e48bf7f8000,0x3f463f0ebf62bec4,0x3f6e3e80bf7e8000,0x3f223f30bf4fbef8,0x3f653e9bbf7d8000,0x3ef13f4dbf38bf14,0x3f5b3eb7bf7c8000,0x3e953f63bf1dbf2b,0x3f4f3ed1bf7a8000,0x3dc93f74befebf3f
.quad 0xbf2dbf5c3ea23f7e,0xbf80be483f6b3f14,0xbed8bf783d8f3f7e,0xbf6bbf0e3f383f51,0xbe01bf80be3a3f72,0xbf2dbf553ed83f76,0x3e3abf74bed83f59,0xbea2bf7b3d8f3f80,0x3ef1bf55bf223f35,0x3dc9bf7bbe953f6d,0x3f38bf25bf4f3f08,0x3efebf55bf1d3f3f,0x3f65bed1bf6e3ea9,0x3f4fbf0ebf5b3ef8,0x3f7dbe0fbf7e3de5,0x3f7abe48bf7c3e2c
.quad 0x3f7d3e0fbf7ebde5,0x3f7a3e48bf7cbe2c,0x3f653ed1bf6ebea9,0x3f4f3f0ebf5bbef8,0x3f383f25bf4fbf08,0x3efe3f55bf1dbf3f,0x3ef13f55bf22bf35,0x3dc93f7bbe95bf6d,0x3e3a3f74bed8bf59,0xbea23f7b3d8fbf80,0xbe013f80be3abf72,0xbf2d3f553ed8bf76,0xbed83f783d8fbf7e,0xbf6b3f0e3f38bf51,0xbf2d3f5c3ea2bf7e,0xbf803e483f6bbf14
.quad 0xbf283f1a3f68be64,0x3e013f7f3e95bf60,0xbf733e0f3f803e64,0xbefe3f443f46bef8,0xbf7abeb73f5e3f20,0xbf6b3e803f7f3d66,0xbf3cbf443f0b3f67,0xbf79beb73f623f14,0xbe95bf7b3dc93f80,0xbf22bf553ef13f6d,0x3e72bf74bebd3f67,0xbd2cbf80bdc93f7c,0x3f32bf30bf413f20,0x3f11bf4dbf223f3f,0x3f77be80bf793e64,0x3f73be9bbf753e8e
.quad 0x3f773e80bf79be64,0x3f733e9bbf75be8e,0x3f323f30bf41bf20,0x3f113f4dbf22bf3f,0x3e723f74bebdbf67,0xbd2c3f80bdc9bf7c,0xbe953f7b3dc9bf80,0xbf223f553ef1bf6d,0xbf3c3f443f0bbf67,0xbf793eb73f62bf14,0xbf7a3eb73f5ebf20,0xbf6bbe803f7fbd66,0xbf73be0f3f80be64,0xbefebf443f463ef8,0xbf28bf1a3f683e64,0x3e01bf7f3e953f60
.quad 0x3f533f3abf05bf72,0x3f79bce6bf7cbec4,0x3e563f803e1dbf72,0x3f4f3f3abf0bbf6d,0xbf053f443f41bf08,0x3d8f3f7f3e72bf6d,0xbf773e0f3f803de5,0xbf383f1a3f5ebec4,0xbf62bf0e3f463f35,0xbf7fbe483f753ec4,0xbea2bf783e3a3f7e,0xbf11bf5c3ee53f6d,0x3ed8bf63befe3f59,0x3e87bf74beb03f6d,0x3f6ebeb7bf703ea9,0x3f68bed1bf6b3ec4
.quad 0x3f6e3eb7bf70bea9,0x3f683ed1bf6bbec4,0x3ed83f63befebf59,0x3e873f74beb0bf6d,0xbea23f783e3abf7e,0xbf113f5c3ee5bf6d,0xbf623f0e3f46bf35,0xbf7f3e483f75bec4,0xbf77be0f3f80bde5,0xbf38bf1a3f5e3ec4,0xbf05bf443f413f08,0x3d8fbf7f3e723f6d,0x3e56bf803e1d3f72,0x3f4fbf3abf0b3f6d,0x3f53bf3abf053f72,0x3f793ce6bf7c3ec4
.quad 0x3ef1bf44bf4a3ede,0xbeb0bf7dbd8f3f76,0x3f7f3dacbf77bede,0x3f2dbf1abf653e8e,0x3f223f5cbebdbf7a,0x3f773ed1bf57bf2b,0xbe953f6a3f05bf48,0x3e563f7f3d2cbf7c,0xbf753e483f7f8000,0xbf463f0e3f62bec4,0xbf46bf303f2d3f48,0xbf6bbeeb3f5b3f14,0x3dc9bf7dbe3a3f7a,0xbd8fbf80bc663f80,0x3f62beebbf653ede,0x3f5bbf02bf5e3ef8
.quad 0x3f623eebbf65bede,0x3f5b3f02bf5ebef8,0x3dc93f7dbe3abf7a,0xbd8f3f80bc66bf80,0xbf463f303f2dbf48,0xbf6b3eeb3f5bbf14,0xbf75be483f7f8000,0xbf46bf0e3f623ec4,0xbe95bf6a3f053f48,0x3e56bf7f3d2c3f7c,0x3f22bf5cbebd3f7a,0x3f77bed1bf573f2b,0x3f7fbdacbf773ede,0x3f2d3f1abf65be8e,0x3ef13f44bf4abede,0xbeb03f7dbd8fbf76
.quad 0xbf6ebf0e3f323f59,0xbf653e803f803e2c,0x3c66bf7bbebd3f59,0xbf28bf5c3eb03f7c,0x3f70be48bf80bde5,0x3f11bf3abf4a3ef8,0x3f283f55bee5bf72,0x3f703eebbf53bf2b,0xbef13f553f22bf35,0xbdc93f7b3e95bf6d,0xbf7ebe483f773ea9,0xbf7d3dac3f803d66,0xbe72bf7b3e1d3f7e,0xbecbbf6f3ea23f76,0x3f53bf0ebf573f08,0x3f4abf1abf4f3f14
.quad 0x3f533f0ebf57bf08,0x3f4a3f1abf4fbf14,0xbe723f7b3e1dbf7e,0xbecb3f6f3ea2bf76,0xbf7e3e483f77bea9,0xbf7dbdac3f80bd66,0xbef1bf553f223f35,0xbdc9bf7b3e953f6d,0x3f28bf55bee53f72,0x3f70beebbf533f2b,0x3f703e48bf803de5,0x3f113f3abf4abef8,0x3c663f7bbebdbf59,0xbf283f5c3eb0bf7c,0xbf6e3f0e3f32bf59,0xbf65be803f80be2c
.quad 0xbe873f633f22bf20,0x3f0b3f6fbe1dbf80,0xbf7ebe9b3f623f20,0xbf533ed13f79bd66,0xbc66bf7dbe953f67,0xbf17bf633ea23f7c,0x3f7dbce6bf7fbe64,0x3f4abf02bf6b3e8e,0x3e953f7bbdc9bf80,0x3f223f55bef1bf6d,0xbf683eb73f75be64,0xbf413f1a3f57bef8,0xbf0bbf5c3ef13f67,0xbf2dbf443f1d3f51,0x3f41bf25bf463f20,0x3f38bf30bf3c3f2b
.quad 0x3f413f25bf46bf20,0x3f383f30bf3cbf2b,0xbf0b3f5c3ef1bf67,0xbf2d3f443f1dbf51,0xbf68beb73f753e64,0xbf41bf1a3f573ef8,0x3e95bf7bbdc93f80,0x3f22bf55bef13f6d,0x3f7d3ce6bf7f3e64,0x3f4a3f02bf6bbe8e,0xbc663f7dbe95bf67,0xbf173f633ea2bf7c,0xbf7e3e9b3f62bf20,0xbf53bed13f793d66,0xbe87bf633f223f20,0x3f0bbf6fbe1d3f80
.quad 0x3f7d3eb7bf57bf35,0x3f46beebbf773d66,0xbe723f6a3f11bf35,0x3ef13f74be01bf80,0xbf73beeb3f4f3f35,0xbf753e0f3f803e2c,0x3ecbbf5cbf1d3f35,0xbdc9bf80be1d3f76,0x3f623f0ebf46bf35,0x3f7f3e48bf75bec4,0xbf0b3f4d3f28bf35,0xbe953f6f3ed8bf60,0xbf4abf253f3c3f35,0xbf62bf023f573f14,0x3f2dbf3abf323f35,0x3f22bf44bf283f3f
.quad 0x3f2d3f3abf32bf35,0x3f223f44bf28bf3f,0xbf4a3f253f3cbf35,0xbf623f023f57bf14,0xbf0bbf4d3f283f35,0xbe95bf6f3ed83f60,0x3f62bf0ebf463f35,0x3f7fbe48bf753ec4,0x3ecb3f5cbf1dbf35,0xbdc93f80be1dbf76,0xbf733eeb3f4fbf35,0xbf75be0f3f80be2c,0xbe72bf6a3f113f35,0x3ef1bf74be013f80,0x3f7dbeb7bf573f35,0x3f463eebbf77bd66
.quad 0x3d2cbf78bee53f48,0xbf38bf553ebd3f7c,0x3f703f02bf41bf48,0x3f6ebe48bf80be2c,0xbf1d3f303f53bede,0xbd2c3f7b3eb0bf60,0xbf11bf633eb03f7a,0xbf65bf0e3f413f3f,0x3f75be48bf7f8000,0x3f46bf0ebf623ec4,0xbc663f7f3e1dbf7a,0x3e873f7bbe01bf80,0xbf73beb73f6b3ede,0xbf7dbe483f793e8e,0x3f17bf4dbf1d3f48,0x3f0bbf55bf113f51
.quad 0x3f173f4dbf1dbf48,0x3f0b3f55bf11bf51,0xbf733eb73f6bbede,0xbf7d3e483f79be8e,0xbc66bf7f3e1d3f7a,0x3e87bf7bbe013f80,0x3f753e48bf7f8000,0x3f463f0ebf62bec4,0xbf113f633eb0bf7a,0xbf653f0e3f41bf3f,0xbf1dbf303f533ede,0xbd2cbf7b3eb03f60,0x3f70bf02bf413f48,0x3f6e3e48bf803e2c,0x3d2c3f78bee5bf48,0xbf383f553ebdbf7c
.quad 0xbf7fbe0f3f703f08,0xbf1d3f253f62be8e,0x3ee5bf4dbf3c3f08,0xbe87bf7fbdc93f76,0x3f0b3f6abe87bf7e,0x3f6e3f02bf46bf3f,0xbf80bdac3f7a3ea9,0xbf5b3ed13f75be2c,0x3ef1bf55bf223f35,0x3dc9bf7bbe953f6d,0x3f053f63becbbf72,0x3f3c3f3abf22bf51,0xbf80bce63f7f3de5,0xbf7c3e0f3f7fbd66,0x3efebf5cbf053f59,0x3ee5bf63bef13f60
.quad 0x3efe3f5cbf05bf59,0x3ee53f63bef1bf60,0xbf803ce63f7fbde5,0xbf7cbe0f3f7f3d66,0x3f05bf63becb3f72,0x3f3cbf3abf223f51,0x3ef13f55bf22bf35,0x3dc93f7bbe95bf6d,0xbf803dac3f7abea9,0xbf5bbed13f753e2c,0x3f0bbf6abe873f7e,0x3f6ebf02bf463f3f,0x3ee53f4dbf3cbf08,0xbe873f7fbdc9bf76,0xbf7f3e0f3f70bf08,0xbf1dbf253f623e8e
.quad 0x3e3a3f803e72bf67,0x3f5b3f30bf11bf6d,0xbf57bf303f173f67,0xbf7dbce63f7a3ec4,0x3f79bdacbf7fbe64,0x3f28bf25bf5b3ec4,0xbefe3f4d3f32bf20,0xbc663f7d3e87bf6d,0xbe95bf7b3dc93f80,0xbf22bf553ef13f6d,0x3f653f02bf53bf20,0x3f7c3e80bf73bec4,0xbf703e9b3f77be64,0xbf5e3eeb3f68bec4,0x3ecbbf6abed83f67,0x3eb0bf6fbebd3f6d
.quad 0x3ecb3f6abed8bf67,0x3eb03f6fbebdbf6d,0xbf70be9b3f773e64,0xbf5ebeeb3f683ec4,0x3f65bf02bf533f20,0x3f7cbe80bf733ec4,0xbe953f7b3dc9bf80,0xbf223f553ef1bf6d,0xbefebf4d3f323f20,0xbc66bf7d3e873f6d,0x3f793dacbf7f3e64,0x3f283f25bf5bbec4,0xbf573f303f17bf67,0xbf7d3ce63f7abec4,0x3e3abf803e723f67,0x3f5bbf30bf113f6d
.quad 0x3f75bdacbf7ebea9,0x3ed8bf4dbf413ef8,0xbf223f253f5ebea9,0x3d2c3f7d3ea2bf60,0x3dc9bf78becb3f59,0xbefebf6f3e563f80,0x3ef13f6fbe72bf7e,0x3f573f25bf2dbf51,0xbf62bf0e3f463f35,0xbf7fbe483f753ec4,0x3f7fbce6bf80bde5,0x3f6ebe9bbf793e2c,0xbf463f1a3f53bf08,0xbf283f3a3f38bf2b,0x3e95bf74bea23f72,0x3e72bf78be873f76
.quad 0x3e953f74bea2bf72,0x3e723f78be87bf76,0xbf46bf1a3f533f08,0xbf28bf3a3f383f2b,0x3f7f3ce6bf803de5,0x3f6e3e9bbf79be2c,0xbf623f0e3f46bf35,0xbf7f3e483f75bec4,0x3ef1bf6fbe723f7e,0x3f57bf25bf2d3f51,0x3dc93f78becbbf59,0xbefe3f6f3e56bf80,0xbf22bf253f5e3ea9,0x3d2cbf7d3ea23f60,0x3f753dacbf7e3ea9,0x3ed83f4dbf41bef8
.quad 0xbecbbf7bbc663f7a,0xbf73bf023f3c3f51,0x3f323f55becbbf7a,0x3f7f3e80bf68bf14,0xbf68bf0e3f3c3f48,0xbf7c3ce63f7e3e8e,0x3f7f3e48bf73bede,0x3f68be9bbf7c3d66,0xbf753e483f7f8000,0xbf463f0e3f62bec4,0x3f4abf0ebf5e3ede,0x3f17bf44bf323f2b,0xbf053f553f17bf48,0xbebd3f6a3ee5bf60,0x3e3abf7bbe563f7a,0x3e01bf7dbe1d3f7c
.quad 0x3e3a3f7bbe56bf7a,0x3e013f7dbe1dbf7c,0xbf05bf553f173f48,0xbebdbf6a3ee53f60,0x3f4a3f0ebf5ebede,0x3f173f44bf32bf2b,0xbf75be483f7f8000,0xbf46bf0e3f623ec4,0x3f7fbe48bf733ede,0x3f683e9bbf7cbd66,0xbf683f0e3f3cbf48,0xbf7cbce63f7ebe8e,0x3f32bf55becb3f7a,0x3f7fbe80bf683f14,0xbecb3f7bbc66bf7a,0xbf733f023f3cbf51
.quad 0xbf5e3e9b3f7f3de5,0xbe563f6a3f17bf2b,0x3f4abeebbf753de5,0x3e3abf6fbf053f3f,0xbf323f1a3f62bea9,0xbe1d3f743ee5bf51,0x3f17bf3abf463f08,0x3e01bf78bebd3f60,0xbef13f553f22bf35,0xbdc93f7b3e95bf6d,0x3eb0bf6abef13f59,0x3d8fbf7dbe563f76,0xbe563f783e95bf72,0xbd2c3f7f3e01bf7c,0x3d8fbf7fbdc93f7e,0x3c66bf80bd2c3f80
.quad 0x3d8f3f7fbdc9bf7e,0x3c663f80bd2cbf80,0xbe56bf783e953f72,0xbd2cbf7f3e013f7c,0x3eb03f6abef1bf59,0x3d8f3f7dbe56bf76,0xbef1bf553f223f35,0xbdc9bf7b3e953f6d,0x3f173f3abf46bf08,0x3e013f78bebdbf60,0xbf32bf1a3f623ea9,0xbe1dbf743ee53f51,0x3f4a3eebbf75bde5,0x3e3a3f6fbf05bf3f,0xbf5ebe9b3f7fbde5,0xbe56bf6a3f173f2b
.quad 0xbf80,0x0,0x3f80,0x0,0xbf80,0x0,0x3f80,0x0,0xbf80,0x0,0x3f80,0x0,0xbf80,0x0,0x3f80,0x0
.quad 0xbf80,0x0,0x3f80,0x0,0xbf80,0x0,0x3f80,0x0,0xbf80,0x0,0x3f80,0x0,0xbf80,0x0,0x3f80,0x0
.quad 0x0,0x0,0x0,0x0,0x0,0x0,0x0,0x0,0x0,0x0,0x0,0x0,0x0,0x0,0x0,0x0
.quad 0x0,0x0,0x0,0x0,0x0,0x0,0x0,0x0,0x0,0x0,0x0,0x0,0x0,0x0,0x0,0x0
.quad 0x3f20bf67be643f80,0x3f80be64bf673f20,0x3f30bf60be803f80,0x3f7bbd66bf743f08,0x3f3fbf59be8e3f80,0x3f6d3de5bf7c3ede,0x3f4dbf51be9b3f80,0x3f553e8ebf803ea9,0x3f59bf48bea93f80,0x3f353edebf7e3e64,0x3f63bf3fbeb73f80,0x3f0e3f14bf783de5,0x3f6dbf35bec43f80,0x3ec43f35bf6d0000,0x3f74bf2bbed13f80,0x3e483f51bf5cbde5
.quad 0x3f7abf20bede3f80,0x3f67bf48be64,0x3f7dbf14beeb3f80,0xbe483f76bf30bea9,0x3f80bf08bef83f80,0xbec43f7ebf14bede,0x3f80bef8bf023f80,0xbf0e3f80beebbf08,0x3f7ebedebf083f80,0xbf353f7abea9bf20,0x3f7bbec4bf0e3f80,0xbf553f6dbe48bf35,0x3f76bea9bf143f80,0xbf6d3f59bd66bf48,0x3f6fbe8ebf1a3f80,0xbf7b3f3f3dacbf59
.quad 0x3f203f20bf67be64,0xbe643f80be64bf67,0x3eb73f51bf44bede,0xbf1a3f6d3e0fbf7e,0x3d663f72bf14bf20,0xbf603f353ef8bf7a,0xbe803f80beb7bf48,0xbf7f3ec43f44bf59,0xbf083f7abde5bf67,0xbf7200003f72bf20,0xbf443f603e0fbf7a,0xbf3abec43f80bea9,0xbf6d3f353ec4bf80,0xbec4bf353f6d8000,0xbf7f3ef83f1abf7a,0x3ce6bf6d3f3a3ea9
.quad 0xbf7a3e643f48bf67,0x3edebf803ede3f20,0xbf5cbd663f6abf48,0x3f44bf6d3dac3f59,0xbf2bbea93f7cbf20,0x3f76bf35be8e3f7a,0xbed1bf143f7fbede,0x3f7dbec4bf1a3f7e,0xbde5bf483f72be64,0x3f598000bf593f67,0x3e48bf6d3f558000,0x3f0e3ec4bf7b3f35,0x3ef8bf7e3f2b3e64,0x3e2c3f35bf7c3ede,0x3f3abf7c3eeb3ede,0xbe803f6dbf5c3de5
.quad 0xbf673f203f20bf67,0xbf67be643f80be64,0xbf7f3e2c3f6abf20,0xbeebbf3f3f553ea9,0xbf51bea93f80be64,0x3e2cbf7e3ec43f48,0xbed1bf3f3f5c3e64,0x3f3abf60be483f7e,0x3de5bf7a3f083f20,0x3f7ebedebf353f67,0x3f1abf763dac3f67,0x3f5c3e2cbf7b3f08,0x3f6dbf35bec43f80,0x3ec43f35bf6d0000,0x3f7dbe8ebf443f67,0xbe803f7cbf0ebf08
.quad 0x3f483e64bf7a3f20,0xbf483f678000bf67,0x3eb73f2bbf783e64,0xbf803ef83f0ebf7e,0xbe2c3f72bf3fbe64,0xbf51bde53f6dbf48,0xbf253f7cbeb7bf20,0xbe9bbf2b3f7bbea9,0xbf723f483de5bf67,0x3ea9bf7a3f353e64,0xbf7b3ec43f0ebf80,0x3f55bf6d3e483f35,0xbf3fbde53f60bf67,0x3f80bf08bec43f7a,0xbe9bbf143f80bf20,0x3f443d66bf553f72
.quad 0xbe64bf673f203f20,0x3f20bf67be643f80,0x3f02bf76bce63f7a,0x3f80be8ebf5c3f35,0x3f76bf08bf2b3f67,0x3f2b3f08bf760000,0x3f633e2cbf7d3ede,0xbe0f3f7cbeebbf35,0x3ea93f48bf59be64,0xbf593f483ea9bf80,0xbed13f80be9bbf48,0xbf743d663f6abf35,0xbf6d3f353ec4bf80,0xbec4bf353f6d8000,0xbf6f3d663f63bf48,0x3eebbf803eb73f35
.quad 0xbedebf203f7abe64,0x3f7abf20bede3f80,0x3e9bbf7c3f1a3ede,0x3f4d3e2cbf743f35,0x3f60bf59bd663f67,0x3d663f59bf600000,0x3f78be8ebf303f7a,0xbf3a3f76be80bf35,0x3f083edebf7e3f20,0xbf7e3ede3f08bf80,0xbe483f6dbf550000,0xbf0ebec43f7bbf35,0xbf513f72be8ebf20,0x3e8ebf723f518000,0xbf7d3ef83ed1bf7a,0x3f6abf603e0f3f35
.quad 0x3f80be64bf673f20,0x3f203f20bf67be64,0x3f0e3f2bbf63be64,0xbed13f7cbdacbf72,0xbec43f7ebe2cbf67,0xbf803ea93f51bf48,0xbf7b3ef83f30bf67,0xbf02bf2b3f6a3de5,0xbf35bede3f7ebe64,0x3f08bf7a3de53f67,0x3e48bf7c3f023f20,0x3f7fbe8ebf4d3f59,0x3f6dbf35bec43f80,0x3ec43f35bf6d0000,0x3f553e2cbf783f20,0xbf253f76be0fbf59
.quad 0x3f67bf48be64,0xbf7a3e643f48bf67,0xbf553f603ce6bf67,0xbe80bf3f3f6fbde5,0xbf6d3de53f51bf67,0x3f3fbf723e2c3f48,0xbe48bf3f3f74be64,0x3f6fbe2cbf443f72,0x3f35bf7a3ea93f20,0x3de53f48bf723e64,0x3f7bbec4bf0e3f80,0xbf553f6dbe48bf35,0x3ec43f08bf803f20,0xbf603de53f3fbf7a,0xbf0e3f80bf25be64,0x3ce6bf513f74bea9
.quad 0xbe643f80be64bf67,0xbf673f203f20bf67,0xbf7d3ec43f4dbf48,0xbf25bf143f6f3de5,0xbef8bf353f603e64,0x3f14bf72bd663f7a,0x3f25bf6dbdac3f7a,0x3f6f3d66bf783f08,0x3f728000bf723f20,0xbde53f7abf08bf20,0x3ce63f6dbf30bede,0xbf7d3ef83f25bf72,0xbf6d3f353ec4bf80,0xbec4bf353f6d8000,0xbf30bec43f80bede,0x3f4dbf60bdac3f72
.quad 0x3edebf803ede3f20,0x3f483e64bf7a3f20,0x3f7fbec4bf253f7a,0xbed13f80bf02bf08,0x3e8e3f35bf763e64,0xbf7c3ea93f2bbf7a,0xbf4d3f6dbe0fbf48,0xbdacbf513f6abde5,0xbf5900003f59bf67,0x3f72bf48bde53f67,0x3e48bf6d3f558000,0x3f0e3ec4bf7b3f35,0x3f7cbf35be2c3f67,0xbf2b3f7ebef8bede,0x3f023ec4bf783f48,0xbf633e2c3f30bf7e
.quad 0xbf67be643f80be64,0xbe64bf673f203f20,0x3e9bbf803e483f67,0x3f78bef8bf3a3f59,0x3f7cbde5bf6d3f20,0x3e8e3f59bf3fbede,0xbce63f76bf0ebf20,0xbf743f143f1abf72,0xbf7e3ede3f35bf67,0xbea9bf483f593e64,0xbe80bf513f553e64,0x3f6fbf2bbeeb3f7e,0x3f6dbf35bec43f80,0x3ec43f35bf6d0000,0x3f023f14bf7b3e64,0xbf6a3f3f3e9bbf7e
.quad 0xbf483f678000bf67,0xbedebf203f7abe64,0xbf3abe8e3f7bbf20,0x3f63bf51be0f3f72,0x3f14bf7e3ec43f20,0x3ef83f08bf803ede,0x3f63bd66bf553f67,0xbf5c3f60bce6bf59,0xbea93f7abf35be64,0xbf08bede3f7ebf20,0xbf7b3ec43f0ebf80,0x3f55bf6d3e483f35,0x3d66bf593f6dbe64,0x3f143ea9bf763f48,0x3f7fbf2bbe483f67,0xbf4d3f76beb7bf08
.quad 0x3f20bf67be643f80,0x3f80be64bf673f20,0x3f3a3ef8bf780000,0xbe483f80be9bbf59,0xbf3f3f593e8ebf80,0xbf6dbde53f7cbede,0xbf1abf143f748000,0x3f0ebf763ce63f72,0x3f59bf48bea93f80,0x3f353edebf7e3e64,0x3eeb3f2bbf6f0000,0xbf553f513e80bf7e,0xbf6d3f353ec4bf80,0xbec4bf353f6d8000,0xbe9bbf3f3f6a8000,0x3f7bbf14bf023f7e
.quad 0x3f7abf20bede3f80,0x3f67bf48be64,0x3e0f3f51bf630000,0xbf7b3e8e3f3abf72,0xbf803f083ef8bf80,0x3ec4bf7e3f143ede,0x3ce6bf603f5c8000,0x3f553d66bf633f59,0x3f7ebedebf083f80,0xbf353f7abea9bf20,0xbe483f6dbf550000,0xbf0ebec43f7bbf35,0xbf763ea93f14bf80,0x3f6dbf593d663f48,0x3eb7bf763f4d8000,0x3e483f2bbf7f3f08
.quad 0x3f203f20bf67be64,0xbe643f80be64bf67,0xbf6f3f143f25bf67,0xbf4dbec43f7dbde5,0xbd66bf723f143f20,0x3f60bf35bef83f7a,0x3f78bd66bf6f3f20,0x3dac3f6dbf25bf08,0xbf083f7abde5bf67,0xbf7200003f72bf20,0xbf25bef83f7dbe64,0x3f30bf6dbce63f72,0x3f6dbf35bec43f80,0x3ec43f35bf6d0000,0x3dac3f60bf4dbe64,0xbf803ec43f30bf72
.quad 0xbf7a3e643f48bf67,0x3edebf803ede3f20,0x3f02bf803ed13f20,0x3f253ec4bf7f3f08,0x3f2b3ea9bf7c3f20,0xbf763f353e8ebf7a,0xbf6a3f513dacbf67,0x3e0fbf6d3f4d3de5,0xbde5bf483f72be64,0x3f598000bf593f67,0x3f7bbec4bf0e3f80,0xbf553f6dbe48bf35,0xbef83f7ebf2bbe64,0xbe2cbf353f7cbede,0xbf30be2c3f63bf67,0x3f78bec4bf023f7e
.quad 0xbf673f203f20bf67,0xbf67be643f80be64,0x3dacbf7c3ed13f48,0x3f63bf2bbf0e3f72,0x3f513ea9bf803e64,0xbe2c3f7ebec4bf48,0xbf6a3f2b3f02bf7a,0xbf30bef83f7bbde5,0x3de5bf7a3f083f20,0x3f7ebedebf353f67,0x3f4d3e8ebf7f3ede,0xbf023f7cbe48bf59,0xbf6d3f353ec4bf80,0xbec4bf353f6d8000,0x3e0fbf763f253ede,0x3f78be2cbf553f59
.quad 0x3f483e64bf7a3f20,0xbf483f678000bf67,0xbf6f3f3f3e80bf7a,0xbce6bf603f553de5,0x3e2cbf723f3f3e64,0x3f513de5bf6d3f48,0x3f443e2cbf6f3f48,0xbf743f3f3e48bf72,0xbf723f483de5bf67,0x3ea9bf7a3f353e64,0x3e48bf6d3f558000,0x3f0e3ec4bf7b3f35,0x3f3f3de5bf603f67,0xbf803f083ec4bf7a,0xbf743f51bce6bf48,0x3f25bf803f0e3ea9
.quad 0xbe64bf673f203f20,0x3f20bf67be643f80,0x3f5c3e8ebf803e64,0x3ce63f76bf02bf35,0xbf763f083f2bbf67,0xbf2bbf083f768000,0x3eebbf7c3e0f3f67,0x3f7dbe2cbf633f35,0x3ea93f48bf59be64,0xbf593f483ea9bf80,0xbf6abd663f74bf20,0x3e9bbf803ed13f35,0x3f6dbf35bec43f80,0x3ec43f35bf6d0000,0xbeb73f80beebbf20,0xbf63bd663f6fbf35
.quad 0xbedebf203f7abe64,0x3f7abf20bede3f80,0x3f74be2cbf4d3f67,0xbf1a3f7cbe9bbf35,0xbf603f593d66bf67,0xbd66bf593f608000,0x3e80bf763f3a3e64,0x3f303e8ebf783f35,0x3f083edebf7e3f20,0xbf7e3ede3f08bf80,0xbf7b3ec43f0ebf80,0x3f55bf6d3e483f35,0x3f51bf723e8e3f20,0xbe8e3f72bf510000,0xbe0f3f60bf6a3e64,0xbed1bef83f7dbf35
.quad 0x3f80be64bf673f20,0x3f203f20bf67be64,0xbf553f3f3eebbf7a,0xbf6abe2c3f7fbea9,0x3ec4bf7e3e2c3f67,0x3f80bea9bf513f48,0x3e483f60bf3abede,0xbf5c3f3f3ed1bf7e,0xbf35bede3f7ebe64,0x3f08bf7a3de53f67,0x3f7bbe2cbf5c3f48,0xbdac3f76bf1abf08,0xbf6d3f353ec4bf80,0xbec4bf353f6d8000,0x3f0ebf7c3e803f48,0x3f443e8ebf7d3f08
.quad 0x3f67bf48be64,0xbf7a3e643f48bf67,0xbf0ebef83f80bede,0x3f78bf2bbeb73f7e,0x3f6dbde5bf513f67,0xbf3f3f72be2cbf48,0xbf7b3f2b3e9bbf7a,0x3eb7bf7c3f253ea9,0x3f35bf7a3ea93f20,0x3de53f48bf723e64,0xbe483f6dbf550000,0xbf0ebec43f7bbf35,0xbec4bf083f80bf20,0x3f60bde5bf3f3f7a,0x3f55bd66bf443f7a,0xbf803f143e9bbf72
.quad 0xbe643f80be64bf67,0xbf673f203f20bf67,0xbe0fbf6d3f1a3f20,0x3f44bf51beb73f7e,0x3ef83f35bf60be64,0xbf143f723d66bf7a,0xbf44bec43f7fbe64,0x3eb7bf803e803f59,0x3f728000bf723f20,0xbde53f7abf08bf20,0xbf803ec43f3abf67,0xbe0fbf603f443ea9,0x3f6dbf35bec43f80,0x3ec43f35bf6d0000,0xbf3a3f6dbce6bf67,0xbf1abef83f7fbea9
.quad 0x3edebf803ede3f20,0x3f483e64bf7a3f20,0xbdac3f6dbf44be64,0xbf6a3d663f5cbf59,0xbe8ebf353f76be64,0x3f7cbea9bf2b3f7a,0x3f1a3ec4bf7d3f20,0xbf7f3f143ed1bf7e,0xbf5900003f59bf67,0x3f72bf48bde53f67,0x3f7bbec4bf0e3f80,0xbf553f6dbe48bf35,0xbf7c3f353e2cbf67,0x3f2bbf7e3ef83ede,0x3f5cbf6d3e803f20,0xbeeb3f7cbf3abde5
.quad 0xbf67be643f80be64,0xbe64bf673f203f20,0x3f743d66bf7b3ede,0x3e803f60bf30bf08,0xbf7c3de53f6dbf20,0xbe8ebf593f3f3ede,0x3f80be8ebf553f48,0x3e9b3f51bf4dbea9,0xbf7e3ede3f35bf67,0xbea9bf483f593e64,0x3f78bf14bf0e3f7a,0x3eb73f3fbf63bde5,0xbf6d3f353ec4bf80,0xbec4bf353f6d8000,0x3f5cbf51be483f7a,0x3ed13f2bbf743de5
.quad 0xbf483f678000bf67,0xbedebf203f7abe64,0x3f30bf763e483f48,0x3eeb3f14bf7d3ea9,0xbf143f7ebec4bf20,0xbef8bf083f80bede,0x3eebbf803f0e3ede,0x3f023ef8bf803f08,0xbea93f7abf35be64,0xbf08bede3f7ebf20,0x3e48bf6d3f558000,0x3f0e3ec4bf7b3f35,0xbd663f59bf6d3e64,0xbf14bea93f76bf48,0xbdacbf3f3f7bbede,0x3f1a3e8ebf6f3f59
.quad 0x3f80,0x0,0xbf80,0x0,0x3f80,0x0,0xbf80,0x0,0x3f80,0x0,0xbf80,0x0,0x3f80,0x0,0xbf80,0x0
.quad 0x3f80,0x0,0xbf80,0x0,0x3f80,0x0,0xbf80,0x0,0x3f80,0x0,0xbf80,0x0,0x3f80,0x0,0xbf80,0x0
.quad 0x0,0x0,0x0,0x0,0x0,0x0,0x0,0x0,0x0,0x0,0x0,0x0,0x0,0x0,0x0,0x0
.quad 0x0,0x0,0x0,0x0,0x0,0x0,0x0,0x0,0x0,0x0,0x0,0x0,0x0,0x0,0x0,0x0
.quad 0x3f483edebf7a8000,0x80003f7abedebf48,0x3f3a3ef8bf788000,0xbe483f80be9bbf59,0x3f2b3f08bf768000,0xbec43f7ebe2cbf67,0x3f1a3f14bf748000,0xbf0e3f76bce6bf72,0x3f083f20bf728000,0xbf353f673de5bf7a,0x3eeb3f2bbf6f8000,0xbf553f513e80bf7e,0x3ec43f35bf6d8000,0xbf6d3f353ec4bf80,0x3e9b3f3fbf6a8000,0xbf7b3f143f02bf7e
.quad 0x3e643f48bf678000,0xbf803ede3f20bf7a,0x3e0f3f51bf638000,0xbf7b3e8e3f3abf72,0x3d663f59bf608000,0xbf6d3de53f51bf67,0xbce63f60bf5c8000,0xbf55bd663f63bf59,0xbde53f67bf598000,0xbf35be643f72bf48,0xbe483f6dbf558000,0xbf0ebec43f7bbf35,0xbe8e3f72bf518000,0xbec4bf083f80bf20,0xbeb73f76bf4d8000,0xbe48bf2b3f7fbf08
.quad 0xbf483f483edebf7a,0xbf7a80003f7abede,0xbf6f3f143f25bf67,0xbf4dbec43f7dbde5,0xbf803ea93f51bf48,0xbef8bf353f603e64,0xbf783d663f6fbf20,0xbdacbf6d3f253f08,0xbf59be643f7ebede,0x3ea9bf803ea93f48,0xbf25bef83f7dbe64,0x3f30bf6dbce63f72,0xbec4bf353f6d8000,0x3f6dbf35bec43f80,0xbdacbf603f4d3e64,0x3f80bec4bf303f72
.quad 0x3e64bf7a3f203ede,0x3f678000bf673f48,0x3f02bf803ed13f20,0x3f253ec4bf7f3f08,0x3f3fbf723e2c3f48,0x3e8e3f35bf763e64,0x3f6abf51bdac3f67,0xbe0f3f6dbf4dbde5,0x3f7ebf20bea93f7a,0xbf083f80bf08bede,0x3f7bbec4bf0e3f80,0xbf553f6dbe48bf35,0x3f60bde5bf3f3f7a,0xbf7c3f353e2cbf67,0x3f303e2cbf633f67,0xbf783ec43f02bf7e
.quad 0xbedebf483f483ede,0x3edebf7a80003f7a,0x3dacbf7c3ed13f48,0x3f63bf2bbf0e3f72,0x3f14bf72bd663f7a,0x3f7cbde5bf6d3f20,0x3f6abf2bbf023f7a,0x3f303ef8bf7b3de5,0x3f7ebe64bf593f48,0x3de53f67bf35bede,0x3f4d3e8ebf7f3ede,0xbf023f7cbe48bf59,0x3ec43f35bf6d8000,0xbf6d3f353ec4bf80,0xbe0f3f76bf25bede,0xbf783e2c3f55bf59
.quad 0xbf203f7abe64bf48,0xbf20bede3f80bede,0xbf6f3f3f3e80bf7a,0xbce6bf603f553de5,0xbf7c3ea93f2bbf7a,0x3f14bf7e3ec43f20,0xbf44be2c3f6fbf48,0x3f74bf3fbe483f72,0xbea9bf203f7ebede,0x3f72be64bf353f7a,0x3e48bf6d3f558000,0x3f0e3ec4bf7b3f35,0x3f2bbf7e3ef83ede,0xbd663f59bf6d3e64,0x3f74bf513ce63f48,0xbf253f80bf0ebea9
.quad 0x3f7abedebf483f48,0x3f483edebf7a8000,0x3f5c3e8ebf803e64,0x3ce63f76bf02bf35,0x3e8e3f59bf3fbede,0xbf3f3f593e8ebf80,0xbeeb3f7cbe0fbf67,0xbf7d3e2c3f63bf35,0xbf723f203f08bf7a,0xbf08bf203f728000,0xbf6abd663f74bf20,0x3e9bbf803ed13f35,0xbec4bf353f6d8000,0x3f6dbf35bec43f80,0x3eb7bf803eeb3f20,0x3f633d66bf6f3f35
.quad 0x3f67bf48be643f7a,0x3e643f48bf678000,0x3f74be2cbf4d3f67,0xbf1a3f7cbe9bbf35,0x3ef83f08bf803ede,0xbf803f083ef8bf80,0xbe803f76bf3abe64,0xbf30be8e3f78bf35,0xbf593f67bde5bf48,0x3de5bf673f598000,0xbf7b3ec43f0ebf80,0x3f55bf6d3e483f35,0xbf14bea93f76bf48,0x3f76bea9bf143f80,0x3e0fbf603f6abe64,0x3ed13ef8bf7d3f35
.quad 0x80003f7abedebf48,0xbf483f483edebf7a,0xbf553f3f3eebbf7a,0xbf6abe2c3f7fbea9,0xbf6dbde53f7cbede,0xbd66bf723f143f20,0xbe48bf603f3a3ede,0x3f5cbf3fbed13f7e,0x3f35bf67bde53f7a,0x3f593e64bf7e3ede,0x3f7bbe2cbf5c3f48,0xbdac3f76bf1abf08,0x3ec43f35bf6d8000,0xbf6d3f353ec4bf80,0xbf0e3f7cbe80bf48,0xbf44be8e3f7dbf08
.quad 0xbf803ede3f20bf7a,0x3e64bf7a3f203ede,0xbf0ebef83f80bede,0x3f78bf2bbeb73f7e,0x3ec4bf7e3f143ede,0x3f2b3ea9bf7c3f20,0x3f7bbf2bbe9b3f7a,0xbeb73f7cbf25bea9,0x3f353e64bf723f48,0xbf7e3f203ea9bf7a,0xbe483f6dbf558000,0xbf0ebec43f7bbf35,0xbf6d3f59bd66bf48,0x3ef8bf7e3f2b3e64,0xbf553d663f44bf7a,0x3f80bf14be9b3f72
.quad 0xbf7a80003f7abede,0xbedebf483f483ede,0xbe0fbf6d3f1a3f20,0x3f44bf51beb73f7e,0x3f60bf35bef83f7a,0x3f513ea9bf803e64,0x3f443ec4bf7f3e64,0xbeb73f80be80bf59,0xbea93f80bea9bf48,0xbf7e3e643f59bf48,0xbf803ec43f3abf67,0xbe0fbf603f443ea9,0xbec4bf353f6d8000,0x3f6dbf35bec43f80,0x3f3abf6d3ce63f67,0x3f1a3ef8bf7f3ea9
.quad 0x3f678000bf673f48,0xbf203f7abe64bf48,0xbdac3f6dbf44be64,0xbf6a3d663f5cbf59,0xbf763f353e8ebf7a,0x3e2cbf723f3f3e64,0xbf1abec43f7dbf20,0x3f7fbf14bed13f7e,0x3f08bf803f083ede,0x3ea93f20bf7e3ede,0x3f7bbec4bf0e3f80,0xbf553f6dbe48bf35,0x3e2c3f35bf7c3ede,0xbf3fbde53f60bf67,0xbf5c3f6dbe80bf20,0x3eebbf7c3f3a3de5
.quad 0x3edebf7a80003f7a,0x3f7abedebf483f48,0x3f743d66bf7b3ede,0x3e803f60bf30bf08,0xbe2c3f7ebec4bf48,0xbf763f083f2bbf67,0xbf803e8e3f55bf48,0xbe9bbf513f4d3ea9,0xbde5bf673f353ede,0x3f72bf20bf083f7a,0x3f78bf14bf0e3f7a,0x3eb73f3fbf63bde5,0x3ec43f35bf6d8000,0xbf6d3f353ec4bf80,0xbf5c3f513e48bf7a,0xbed1bf2b3f74bde5
.quad 0xbf20bede3f80bede,0x3f67bf48be643f7a,0x3f30bf763e483f48,0x3eeb3f14bf7d3ea9,0x3f513de5bf6d3f48,0xbf603f593d66bf67,0xbeeb3f80bf0ebede,0xbf02bef83f80bf08,0xbf723e643f35bf7a,0x3f59bf673de53f48,0x3e48bf6d3f558000,0x3f0e3ec4bf7b3f35,0x3f80bf08bec43f7a,0xbf513f72be8ebf20,0x3dac3f3fbf7b3ede,0xbf1abe8e3f6fbf59
.quad 0x3f483edebf7a8000,0x80003f7abedebf48,0xbf303f603e80bf80,0xbf7b3d663f74bf08,0xbf2bbf083f768000,0x3ec4bf7e3e2c3f67,0x3f4dbf51be9b3f80,0x3f553e8ebf803ea9,0x3f083f20bf728000,0xbf353f673de5bf7a,0xbf633f3f3eb7bf80,0xbf0ebf143f78bde5,0xbec4bf353f6d8000,0x3f6dbf35bec43f80,0x3f74bf2bbed13f80,0x3e483f51bf5cbde5
.quad 0x3e643f48bf678000,0xbf803ede3f20bf7a,0xbf7d3f143eebbf80,0x3e48bf763f303ea9,0xbd66bf593f608000,0x3f6dbde5bf513f67,0x3f80bef8bf023f80,0xbf0e3f80beebbf08,0xbde53f67bf598000,0xbf35be643f72bf48,0xbf7b3ec43f0ebf80,0x3f55bf6d3e483f35,0x3e8ebf723f518000,0x3ec43f08bf803f20,0x3f6fbe8ebf1a3f80,0xbf7b3f3f3dacbf59
.quad 0xbf483f483edebf7a,0xbf7a80003f7abede,0xbeb7bf513f443ede,0x3f1abf6dbe0f3f7e,0x3f80bea9bf513f48,0x3ef83f35bf60be64,0xbe803f80beb7bf48,0xbf7f3ec43f44bf59,0xbf59be643f7ebede,0x3ea9bf803ea93f48,0x3f44bf60be0f3f7a,0x3f3a3ec4bf803ea9,0x3ec43f35bf6d8000,0xbf6d3f353ec4bf80,0xbf7f3ef83f1abf7a,0x3ce6bf6d3f3a3ea9
.quad 0x3e64bf7a3f203ede,0x3f678000bf673f48,0x3f5c3d66bf6a3f48,0xbf443f6dbdacbf59,0xbf3f3f72be2cbf48,0xbe8ebf353f76be64,0xbed1bf143f7fbede,0x3f7dbec4bf1a3f7e,0x3f7ebf20bea93f7a,0xbf083f80bf08bede,0xbe483f6dbf558000,0xbf0ebec43f7bbf35,0xbf603de53f3fbf7a,0x3f7cbf35be2c3f67,0x3f3abf7c3eeb3ede,0xbe803f6dbf5c3de5
.quad 0xbedebf483f483ede,0x3edebf7a80003f7a,0x3f7fbe2cbf6a3f20,0x3eeb3f3fbf55bea9,0xbf143f723d66bf7a,0xbf7c3de53f6dbf20,0xbed1bf3f3f5c3e64,0x3f3abf60be483f7e,0x3f7ebe64bf593f48,0x3de53f67bf35bede,0xbf1a3f76bdacbf67,0xbf5cbe2c3f7bbf08,0xbec4bf353f6d8000,0x3f6dbf35bec43f80,0x3f7dbe8ebf443f67,0xbe803f7cbf0ebf08
.quad 0xbf203f7abe64bf48,0xbf20bede3f80bede,0xbeb7bf2b3f78be64,0x3f80bef8bf0e3f7e,0x3f7cbea9bf2b3f7a,0xbf143f7ebec4bf20,0xbf253f7cbeb7bf20,0xbe9bbf2b3f7bbea9,0xbea9bf203f7ebede,0x3f72be64bf353f7a,0x3f7bbec4bf0e3f80,0xbf553f6dbe48bf35,0xbf2b3f7ebef8bede,0x3d66bf593f6dbe64,0xbe9bbf143f80bf20,0x3f443d66bf553f72
.quad 0x3f7abedebf483f48,0x3f483edebf7a8000,0xbf023f763ce6bf7a,0xbf803e8e3f5cbf35,0xbe8ebf593f3f3ede,0x3f3fbf59be8e3f80,0x3f633e2cbf7d3ede,0xbe0f3f7cbeebbf35,0xbf723f203f08bf7a,0xbf08bf203f728000,0x3ed1bf803e9b3f48,0x3f74bd66bf6a3f35,0x3ec43f35bf6d8000,0xbf6d3f353ec4bf80,0xbf6f3d663f63bf48,0x3eebbf803eb73f35
.quad 0x3f67bf48be643f7a,0x3e643f48bf678000,0xbe9b3f7cbf1abede,0xbf4dbe2c3f74bf35,0xbef8bf083f80bede,0x3f80bf08bef83f80,0x3f78be8ebf303f7a,0xbf3a3f76be80bf35,0xbf593f67bde5bf48,0x3de5bf673f598000,0x3e48bf6d3f558000,0x3f0e3ec4bf7b3f35,0x3f143ea9bf763f48,0xbf763ea93f14bf80,0xbf7d3ef83ed1bf7a,0x3f6abf603e0f3f35
.quad 0x80003f7abedebf48,0xbf483f483edebf7a,0xbf0ebf2b3f633e64,0x3ed1bf7c3dac3f72,0x3f6d3de5bf7c3ede,0x3d663f72bf14bf20,0xbf7b3ef83f30bf67,0xbf02bf2b3f6a3de5,0x3f35bf67bde53f7a,0x3f593e64bf7e3ede,0xbe483f7cbf02bf20,0xbf7f3e8e3f4dbf59,0xbec4bf353f6d8000,0x3f6dbf35bec43f80,0x3f553e2cbf783f20,0xbf253f76be0fbf59
.quad 0xbf803ede3f20bf7a,0x3e64bf7a3f203ede,0x3f55bf60bce63f67,0x3e803f3fbf6f3de5,0xbec43f7ebf14bede,0xbf2bbea93f7cbf20,0xbe48bf3f3f74be64,0x3f6fbe2cbf443f72,0x3f353e64bf723f48,0xbf7e3f203ea9bf7a,0xbf7b3ec43f0ebf80,0x3f55bf6d3e483f35,0x3f6dbf593d663f48,0xbef83f7ebf2bbe64,0xbf0e3f80bf25be64,0x3ce6bf513f74bea9
.quad 0xbf7a80003f7abede,0xbedebf483f483ede,0x3f7dbec4bf4d3f48,0x3f253f14bf6fbde5,0xbf603f353ef8bf7a,0xbf51bea93f80be64,0x3f25bf6dbdac3f7a,0x3f6f3d66bf783f08,0xbea93f80bea9bf48,0xbf7e3e643f59bf48,0xbce6bf6d3f303ede,0x3f7dbef8bf253f72,0x3ec43f35bf6d8000,0xbf6d3f353ec4bf80,0xbf30bec43f80bede,0x3f4dbf60bdac3f72
.quad 0x3f678000bf673f48,0xbf203f7abe64bf48,0xbf7f3ec43f25bf7a,0x3ed1bf803f023f08,0x3f76bf35be8e3f7a,0xbe2c3f72bf3fbe64,0xbf4d3f6dbe0fbf48,0xbdacbf513f6abde5,0x3f08bf803f083ede,0x3ea93f20bf7e3ede,0xbe483f6dbf558000,0xbf0ebec43f7bbf35,0xbe2cbf353f7cbede,0x3f3f3de5bf603f67,0x3f023ec4bf783f48,0xbf633e2c3f30bf7e
.quad 0x3edebf7a80003f7a,0x3f7abedebf483f48,0xbe9b3f80be48bf67,0xbf783ef83f3abf59,0x3e2cbf7e3ec43f48,0x3f76bf08bf2b3f67,0xbce63f76bf0ebf20,0xbf743f143f1abf72,0xbde5bf673f353ede,0x3f72bf20bf083f7a,0x3e803f51bf55be64,0xbf6f3f2b3eebbf7e,0xbec4bf353f6d8000,0x3f6dbf35bec43f80,0x3f023f14bf7b3e64,0xbf6a3f3f3e9bbf7e
.quad 0xbf20bede3f80bede,0x3f67bf48be643f7a,0x3f3a3e8ebf7b3f20,0xbf633f513e0fbf72,0xbf51bde53f6dbf48,0x3f60bf59bd663f67,0x3f63bd66bf553f67,0xbf5c3f60bce6bf59,0xbf723e643f35bf7a,0x3f59bf673de53f48,0x3f7bbec4bf0e3f80,0xbf553f6dbe48bf35,0xbf803f083ec4bf7a,0x3f51bf723e8e3f20,0x3f7fbf2bbe483f67,0xbf4d3f76beb7bf08
.quad 0x8000,0x0,0x8000,0x0,0x8000,0x0,0x8000,0x0,0x8000,0x0,0x8000,0x0,0x8000,0x0,0x8000,0x0
.quad 0x8000,0x0,0x8000,0x0,0x8000,0x0,0x8000,0x0,0x8000,0x0,0x8000,0x0,0x8000,0x0,0x8000,0x0
.quad 0x0,0x0,0x0,0x0,0x0,0x0,0x0,0x0,0x0,0x0,0x0,0x0,0x0,0x0,0x0,0x0
.quad 0x0,0x0,0x0,0x0,0x0,0x0,0x0,0x0,0x0,0x0,0x0,0x0,0x0,0x0,0x0,0x0
.quad 0x3f28bf63be723f80,0x3f7fbe0fbf6e3f14,0x3f38bf5cbe873f80,0x3f753ce6bf793ef8,0x3f46bf55be953f80,0x3f623e48bf7f3ec4,0x3f53bf4dbea23f80,0x3f463eb7bf803e8e,0x3f5ebf44beb03f80,0x3f223f02bf7c3e2c,0x3f68bf3abebd3f80,0x3ef13f25bf733d66,0x3f70bf30becb3f80,0x3e953f44bf65bd66,0x3f77bf25bed83f80,0x3dc93f5cbf53be2c
.quad 0x3f7cbf1abee53f80,0xbdc93f6fbf3cbe8e,0x3f7fbf0ebef13f80,0xbe953f7bbf22bec4,0x3f80bf02befe3f80,0xbef13f80bf05bef8,0x3f7fbeebbf053f80,0xbf223f7dbecbbf14,0x3f7dbed1bf0b3f80,0xbf463f74be87bf2b,0x3f79beb7bf113f80,0xbf623f63be01bf3f,0x3f73be9bbf173f80,0xbf753f4d3c66bf51,0x3f6bbe80bf1d3f80,0xbf7f3f303e1dbf60
.quad 0x3efe3f3abf57bea9,0xbed83f7bbd2cbf76,0x3e563f63bf2dbf08,0xbf413f553ea2bf80,0xbdc93f7bbef1bf35,0xbf753f0e3f22bf6d,0xbecb3f7fbe72bf59,0xbf7e3e483f5ebf3f,0xbf283f6f3c66bf72,0xbf5bbe483f7dbef8,0xbf5b3f4d3e87bf7e,0xbf11bf0e3f7abe2c,0xbf793f1a3efebf7e,0xbe3abf553f573e2c,0xbf7f3eb73f32bf72,0x3e72bf7b3f173ef8
.quad 0xbf6e3dac3f5bbf59,0x3f1dbf7b3e873f3f,0xbf46be483f75bf35,0x3f62bf55bdc93f6d,0xbf0bbeeb3f80bf08,0x3f7fbf0ebee53f80,0xbe87bf303f7abea9,0x3f70be48bf3c3f76,0x3d2cbf5c3f65bde5,0x3f383e48bf6e3f51,0x3eb0bf783f413de5,0x3ebd3f0ebf803f14,0x3f1dbf803f113ea9,0xbd2c3f55bf703e8e,0x3f53bf743eb03f08,0xbee53f7bbf41bd66
.quad 0xbf7c3ed13f4abf48,0xbf38bf023f753d66,0xbf70bdac3f7cbede,0xbe1dbf6a3f223f14,0xbf22bf0e3f758000,0x3ef1bf7b3dc93f6d,0xbe1dbf633f383ede,0x3f68bf30bef13f7c,0x3ebdbf803ea23f48,0x3f7abe0fbf623f3f,0x3f4abf5cbe1d3f7a,0x3f283eebbf7f3e8e,0x3f7ebf02bf173f7a,0x3d8f3f63bf46be8e,0x3f6bbce6bf653f48,0xbf0b3f7dbe95bf3f
.quad 0x3f173eebbf803ede,0xbf703f3a3e95bf7c,0x3dc93f55bf620000,0xbf753e483f46bf6d,0xbed83f7fbf11bede,0xbf17bed13f7fbf14,0xbf533f6abe01bf48,0x3c66bf5c3f62bd66,0xbf7f3f1a3eb0bf7a,0x3f1dbf7f3ef13ef8,0xbf653e0f3f3cbf7a,0x3f77bf44bdc93f60,0xbf0bbeb73f77bf48,0x3f6ebe80bf223f80,0xbd2cbf443f7abede,0x3f053eb7bf753f51
.quad 0x3e1dbf7f3ea23f59,0x3f65bf25bf173f6d,0x3f4abf4dbebd3f7e,0x3f6b3e0fbf7e3ec4,0x3f7fbe48bf623f35,0x3e953f55bf46bec4,0x3f283f02bf7a3de5,0xbf0b3f78bd8fbf6d,0xbd2c3f74bf1dbf08,0xbf7e3eeb3f2dbf6d,0xbf383f6a3d2cbf72,0xbf3cbeb73f80bec4,0xbf803ed13f2dbf72,0x3d2cbf6f3f323ec4,0xbf3cbe9b3f7ebf08,0x3f4abf63bd2c3f6d
.quad 0xbd8fbf5c3f573de5,0x3f7abe80bf413f6d,0x3f22bf7b3e953f35,0x3ef13f0ebf7f3ec4,0x3f7ebf1abecb3f7e,0xbebd3f7dbf1dbec4,0x3f4f3dacbf653f59,0xbf733f443e1dbf6d,0x3e3a3f3abf793ea9,0xbf5b3ce63f53bf6d,0xbf0b3f80bf17bea9,0xbe1dbf3a3f7abec4,0xbf793f443d8fbf59,0x3f28bf7f3f053ec4,0xbf5e3e0f3f32bf7e,0x3f80bf1abe873f6d
.quad 0x3f623e80bf803e64,0x3e013f6fbf11bf2b,0x3dc93f6fbf17bf20,0xbf533f443ed8bf7c,0xbf463f553e95bf80,0xbf62be483f7fbec4,0xbf753ce63f70bf20,0x3c66bf743f173f14,0xbe95bf4d3f573e64,0x3f65bf3abecb3f80,0x3f22bf743d8f3f67,0x3f4f3e80bf7e3ef8,0x3f7fbe9bbf413f67,0xbe1d3f78bf1dbef8,0x3ef13f1abf7a3e64,0xbf733f303ebdbf80
.quad 0xbef13f80bed8bf20,0xbf38be9b3f7dbf14,0xbf7f3f0e3ef1bf80,0x3e95bf7b3f223ec4,0xbf22beb73f7dbf20,0x3f7cbf25beb03f7c,0x3e95bf783f383e64,0x3f1d3eb7bf7c3f2b,0x3f75bf44be013f67,0xbed83f7dbf28be8e,0x3f463dacbf5e3f67,0xbf803f1a3ea2bf76,0xbdc93f5cbf6b3e64,0xbefebed13f7abf3f,0xbf623f6abe72bf20,0x3f0bbf7f3f2d3e2c
.quad 0xbf3c3f553eb0bf7e,0xbf7a3ce63f77bef8,0xbf65be483f7fbea9,0xbd2cbf743f0b3f2b,0x3dc9bf7b3ef13f35,0x3f75bf0ebf223f6d,0x3f77bf0ebf1d3f72,0x3f053f25bf6ebd66,0x3f173f0ebf793de5,0xbf323f6a3d8fbf76,0xbf0b3f7bbe3abf59,0xbf5ebe0f3f79bf14,0xbf7a3e483f53bf59,0x3e87bf7d3f053f14,0xbe1dbf553f5b3de5,0x3f80bed1bf283f76
.quad 0x3f5ebf55be013f72,0x3e723f44bf6b3d66,0x3f463e48bf753f35,0xbf623f553dc9bf6d,0xbea23f7bbf28bea9,0xbf2dbe9b3f7abf2b,0xbf803f0e3ed8bf7e,0x3f0bbf803efe3ef8,0xbecbbf0e3f80bf08,0x3f73be80bf2d3f7c,0x3f38bf7b3ecb3f08,0xbd8f3f5cbf683e2c,0x3f68be48bf2d3f7e,0xbf7c3f3a3e01bf60,0xbd8f3f55bf733ea9,0xbed8beeb3f7cbf3f
.quad 0xbecbbf4d3f463ede,0x3f05bf74bd8f3f7c,0x3f5bbf3abef13f7a,0x3f5e3e80bf803e8e,0x3f223f0ebf750000,0xbef13f7bbdc9bf6d,0xbf2d3f6a3dc9bf7a,0xbf65be0f3f7cbef8,0xbf53be803f7fbede,0x3ed8bf7f3e873f51,0x3ee5bf7f3e953f48,0x3f6b3ce6bf703f2b,0x3f73bdacbf623f48,0xbebd3f80bed8bf2b,0xbe3a3f78bf22bede,0xbf703dac3f5ebf51
.quad 0xbf803ed13f22bf7a,0x3ea2bf7d3f113ef8,0xbdc9bf553f628000,0x3f75be48bf463f6d,0x3f79bf30be953f7a,0xbe873f78bf32be8e,0x3ebd3f1abf7f3ede,0xbf793e9b3f28bf7c,0xbf5e3f63bdc9bf48,0x3e56bf6f3f4f3d66,0xbf1dbe9b3f75bf48,0x3f7cbed1bf053f80,0x3f32bf7d3ef13ede,0xbe1d3f63bf653e2c,0x3f4fbce6bf463f7a,0xbf7e3f023ebdbf76
.quad 0x3f7fbe9bbf5b3f35,0x3f223f1abf6bbe2c,0xbc663f78befebf35,0xbf623f303f05bf76,0xbf7f3e483f62bf35,0xbe95bf553f463ec4,0x3e3abf7d3ee53f35,0x3f7fbed1bf3c3f60,0x3f77bdacbf683f35,0xbdc93f78bf11bf14,0xbeb03f80becbbf35,0xbf753dac3f65bf3f,0xbf68bce63f6ebf35,0x3ef1bf7f3ea23f3f,0x3efebf7f3eb03f35,0x3f463e80bf7c3f14
.quad 0x3f533e0fbf733f35,0xbf463f6abd2cbf60,0xbf223f7bbe95bf35,0xbef1bf0e3f7fbec4,0xbf38be803f77bf35,0x3f75bf3abe723f76,0x3f41bf743e723f35,0x3dc93f4dbf6e3e2c,0x3f173eb7bf7a3f35,0xbf7f3eeb3efebf80,0xbf5b3f6abe3abf35,0x3e95bf743f4a3d66,0xbee5beeb3f7dbf35,0x3f62be0fbf383f7c,0x3f6ebf5c3e013f35,0xbf223f80bf17be8e
.quad 0xbe873f80be56bf67,0xbf703f0e3f2dbf60,0xbf57be9b3f80be64,0x3d8fbf7b3ee53f3f,0x3f46bf55be953f80,0x3f623e48bf7f3ec4,0x3ebd3f44bf5bbe64,0xbf4a3f553e87bf80,0xbf7f3ed13f38bf67,0xbe72bf553f4f3e8e,0x3e72bf7d3efe3f20,0x3f7cbe48bf573f51,0x3f5b3e0fbf773f20,0xbf113f7bbe56bf51,0xbf413f6abc66bf67,0xbf05bf0e3f7dbe8e
.quad 0xbecbbf253f79be64,0x3f7ebf0ebefe3f80,0x3f7fbf0ebef13f80,0xbe953f7bbf22bec4,0xbe563f74bf3cbe64,0xbf41be483f73bf3f,0xbf5e3ce63f57bf67,0x3f68bf55bd2c3f60,0x3f3cbf783ea23f20,0x3c663f55bf6b3e2c,0x3ed83f02bf7f3f20,0xbf6b3e483f32bf7c,0xbf7e3f303e3abf67,0x3f3cbf7b3ed83ef8,0x3e3abf633f68be64,0x3ea23f0ebf7f3f2b
.quad 0xbf53beb73f7ebde5,0xbc66bf783ef13f3f,0x3f68bf25bf113f72,0x3f4f3eb7bf7f3e2c,0xbdc93f7bbef1bf35,0xbf753f0e3f22bf6d,0xbf4fbe9b3f80bea9,0x3eb0bf803e953f51,0x3f6bbf30bee53f7e,0x3f0b3f1abf753d66,0xbe013f78bf17bf08,0xbf7f3e9b3f46bf60,0xbf4abe803f7dbf08,0x3f28bf743dc93f60,0x3f6ebf3abea23f7e,0x3e563f4dbf62bd66
.quad 0xbe1d3f74bf32bea9,0xbf683ce63f62bf51,0xbf46be483f75bf35,0x3f62bf55bdc93f6d,0x3f70bf44be3a3f72,0xbe1d3f6fbf46be2c,0xbe3a3f6fbf4abde5,0xbf32be803f75bf3f,0xbf41be0f3f68bf59,0x3f7ebf25be953f76,0x3f73bf4dbd2c3f59,0xbefe3f7fbf22be8e,0xbe563f6abf5e3de5,0xbecbbf023f7fbf2b,0xbf3cbdac3f57bf72,0x3f79bed1bef13f7c
.quad 0x3f4fbf44bee53f7a,0x3f733dacbf7d3ec4,0xbe013f7dbecbbf48,0xbf6e3f1a3f1dbf6d,0xbf22bf0e3f758000,0x3ef1bf7b3dc93f6d,0x3f7fbe80bf573f48,0x3e563f5cbf41bec4,0xbf3c3f633e01bf7a,0xbf4abe9b3f80bec4,0x3c66bf6f3f2d3ede,0x3f80bed1bf323f6d,0x3f383eb7bf803ede,0xbf3c3f6a3c66bf6d,0xbf803eeb3f1dbf7a,0x3e01bf743f2d3ec4
.quad 0x3f28bf783e563f48,0x3f0b3f02bf7f3ec4,0x3dc93f55bf620000,0xbf753e483f46bf6d,0xbf4abe0f3f6ebf48,0x3f6bbf4dbe013f6d,0x3f7dbf25bea23f7a,0xbee53f7fbf17bec4,0xbf113f80bf05bede,0xbe72bf303f7cbec4,0xbe56bf303f7dbede,0x3f4f3ce6bf573f6d,0x3f5bbdacbf413f7a,0xbf7f3f253e72bf6d,0xbf773f4dbc66bf48,0x3f38bf7d3efe3ec4
.quad 0x3e953f5cbf32bf08,0xbf1d3f6a3e3abf80,0xbf46bed13f7dbde5,0x3e3abf7f3eb03f51,0x3f7fbe48bf623f35,0x3e953f55bf46bec4,0xbf623f3a3ed8bf7e,0xbf32beeb3f7dbe2c,0x3ef1bf7d3e563f59,0x3f73bce6bf6e3f2b,0x3dc93f63bf41bea9,0xbf7d3f023f1dbf76,0xbf22beeb3f7fbea9,0x3f4fbf5cbe013f76,0x3f75be0fbf573f59,0xbee53f80becbbf2b
.quad 0xbf753f303eb0bf7e,0xbc66bf633f4f3e2c,0x3f22bf7b3e953f35,0x3ef13f0ebf7f3ec4,0xbdc93f6abf4fbde5,0xbf53bdac3f68bf51,0xbef1bf023f80bf08,0x3f7ebed1bf113f80,0x3f62bdacbf4a3f72,0xbf703f4d3d8fbf60,0xbf7f3f253e87bf72,0x3f2dbf7d3ee53ef8,0x3f46bf783ebd3f08,0xbe873f6fbf573d66,0xbe953f6fbf5b3de5,0xbe56bf253f80bf14
.quad 0xbf803e483f68bf20,0xbf0bbf303f5e3e8e,0x3f73bf0ebf283f67,0x3f3c3eebbf7a3d66,0xbf463f553e95bf80,0xbf62be483f7fbec4,0x3efebf7b3e013f67,0x3f79bdacbf6b3f2b,0xbe1d3f7bbf05bf20,0xbf803eb73f41bf60,0xbe56bf553f533e64,0x3f77bf1abf053f7c,0x3f0b3f0ebf7c3e64,0xbf5e3f4d3e72bf7c,0xbf4fbe483f79bf20,0x3f38bf6f3d8f3f60
.quad 0x3f77be48bf4a3f67,0xbf053f7fbebdbf2b,0xbf7f3f0e3ef1bf80,0x3e95bf7b3f223ec4,0x3f65bf55bd8f3f67,0xbd2c3f63bf57bd66,0xbf2d3f7bbeb0bf20,0xbe56bf3a3f77be8e,0x3ebdbf7b3f323e64,0x3ee53f02bf803f14,0xbc663f55bf6e3e64,0xbf28be803f70bf51,0xbeb0bf0e3f80bf20,0x3f53bce6bf4a3f76,0x3f283e48bf653f67,0xbf703e9b3f11bf80
.quad 0x3ebdbf7d3dc93f72,0x3f79beebbf413f51,0xbe723f80be95bf59,0xbf773f023f32bf60,0x3dc9bf7b3ef13f35,0x3f75bf0ebf223f6d,0x3d2c3f6fbf22bf08,0xbf733f1a3f11bf76,0xbe3abf5c3f463ea9,0x3f70bf25befe3f7c,0x3ea23f44bf62bde5,0xbf6e3f303ed8bf80,0xbee5bf253f75bde5,0x3f6bbf3abeb03f80,0x3f113f02bf7f3ea9,0xbf683f443e87bf7c
.quad 0xbf2dbeb73f7fbf08,0x3f65bf4dbe3a3f76,0x3f463e48bf753f35,0xbf623f553dc9bf6d,0xbf5bbce63f62bf59,0x3f5ebf5cbc663f60,0x3f6bbe0fbf463f72,0xbf5b3f63bd8fbf51,0xbf773e9b3f22bf7e,0x3f57bf6a3e1d3f3f,0x3f7ebeebbef13f7e,0xbf533f6fbe72bf2b,0xbf803f1a3e95bf72,0x3f4fbf743ea23f14,0x3f7dbf3abdc93f59,0xbf4a3f78becbbef8
.quad 0x0,0x0,0x8000,0x0,0x0,0x0,0x8000,0x0,0x0,0x0,0x8000,0x0,0x0,0x0,0x8000,0x0
.quad 0x0,0x0,0x8000,0x0,0x0,0x0,0x8000,0x0,0x0,0x0,0x8000,0x0,0x0,0x0,0x8000,0x0
.quad 0x0,0x0,0x0,0x0,0x0,0x0,0x0,0x0,0x0,0x0,0x0,0x0,0x0,0x0,0x0,0x0
.quad 0x0,0x0,0x0,0x0,0x0,0x0,0x0,0x0,0x0,0x0,0x0,0x0,0x0,0x0,0x0,0x0
.quad 0x3f413eebbf798000,0xbdc93f7dbebdbf51,0x3f323f02bf778000,0xbe953f80be72bf60,0x3f223f0ebf758000,0xbef13f7bbdc9bf6d,0x3f113f1abf738000,0xbf223f6f3d2cbf76,0x3efe3f25bf708000,0xbf463f5c3e3abf7c,0x3ed83f30bf6e8000,0xbf623f443ea2bf80,0x3eb03f3abf6b8000,0xbf753f253ee5bf80,0x3e873f44bf688000,0xbf7f3f023f11bf7c
.quad 0x3e3a3f4dbf658000,0xbf7f3eb73f2dbf76,0x3dc93f55bf628000,0xbf753e483f46bf6d,0x3c663f5cbf5e8000,0xbf623ce63f5bbf60,0xbd8f3f63bf5b8000,0xbf46be0f3f6bbf51,0xbe1d3f6abf578000,0xbf22be9b3f77bf3f,0xbe723f6fbf538000,0xbef1beeb3f7ebf2b,0xbea23f74bf4f8000,0xbe95bf1a3f80bf14,0xbecb3f78bf4a8000,0xbdc9bf3a3f7dbef8
.quad 0xbf5e3f303f0bbf72,0xbf68be483f80be8e,0xbf7a3eeb3f3cbf59,0xbf28bf0e3f733d66,0xbf7f3e483f62bf35,0xbe95bf553f463ec4,0xbf6bbdac3f79bf08,0x3e01bf7b3efe3f2b,0xbf41beb73f80bea9,0x3f05bf7b3e1d3f60,0xbf05bf1a3f77bde5,0x3f53bf55be563f7c,0xbe72bf4d3f5e3de5,0x3f7cbf0ebf0b3f7c,0x3d8fbf6f3f383ea9,0x3f79be48bf4f3f60
.quad 0x3ebdbf7f3f053f08,0x3f4a3e48bf773f2b,0x3f22bf7b3e953f35,0x3ef13f0ebf7f3ec4,0x3f57bf633d2c3f59,0x3d8f3f55bf653d66,0x3f77bf3abe563f72,0xbeb03f7bbf2dbe8e,0x3f80bf02bee53f7e,0xbf323f7bbebdbf14,0x3f70be80bf283f7e,0xbf6e3f55bc66bf51,0x3f4a3ce6bf533f72,0xbf803f0e3eb0bf76,0x3f113e9bbf703f59,0xbf653e483f28bf80
.quad 0xbe3abf6a3f1d3f20,0x3f32bf5cbe953f80,0x3eb0bf7f3e3a3f67,0x3f7dbed1bf463f51,0x3f46bf55be953f80,0x3f623e48bf7f3ec4,0x3f7dbeebbf323f67,0x3ed83f3abf62be2c,0x3f6e3ce6bf733f20,0xbe563f7dbef1bf2b,0x3f1d3f02bf7d3e64,0xbf413f633dc9bf76,0x3e013f5cbf4fbe64,0xbf7f3eeb3f22bf76,0xbecb3f80bee5bf20,0xbf57be0f3f75bf2b
.quad 0xbf4f3f633c66bf67,0xbeb0bf303f75be2c,0xbf7f3f0e3ef1bf80,0x3e95bf7b3f223ec4,0xbf683dac3f53bf67,0x3f4fbf6a3dc93f51,0xbf11bed13f7ebf20,0x3f80bf02bef13f80,0xbd8fbf4d3f70be64,0x3f4a3dacbf623f60,0x3ee5bf7d3f2d3e64,0x3e873f25bf7f3ef8,0x3f57bf6f3e873f20,0xbebd3f78bf46bd66,0x3f80bf25be563f67,0xbf5b3f6fbe95bf14
.quad 0x3f7dbdacbf733f08,0x3ee53f44bf4fbec4,0x3f1d3f1abf6ebde5,0xbecb3f7dbe01bf6d,0xbdc93f7bbef1bf35,0xbf753f0e3f22bf6d,0xbf413f5c3e56bf7e,0xbf57be803f7fbec4,0xbf803e9b3f4abf59,0xbe01bf633f3c3ec4,0xbf32bed13f80bea9,0x3f2dbf6f3c663f6d,0xbc66bf6a3f3c3ea9,0x3f80beb7bf383f6d,0x3f2dbf743e013f59,0x3f1d3eebbf803ec4
.quad 0x3f7fbf02bf0b3f7e,0xbe563f78bf28bec4,0x3f463e48bf753f35,0xbf623f553dc9bf6d,0x3e013f4dbf6b3de5,0xbf6e3e0f3f4abf6d,0xbf173f7fbee5bf08,0xbea2bf253f7dbec4,0xbf7c3f303e72bf72,0x3f05bf803f113ec4,0xbf573ce63f4fbf72,0x3f7dbf30be563f6d,0xbe72bf253f7fbf08,0x3f413dacbf5b3f6d,0x3efebf7d3f383de5,0xbc663f4dbf773ec4
.quad 0xbef13f783c66bf7a,0xbf7e3eb73f53bf3f,0xbf7f3eb73f4fbf48,0xbf11bf253f683e2c,0xbf22bf0e3f758000,0x3ef1bf7b3dc93f6d,0x3e95bf803eb03f48,0x3f80be9bbf4f3f51,0x3f75bf1abf0b3f7a,0x3ee53f30bf6bbd66,0x3f463e9bbf7f3ede,0xbf173f78be01bf60,0xbdc93f74bf28bede,0xbf7d3e803f4abf60,0xbf623f4d3e56bf7a,0xbea2bf3a3f6ebd66
.quad 0xbf62bce63f68bf48,0x3f32bf743e1d3f51,0xbdc9bf553f628000,0x3f75be48bf463f6d,0x3f46bf6f3e1d3f48,0x3e3a3f44bf703e2c,0x3f75be80bf323f7a,0xbf4a3f6fbe3abf3f,0x3e953f25bf7e3ede,0xbf683e0f3f41bf76,0xbf223f7fbefebede,0xbd2cbf4d3f73be8e,0xbf7f3f023ecbbf7a,0x3f5ebf6a3e563f2b,0xbef1bed13f79bf48,0x3f57bdacbf3c3f7c
.quad 0xbf2dbf0e3f703de5,0x3e56bf803e873f60,0x3ee5bf7b3d8f3f72,0x3f80be9bbf573f3f,0x3f7fbe48bf623f35,0x3e953f55bf46bec4,0x3e873f55bf4abea9,0xbf5b3f443ebdbf80,0xbf4f3f553e72bf7e,0xbf38bed13f7fbe8e,0xbf57be483f7cbf08,0x3efebf7d3e723f51,0x3e56bf7b3f113f08,0x3f77be0fbf5b3f51,0x3f7dbf0ebf053f7e,0xbc663f6abf41be8e
.quad 0x3efe3f0ebf7e3ea9,0xbf793f253ecbbf80,0xbf223f7bbe95bf35,0xbef1bf0e3f7fbec4,0xbf733e483f41bf72,0x3f3cbf743e563f3f,0xbd2cbf553f68bde5,0x3f573ce6bf5e3f60,0x3f6bbf55bc663f59,0xbea23f78bf3cbe2c,0x3f323e48bf6b3f59,0xbf7f3f023ed8bf7c,0xbed83f7bbf3cbde5,0xbe3abf303f7ebef8,0xbf7f3f0e3ea2bf72,0x3f68bf633e3a3f2b
.quad 0x3f6bbf1abf223f67,0x3f5b3e9bbf7f3e2c,0x3f053f30bf62be64,0xbefe3f78bc66bf76,0xbf463f553e95bf80,0xbf62be483f7fbec4,0xbf3cbed13f7fbe64,0x3ee5bf7d3e3a3f60,0x3f11bf783dc93f67,0x3f683dacbf773f14,0x3f653dacbf753f20,0xbecb3f80beb0bf3f,0xbea23f7fbef1bf20,0xbf6e3ce63f68bf3f,0xbf7c3e803f46bf67,0x3eb0bf7f3efe3f14
.quad 0x3d2cbf6a3f463e64,0x3f73be0fbf533f60,0x3f7fbf0ebef13f80,0xbe953f7bbf22bec4,0x3e723f3abf753e64,0xbf773e803f38bf76,0xbf6e3f4d3dc9bf67,0x3e72bf743f413e2c,0xbefebeeb3f7fbf20,0x3f7abeb7bf173f80,0x3f4abf743e953f20,0xbe3a3f6abf5b3d66,0x3f383e0fbf623f67,0xbf7d3eeb3ee5bf7c,0xbf173f80bf22be64,0x3e01bf5c3f6ebe8e
.quad 0x3d8f3f74bf05bf35,0xbf463f4d3ecbbf7c,0xbf803e803f5ebf35,0xbef1bf3a3f5b3e8e,0x3dc9bf7b3ef13f35,0x3f75bf0ebf223f6d,0x3f7cbe0fbf653f35,0x3dc93f6abf2dbef8,0xbe873f7fbed8bf35,0xbf7f3e803f53bf51,0xbf703ce63f6bbf35,0x3e95bf7f3ee53f2b,0x3ed8bf803ebd3f35,0x3f623dacbf733f2b,0x3f5e3dacbf703f35,0xbf223f78be3abf51
.quad 0xbf113f7dbea2bf35,0xbf22bed13f80bef8,0xbf46be483f75bf35,0x3f62bf55bdc93f6d,0x3f32bf783e873f35,0x3e953f30bf793e8e,0x3f283e9bbf793f35,0xbf7f3f1a3ebdbf7c,0xbf4f3f6fbe56bf35,0x3dc9bf633f5ebd66,0xbf05bed13f7cbf35,0x3f75be9bbf1d3f80,0x3f65bf633e1d3f35,0xbef13f7dbf32be2c,0x3ebd3f02bf7e3f35,0xbf46bce63f4fbf76
.quad 0xbf77bce63f7abede,0xbeb0bf553f3c3ef8,0x3f0bbf74bd2c3f7a,0x3f7fbe48bf653f2b,0x3f223f0ebf758000,0xbef13f7bbdc9bf6d,0xbf6e3f253f05bf7a,0xbf1dbf0e3f77bd66,0xbd8fbf6a3f323ede,0x3f79bf0ebf173f76,0x3f79be0fbf5e3f48,0xbe3a3f7bbf0bbf14,0xbf053f7dbe87bf48,0xbf53be483f7abf14,0xbf28bed13f80bede,0x3f5bbf55be1d3f76
.quad 0x3f6bbf44be723f7a,0x3e013f55bf5ebd66,0x3dc93f55bf628000,0xbf753e483f46bf6d,0xbf7a3e9b3f2dbf7a,0x3f28bf7b3ea23f2b,0x3efebf803f0b3ede,0x3ed83f0ebf803ef8,0x3f2d3e80bf733f48,0xbf803f0e3ecbbf7c,0xbf683f5cbd8fbf48,0x3ecbbf7b3f383e2c,0xbe01bf3a3f7cbede,0x3f2d3e48bf683f60,0x3f7cbeebbed83f7a,0xbf733f55bd8fbf3f
.quad 0x3f11bf6fbe013f7e,0x3f80be80bf623f2b,0x3ed83f44bf53bea9,0xbf173f6f3dc9bf7c,0xbf7f3e483f62bf35,0xbe95bf553f463ec4,0x3f17bf743c663f72,0x3f703ce6bf753f14,0x3ecb3f3abf65bde5,0xbf573f4d3e95bf80,0xbf7e3e803f4fbf59,0x3d8fbf743f223ef8,0x3f1dbf783e1d3f59,0x3f413e9bbf7f3ef8,0x3ebd3f30bf733de5,0xbf7a3f1a3ef1bf80
.quad 0xbf7d3e9b3f38bf72,0x3ed8bf803ef13f14,0x3f22bf7b3e953f35,0x3ef13f0ebf7f3ec4,0x3eb03f25bf7c3ea9,0xbf7d3eb73f22bf7c,0xbf7c3eb73f1dbf7e,0x3f38bf783e953f2b,0x3f28bf7d3ed83f08,0x3e013f44bf753e8e,0x3ea23f1abf803f08,0xbf5e3dac3f46bf76,0xbf7a3ed13efebf7e,0x3f6bbf5c3dc93f3f,0x3f2dbf7f3f0b3ea9,0xbe723f6abf623e2c
.quad 0x3f173f25bf65be64,0xbea23f7fbe1dbf6d,0xbf7e3e0f3f6bbf20,0xbebdbf4d3f4a3ec4,0x3f46bf55be953f80,0x3f623e48bf7f3ec4,0xbd8f3f78bf0bbf20,0xbf7a3f023f28bf6d,0xbf2dbeeb3f7ebe64,0x3f1dbf743d2c3f6d,0x3f80beb7bf3c3f67,0x3d2c3f6abf38bec4,0xbf323f6fbd2cbf67,0xbf2dbed13f80bec4,0xbd2cbf633f4a3e64,0x3f7ebe9bbf3c3f6d
.quad 0x3f413e80bf7a3f20,0xbf573f5c3d8fbf6d,0xbf7f3f0e3ef1bf80,0x3e95bf7b3f223ec4,0x3f1dbf7d3ebd3f20,0x3ecb3f1abf7e3ec4,0x3e1d3f44bf733e64,0xbf653dac3f4fbf6d,0xbf53bce63f5bbf67,0x3f79bf3abe3a3f6d,0x3f7abf3abe1d3f67,0xbf173f80bf0bbec4,0xbf053f7fbf28be64,0xbd8fbf443f79bec4,0xbe87bf1a3f80bf20,0x3f323e0fbf5e3f6d
.quad 0xbf753f023f38bf59,0xbf4abed13f7cbd66,0x3f22bf6abe1d3f7e,0x3f7cbdacbf703f14,0xbdc93f7bbef1bf35,0xbf753f0e3f22bf6d,0xbef1bf303f683de5,0x3f38bf63be1d3f7c,0x3f623e0fbf7a3f08,0xbea23f80bebdbf3f,0xbf7f3eeb3f28bf72,0xbe1dbf5c3f4a3e8e,0x3f46bf63bd8f3f72,0x3f173f02bf7e3e8e,0xbe953f7dbf0bbf08,0xbf65bce63f6bbf3f
.quad 0xbe95bf3a3f70bde5,0x3f80beebbf173f7c,0x3f463e48bf753f35,0xbf623f553dc9bf6d,0xbf7f3ed13f17bf7e,0x3f11bf7f3ed83f14,0x3f62bf5c3c663f59,0xbe013f6abf53bd66,0xbef13f7fbf1dbea9,0xbeb0bf1a3f7fbef8,0xbdc9bf443f77bea9,0x3f3c3e0fbf653f60,0x3f223e80bf6e3f59,0xbf773eb73f0bbf80,0xbf753eb73f05bf7e,0x3f7abf44bd2c3f51
.quad 0x3d2cbf7b3ed83f48,0x3f57bf3abefe3f76,0x3ea23f55bf41bede,0xbf2d3f633e56bf80,0xbf22bf0e3f758000,0x3ef1bf7b3dc93f6d,0x3f5e3e48bf7e3ede,0xbe723f7fbecbbf3f,0xbf7d3e483f5bbf48,0xbc66bf6f3f283ef8,0x3f7abf0ebf113f7a,0x3e873f4dbf5bbe2c,0xbf573f553e3abf7a,0xbefebf1a3f79be2c,0x3f17bf7b3e723f48,0x3f323eb7bf7f3ef8
.quad 0xbe873f7bbf1dbede,0xbf5bbdac3f6ebf3f,0xbdc9bf553f628000,0x3f75be48bf463f6d,0x3ee53f0ebf7f3ede,0xbf803eeb3f0bbf80,0xbf3cbe483f70bf48,0x3f7abf30be873f76,0x3f6ebe48bf383f7a,0xbf653f5cbd2cbf51,0xbf803f0e3ebdbf7a,0x3f41bf783eb03f14,0x3f70bf553d2c3f48,0xbf113f80bf1dbe8e,0xbf413f7bbee5bede,0x3eb0bf743f53bd66
.quad 0x3f6e3e0fbf7f3ea9,0x3e723f63bf28bf14,0xbf793ce63f75bf08,0xbe87bf5c3f383ef8,0x3f7fbe48bf623f35,0x3e953f55bf46bec4,0xbf803eb73f46bf59,0xbea2bf4d3f533e8e,0x3f7cbf02bf223f72,0x3eb03f44bf5ebe2c,0xbf733f253ef1bf7e,0xbebdbf3a3f683d66,0x3f65bf44be953f7e,0x3ecb3f30bf703d66,0xbf533f5c3dc9bf72,0xbed8bf253f77be2c
.quad 0x3f3cbf6f3dc93f59,0x3ee53f1abf7c3e8e,0xbf223f7bbe95bf35,0xbef1bf0e3f7fbec4,0x3f05bf803ef13f08,0x3efe3f02bf803ef8,0xbecb3f7dbf22bea9,0xbf05beeb3f7fbf14,0x3e87bf743f463de5,0x3f0b3ed1bf7d3f2b,0xbe013f63bf623de5,0xbf11beb73f79bf3f,0xbc66bf4d3f75bea9,0x3f173e9bbf733f51,0x3e1d3f30bf7f3f08,0xbf1dbe803f6bbf60
.quad 0xbf80,0x0,0x3f80,0x0,0xbf80,0x0,0x3f80,0x0,0xbf80,0x0,0x3f80,0x0,0xbf80,0x0,0x3f80,0x0
.quad 0xbf80,0x0,0x3f80,0x0,0xbf80,0x0,0x3f80,0x0,0xbf80,0x0,0x3f80,0x0,0xbf80,0x0,0x3f80,0x0
.quad 0x0,0x0,0x0,0x0,0x0,0x0,0x0,0x0,0x0,0x0,0x0,0x0,0x0,0x0,0x0,0x0
.quad 0x0,0x0,0x0,0x0,0x0,0x0,0x0,0x0,0x0,0x0,0x0,0x0,0x0,0x0,0x0,0x0
.quad 0x3f67be64bf203f80,0xbf803f203e64bf67,0x3f5cbe2cbf253f80,0xbf7b3ef83eb7bf72,0x3f51bde5bf2b3f80,0xbf6d3ea93ef8bf7a,0x3f44bd66bf303f80,0xbf553e2c3f1abf7e,0x3f358000bf353f80,0xbf3500003f35bf80,0x3f253d66bf3a3f80,0xbf0ebe2c3f4dbf7e,0x3f143de5bf3f3f80,0xbec4bea93f60bf7a,0x3f023e2cbf443f80,0xbe48bef83f6fbf72
.quad 0x3ede3e64bf483f80,0x8000bf203f7abf67,0x3eb73e8ebf4d3f80,0x3e48bf3f3f7fbf59,0x3e8e3ea9bf513f80,0x3ec4bf593f80bf48,0x3e483ec4bf553f80,0x3f0ebf6d3f7bbf35,0x3de53edebf593f80,0x3f35bf7a3f72bf20,0x3ce63ef8bf5c3f80,0x3f55bf803f63bf08,0xbd663f08bf603f80,0x3f6dbf7e3f51bede,0xbe0f3f14bf633f80,0x3f7bbf763f3abea9
.quad 0x3f67bf673e643f20,0xbf203f80bf20be64,0x3f7dbf3fbce63f48,0xbf633f6dbe9bbf08,0x3f7cbf08be8e3f67,0xbf803f353d66bf48,0x3f63be8ebf023f7a,0xbf6f3ec43ed1bf72,0x3f358000bf353f80,0xbf3500003f35bf80,0x3eeb3e8ebf5c3f7a,0xbeb7bec43f6abf72,0x3e2c3f08bf763f67,0x3d66bf353f80bf48,0xbe0f3f3fbf803f48,0x3eebbf6d3f74bf08
.quad 0xbede3f67bf7a3f20,0x3f48bf803f48be64,0xbf303f7cbf633ede,0x3f78bf6d3f023de5,0xbf603f7ebf3f3e64,0x3f7cbf353e2c3ede,0xbf7b3f6dbf0e0000,0x3f55bec4be483f35,0xbf7e3f48bea9be64,0x3f088000bf083f67,0xbf6a3f14bdacbede,0x3e0f3ec4bf4d3f7e,0xbf3f3ea93e2cbf20,0xbe8e3f35bf763f7a,0xbf023d663ed1bf48,0xbf253f6dbf7f3f59
.quad 0x3e64bf673f67be64,0x3e643f20bf803f20,0x3f30bf803f1a3e64,0xbed13f76bf553de5,0x3f76bf593e2c3f20,0xbf603f72bec4bede,0x3f78bef8be9b3f67,0xbf7d3f143e48bf59,0x3f358000bf353f80,0xbf3500003f35bf80,0x3e803ef8bf743f67,0xbe0fbf143f7bbf59,0xbe8e3f59bf7c3f20,0x3ef8bf723f6dbede,0xbf3a3f80bf4d3e64,0x3f6abf763f0e3de5
.quad 0xbf7a3f67bedebe64,0x3f7abf2000003f20,0xbf743f143ce6bf20,0x3f25bd66bf0e3f72,0xbf2b3de53ef8bf67,0x3d663f08bf6d3f7a,0xbe48bec43f55bf80,0xbf0e3f6dbf7b3f35,0x3ea9bf483f7ebf67,0xbf723f7abf353e64,0x3f44bf7c3f6fbf20,0xbf743f2bbe48bea9,0x3f7cbf723f2bbe64,0xbf143de53ec4bf48,0x3f6fbf2b3e803e64,0x3ce6bef83f55bf7e
.quad 0xbf20be643f67bf67,0x3f67be64bf203f80,0x3dacbf513f78bede,0x3e803f14bf7f3f35,0x3f3fbf7e3f143e64,0xbf143f7ebf3f0000,0x3f80bf2bbdac3f48,0xbf7f3f3fbce6bf35,0x3f358000bf353f80,0xbf3500003f35bf80,0x3ce63f2bbf7f3f48,0x3dacbf3f3f80bf35,0xbf2b3f7ebf513e64,0x3f51bf7e3f2b8000,0xbf7f3f51be80bede,0x3f78bf14bdac3f35
.quad 0xbf483e643edebf67,0x3ede3e64bf483f80,0xbe0fbef83f6abf7a,0xbed13f60bf7d3f35,0x3f14bf723f76bf20,0xbf763f72bf140000,0x3f7bbf6d3f0e8000,0xbf553ec43e48bf35,0x3f59bedebde53f20,0xbde5bede3f59bf80,0x3e803e8ebf3a3f7a,0x3f30bf763f78bf35,0xbef83f59bf803f67,0x3f80bf593ef88000,0xbf743f7cbf4d3ede,0x3f1abe2cbe9b3f35
.quad 0xbf803f203e64bf67,0x3f67bf673e643f20,0xbf0ebe8e3f6abf67,0x3f4dbd66bf3a3f7e,0x3ec4bf723f60be64,0xbe2c3f59bf763ede,0x3f7bbf513e0f3f20,0xbf743f60be80bf08,0x3f358000bf353f80,0xbf3500003f35bf80,0xbe483f51bf7d3f20,0x3e9bbf603f78bf08,0xbf6d3f72bef8be64,0x3f7cbf593e8e3ede,0xbf553e8e3ed1bf67,0x3f1a3d66bf303f7e
.quad 0x8000bf203f7abf67,0xbede3f67bf7a3f20,0x3f55bf803f44be64,0xbf803f51be9bbea9,0x3f6dbf08bd663f20,0xbef8bde53f2bbf7a,0x3e483ec4bf553f80,0x3f0ebf6d3f7bbf35,0xbf353f7abf723f20,0x3f7ebf483ea93e64,0xbf7b3f3fbe9bbe64,0x3eb73e2cbf253f72,0xbec4bde53f14bf67,0xbf2b3f72bf7c3f48,0x3f0ebf603f80bf67,0xbf783f3fbeb7bde5
.quad 0xbf203f80bf20be64,0x3e64bf673f67be64,0xbf743ec43eebbf7a,0x3f80bf2bbe0f3f59,0xbd66bf353f80bf20,0x3e8e3f08bf7c3f48,0x3f6abf6d3eb73ede,0xbf5c3f76beebbea9,0x3f358000bf353f80,0xbf3500003f35bf80,0xbed13f6dbf6f3ede,0x3f02bf763f63bea9,0xbf803f35bd66bf20,0x3f76bf08be2c3f48,0xbe9bbec43f63bf7a,0xbce63f2bbf7d3f59
.quad 0x3f48bf803f48be64,0xbf7a3f67bedebe64,0x3f5cbec4be803f48,0xbeebbe2c3f3abf7e,0xbe2c3f35bf7c3f67,0x3f3fbf7e3f60bede,0xbf7b3f6dbf0e0000,0x3f55bec4be483f35,0xbf0800003f08bf67,0xbea93f48bf7e3f67,0x3f1abf6d3f7dbf48,0xbf7f3f51bed1bde5,0x3f76bf353e8e3e64,0xbe2cbea93f3fbf7a,0x3dac3ec4bf443f7a,0x3f6abf803f5cbf08
.quad 0x3e643f20bf803f20,0xbf20be643f67bf67,0xbf6f3f60be48bf20,0x3f44bf7c3f023ea9,0xbef8bea93f6dbf67,0x3f2b3de5bf513f7a,0x3f4dbf7c3f0e3e64,0xbf3a3f80bf25bde5,0x3f358000bf353f80,0xbf3500003f35bf80,0xbf1a3f7cbf553e64,0x3f30bf803f44bde5,0xbf603ea93ec4bf67,0x3f3fbde5bf143f7a,0x3eb7bf603f7bbf20,0xbf253f7cbf5c3ea9
.quad 0x3f7abf2000003f20,0xbf483e643edebf67,0xbdac3f2bbf7b3f67,0x3f1abf763f6fbf08,0xbf803f59bec4be64,0x3f51bea9be8e3f48,0xbe48bec43f55bf80,0xbf0e3f6dbf7b3f35,0x3f72bf7a3f35be64,0xbf593ede3de5bf20,0x3eeb3d66bf0e3f67,0x3f02bf603f80bf59,0xbf513f7ebf6d3f20,0x3f60bf083d663ede,0xbf303e8e3e48bf20,0xbeeb3f51bf7d3f72
.quad 0x3f67be64bf203f80,0xbf803f203e64bf67,0xbf023f7cbf440000,0x3e48bf603f6fbea9,0xbf513de53f2bbf80,0x3f6dbea9bef83f7a,0x3f25bf803f3a8000,0xbf0e3f7cbf4d3de5,0x3f358000bf353f80,0xbf3500003f35bf80,0xbf443f80bf300000,0x3f55bf7c3f1a3de5,0xbf14bde53f3fbf80,0x3ec43ea9bf603f7a,0x3f5cbf7c3f258000,0xbf7b3f60beb7bea9
.quad 0x3ede3e64bf483f80,0x8000bf203f7abf67,0xbf6f3f76bf1a0000,0x3f7bbf2b3dac3f08,0xbe8ebea93f51bf80,0xbec43f59bf803f48,0x3f7bbf6d3f0e8000,0xbf553ec43e48bf35,0x3de53edebf593f80,0x3f35bf7a3f72bf20,0xbf803f60bf020000,0x3f0ebd66beeb3f59,0x3d66bf083f60bf80,0xbf6d3f7ebf513ede,0x3f7dbf513eeb8000,0xbe48be8e3f30bf72
.quad 0x3f67bf673e643f20,0xbf203f80bf20be64,0x3e0f3f2bbf803f20,0xbeebbec43f74bf59,0xbf7c3f083e8ebf67,0x3f80bf35bd663f48,0x3eebbf763f5cbe64,0xbeb73f6dbf6a3ea9,0x3f358000bf353f80,0xbf3500003f35bf80,0xbf633f76bf02be64,0x3f6fbf6d3ed13ea9,0xbe2cbf083f76bf67,0xbd663f35bf803f48,0x3f7dbf2b3ce63f20,0xbf633ec43e9bbf59
.quad 0xbede3f67bf7a3f20,0x3f48bf803f48be64,0xbf3a3e2c3eebbf67,0x3e803ec4bf5c3f7e,0x3f60bf7e3f3fbe64,0xbf7c3f35be2cbede,0x3e483ec4bf553f80,0x3f0ebf6d3f7bbf35,0xbf7e3f48bea9be64,0x3f088000bf083f67,0x3ed1bf513f7fbf67,0xbf7d3f6dbf1a3de5,0x3f3fbea9be2c3f20,0x3e8ebf353f76bf7a,0xbf5c3f80bf6a3f20,0x3f44bec4bdac3f08
.quad 0x3e64bf673f67be64,0x3e643f20bf803f20,0x3f3a3d66bf4d3f7a,0xbf6a3e8e3f0ebf7e,0xbf763f59be2cbf20,0x3f60bf723ec43ede,0x3e80bf603f74bede,0xbe0f3f51bf7b3f08,0x3f358000bf353f80,0xbf3500003f35bf80,0xbf783f60be9bbede,0x3f7dbf513e483f08,0x3e8ebf593f7cbf20,0xbef83f72bf6d3ede,0x3f30bd66bf1a3f7a,0xbed1be8e3f55bf7e
.quad 0xbf7a3f67bedebe64,0x3f7abf2000003f20,0x3e9bbf513f80bf48,0xbf443f80bf553ea9,0x3f2bbde5bef83f67,0xbd66bf083f6dbf7a,0xbf7b3f6dbf0e0000,0x3f55bec4be483f35,0x3ea9bf483f7ebf67,0xbf723f7abf353e64,0x3f25be2cbeb73f48,0x3e9bbf3f3f7bbf72,0xbf7c3f72bf2b3e64,0x3f14bde5bec43f48,0x3eb7bf3f3f78bf7a,0xbf803f60bf0e3de5
.quad 0xbf20be643f67bf67,0x3f67be64bf203f80,0x3f7fbf14be803f67,0xbf783f51bdacbf35,0xbf3f3f7ebf14be64,0x3f14bf7e3f3f8000,0x3ce6bf3f3f7fbf20,0x3dac3f2bbf803f35,0x3f358000bf353f80,0xbf3500003f35bf80,0xbf803f3fbdacbf20,0x3f7fbf2bbce63f35,0x3f2bbf7e3f51be64,0xbf513f7ebf2b0000,0x3dac3f14bf783f67,0x3e80bf513f7fbf35
.quad 0xbf483e643edebf67,0x3ede3e64bf483f80,0x3f7dbf603ed13e64,0xbf6a3ef83e0fbf35,0xbf143f72bf763f20,0x3f76bf723f148000,0xbe48bec43f55bf80,0xbf0e3f6dbf7b3f35,0x3f59bedebde53f20,0xbde5bede3f59bf80,0xbf783f76bf303e64,0x3f3abe8ebe803f35,0x3ef8bf593f80bf67,0xbf803f59bef80000,0x3e9b3e2cbf1a3f67,0x3f4dbf7c3f74bf35
.quad 0xbf803f203e64bf67,0x3f67bf673e643f20,0x3f55bf763ed13ede,0xbf1a3f80bf30bde5,0xbec43f72bf603e64,0x3e2cbf593f76bede,0xbe48bf143f7dbf48,0x3e9b3ef8bf783f59,0x3f358000bf353f80,0xbf3500003f35bf80,0xbf7b3f143e0fbf48,0x3f74bef8be803f59,0x3f6dbf723ef83e64,0xbf7c3f59be8ebede,0xbf0e3f76bf6a3ede,0x3f4dbf803f3abde5
.quad 0x8000bf203f7abf67,0xbede3f67bf7a3f20,0x3f0e3d66bf253f7a,0xbce6bf143f74bf72,0xbf6d3f083d66bf20,0x3ef83de5bf2b3f7a,0x3f7bbf6d3f0e8000,0xbf553ec43e48bf35,0xbf353f7abf723f20,0x3f7ebf483ea93e64,0x3e48bf2b3f74bf7a,0xbf6f3f7cbf443ea9,0x3ec43de5bf143f67,0x3f2bbf723f7cbf48,0xbf553ef8bce6bede,0xbe803f2bbf6f3f7e
.quad 0xbf203f80bf20be64,0x3e64bf673f67be64,0x3e9bbf6d3f63be64,0x3ce63f3fbf7d3f08,0x3d663f35bf803f20,0xbe8ebf083f7cbf48,0xbed1bec43f6fbf67,0x3f023e8ebf633f72,0x3f358000bf353f80,0xbf3500003f35bf80,0xbf6a3ec43eb7bf67,0x3f5cbe8ebeeb3f72,0x3f80bf353d663f20,0xbf763f083e2cbf48,0xbf743f6dbeebbe64,0x3f80bf3f3e0f3f08
.quad 0x3f48bf803f48be64,0xbf7a3f67bedebe64,0xbf023f6dbf783f20,0x3f63bf7c3f30bde5,0x3e2cbf353f7cbf67,0xbf3f3f7ebf603ede,0x3e483ec4bf553f80,0x3f0ebf6d3f7bbf35,0xbf0800003f08bf67,0xbea93f48bf7e3f67,0x3f4dbec4be0f3f20,0x3dacbf143f6abf7e,0xbf763f35be8ebe64,0x3e2c3ea9bf3f3f7a,0x3f7fbf6d3f25be64,0xbed1bd663f02bf59
.quad 0x3e643f20bf803f20,0xbf20be643f67bf67,0xbeb7bef83f7bbf48,0x3f253e2cbf5c3f72,0x3ef83ea9bf6d3f67,0xbf2bbde53f51bf7a,0xbf1abe2c3f55bf7a,0x3f303d66bf443f7e,0x3f358000bf353f80,0xbf3500003f35bf80,0xbf4d3e2c3f0ebf7a,0x3f3abd66bf253f7e,0x3f60bea9bec43f67,0xbf3f3de53f14bf7a,0xbf6f3ef83e48bf48,0x3f44be2cbf023f72
.quad 0x3f7abf2000003f20,0xbf483e643edebf67,0xbf7f3f3fbe48bede,0x3f4dbe8ebeb73f59,0x3f80bf593ec43e64,0xbf513ea93e8ebf48,0xbf7b3f6dbf0e0000,0x3f55bec4be483f35,0x3f72bf7a3f35be64,0xbf593ede3de5bf20,0xbf633f80bf553ede,0x3f5cbef8bce63f08,0x3f51bf7e3f6dbf20,0xbf603f08bd66bede,0xbf3a3f76bf7b3f48,0x3f63bf143e0f3ea9
.quad 0x3f80,0x0,0xbf80,0x0,0x3f80,0x0,0xbf80,0x0,0x3f80,0x0,0xbf80,0x0,0x3f80,0x0,0xbf80,0x0
.quad 0x3f80,0x0,0xbf80,0x0,0x3f80,0x0,0xbf80,0x0,0x3f80,0x0,0xbf80,0x0,0x3f80,0x0,0xbf80,0x0
.quad 0x0,0x0,0x0,0x0,0x0,0x0,0x0,0x0,0x0,0x0,0x0,0x0,0x0,0x0,0x0,0x0
.quad 0x0,0x0,0x0,0x0,0x0,0x0,0x0,0x0,0x0,0x0,0x0,0x0,0x0,0x0,0x0,0x0
.quad 0xbede3f7abf488000,0x8000bf483f7abede,0xbf023f7cbf448000,0x3e48bf603f6fbea9,0xbf143f7ebf3f8000,0x3ec4bf723f60be64,0xbf253f80bf3a8000,0x3f0ebf7c3f4dbde5,0xbf353f80bf358000,0x3f35bf803f358000,0xbf443f80bf308000,0x3f55bf7c3f1a3de5,0xbf513f7ebf2b8000,0x3f6dbf723ef83e64,0xbf5c3f7cbf258000,0x3f7bbf603eb73ea9
.quad 0xbf673f7abf208000,0x3f80bf483e643ede,0xbf6f3f76bf1a8000,0x3f7bbf2b3dac3f08,0xbf763f72bf148000,0x3f6dbf08bd663f20,0xbf7b3f6dbf0e8000,0x3f55bec4be483f35,0xbf7e3f67bf088000,0x3f35be64bea93f48,0xbf803f60bf028000,0x3f0ebd66beeb3f59,0xbf803f59bef88000,0x3ec43de5bf143f67,0xbf7d3f51beeb8000,0x3e483e8ebf303f72
.quad 0x3ede3edebf7a3f48,0xbf4880003f48bf7a,0x3e0f3f2bbf803f20,0xbeebbec43f74bf59,0xbe2c3f59bf763ede,0xbd66bf353f80bf20,0xbeeb3f76bf5c3e64,0x3eb7bf6d3f6abea9,0xbf353f80bf358000,0x3f35bf803f358000,0xbf633f76bf02be64,0x3f6fbf6d3ed13ea9,0xbf7c3f59be8ebede,0x3f80bf353d663f20,0xbf7d3f2bbce6bf20,0x3f63bec4be9b3f59
.quad 0xbf673ede3e64bf48,0x3f208000bf203f7a,0xbf3a3e2c3eebbf67,0x3e803ec4bf5c3f7e,0xbef8bde53f2bbf7a,0xbe2c3f35bf7c3f67,0xbe48bec43f55bf80,0xbf0e3f6dbf7b3f35,0x3de5bf203f72bf7a,0xbf593f80bf593ede,0x3ed1bf513f7fbf67,0xbf7d3f6dbf1a3de5,0x3f2bbf723f7cbf48,0xbf763f35be8ebe64,0x3f5cbf803f6abf20,0xbf443ec43dacbf08
.quad 0x3f7abedebede3f7a,0xbf7a3f488000bf48,0x3f3a3d66bf4d3f7a,0xbf6a3e8e3f0ebf7e,0x3e8e3f08bf7c3f48,0xbef8bea93f6dbf67,0xbe803f60bf743ede,0x3e0fbf513f7bbf08,0xbf353f80bf358000,0x3f35bf803f358000,0xbf783f60be9bbede,0x3f7dbf513e483f08,0xbf763f083e2cbf48,0x3f60bea9bec43f67,0xbf303d663f1abf7a,0x3ed13e8ebf553f7e
.quad 0xbe64bede3f67bf7a,0xbe643f48bf803f48,0x3e9bbf513f80bf48,0xbf443f80bf553ea9,0x3f3fbf7e3f60bede,0xbf803f59bec4be64,0x3f7bbf6d3f0e8000,0xbf553ec43e48bf35,0x3f72bf203de53ede,0xbea9be643f35bf7a,0x3f25be2cbeb73f48,0x3e9bbf3f3f7bbf72,0x3e2c3ea9bf3f3f7a,0x3f51bf7e3f6dbf20,0xbeb73f3fbf783f7a,0x3f80bf603f0ebde5
.quad 0x3f48bf7a3ede3ede,0xbede3f7abf488000,0x3f7fbf14be803f67,0xbf783f51bdacbf35,0x3f2b3de5bf513f7a,0xbf513de53f2bbf80,0xbce63f3fbf7f3f20,0xbdacbf2b3f80bf35,0xbf353f80bf358000,0x3f35bf803f358000,0xbf803f3fbdacbf20,0x3f7fbf2bbce63f35,0xbf3f3de53f14bf7a,0x3f143de5bf3f3f80,0xbdacbf143f78bf67,0xbe803f51bf7f3f35
.quad 0x3f20bf7a3f67bede,0xbf673f7abf208000,0x3f7dbf603ed13e64,0xbf6a3ef83e0fbf35,0x3f51bea9be8e3f48,0xbe8ebea93f51bf80,0x3e483ec4bf553f80,0x3f0ebf6d3f7bbf35,0xbf083f67bf7e3f48,0x3f7ebf673f088000,0xbf783f76bf303e64,0x3f3abe8ebe803f35,0xbf603f08bd66bede,0xbd663f08bf603f80,0xbe9bbe2c3f1abf67,0xbf4d3f7cbf743f35
.quad 0x8000bf483f7abede,0x3ede3edebf7a3f48,0x3f55bf763ed13ede,0xbf1a3f80bf30bde5,0x3f6dbea9bef83f7a,0xbf7c3f083e8ebf67,0x3e483f14bf7d3f48,0xbe9bbef83f78bf59,0xbf353f80bf358000,0x3f35bf803f358000,0xbf7b3f143e0fbf48,0x3f74bef8be803f59,0xbec4bea93f60bf7a,0x3e2c3f08bf763f67,0x3f0ebf763f6abede,0xbf4d3f80bf3a3de5
.quad 0x3f80bf483e643ede,0xbf673ede3e64bf48,0x3f0e3d66bf253f7a,0xbce6bf143f74bf72,0xbec43f59bf803f48,0x3f60bf7e3f3fbe64,0xbf7b3f6dbf0e8000,0x3f55bec4be483f35,0xbf353e643ea9bf48,0xbde53f20bf723f7a,0x3e48bf2b3f74bf7a,0xbf6f3f7cbf443ea9,0x3f6dbf7e3f51bede,0xbf3f3ea93e2cbf20,0x3f55bef83ce63ede,0x3e80bf2b3f6fbf7e
.quad 0xbf4880003f48bf7a,0x3f7abedebede3f7a,0x3e9bbf6d3f63be64,0x3ce63f3fbf7d3f08,0x3f80bf35bd663f48,0xbf763f59be2cbf20,0x3ed13ec4bf6f3f67,0xbf02be8e3f63bf72,0xbf353f80bf358000,0x3f35bf803f358000,0xbf6a3ec43eb7bf67,0x3f5cbe8ebeeb3f72,0x3d66bf353f80bf48,0xbe8e3f59bf7c3f20,0x3f74bf6d3eeb3e64,0xbf803f3fbe0fbf08
.quad 0x3f208000bf203f7a,0xbe64bede3f67bf7a,0xbf023f6dbf783f20,0x3f63bf7c3f30bde5,0xbf7c3f35be2cbede,0x3f2bbde5bef83f67,0xbe48bec43f55bf80,0xbf0e3f6dbf7b3f35,0x3f59bf803f59bede,0xbf723f20bde5bede,0x3f4dbec4be0f3f20,0x3dacbf143f6abf7e,0xbe8e3f35bf763f7a,0x3f7cbf723f2bbe64,0xbf7f3f6dbf253e64,0x3ed13d66bf023f59
.quad 0xbf7a3f488000bf48,0x3f48bf7a3ede3ede,0xbeb7bef83f7bbf48,0x3f253e2cbf5c3f72,0x3f60bf723ec43ede,0xbf3f3f7ebf14be64,0x3f1a3e2cbf553f7a,0xbf30bd663f44bf7e,0xbf353f80bf358000,0x3f35bf803f358000,0xbf4d3e2c3f0ebf7a,0x3f3abd66bf253f7e,0x3ef8bf723f6dbede,0xbf2b3f7ebf513e64,0x3f6fbef8be483f48,0xbf443e2c3f02bf72
.quad 0xbe643f48bf803f48,0x3f20bf7a3f67bede,0xbf7f3f3fbe48bede,0x3f4dbe8ebeb73f59,0xbd66bf083f6dbf7a,0xbf143f72bf763f20,0x3f7bbf6d3f0e8000,0xbf553ec43e48bf35,0x3ea93e64bf353f7a,0x3f08bf673f7ebf48,0xbf633f80bf553ede,0x3f5cbef8bce63f08,0xbf143de53ec4bf48,0xbef83f59bf803f67,0x3f3abf763f7bbf48,0xbf633f14be0fbea9
.quad 0xbede3f7abf488000,0x8000bf483f7abede,0xbf5c3e2c3f25bf80,0x3f7bbef8beb73f72,0x3f14bf7e3f3f8000,0xbec43f72bf603e64,0x3f44bd66bf303f80,0xbf553e2c3f1abf7e,0xbf353f80bf358000,0x3f35bf803f358000,0xbf25bd663f3abf80,0x3f0e3e2cbf4d3f7e,0x3f51bf7e3f2b8000,0xbf6d3f72bef8be64,0x3f023e2cbf443f80,0xbe48bef83f6fbf72
.quad 0xbf673f7abf208000,0x3f80bf483e643ede,0xbeb7be8e3f4dbf80,0xbe483f3fbf7f3f59,0x3f76bf723f148000,0xbf6d3f083d66bf20,0x3e483ec4bf553f80,0x3f0ebf6d3f7bbf35,0xbf7e3f67bf088000,0x3f35be64bea93f48,0xbce6bef83f5cbf80,0xbf553f80bf633f08,0x3f80bf593ef88000,0xbec4bde53f14bf67,0xbe0f3f14bf633f80,0x3f7bbf763f3abea9
.quad 0x3ede3edebf7a3f48,0xbf4880003f48bf7a,0xbf7d3f3f3ce6bf48,0x3f63bf6d3e9b3f08,0x3e2cbf593f76bede,0x3d663f35bf803f20,0x3f63be8ebf023f7a,0xbf6f3ec43ed1bf72,0xbf353f80bf358000,0x3f35bf803f358000,0xbeebbe8e3f5cbf7a,0x3eb73ec4bf6a3f72,0x3f7cbf593e8e3ede,0xbf803f35bd66bf20,0xbe0f3f3fbf803f48,0x3eebbf6d3f74bf08
.quad 0xbf673ede3e64bf48,0x3f208000bf203f7a,0x3f30bf7c3f63bede,0xbf783f6dbf02bde5,0x3ef83de5bf2b3f7a,0x3e2cbf353f7cbf67,0xbf7b3f6dbf0e8000,0x3f55bec4be483f35,0x3de5bf203f72bf7a,0xbf593f80bf593ede,0x3f6abf143dac3ede,0xbe0fbec43f4dbf7e,0xbf2b3f72bf7c3f48,0x3f76bf353e8e3e64,0xbf023d663ed1bf48,0xbf253f6dbf7f3f59
.quad 0x3f7abedebede3f7a,0xbf7a3f488000bf48,0xbf303f80bf1abe64,0x3ed1bf763f55bde5,0xbe8ebf083f7cbf48,0x3ef83ea9bf6d3f67,0x3f78bef8be9b3f67,0xbf7d3f143e48bf59,0xbf353f80bf358000,0x3f35bf803f358000,0xbe80bef83f74bf67,0x3e0f3f14bf7b3f59,0x3f76bf08be2c3f48,0xbf603ea93ec4bf67,0xbf3a3f80bf4d3e64,0x3f6abf763f0e3de5
.quad 0xbe64bede3f67bf7a,0xbe643f48bf803f48,0x3f74bf14bce63f20,0xbf253d663f0ebf72,0xbf3f3f7ebf603ede,0x3f80bf593ec43e64,0xbe48bec43f55bf80,0xbf0e3f6dbf7b3f35,0x3f72bf203de53ede,0xbea9be643f35bf7a,0xbf443f7cbf6f3f20,0x3f74bf2b3e483ea9,0xbe2cbea93f3fbf7a,0xbf513f7ebf6d3f20,0x3f6fbf2b3e803e64,0x3ce6bef83f55bf7e
.quad 0x3f48bf7a3ede3ede,0xbede3f7abf488000,0xbdac3f51bf783ede,0xbe80bf143f7fbf35,0xbf2bbde53f51bf7a,0x3f51bde5bf2b3f80,0x3f80bf2bbdac3f48,0xbf7f3f3fbce6bf35,0xbf353f80bf358000,0x3f35bf803f358000,0xbce6bf2b3f7fbf48,0xbdac3f3fbf803f35,0x3f3fbde5bf143f7a,0xbf14bde53f3fbf80,0xbf7f3f51be80bede,0x3f78bf14bdac3f35
.quad 0x3f20bf7a3f67bede,0xbf673f7abf208000,0x3e0f3ef8bf6a3f7a,0x3ed1bf603f7dbf35,0xbf513ea93e8ebf48,0x3e8e3ea9bf513f80,0x3f7bbf6d3f0e8000,0xbf553ec43e48bf35,0xbf083f67bf7e3f48,0x3f7ebf673f088000,0xbe80be8e3f3abf7a,0xbf303f76bf783f35,0x3f60bf083d663ede,0x3d66bf083f60bf80,0xbf743f7cbf4d3ede,0x3f1abe2cbe9b3f35
.quad 0x8000bf483f7abede,0x3ede3edebf7a3f48,0x3f0e3e8ebf6a3f67,0xbf4d3d663f3abf7e,0xbf6d3ea93ef8bf7a,0x3f7cbf08be8e3f67,0x3f7bbf513e0f3f20,0xbf743f60be80bf08,0xbf353f80bf358000,0x3f35bf803f358000,0x3e48bf513f7dbf20,0xbe9b3f60bf783f08,0x3ec43ea9bf603f7a,0xbe2cbf083f76bf67,0xbf553e8e3ed1bf67,0x3f1a3d66bf303f7e
.quad 0x3f80bf483e643ede,0xbf673ede3e64bf48,0xbf553f80bf443e64,0x3f80bf513e9b3ea9,0x3ec4bf593f80bf48,0xbf603f7ebf3f3e64,0x3e483ec4bf553f80,0x3f0ebf6d3f7bbf35,0xbf353e643ea9bf48,0xbde53f20bf723f7a,0x3f7bbf3f3e9b3e64,0xbeb7be2c3f25bf72,0xbf6d3f7ebf513ede,0x3f3fbea9be2c3f20,0x3f0ebf603f80bf67,0xbf783f3fbeb7bde5
.quad 0xbf4880003f48bf7a,0x3f7abedebede3f7a,0x3f74bec4beeb3f7a,0xbf803f2b3e0fbf59,0xbf803f353d66bf48,0x3f76bf593e2c3f20,0x3f6abf6d3eb73ede,0xbf5c3f76beebbea9,0xbf353f80bf358000,0x3f35bf803f358000,0x3ed1bf6d3f6fbede,0xbf023f76bf633ea9,0xbd663f35bf803f48,0x3e8ebf593f7cbf20,0xbe9bbec43f63bf7a,0xbce63f2bbf7d3f59
.quad 0x3f208000bf203f7a,0xbe64bede3f67bf7a,0xbf5c3ec43e80bf48,0x3eeb3e2cbf3a3f7e,0x3f7cbf353e2c3ede,0xbf2b3de53ef8bf67,0xbf7b3f6dbf0e8000,0x3f55bec4be483f35,0x3f59bf803f59bede,0xbf723f20bde5bede,0xbf1a3f6dbf7d3f48,0x3f7fbf513ed13de5,0x3e8ebf353f76bf7a,0xbf7c3f72bf2b3e64,0x3dac3ec4bf443f7a,0x3f6abf803f5cbf08
.quad 0xbf7a3f488000bf48,0x3f48bf7a3ede3ede,0x3f6fbf603e483f20,0xbf443f7cbf02bea9,0xbf603f72bec4bede,0x3f3fbf7e3f143e64,0x3f4dbf7c3f0e3e64,0xbf3a3f80bf25bde5,0xbf353f80bf358000,0x3f35bf803f358000,0x3f1abf7c3f55be64,0xbf303f80bf443de5,0xbef83f72bf6d3ede,0x3f2bbf7e3f51be64,0x3eb7bf603f7bbf20,0xbf253f7cbf5c3ea9
.quad 0xbe643f48bf803f48,0x3f20bf7a3f67bede,0x3dacbf2b3f7bbf67,0xbf1a3f76bf6f3f08,0x3d663f08bf6d3f7a,0x3f14bf723f76bf20,0xbe48bec43f55bf80,0xbf0e3f6dbf7b3f35,0x3ea93e64bf353f7a,0x3f08bf673f7ebf48,0xbeebbd663f0ebf67,0xbf023f60bf803f59,0x3f14bde5bec43f48,0x3ef8bf593f80bf67,0xbf303e8e3e48bf20,0xbeeb3f51bf7d3f72
.quad 0x8000,0x0,0x8000,0x0,0x8000,0x0,0x8000,0x0,0x8000,0x0,0x8000,0x0,0x8000,0x0,0x8000,0x0
.quad 0x8000,0x0,0x8000,0x0,0x8000,0x0,0x8000,0x0,0x8000,0x0,0x8000,0x0,0x8000,0x0,0x8000,0x0
.quad 0x0,0x0,0x0,0x0,0x0,0x0,0x0,0x0,0x0,0x0,0x0,0x0,0x0,0x0,0x0,0x0
.quad 0x0,0x0,0x0,0x0,0x0,0x0,0x0,0x0,0x0,0x0,0x0,0x0,0x0,0x0,0x0,0x0
.quad 0x3f62be48bf223f80,0xbf7f3f0e3e95bf6d,0x3f57be0fbf283f80,0xbf753ed13ed8bf76,0x3f4abdacbf2d3f80,0xbf623e803f0bbf7c,0x3f3cbce6bf323f80,0xbf463dac3f28bf80,0x3f2d3ce6bf383f80,0xbf22bdac3f41bf80,0x3f1d3dacbf3c3f80,0xbef1be803f57bf7c,0x3f0b3e0fbf413f80,0xbe95bed13f68bf76,0x3ef13e48bf463f80,0xbdc9bf0e3f75bf6d
.quad 0x3ecb3e80bf4a3f80,0x3dc9bf303f7dbf60,0x3ea23e9bbf4f3f80,0x3e95bf4d3f80bf51,0x3e723eb7bf533f80,0x3ef1bf633f7ebf3f,0x3e1d3ed1bf573f80,0x3f22bf743f77bf2b,0x3d8f3eebbf5b3f80,0x3f46bf7d3f6bbf14,0xbc663f02bf5e3f80,0x3f62bf803f5bbef8,0xbdc93f0ebf623f80,0x3f75bf7b3f46bec4,0xbe3a3f1abf653f80,0x3f7fbf6f3f2dbe8e
.quad 0x3f75bf553dc93f35,0xbf463f7bbef1bec4,0x3f80bf25be1d3f59,0xbf773f55be01bf2b,0x3f73bed1becb3f72,0xbf7d3f0e3e72bf60,0x3f4fbe0fbf1d3f7e,0xbf573e483f11bf7c,0x3f173e0fbf4a3f7e,0xbf0bbe483f53bf7c,0x3ea23ed1bf6b3f72,0xbe1dbf0e3f79bf60,0x3c663f25bf7d3f59,0x3e87bf553f7ebf2b,0xbe953f55bf7f3f35,0x3f22bf7b3f62bec4
.quad 0xbf113f74bf703f08,0x3f65bf7b3f28bd66,0xbf4a3f80bf533ea9,0x3f80bf553eb03e8e,0xbf703f78bf283de5,0x3f6ebf0ebc663f14,0xbf803f5cbee5bde5,0x3f32be48bebd3f51,0xbf773f30be56bea9,0x3eb03e48bf2d3f76,0xbf573eeb3d2cbf08,0xbd8f3f0ebf653f80,0xbf223e483e95bf35,0xbef13f55bf7f3f6d,0xbebdbdac3f05bf59,0xbf4a3f7bbf773f3f
.quad 0x3ef1bf7b3f468000,0xbdc93f55bf753ec4,0x3f5bbf743ecb3ede,0xbf2d3f80bf22be2c,0x3f80bf30bd8f3f48,0xbf7c3f4dbdc9bf2b,0x3f5ebe80bf053f7a,0xbf653e9b3ef1bf76,0x3efe3e80bf5b3f7a,0xbee5be9b3f62bf76,0xbc663f30bf7f3f48,0x3e3abf4d3f7fbf2b,0xbf053f74bf6b3ede,0x3f3cbf803f46be2c,0xbf623f7bbf220000,0x3f7fbf553e953ec4
.quad 0xbf803f44be56bede,0x3f5bbeb7be953f51,0xbf573eb73e87bf48,0x3ebd3e80bf463f80,0xbee5be0f3f2dbf7a,0xbe873f44bf7f3f60,0x3d8fbf1a3f70bf7a,0xbf4a3f7fbf623ef8,0x3f11bf6a3f7ebf48,0xbf803f5cbef1bd66,0x3f68bf7f3f53bede,0xbf4f3ed13dc9bf14,0x3f7fbf553ef18000,0xbe95be483f22bf6d,0x3f4fbeeb3c663ede,0x3eb0bf3a3f75bf7c
.quad 0xbe95bf0e3f7fbf35,0x3f223e48bf623f6d,0x3ee5bf783f53bde5,0xbe3a3f5cbf733ec4,0x3f70bf633e873f08,0xbf5e3f74bed8bec4,0x3f6bbeb7bed83f72,0xbf703ed13ebdbf6d,0x3ecb3eb7bf683f72,0xbeb0bed13f6ebf6d,0xbeb03f63bf773f08,0x3efebf743f68bec4,0xbf653f78bf11bde5,0x3f7cbf5c3ea23ec4,0xbf753f0e3dc9bf35,0x3f46be48bef13f6d
.quad 0xbefebe0f3f38bf7e,0x3c663f1abf773f6d,0x3e72bf443f7fbf59,0xbf413f7fbf5b3ec4,0x3f57bf803f4fbea9,0xbf7d3f3abe56bec4,0x3f7cbf3a3e723ea9,0xbf05bce63f11bf6d,0x3f17bdacbee53f59,0x3ea2bf443f7dbf6d,0xbe013f1abf6b3f7e,0x3f6ebf7d3f4abec4,0xbf463f7bbf753f35,0x3f62bf0e3dc93ec4,0xbf7f3f5cbf0b3de5,0x3e563e80bf283f6d
.quad 0xbf623e483f22bf80,0x3f7fbf0ebe953f6d,0xbdc9bf303f80bf20,0x3ebd3eebbf793f51,0x3f46bf7d3f113e64,0xbf283f80bf32bd66,0x3f75beebbea23f67,0xbf793f023e87bf60,0x3e953eebbf733f67,0xbe72bf023f77bf60,0xbf223f7dbf533e64,0x3f41bf803f38bd66,0xbf7f3f30bd2cbf20,0x3f6ebeebbe723f51,0xbef1be483f46bf80,0x3dc93f0ebf753f6d
.quad 0x3ef1bf6a3f79bf20,0xbf573f7fbf3c3e2c,0x3f7fbf5c3ecb3e64,0xbf5e3ed13e56bf3f,0x3f22bdacbefe3f67,0x3d2cbf1a3f73bf76,0xbe953f44bf7e3f67,0x3f68bf7d3f41be8e,0xbf753f78bf323e64,0x3f4abeb7be3a3f2b,0xbf463eb73e1dbf20,0xbe3a3f25bf703f7c,0x3dc9bf0e3f62bf80,0xbf753f7bbf463ec4,0x3f62bf803f68bf20,0xbf323e9b3e1dbf14
.quad 0xbf753f55bdc9bf35,0x3f46bf7b3ef13ec4,0xbf1dbe483f5ebf72,0x3f4fbdacbf323f80,0x3f05bf7b3f4fbde5,0xbebd3f6fbf653e8e,0x3f7cbf0ebe563f59,0xbf7e3f1a3e1dbf51,0x3e3a3f0ebf7a3f59,0xbe01bf1a3f7dbf51,0xbf5b3f7bbf17bde5,0x3f6ebf6f3ee53e8e,0xbf4a3e483efebf72,0x3f173dacbf383f80,0x3e95bf553f7fbf35,0xbf223f7bbf623ec4
.quad 0x3f7fbf553ea23ea9,0xbf683eeb3e3abf3f,0x3ed83e48bf3c3f7e,0x3e3abf3a3f7ebf60,0xbf323f7bbf6b3f08,0x3f7fbf5c3ed83e2c,0xbf6b3f0ebc66bf08,0x3ea23e80bf3c3f7c,0x3d2cbf0e3f68bf7e,0xbf573f80bf5e3ef8,0x3f73bf7b3f41bea9,0xbf3c3e9b3e56bf2b,0x3f22be48be953f35,0x3ef1bf553f7fbf6d,0xbefe3f55bf7e3f72,0x3f79bf443ecb3d66
.quad 0xbef13f7bbf460000,0x3dc9bf553f75bec4,0xbf703eb73ef1bf7a,0x3f7fbf1abe563f60,0x3e56bf5c3f75bede,0xbd2c3f44bf7e3f14,0x3f7fbf25bdc93f48,0xbf803f303d2cbf3f,0x3d8f3f25bf7f3f48,0xbc66bf303f80bf3f,0xbf7a3f5cbe95bede,0x3f80bf443e013f14,0xbeb0beb73f62bf7a,0x3d8f3f1abf7a3f60,0x3f62bf7b3f228000,0xbf7f3f55be95bec4
.quad 0x3f173ce6bf223f7a,0xbe01bf023f6ebf76,0xbf383f7dbf623ede,0x3f7dbf633ee53e2c,0xbf4a3e9b3e95bf48,0x3e3a3ed1bf5b3f80,0x3efebf633f7fbf48,0xbf7a3f6fbf173d66,0x3f6ebf1a3dc93ede,0xbe72be9b3f41bf7c,0xbe723f30bf753f7a,0x3f77bf783f38be8e,0xbf7f3f55bef10000,0x3e953e48bf223f6d,0xbd2cbed13f46bf7a,0xbf733f7dbf533ef8
.quad 0x3e953f0ebf7f3f35,0xbf22be483f62bf6d,0xbf7a3f4dbd8fbf35,0x3f62bf6f3eb03ef8,0xbe01bf253f80bf35,0x3e953f02bf7a3f51,0x3f80bf3a3c663f35,0xbf7f3f44bd8fbf2b,0xbd2c3f3abf803f35,0x3dc9bf443f7fbf2b,0xbf7e3f253d2cbf35,0x3f75bf02be563f51,0x3e56bf4d3f7fbf35,0xbef13f6fbf703ef8,0x3f75bf0ebdc93f35,0xbf463e483ef1bf6d
.quad 0xbebd3f5cbf7e3f35,0x3f46bf803f4fbe8e,0xbf653eeb3e1dbf35,0x3ef13e0fbf323f7c,0x3f05bf6a3f7cbf35,0xbf753f74bf1d3d66,0x3f4fbeb7be563f35,0xbdc9beeb3f5ebf80,0xbf283f74bf793f35,0x3f7fbf4d3ebd3e2c,0xbf323e803e87bf35,0xbe953f3abf793f76,0x3f46bf7b3f75bf35,0xbf623f0ebdc9bec4,0x3f11be0fbea23f35,0x3f22bf6a3f80bf60
.quad 0x3f62be48bf223f80,0xbf7f3f0e3e95bf6d,0xbf383f7fbf17be64,0x3efebf7b3f4abd66,0xbee5beb73f6ebf67,0x3f173e48bf5b3f76,0x3f7dbf4d3e013f20,0xbf7a3f55be3abf14,0xbe1d3f4dbf7e3f20,0x3e56bf553f7cbf14,0xbf653eb73ebdbf67,0x3f4fbe48bf053f76,0x3f32bf7f3f4fbe64,0xbf5e3f7bbf1dbd66,0x3ef13e48bf463f80,0xbdc9bf0e3f75bf6d
.quad 0xbf7c3f63bed8be64,0x3f73bf0ebd8f3f2b,0x3e01bf303f7cbf67,0xbf2d3f7bbf683ef8,0x3f68bf02bd8f3f20,0xbecbbe483f38bf7c,0xbf2d3f78bf733f20,0x3f80bf553ecb3e2c,0xbefebce63f0bbf67,0xbed83f55bf803f60,0x3f7abf743f2dbe64,0xbf283e483ea2bf3f,0xbdc93f0ebf623f80,0x3f75bf7b3f46bec4,0xbf6b3f25be72be64,0xbe013f0ebf5e3f80
.quad 0x3f75bf553dc93f35,0xbf463f7bbef1bec4,0xbe723f63bf6e3ea9,0xbd2cbf3a3f7fbf14,0xbf38bce63f41bf7e,0x3f53be0fbf223f80,0x3f77bf5c3e723f08,0xbf733f63be95bef8,0xbe873f5cbf793f08,0x3ea2bf633f75bef8,0xbf323ce63f28bf7e,0x3f113e0fbf463f80,0x3f79bf633ebd3ea9,0xbf803f3abdc9bf14,0xbe953f55bf7f3f35,0x3f22bf7b3f62bec4
.quad 0xbf2d3dac3f0bbf72,0x3e723ed1bf623f7c,0x3f7abf6a3efe3de5,0xbf6b3f023dc9bf2b,0xbea23f4dbf803f59,0x3f5ebf7f3f46be8e,0xbf283e0f3ed8bf59,0xbe013f25bf753f76,0x3f7cbf6f3f1dbde5,0xbf383e803e95bf3f,0xbeb03f44bf7c3f72,0x3f7dbf6f3f22be2c,0xbf223e483e95bf35,0xbef13f55bf7f3f6d,0x3f7dbf743f38bea9,0xbed8bce63ef1bf51
.quad 0x3ef1bf7b3f468000,0xbdc93f55bf753ec4,0x3ea23f02bf7c3f48,0xbf11be803f65bf6d,0xbf683e9b3efebf7a,0x3f77beebbeb03f6d,0x3f6ebf6a3eb03ede,0xbf683f6fbecbbec4,0xbebd3f6abf703ede,0x3ed8bf6f3f6bbec4,0xbed8be9b3f5ebf7a,0x3e873eebbf703f6d,0x3f73bf02be3a3f48,0xbf533e803ee5bf6d,0xbf623f7bbf220000,0x3f7fbf553e953ec4
.quad 0x3e87bf4d3f80bf48,0xbf323f7dbf5e3ec4,0x3f053dacbf283f7a,0x3d8fbf253f79bf6d,0xbf7a3f30be1dbede,0x3f17bce6bf0b3f6d,0x3f53bf803f5bbede,0xbf793f30be3abec4,0xbe1d3f25bf733f7a,0x3f65bf7f3f4fbec4,0xbf1d3e0f3ebdbf48,0xbecb3f4dbf7e3f6d,0x3f7fbf553ef18000,0xbe95be483f22bf6d,0xbf413f78bf7a3f48,0x3f57bf023d8f3ec4
.quad 0xbe95bf0e3f7fbf35,0x3f223e48bf623f6d,0x3f46bce6bf3c3f7e,0xbf6b3e9b3f05bf7c,0xbf7f3f1a3e3abf59,0x3f7fbf3abc663f3f,0x3f62bf743ee53ea9,0xbf5b3f78befebe8e,0xbef13f74bf653ea9,0x3f05bf783f5ebe8e,0xbdc9bf1a3f7cbf59,0xbd8f3f3abf803f3f,0x3f223ce6bf2d3f7e,0xbecbbe9b3f5bbf7c,0xbf753f0e3dc9bf35,0x3f46be48bef13f6d
.quad 0x3f75bf6f3f053de5,0xbf7a3f25bd2cbf14,0xbf223f78bf6e3f08,0x3f77bf6f3f0b3d66,0x3dc9bf253f77bf72,0xbf3c3f7dbf653ef8,0x3ef13dacbf1d3f72,0x3eb0bf4d3f7fbf60,0xbf623f023c66bf08,0x3e013ed1bf533f80,0x3f7fbf6a3f17bde5,0xbf113dac3ed8bf51,0xbf463f7bbf753f35,0x3f62bf0e3dc93ec4,0x3e95bf303f70bf7e,0xbf803f63bf173e2c
.quad 0xbf623e483f22bf80,0x3f7fbf0ebe953f6d,0x3f7ebf0ebe873f67,0xbf7d3f44bc66bf3f,0xbf793f55be1dbf20,0x3f6bbf6a3ea23ef8,0x3f53bf7b3f0b3e64,0xbf4a3f7dbf17be2c,0xbf113f7bbf573e64,0x3f1dbf7d3f4fbe2c,0x3e72bf553f7dbf20,0xbecb3f6abf733ef8,0x3e013f0ebf773f67,0x3e1dbf443f80bf3f,0xbef1be483f46bf80,0x3dc93f0ebf753f6d
.quad 0x3f41be48bee53f67,0xbeb0be9b3f53bf80,0xbf703f0e3d2cbf20,0x3f113ce6bf1d3f76,0x3f80bf553ebd3e64,0xbf413e803eb0bf51,0xbf6e3f7bbf383e64,0x3f65bf02bd2c3f14,0x3f3cbf7b3f70bf20,0xbf7a3f3abe87be8e,0xbee53f55bf7f3f67,0x3f80bf633f0bbd66,0x3dc9bf0e3f62bf80,0xbf753f7bbf463ec4,0x3e873e48bf1d3f67,0x3f5bbf7f3f6ebf2b
.quad 0xbf753f55bdc9bf35,0x3f46bf7b3ef13ec4,0x3f68bf6a3e953f08,0xbf413f7dbf0bbe8e,0xbf573f78bef1bea9,0x3f3cbf7f3f1d3e2c,0x3f41bf7f3f223de5,0xbf383f80bf2dbd66,0xbf283f7fbf463de5,0x3f32bf803f3cbd66,0x3f0bbf783f62bea9,0xbf2d3f7fbf4a3e2c,0xbed83f6abf753f08,0x3f28bf7d3f57be8e,0x3e95bf553f7fbf35,0xbf223f7bbf623ec4
.quad 0xbe1d3f3abf7f3f59,0x3f1dbf783f6bbef8,0x3c66bf1a3f75bf72,0xbf173f74bf733f14,0x3e013eebbf623f7e,0x3f11bf6f3f79bf2b,0xbe87be9b3f46bf7e,0xbf0b3f6abf7d3f3f,0x3ecb3e0fbf223f72,0x3f05bf633f7fbf51,0xbf053ce63ef1bf59,0xbefe3f5cbf803f60,0x3f22be48be953f35,0x3ef1bf553f7fbf6d,0xbf3c3eb73dc9bf08,0xbee53f4dbf7c3f76
.quad 0x0,0x0,0x8000,0x0,0x0,0x0,0x8000,0x0,0x0,0x0,0x8000,0x0,0x0,0x0,0x8000,0x0
.quad 0x0,0x0,0x8000,0x0,0x0,0x0,0x8000,0x0,0x0,0x0,0x8000,0x0,0x0,0x0,0x8000,0x0
.quad 0x0,0x0,0x0,0x0,0x0,0x0,0x0,0x0,0x0,0x0,0x0,0x0,0x0,0x0,0x0,0x0
.quad 0x0,0x0,0x0,0x0,0x0,0x0,0x0,0x0,0x0,0x0,0x0,0x0,0x0,0x0,0x0,0x0
.quad 0xbef13f7bbf468000,0x3dc9bf553f75bec4,0xbf0b3f7dbf418000,0x3e95bf6a3f68be8e,0xbf1d3f7fbf3c8000,0x3ef1bf783f57be2c,0xbf2d3f80bf388000,0x3f22bf7f3f41bd66,0xbf3c3f80bf328000,0x3f46bf7f3f283d66,0xbf4a3f7fbf2d8000,0x3f62bf783f0b3e2c,0xbf573f7dbf288000,0x3f75bf6a3ed83e8e,0xbf623f7bbf228000,0x3f7fbf553e953ec4
.quad 0xbf6b3f78bf1d8000,0x3f7fbf3a3e1d3ef8,0xbf733f74bf178000,0x3f75bf1a3c663f14,0xbf793f6fbf118000,0x3f62beebbe013f2b,0xbf7d3f6abf0b8000,0x3f46be9bbe873f3f,0xbf7f3f63bf058000,0x3f22be0fbecb3f51,0xbf803f5cbefe8000,0x3ef13ce6bf053f60,0xbf7f3f55bef18000,0x3e953e48bf223f6d,0xbf7c3f4dbee58000,0x3dc93eb7bf3c3f76
.quad 0x3e953f0ebf7f3f35,0xbf22be483f62bf6d,0xbc663f44bf7d3f08,0xbe87bf0e3f7ebf3f,0xbea23f6abf6b3ea9,0x3e1dbf553f79bef8,0xbf173f7dbf4a3de5,0x3f0bbf7b3f53be2c,0xbf4f3f7dbf1dbde5,0x3f57bf7b3f113e2c,0xbf733f6abecbbea9,0x3f7dbf553e723ef8,0xbf803f44be1dbf08,0x3f77bf0ebe013f3f,0xbf753f0e3dc9bf35,0x3f46be48bef13f6d
.quad 0xbf533e9b3eb0bf59,0x3ee53e48bf413f80,0xbf1d3ce63f11bf72,0x3d2c3f0ebf703f76,0xbeb0be803f41bf7e,0xbebd3f55bf803f51,0xbd2cbf023f65bf7e,0xbf383f7bbf6e3f14,0x3e87bf3a3f7abf72,0xbf703f7bbf3c3e8e,0x3f0bbf633f80bf59,0xbf7f3f55bee5bd66,0x3f46bf7b3f75bf35,0xbf623f0ebdc9bec4,0x3f6ebf7f3f5bbf08,0xbf1d3e483e87bf2b
.quad 0x3f62be48bf223f80,0xbf7f3f0e3e95bf6d,0x3f053e9bbf6b3f67,0xbf3cbce63f46bf7c,0x3c663f3abf7f3f20,0xbe3abf1a3f7fbf3f,0xbefe3f78bf5b3e64,0x3ee5bf743f62be8e,0xbf5e3f78bf05be64,0x3f65bf743ef13e8e,0xbf803f3abd8fbf20,0x3f7cbf1abdc93f3f,0xbf5b3e9b3ecbbf67,0x3f2dbce6bf223f7c,0xbef1be483f46bf80,0x3dc93f0ebf753f6d
.quad 0x3d2cbf253f7abf67,0xbf053f6fbf753f14,0x3f0bbf6f3f77bf20,0xbf6e3f78bf223d66,0x3f65bf7d3f3cbe64,0xbf773f25bdc9bef8,0x3f7fbf4d3eb03e64,0xbf1d3dac3ef1bf60,0x3f53bed1be013f20,0xbc66bf023f62bf80,0x3ed83dacbf113f67,0x3f17bf6a3f7fbf51,0xbdc93f0ebf623f80,0x3f75bf7b3f46bec4,0xbf173f63bf803f67,0x3f70bf303e953e2c
.quad 0x3f75bf553dc93f35,0xbf463f7bbef1bec4,0x3f65be80bf113f7e,0xbf7c3f023ea2bf6d,0x3eb03eebbf773f59,0xbefebe9b3f68bf6d,0xbecb3f6fbf683ea9,0x3eb0bf6a3f6ebec4,0xbf6b3f6fbed8bea9,0x3f70bf6a3ebd3ec4,0xbf703eeb3e87bf59,0x3f5ebe9bbed83f6d,0xbee5be803f53bf7e,0x3e3a3f02bf733f6d,0x3e95bf553f7fbf35,0xbf223f7bbf623ec4
.quad 0x3f5ebf7d3f32bde5,0xbf803f4dbe87bec4,0x3f79bf253d8f3f08,0xbf283dac3f05bf6d,0x3f0b3ce6bf173f72,0x3e1dbf303f7abf6d,0xbe3a3f30bf793f72,0x3f5bbf803f53bec4,0xbf4f3f7fbf653f08,0x3f73bf253e1d3ec4,0xbf7e3f4dbecbbde5,0x3ebd3e0fbf1d3f6d,0xbf223e483e95bf35,0xbef13f55bf7f3f6d,0x3d8fbf023f57bf7e,0xbf7a3f78bf413ec4
.quad 0x3ef1bf7b3f468000,0xbdc93f55bf753ec4,0x3f7fbf3abd2c3f48,0xbf6e3f63be72bf14,0x3f223e0fbf533f7a,0xbf413ce63f38bf80,0xbe953f63bf733ede,0x3e72bf5c3f77bef8,0xbf753f63bea2bede,0x3f79bf5c3e873ef8,0xbf463e0f3f11bf7a,0x3f283ce6bf323f80,0x3dc9bf3a3f80bf48,0xbebd3f63bf793f14,0x3f62bf7b3f228000,0xbf7f3f55be95bec4
.quad 0x3f62bed1be723f48,0xbf0bbdac3f2dbf7c,0x3dc93f02bf6b3f7a,0x3efebf6a3f7abf2b,0xbf463f7fbf5e3ede,0x3f80bf4d3ea23e8e,0xbf753f25be01bede,0x3ed83e0fbf283f76,0xbe95be803f38bf7a,0xbf1d3f6fbf7c3f3f,0x3f22bf6f3f7dbf48,0xbf7c3f44beb0be2c,0x3f7fbf553ef18000,0xbe95be483f22bf6d,0x3ef1bce6bed83f48,0x3f38bf743f7dbf51
.quad 0xbe95bf0e3f7fbf35,0x3f223e48bf623f6d,0x3f4abf7b3efe3ea9,0xbf173f7fbf38bd66,0x3f5bbe48bf173f7e,0xbf6e3eb73ee5bf76,0xbe3a3f55bf7a3f08,0x3e01bf4d3f7dbf14,0xbf7c3f55be56bf08,0x3f7ebf4d3e1d3f14,0xbf05be483f4fbf7e,0x3ebd3eb7bf653f76,0x3f1dbf7b3f5ebea9,0xbf4f3f7fbf323d66,0x3f75bf0ebdc93f35,0xbf463e483ef1bf6d
.quad 0x3d8f3f0ebf733f72,0x3ed8bf633f7cbf2b,0xbf683f7bbf2d3de5,0x3f7cbf303e013ef8,0xbf383e483ecbbf59,0x3d8f3f02bf683f7c,0x3ecbbf553f80bf59,0xbf733f78bf2d3e2c,0x3f80bf553ed83de5,0xbf0b3ce63efebf60,0x3ea23e48bf283f72,0x3f2dbf743f7abf3f,0xbf463f7bbf753f35,0x3f62bf0e3dc93ec4,0xbf5e3f0ebe01bea9,0xbe723f25bf6b3f80
.quad 0xbf623e483f22bf80,0x3f7fbf0ebe953f6d,0x3eb0bf6f3f62be64,0xbd8f3f4dbf7a3ef8,0x3f7abf02be953f67,0xbf803f253e01bf51,0xbd8f3f44bf7f3f20,0x3c66bf3a3f80bf2b,0xbf7f3f44bdc9bf20,0x3f80bf3a3d2c3f2b,0xbe56bf023f75bf67,0x3d2c3f25bf7e3f51,0x3f70bf6f3ef13e64,0xbf7f3f4dbe56bef8,0x3ef13e48bf463f80,0xbdc9bf0e3f75bf6d
.quad 0xbf4f3f80bf463e64,0x3f7ebf5c3ebd3e8e,0xbf323e0f3ef1bf67,0x3e1d3eebbf653f7c,0x3f1dbf743f75bf20,0xbf7c3f6abf05bd66,0x3f5ebeebbdc93f20,0xbe56beb73f4fbf80,0xbebd3f4dbf7f3f67,0x3f79bf743f28be2c,0xbf793f3abe95be64,0x3e873e80bf323f76,0x3dc9bf0e3f62bf80,0xbf753f7bbf463ec4,0x3f80bf6a3f22be64,0xbea2be0f3f11bf60
.quad 0xbf753f55bdc9bf35,0x3f46bf7b3ef13ec4,0xbe56bf1a3f7fbf35,0x3ef13eb7bf703f60,0x3f7ebf443d2c3f35,0xbf753f5cbe56bf14,0x3d2c3f30bf803f35,0xbdc9bf253f7fbf3f,0xbf803f303c66bf35,0x3f7fbf25bd8f3f3f,0x3e01bf443f80bf35,0xbe953f5cbf7a3f14,0x3f7abf1abd8f3f35,0xbf623eb73eb0bf60,0xbe953f55bf7f3f35,0x3f22bf7b3f62bec4
.quad 0xbf6e3f023e01bf35,0x3f22bce6bf173f76,0x3ee5bf633f7dbf35,0xbf623f7dbf383e2c,0x3f5bbed1be3a3f35,0xbe95be9b3f4abf80,0xbf173f6fbf7a3f35,0x3f7fbf633efe3d66,0xbf413e9b3e72bf35,0xbdc93f1abf6e3f7c,0x3f38bf783f77bf35,0xbf753f30be72be8e,0x3f22be48be953f35,0x3ef1bf553f7fbf6d,0xbf533f7dbf733f35,0x3f46bed1bd2c3ef8
.quad 0xbef13f7bbf468000,0x3dc9bf553f75bec4,0xbf32bdac3f4fbf7a,0x3f5ebe48bf1d3f80,0x3f65bf6f3ebd3ede,0xbf4f3f7bbf05be8e,0x3e1d3f1abf7e3f48,0xbe56bf0e3f7cbf51,0xbf7d3f1a3e01bf48,0x3f7abf0ebe3a3f51,0x3ee5bf6f3f6ebede,0xbf173f7bbf5b3e8e,0x3f38bdacbf173f7a,0xbefebe483f4abf80,0xbf623f7bbf228000,0x3f7fbf553e953ec4
.quad 0xbe3abeeb3f68bf7a,0xbea23f55bf7f3f3f,0x3f7ebf3a3e3a3ede,0xbf3c3e483ed8bf60,0xbed83f5cbf7f3f48,0x3f6bbf7b3f32be2c,0xbf3c3e803ea2bf48,0xbc663f0ebf6b3f7c,0x3f5ebf803f57bede,0xbf683f0ebd2cbef8,0x3e563e9bbf3c3f7a,0x3f41bf7b3f73bf2b,0xbf7f3f55bef18000,0x3e953e48bf223f6d,0x3ecbbf443f79bf7a,0xbf7e3f55befe3d66
.quad 0x3e953f0ebf7f3f35,0xbf22be483f62bf6d,0xbf793eeb3ebdbf72,0x3f80bf30bdc93f51,0x3f32bf803f283de5,0xbf113f7dbf463d66,0x3e873f02bf793f59,0xbea2beeb3f75bf60,0xbf773f023e72bf59,0x3f73beebbe953f60,0x3f38bf803f41bde5,0xbf533f7dbf22bd66,0x3e723eebbf6e3f72,0x3d2cbf303f7fbf51,0xbf753f0e3dc9bf35,0x3f46be48bef13f6d
.quad 0x3f3cbf7f3f57bea9,0xbf793f6abef1be2c,0x3e563ed1bf5e3f7e,0x3ecbbf5c3f7fbf3f,0xbf733f1abd2cbf08,0x3efe3dacbf223f76,0x3f41bf7d3f68bf08,0xbf7e3f44be95be8e,0x3e3a3eb7bf4a3f7e,0x3f32bf783f75bf2b,0xbf703f25be3abea9,0x3e1d3eb7bf463f7c,0x3f46bf7b3f75bf35,0xbf623f0ebdc9bec4,0x3e1d3e9bbf323f72,0x3f68bf803f62bf14
.quad 0x3f62be48bf223f80,0xbf7f3f0e3e95bf6d,0xbf733f5cbe3abf20,0x3f53bf783ee53ec4,0x3ed8bf743f5ebe64,0xbe873f63bf703ec4,0x3ebd3ed1bf703f67,0xbed8beb73f6bbf6d,0xbf6e3ed13eb0bf67,0x3f68beb7becb3f6d,0x3f68bf743efe3e64,0xbf773f63beb0bec4,0xbea23f5cbf7c3f20,0x3f11bf783f65bec4,0xbef1be483f46bf80,0x3dc93f0ebf753f6d
.quad 0x3f77bf1abc663f20,0xbf383e0f3efebf6d,0xbf5b3f7fbf413e64,0x3f7fbf443e723ec4,0x3e56bf3a3f7dbf67,0xbf4f3f80bf573ec4,0x3f11bce6bf053f67,0x3e72bf3a3f7cbf6d,0xbf7d3f44bea2be64,0x3ee53dacbf173f6d,0x3f4abf7d3f6ebf20,0xbf6b3f1abe01bec4,0xbdc93f0ebf623f80,0x3f75bf7b3f46bec4,0xbf283e803e56bf20,0xbf0b3f5cbf7f3f6d
.quad 0x3f75bf553dc93f35,0xbf463f7bbef1bec4,0xbf223f80bf2dbde5,0x3ecbbf743f5bbe2c,0x3dc9bf4d3f7cbf08,0x3d8f3f30bf803f2b,0x3ef13e9bbf653f72,0xbf05be803f5ebf76,0xbf623e9b3ee5bf72,0x3f5bbe80befe3f76,0x3f7fbf4d3e3a3f08,0xbf7f3f30bc66bf2b,0xbf463f80bf3c3de5,0x3f6bbf743f053e2c,0x3e95bf553f7fbf35,0xbf223f7bbf623ec4
.quad 0x3e953eb7bf5b3f7e,0x3e56bf443f80bf51,0xbf463e803ebdbf59,0x3e873eb7bf573f80,0x3f7fbf443e873ea9,0xbf2d3e0f3ee5bf60,0xbf623f7fbf4a3ea9,0x3f70bf1a3d8f3ef8,0x3ef1bf5c3f80bf59,0xbf7e3f6abf113d66,0x3dc93ed1bf4f3f7e,0x3f53bf7f3f68bf14,0xbf223e483e95bf35,0xbef13f55bf7f3f6d,0x3f75bf3a3eb03de5,0x3c66beeb3f4fbf7c
.quad 0x3ef1bf7b3f468000,0xbdc93f55bf753ec4,0xbe013f55bf773ede,0xbe1dbf253f80bf2b,0xbe72bf0e3f7dbf48,0x3ecb3ed1bf733f60,0x3f113e48bf573f7a,0xbf1dbe0f3f4fbf7c,0xbf533e483f0bbf7a,0x3f4abe0fbf173f7c,0x3f79bf0ebe1d3f48,0xbf6b3ed13ea2bf60,0xbf7e3f55be87bede,0x3f7dbf25bc663f2b,0x3f62bf7b3f228000,0xbf7f3f55be95bec4
.quad 0xbf283f7bbf653ede,0x3f70bf743f113d66,0x3eb0bf553f80bf48,0xbf533f80bf4a3e8e,0x3c663f0ebf6e3f7a,0x3f28bf783f70bf14,0xbebdbe483f32bf7a,0xbee53f5cbf803f51,0x3f2dbe48beb03f48,0x3e56bf303f77bf76,0xbf653f0ebd8fbede,0x3d2c3eebbf573f80,0x3f7fbf553ef18000,0xbe95be483f22bf6d,0xbf773f7bbf4a3ede,0x3f05bdacbebd3f3f
.quad 0xbe95bf0e3f7fbf35,0x3f223e48bf623f6d,0x3ed83ed1bf753f59,0xbf28be0f3f57bf76,0xbf0bbe803f62bf72,0x3f2d3dacbf4a3f7c,0x3f283dacbf463f7e,0xbf32bce63f3cbf80,0xbf413dac3f22bf7e,0x3f38bce6bf2d3f80,0x3f57be80bef13f72,0xbf3c3dac3f1dbf7c,0xbf683ed13e95bf59,0x3f41be0fbf0b3f76,0x3f75bf0ebdc93f35,0xbf463e483ef1bf6d
.quad 0xbf7d3f30bdc9bf08,0x3f4abe80becb3f60,0x3f80bf4d3e953ea9,0xbf4f3e9b3ea2bf51,0xbf7e3f63bef1bde5,0x3f53beb7be723f3f,0x3f77bf743f22bde5,0xbf573ed13e1dbf2b,0xbf6b3f7dbf463ea9,0x3f5bbeebbd8f3f14,0x3f5bbf803f62bf08,0xbf5e3f02bc66bef8,0xbf463f7bbf753f35,0x3f62bf0e3dc93ec4,0x3f2dbf6f3f7fbf59,0xbf653f1abe3abe8e
.quad 0xbf80,0x0,0x3f80,0x0,0xbf80,0x0,0x3f80,0x0,0xbf80,0x0,0x3f80,0x0,0xbf80,0x0,0x3f80,0x0
.quad 0xbf80,0x0,0x3f80,0x0,0xbf80,0x0,0x3f80,0x0,0xbf80,0x0,0x3f80,0x0,0xbf80,0x0,0x3f80,0x0
.quad 0x0,0x0,0x0,0x0,0x0,0x0,0x0,0x0,0x0,0x0,0x0,0x0,0x0,0x0,0x0,0x0
.quad 0x0,0x0,0x0,0x0,0x0,0x0,0x0,0x0,0x0,0x0,0x0,0x0,0x0,0x0,0x0,0x0
.quad 0xbe643f20bf673f80,0x3f80bf673f20be64,0xbe9b3f2bbf6a3f80,0x3f7bbf513f02bde5,0xbec43f35bf6d3f80,0x3f6dbf353ec48000,0xbeeb3f3fbf6f3f80,0x3f55bf143e803de5,0xbf083f48bf723f80,0x3f35bede3de53e64,0xbf1a3f51bf743f80,0x3f0ebe8ebce63ea9,0xbf2b3f59bf763f80,0x3ec4bde5be2c3ede,0xbf3a3f60bf783f80,0x3e483d66be9b3f08
.quad 0xbf483f67bf7a3f80,0x3e64bede3f20,0xbf553f6dbf7b3f80,0xbe483ec4bf0e3f35,0xbf603f72bf7c3f80,0xbec43f08bf2b3f48,0xbf6a3f76bf7d3f80,0xbf0e3f2bbf443f59,0xbf723f7abf7e3f80,0xbf353f48bf593f67,0xbf783f7cbf7f3f80,0xbf553f60bf6a3f72,0xbf7c3f7ebf803f80,0xbf6d3f72bf763f7a,0xbf7f3f80bf803f80,0xbf7b3f7cbf7d3f7e
.quad 0xbe64be643f20bf67,0xbf673f80bf673f20,0x3dacbef83f4dbf7a,0xbf803f6dbf303ea9,0x3ec4bf353f6dbf80,0xbf6d3f35bec40000,0x3f25bf603f7dbf7a,0xbf303ec4bce6bea9,0x3f59bf7a3f7ebf67,0xbea900003ea9bf20,0x3f78bf803f6fbf48,0x3dacbec43f25bf59,0x3f80bf723f51bf20,0x3ef8bf353f60bf7a,0x3f6fbf513f25bede,0x3f4dbf6d3f7dbf7e
.quad 0x3f48bf203edebe64,0x3f7abf803f7abf67,0x3f0ebec43e488000,0x3f7bbf6d3f55bf35,0x3e8ebde5bd663e64,0x3f51bf353f14bede,0xbce63e2cbe9b3ede,0x3f02bec43e80bde5,0xbea93edebf083f20,0x3de58000bde53e64,0xbf1a3f2bbf3a3f48,0xbe9b3ec4beeb3f08,0xbf513f59bf603f67,0xbf2b3f35bf3f3f48,0xbf743f76bf783f7a,0xbf6a3f6dbf6f3f72
.quad 0x3f20be64be643f20,0x3f20bf673f80bf67,0x3e0f3e8ebf253f67,0x3f78bf7c3f55bf08,0xbec43f35bf6d3f80,0x3f6dbf353ec48000,0xbf4d3f76bf7f3f67,0x3f02be2cbe483f08,0xbf7e3f7abf593f20,0xbde53edebf353f67,0xbf6a3f3fbf023e64,0xbf303f60bf7b3f7e,0xbf143ea9bd66be64,0xbf7c3f7ebf6d3f48,0xbdacbe2c3ed1bf20,0xbf633f3fbf0e3ea9
.quad 0x3edebf203f48bf67,0xbede3e648000be64,0x3f55bf6d3f7bbf80,0x3e48bec43f0ebf35,0x3f80bf7e3f76bf67,0x3f3fbf593f6dbf7a,0x3f63bf513f3abf20,0x3f7fbf803f7bbf72,0x3f08bede3ea9be64,0x3f59bf483f35bf20,0x3ce63d66be0f3e64,0x3eb7be8e3e48bde5,0xbef83f08bf143f20,0xbe8e3ea9bec43ede,0xbf5c3f60bf633f67,0xbf4d3f51bf553f59
.quad 0xbf673f20be64be64,0xbe643f20bf673f80,0xbeb7bd663eebbf48,0xbf633f80bf6f3f35,0x3ec4bf353f6dbf80,0xbf6d3f35bec40000,0x3f6abf803f74bf48,0xbe9bbd663ed1bf35,0x3f72bf483f08be64,0x3f08bf483f72bf80,0x3eebbe2cbe0f3ede,0x3f7dbf7c3f63bf35,0xbe8e3f08bf3f3f67,0x3f3fbf083e8e8000,0xbf5c3f76bf803f7a,0xbce63e8ebf023f35
.quad 0xbf7a3f67bf483f20,0xbf483f67bf7a3f80,0xbf0e3ec4be480000,0xbf7b3f6dbf553f35,0x3e2cbea93ef8bf20,0xbef83ea9be2c0000,0x3f4dbf603f6fbf7a,0x3eb7bef83f1abf35,0x3f7ebf7a3f72bf67,0x3f72bf7a3f7ebf80,0x3f25bf143f02bede,0x3f5cbf513f44bf35,0xbd663de5be2c3e64,0x3e2cbde53d668000,0xbf3a3f3fbf443f48,0xbf253f2bbf303f35
.quad 0x3f80bf673f20be64,0xbe64be643f20bf67,0x3f0ebe2cbe803f20,0x3f44bf763f7dbf59,0xbec43f35bf6d3f80,0x3f6dbf353ec48000,0xbf7b3f7cbf5c3f20,0x3dac3e8ebf1a3f59,0xbf353edebde5be64,0xbf593f7abf7e3f67,0x3e48bef83f3abf67,0xbf5c3f2bbed13de5,0x3f6dbf7e3f7cbf67,0x3d66bea93f14bf48,0x3f55bf2b3eebbe64,0x3f6abf7c3f7fbf72
.quad 0x3e64bede3f20,0x3f48bf203edebe64,0xbf553f6dbf7b3f80,0xbe483ec4bf0e3f35,0xbf6d3f59bf3f3f20,0xbf763f7ebf803f7a,0xbe483d663dacbe64,0xbf303f14beeb3ea9,0x3f35bf483f59bf67,0x3ea9bede3f08bf20,0x3f7bbf763f6fbf67,0x3f7dbf803f80bf7e,0x3ec4bea93e8ebe64,0x3f14bf083ef8bede,0xbf0e3f14bf1a3f20,0xbeeb3ef8bf023f08
.quad 0xbf673f80bf673f20,0x3f20be64be643f20,0xbf3a3ec43ce6bede,0xbf1a3f60bf7f3f72,0x3ec4bf353f6dbf80,0xbf6d3f35bec40000,0x3f80bf6d3f3abede,0x3e0fbef83f44bf72,0x3ea98000bea93f20,0x3f7ebf7a3f59bf20,0xbf443f6dbf7f3f7a,0x3eb7bd66be803f08,0xbf603f35bef83e64,0xbf513f72bf803f7a,0x3e0fbec43f1abf48,0xbf443f14beb73de5
.quad 0x3f7abf803f7abf67,0x3edebf203f48bf67,0x3f0ebec43e488000,0x3f7bbf6d3f55bf35,0xbf143f35bf513f67,0x3d663de5be8e3ede,0xbf783f6dbf5c3f48,0xbf743f7cbf803f7e,0xbde500003de5be64,0xbf083edebea93e64,0x3f63bf6d3f74bf7a,0x3f30bf3f3f4dbf59,0x3f3fbf353f2bbf20,0x3f60bf593f51bf48,0xbeb73ec4bed13ede,0xbe803e8ebe9b3ea9
.quad 0x3f20bf673f80bf67,0xbf673f20be64be64,0x3f5cbf143e483e64,0x3ed1bf3f3f74bf7e,0xbec43f35bf6d3f80,0x3f6dbf353ec48000,0xbf783f51bf0e3e64,0xbeb73f2bbf633f7e,0x3de5bede3f35bf67,0xbf723f48bf083e64,0x3f80bf763f55bf20,0x3e9bbf143f4dbf72,0x3e2c3de5bec43f20,0x3f76bf593f2bbede,0xbf743f80bf7b3f67,0xbe803ef8bf303f59
.quad 0xbede3e648000be64,0xbf7a3f67bf483f20,0x3f55bf6d3f7bbf80,0x3e48bec43f0ebf35,0x3f2bbf083ec4be64,0x3f7cbf723f60bf48,0xbf253f3fbf553f67,0xbe0f3e8ebed13f08,0xbf593f48bf353f20,0xbf7e3f7abf723f67,0x3ed1bef83f0ebf20,0x3dacbe2c3e80bea9,0x3f76bf723f6dbf67,0x3f80bf7e3f7cbf7a,0xbe0f3e2cbe483e64,0xbce63d66bdac3de5
.quad 0xbe643f20bf673f80,0x3f80bf673f20be64,0xbf743f3fbed10000,0xbe483f14bf5c3f7e,0x3ec4bf353f6dbf80,0xbf6d3f35bec40000,0x3f63bf2b3eb78000,0x3f0ebf513f78bf7e,0xbf083f48bf723f80,0x3f35bede3de53e64,0xbf4d3f14be9b0000,0xbf553f76bf803f72,0x3f2bbf593f76bf80,0xbec43de53e2cbede,0x3f30bef83e808000,0x3f7bbf803f74bf59
.quad 0xbf483f67bf7a3f80,0x3e64bede3f20,0xbf0e3ec4be480000,0xbf7b3f6dbf553f35,0x3f60bf723f7cbf80,0x3ec4bf083f2bbf48,0x3ed1be8e3e0f8000,0x3f55bf3f3f25bf08,0xbf723f7abf7e3f80,0xbf353f48bf593f67,0xbe803e2cbdac0000,0xbf0e3ef8bed13ea9,0x3f7cbf7e3f80bf80,0x3f6dbf723f76bf7a,0x3dacbd663ce68000,0x3e48be2c3e0fbde5
.quad 0xbe64be643f20bf67,0xbf673f80bf673f20,0x3f7fbf603f1abe64,0xbce6bec43f3abf72,0xbec43f35bf6d3f80,0x3f6dbf353ec48000,0xbf443ef8be0fbe64,0xbf3a3f6dbf803f72,0x3f59bf7a3f7ebf67,0xbea900003ea9bf20,0x3e803d66beb73f20,0x3f7fbf6d3f44bf08,0xbf803f72bf513f20,0xbef83f35bf603f7a,0x3eb7bf143f44bf67,0xbf1a3ec4be0fbde5
.quad 0x3f48bf203edebe64,0x3f7abf803f7abf67,0xbf553f6dbf7b3f80,0xbe483ec4bf0e3f35,0xbe8e3de53d66be64,0xbf513f35bf143ede,0x3f80bf7c3f74bf67,0x3f5cbf6d3f78bf7e,0xbea93edebf083f20,0x3de58000bde53e64,0xbf4d3f3fbf303f20,0xbf743f6dbf633f59,0x3f51bf593f60bf67,0x3f2bbf353f3fbf48,0x3e9bbe8e3e80be64,0x3ed1bec43eb7bea9
.quad 0x3f20be64be643f20,0x3f20bf673f80bf67,0xbf7d3f76bf443ede,0x3e803e2cbf0e3f59,0x3ec4bf353f6dbf80,0xbf6d3f35bec40000,0x3f1abe8ebdac3ede,0x3f5cbf7c3f7bbf59,0xbf7e3f7abf593f20,0xbde53edebf353f67,0x3ed1bf2b3f5cbf7a,0xbf3a3ef8be48bde5,0x3f14bea93d663e64,0x3f7cbf7e3f6dbf48,0xbf7f3f7cbf6a3f48,0xbeeb3f2bbf553f72
.quad 0x3edebf203f48bf67,0xbede3e648000be64,0x3f0ebec43e488000,0x3f7bbf6d3f55bf35,0xbf803f7ebf763f67,0xbf3f3f59bf6d3f7a,0x3eebbf143f30bf48,0xbdacbd663e48bea9,0x3f08bede3ea9be64,0x3f59bf483f35bf20,0xbf803f80bf7d3f7a,0xbf6f3f76bf7b3f7e,0x3ef8bf083f14bf20,0x3e8ebea93ec4bede,0x3f02bef83eebbede,0x3f1abf143f0ebf08
.quad 0xbf673f20be64be64,0xbe643f20bf673f80,0x3f6fbf803f63bf20,0xbeeb3d663eb7bf35,0xbec43f35bf6d3f80,0x3f6dbf353ec48000,0xbed13d663e9bbf20,0xbf743f80bf6a3f35,0x3f72bf483f08be64,0x3f08bf483f72bf80,0xbf633f7cbf7d3f67,0x3e0f3e2cbeeb3f35,0x3e8ebf083f3fbf67,0xbf3f3f08be8e0000,0x3f02be8e3ce63e64,0x3f80bf763f5cbf35
.quad 0xbf7a3f67bf483f20,0xbf483f67bf7a3f80,0x3f55bf6d3f7bbf80,0x3e48bec43f0ebf35,0xbe2c3ea9bef83f20,0x3ef8bea93e2c8000,0xbf1a3ef8beb73e64,0xbf6f3f60bf4d3f35,0x3f7ebf7a3f72bf67,0x3f72bf7a3f7ebf80,0xbf443f51bf5c3f67,0xbf023f14bf253f35,0x3d66bde53e2cbe64,0xbe2c3de5bd660000,0x3f30bf2b3f25bf20,0x3f44bf3f3f3abf35
.quad 0x3f80bf673f20be64,0xbe64be643f20bf67,0xbf553f7cbf783f48,0x3f25be8ebe0f3f08,0x3ec4bf353f6dbf80,0xbf6d3f35bec40000,0x3e483e2cbf023f48,0x3f7fbf763f4dbf08,0xbf353edebde5be64,0xbf593f7abf7e3f67,0x3f7bbf603f30bede,0x3f02bf3f3f6abf7e,0xbf6d3f7ebf7c3f67,0xbd663ea9bf143f48,0x3f0ebf3f3f63bf7a,0xbed13e2c3dacbea9
.quad 0x3e64bede3f20,0x3f48bf203edebe64,0xbf0e3ec4be480000,0xbf7b3f6dbf553f35,0x3f6dbf593f3fbf20,0x3f76bf7e3f80bf7a,0xbf7b3f80bf7f3f7a,0xbf3a3f51bf633f72,0x3f35bf483f59bf67,0x3ea9bede3f08bf20,0xbe483e8ebeb73ede,0x3e0fbd66bce63de5,0xbec43ea9be8e3e64,0xbf143f08bef83ede,0x3f55bf513f4dbf48,0x3f63bf603f5cbf59
.quad 0xbf673f80bf673f20,0x3f20be64be643f20,0x3f30bf6d3f80bf67,0xbf4d3ef8bdacbea9,0xbec43f35bf6d3f80,0x3f6dbf353ec48000,0x3ce6bec43f30bf67,0xbf7d3f60bf253ea9,0x3ea98000bea93f20,0x3f7ebf7a3f59bf20,0xbf253ec4bdacbe64,0xbf6f3f80bf783f59,0x3f60bf353ef8be64,0x3f51bf723f80bf7a,0xbf7d3f6dbf4d3f20,0xbf253f51bf6f3f7e
.quad 0x3f7abf803f7abf67,0x3edebf203f48bf67,0xbf553f6dbf7b3f80,0xbe483ec4bf0e3f35,0x3f14bf353f51bf67,0xbd66bde53e8ebede,0xbe803ec4bf023f20,0x3e9bbe2c3ce63de5,0xbde500003de5be64,0xbf083edebea93e64,0x3eebbec43e9bbe64,0x3f3abf2b3f1abf08,0xbf3f3f35bf2b3f20,0xbf603f59bf513f48,0x3f6fbf6d3f6abf67,0x3f78bf763f74bf72
.quad 0x3f20bf673f80bf67,0xbf673f20be64be64,0xbf023f51bf7b3f7a,0x3f6abf2b3e9b3de5,0x3ec4bf353f6dbf80,0xbf6d3f35bec40000,0xbe803f14bf553f7a,0x3f6fbf3f3eebbde5,0x3de5bede3f35bf67,0xbf723f48bf083e64,0x3ce63e8ebf0e3f48,0x3f74bf513f1abea9,0xbe2cbde53ec4bf20,0xbf763f59bf2b3ede,0x3e9bbd66be483ede,0x3f78bf603f3abf08
.quad 0xbede3e648000be64,0xbf7a3f67bf483f20,0x3f0ebec43e488000,0x3f7bbf6d3f55bf35,0xbf2b3f08bec43e64,0xbf7c3f72bf603f48,0x3f44bf2b3f0ebede,0x3f7dbf763f6abf59,0xbf593f48bf353f20,0xbf7e3f7abf723f67,0x3f6abf603f55bf48,0x3f7fbf7c3f78bf72,0xbf763f72bf6d3f67,0xbf803f7ebf7c3f7a,0x3f7dbf7c3f7bbf7a,0x3f80bf803f7fbf7e
.quad 0x3f80,0x0,0xbf80,0x0,0x3f80,0x0,0xbf80,0x0,0x3f80,0x0,0xbf80,0x0,0x3f80,0x0,0xbf80,0x0
.quad 0x3f80,0x0,0xbf80,0x0,0x3f80,0x0,0xbf80,0x0,0x3f80,0x0,0xbf80,0x0,0x3f80,0x0,0xbf80,0x0
.quad 0x0,0x0,0x0,0x0,0x0,0x0,0x0,0x0,0x0,0x0,0x0,0x0,0x0,0x0,0x0,0x0
.quad 0x0,0x0,0x0,0x0,0x0,0x0,0x0,0x0,0x0,0x0,0x0,0x0,0x0,0x0,0x0,0x0
.quad 0xbf7a3f48bede8000,0x80003edebf483f7a,0xbf743f3fbed18000,0xbe483f14bf5c3f7e,0xbf6d3f35bec48000,0xbec43f35bf6d3f80,0xbf633f2bbeb78000,0xbf0e3f51bf783f7e,0xbf593f20bea98000,0xbf353f67bf7e3f7a,0xbf4d3f14be9b8000,0xbf553f76bf803f72,0xbf3f3f08be8e8000,0xbf6d3f7ebf7c3f67,0xbf303ef8be808000,0xbf7b3f80bf743f59
.quad 0xbf203edebe648000,0xbf803f7abf673f48,0xbf0e3ec4be488000,0xbf7b3f6dbf553f35,0xbef83ea9be2c8000,0xbf6d3f59bf3f3f20,0xbed13e8ebe0f8000,0xbf553f3fbf253f08,0xbea93e64bde58000,0xbf353f20bf083ede,0xbe803e2cbdac8000,0xbf0e3ef8bed13ea9,0xbe2c3de5bd668000,0xbec43ea9be8e3e64,0xbdac3d66bce68000,0xbe483e2cbe0f3de5
.quad 0x3f7abf7a3f48bede,0xbede80003edebf48,0x3f7fbf603f1abe64,0xbce6bec43f3abf72,0x3f6dbf353ec48000,0x3ec4bf353f6dbf80,0x3f44bef83e0f3e64,0x3f3abf6d3f80bf72,0x3f08be64bde53ede,0x3f72bf803f72bf48,0x3e803d66beb73f20,0x3f7fbf6d3f44bf08,0xbd663ea9bf143f48,0x3f60bf353ef8be64,0xbeb73f14bf443f67,0x3f1abec43e0f3de5
.quad 0xbf203f48bf673f7a,0x3e648000be643ede,0xbf553f6dbf7b3f80,0xbe483ec4bf0e3f35,0xbf763f7ebf803f7a,0xbf143f35bf513f67,0xbf803f7cbf743f67,0xbf5c3f6dbf783f7e,0xbf723f67bf593f48,0xbf7e3f80bf7e3f7a,0xbf4d3f3fbf303f20,0xbf743f6dbf633f59,0xbf143f08bef83ede,0xbf3f3f35bf2b3f20,0xbe9b3e8ebe803e64,0xbed13ec4beb73ea9
.quad 0xbf483f7abf7a3f48,0x3f48bede80003ede,0xbf7d3f76bf443ede,0x3e803e2cbf0e3f59,0xbf6d3f35bec48000,0xbec43f35bf6d3f80,0xbf1a3e8e3dacbede,0xbf5c3f7cbf7b3f59,0xbde5be643f08bf48,0xbf7e3f67bf353ede,0x3ed1bf2b3f5cbf7a,0xbf3a3ef8be48bde5,0x3f51bf723f80bf7a,0xbe2cbde53ec4bf20,0x3f7fbf7c3f6abf48,0x3eebbf2b3f55bf72
.quad 0x3f67bf483f20bede,0x3f67bf7a3f80bf7a,0x3f0ebec43e488000,0x3f7bbf6d3f55bf35,0x3d663de5be8e3ede,0x3f2bbf083ec4be64,0xbeeb3f14bf303f48,0x3dac3d66be483ea9,0xbf593f67bf723f7a,0xbf083f20bf353f48,0xbf803f80bf7d3f7a,0xbf6f3f76bf7b3f7e,0xbf603f59bf513f48,0xbf763f72bf6d3f67,0xbf023ef8beeb3ede,0xbf1a3f14bf0e3f08
.quad 0x3edebf483f7abf7a,0xbf7a3f48bede8000,0x3f6fbf803f63bf20,0xbeeb3d663eb7bf35,0x3f6dbf353ec48000,0x3ec4bf353f6dbf80,0x3ed1bd66be9b3f20,0x3f74bf803f6abf35,0xbea93f20bf593f7a,0x3f59bf203ea98000,0xbf633f7cbf7d3f67,0x3e0f3e2cbeeb3f35,0xbf763f59bf2b3ede,0xbf2b3f59bf763f80,0xbf023e8ebce6be64,0xbf803f76bf5c3f35
.quad 0x3e64bede3f20bf48,0xbf203edebe648000,0x3f55bf6d3f7bbf80,0x3e48bec43f0ebf35,0x3f7cbf723f60bf48,0x3f60bf723f7cbf80,0x3f1abef83eb7be64,0x3f6fbf603f4dbf35,0xbde53e64bea93ede,0x3ea9be643de58000,0xbf443f51bf5c3f67,0xbf023f14bf253f35,0xbf803f7ebf7c3f7a,0xbf7c3f7ebf803f80,0xbf303f2bbf253f20,0xbf443f3fbf3a3f35
.quad 0x80003edebf483f7a,0x3f7abf7a3f48bede,0xbf553f7cbf783f48,0x3f25be8ebe0f3f08,0xbf6d3f35bec48000,0xbec43f35bf6d3f80,0xbe48be2c3f02bf48,0xbf7f3f76bf4d3f08,0x3f35bf673f7ebf7a,0xbf083e643de5bede,0x3f7bbf603f30bede,0x3f02bf3f3f6abf7e,0x3ec4bde5be2c3ede,0x3f80bf723f51bf20,0xbf0e3f3fbf633f7a,0x3ed1be2cbdac3ea9
.quad 0xbf803f7abf673f48,0xbf203f48bf673f7a,0xbf0e3ec4be488000,0xbf7b3f6dbf553f35,0x3ec4bf083f2bbf48,0xbe8e3de53d66be64,0x3f7bbf803f7fbf7a,0x3f3abf513f63bf72,0x3f35bf203f08bede,0x3f72bf673f59bf48,0xbe483e8ebeb73ede,0x3e0fbd66bce63de5,0xbf6d3f72bf763f7a,0xbf513f59bf603f67,0xbf553f51bf4d3f48,0xbf633f60bf5c3f59
.quad 0xbede80003edebf48,0xbf483f7abf7a3f48,0x3f30bf6d3f80bf67,0xbf4d3ef8bdacbea9,0x3f6dbf353ec48000,0x3ec4bf353f6dbf80,0xbce63ec4bf303f67,0x3f7dbf603f25bea9,0xbf723f80bf723f48,0x3de53e64bf083f48,0xbf253ec4bdacbe64,0xbf6f3f80bf783f59,0x3ef8bf353f60bf7a,0xbf143ea9bd66be64,0x3f7dbf6d3f4dbf20,0x3f25bf513f6fbf7e
.quad 0x3e648000be643ede,0x3f67bf483f20bede,0xbf553f6dbf7b3f80,0xbe483ec4bf0e3f35,0xbf513f35bf143ede,0xbf803f7ebf763f67,0x3e80bec43f02bf20,0xbe9b3e2cbce6bde5,0x3f7ebf803f7ebf7a,0x3f59bf673f72bf7a,0x3eebbec43e9bbe64,0x3f3abf2b3f1abf08,0xbf2b3f35bf3f3f48,0xbef83f08bf143f20,0xbf6f3f6dbf6a3f67,0xbf783f76bf743f72
.quad 0x3f48bede80003ede,0x3edebf483f7abf7a,0xbf023f51bf7b3f7a,0x3f6abf2b3e9b3de5,0xbf6d3f35bec48000,0xbec43f35bf6d3f80,0x3e80bf143f55bf7a,0xbf6f3f3fbeeb3de5,0x3f7ebf673f35bede,0x3ea9bf203f59bf7a,0x3ce63e8ebf0e3f48,0x3f74bf513f1abea9,0xbf7c3f7ebf6d3f48,0xbe8e3f08bf3f3f67,0xbe9b3d663e48bede,0xbf783f60bf3a3f08
.quad 0x3f67bf7a3f80bf7a,0x3e64bede3f20bf48,0x3f0ebec43e488000,0x3f7bbf6d3f55bf35,0xbf3f3f59bf6d3f7a,0xbe2c3ea9bef83f20,0xbf443f2bbf0e3ede,0xbf7d3f76bf6a3f59,0x3f08bf203f35bf48,0x3de5be643ea9bede,0x3f6abf603f55bf48,0x3f7fbf7c3f78bf72,0xbe8e3ea9bec43ede,0xbd663de5be2c3e64,0xbf7d3f7cbf7b3f7a,0xbf803f80bf7f3f7e
.quad 0xbf7a3f48bede8000,0x80003edebf483f7a,0x3e9bbf2b3f6abf80,0xbf7b3f51bf023de5,0x3f6dbf353ec48000,0x3ec4bf353f6dbf80,0xbeeb3f3fbf6f3f80,0x3f55bf143e803de5,0xbf593f20bea98000,0xbf353f67bf7e3f7a,0x3f1abf513f74bf80,0xbf0e3e8e3ce6bea9,0x3f3fbf083e8e8000,0x3f6dbf7e3f7cbf67,0xbf3a3f60bf783f80,0x3e483d66be9b3f08
.quad 0xbf203edebe648000,0xbf803f7abf673f48,0x3f55bf6d3f7bbf80,0x3e48bec43f0ebf35,0x3ef8bea93e2c8000,0x3f6dbf593f3fbf20,0xbf6a3f76bf7d3f80,0xbf0e3f2bbf443f59,0xbea93e64bde58000,0xbf353f20bf083ede,0x3f78bf7c3f7fbf80,0x3f55bf603f6abf72,0x3e2cbde53d668000,0x3ec4bea93e8ebe64,0xbf7f3f80bf803f80,0xbf7b3f7cbf7d3f7e
.quad 0x3f7abf7a3f48bede,0xbede80003edebf48,0xbdac3ef8bf4d3f7a,0x3f80bf6d3f30bea9,0xbf6d3f35bec48000,0xbec43f35bf6d3f80,0x3f25bf603f7dbf7a,0xbf303ec4bce6bea9,0x3f08be64bde53ede,0x3f72bf803f72bf48,0xbf783f80bf6f3f48,0xbdac3ec4bf253f59,0x3d66bea93f14bf48,0xbf603f35bef83e64,0x3f6fbf513f25bede,0x3f4dbf6d3f7dbf7e
.quad 0xbf203f48bf673f7a,0x3e648000be643ede,0xbf0e3ec4be488000,0xbf7b3f6dbf553f35,0x3f76bf7e3f80bf7a,0x3f14bf353f51bf67,0xbce63e2cbe9b3ede,0x3f02bec43e80bde5,0xbf723f67bf593f48,0xbf7e3f80bf7e3f7a,0x3f1abf2b3f3abf48,0x3e9bbec43eebbf08,0x3f14bf083ef8bede,0x3f3fbf353f2bbf20,0xbf743f76bf783f7a,0xbf6a3f6dbf6f3f72
.quad 0xbf483f7abf7a3f48,0x3f48bede80003ede,0xbe0fbe8e3f25bf67,0xbf783f7cbf553f08,0x3f6dbf353ec48000,0x3ec4bf353f6dbf80,0xbf4d3f76bf7f3f67,0x3f02be2cbe483f08,0xbde5be643f08bf48,0xbf7e3f67bf353ede,0x3f6abf3f3f02be64,0x3f30bf603f7bbf7e,0xbf513f72bf803f7a,0x3e2c3de5bec43f20,0xbdacbe2c3ed1bf20,0xbf633f3fbf0e3ea9
.quad 0x3f67bf483f20bede,0x3f67bf7a3f80bf7a,0xbf553f6dbf7b3f80,0xbe483ec4bf0e3f35,0xbd66bde53e8ebede,0xbf2b3f08bec43e64,0x3f63bf513f3abf20,0x3f7fbf803f7bbf72,0xbf593f67bf723f7a,0xbf083f20bf353f48,0xbce6bd663e0fbe64,0xbeb73e8ebe483de5,0x3f60bf593f51bf48,0x3f76bf723f6dbf67,0xbf5c3f60bf633f67,0xbf4d3f51bf553f59
.quad 0x3edebf483f7abf7a,0xbf7a3f48bede8000,0x3eb73d66beeb3f48,0x3f63bf803f6fbf35,0xbf6d3f35bec48000,0xbec43f35bf6d3f80,0x3f6abf803f74bf48,0xbe9bbd663ed1bf35,0xbea93f20bf593f7a,0x3f59bf203ea98000,0xbeeb3e2c3e0fbede,0xbf7d3f7cbf633f35,0x3f76bf593f2bbede,0x3f2bbf593f76bf80,0xbf5c3f76bf803f7a,0xbce63e8ebf023f35
.quad 0x3e64bede3f20bf48,0xbf203edebe648000,0x3f0ebec43e488000,0x3f7bbf6d3f55bf35,0xbf7c3f72bf603f48,0xbf603f72bf7c3f80,0x3f4dbf603f6fbf7a,0x3eb7bef83f1abf35,0xbde53e64bea93ede,0x3ea9be643de58000,0xbf253f14bf023ede,0xbf5c3f51bf443f35,0x3f80bf7e3f7cbf7a,0x3f7cbf7e3f80bf80,0xbf3a3f3fbf443f48,0xbf253f2bbf303f35
.quad 0x80003edebf483f7a,0x3f7abf7a3f48bede,0xbf0e3e2c3e80bf20,0xbf443f76bf7d3f59,0x3f6dbf353ec48000,0x3ec4bf353f6dbf80,0xbf7b3f7cbf5c3f20,0x3dac3e8ebf1a3f59,0x3f35bf673f7ebf7a,0xbf083e643de5bede,0xbe483ef8bf3a3f67,0x3f5cbf2b3ed1bde5,0xbec43de53e2cbede,0xbf803f72bf513f20,0x3f55bf2b3eebbe64,0x3f6abf7c3f7fbf72
.quad 0xbf803f7abf673f48,0xbf203f48bf673f7a,0x3f55bf6d3f7bbf80,0x3e48bec43f0ebf35,0xbec43f08bf2b3f48,0x3e8ebde5bd663e64,0xbe483d663dacbe64,0xbf303f14beeb3ea9,0x3f35bf203f08bede,0x3f72bf673f59bf48,0xbf7b3f76bf6f3f67,0xbf7d3f80bf803f7e,0x3f6dbf723f76bf7a,0x3f51bf593f60bf67,0xbf0e3f14bf1a3f20,0xbeeb3ef8bf023f08
.quad 0xbede80003edebf48,0xbf483f7abf7a3f48,0x3f3abec4bce63ede,0x3f1abf603f7fbf72,0xbf6d3f35bec48000,0xbec43f35bf6d3f80,0x3f80bf6d3f3abede,0x3e0fbef83f44bf72,0xbf723f80bf723f48,0x3de53e64bf083f48,0x3f44bf6d3f7fbf7a,0xbeb73d663e80bf08,0xbef83f35bf603f7a,0x3f14bea93d663e64,0x3e0fbec43f1abf48,0xbf443f14beb73de5
.quad 0x3e648000be643ede,0x3f67bf483f20bede,0xbf0e3ec4be488000,0xbf7b3f6dbf553f35,0x3f51bf353f14bede,0x3f80bf7e3f76bf67,0xbf783f6dbf5c3f48,0xbf743f7cbf803f7e,0x3f7ebf803f7ebf7a,0x3f59bf673f72bf7a,0xbf633f6dbf743f7a,0xbf303f3fbf4d3f59,0x3f2bbf353f3fbf48,0x3ef8bf083f14bf20,0xbeb73ec4bed13ede,0xbe803e8ebe9b3ea9
.quad 0x3f48bede80003ede,0x3edebf483f7abf7a,0xbf5c3f14be48be64,0xbed13f3fbf743f7e,0x3f6dbf353ec48000,0x3ec4bf353f6dbf80,0xbf783f51bf0e3e64,0xbeb73f2bbf633f7e,0x3f7ebf673f35bede,0x3ea9bf203f59bf7a,0xbf803f76bf553f20,0xbe9b3f14bf4d3f72,0x3f7cbf7e3f6dbf48,0x3e8ebf083f3fbf67,0xbf743f80bf7b3f67,0xbe803ef8bf303f59
.quad 0x3f67bf7a3f80bf7a,0x3e64bede3f20bf48,0xbf553f6dbf7b3f80,0xbe483ec4bf0e3f35,0x3f3fbf593f6dbf7a,0x3e2cbea93ef8bf20,0xbf253f3fbf553f67,0xbe0f3e8ebed13f08,0x3f08bf203f35bf48,0x3de5be643ea9bede,0xbed13ef8bf0e3f20,0xbdac3e2cbe803ea9,0x3e8ebea93ec4bede,0x3d66bde53e2cbe64,0xbe0f3e2cbe483e64,0xbce63d66bdac3de5
.quad 0x8000,0x0,0x8000,0x0,0x8000,0x0,0x8000,0x0,0x8000,0x0,0x8000,0x0,0x8000,0x0,0x8000,0x0
.quad 0x8000,0x0,0x8000,0x0,0x8000,0x0,0x8000,0x0,0x8000,0x0,0x8000,0x0,0x8000,0x0,0x8000,0x0
.quad 0x0,0x0,0x0,0x0,0x0,0x0,0x0,0x0,0x0,0x0,0x0,0x0,0x0,0x0,0x0,0x0
.quad 0x0,0x0,0x0,0x0,0x0,0x0,0x0,0x0,0x0,0x0,0x0,0x0,0x0,0x0,0x0,0x0
.quad 0xbe873f25bf683f80,0x3f7fbf5c3f11be2c,0xbeb03f30bf6b3f80,0x3f75bf443ee5bd66,0xbed83f3abf6e3f80,0x3f62bf253ea23d66,0xbefe3f44bf703f80,0x3f46bf023e3a3e2c,0xbf113f4dbf733f80,0x3f22beb73d2c3e8e,0xbf223f55bf753f80,0x3ef1be48bdc93ec4,0xbf323f5cbf773f80,0x3e95bce6be723ef8,0xbf413f63bf793f80,0x3dc93e0fbebd3f14
.quad 0xbf4f3f6abf7a3f80,0xbdc93e9bbefe3f2b,0xbf5b3f6fbf7c3f80,0xbe953eebbf1d3f3f,0xbf653f74bf7d3f80,0xbef13f1abf383f51,0xbf6e3f78bf7e3f80,0xbf223f3abf4f3f60,0xbf753f7bbf7f3f80,0xbf463f55bf623f6d,0xbf7a3f7dbf7f3f80,0xbf623f6abf703f76,0xbf7e3f7fbf803f80,0xbf753f78bf7a3f7c,0xbf803f80bf803f80,0xbf7f3f7fbf7f3f80
.quad 0xbd8fbeb73f38bf72,0xbf793f7bbf4f3ef8,0x3e72bf1a3f5ebf7e,0xbf7c3f55bf0b3e2c,0x3f05bf4d3f77bf7e,0xbf533f0ebe56be2c,0x3f41bf6f3f80bf72,0xbf053e483e1dbef8,0x3f6bbf7f3f79bf59,0xbe01be483efebf3f,0x3f7fbf7b3f62bf35,0x3e95bf0e3f46bf6d,0x3f7abf633f3cbf08,0x3f28bf553f73bf80,0x3f5ebf3a3f0bbea9,0x3f68bf7b3f80bf76
.quad 0x3f2dbf023ea2bde5,0x3f80bf7b3f6bbf51,0x3ed8be803d8f3de5,0x3f6bbf553f38bf14,0x3e013ce6be3a3ea9,0x3f2dbf0e3ed8be8e,0xbe3a3e9bbed83f08,0x3ea2be483d8f3d66,0xbef13f0ebf223f35,0xbdc93e48be953ec4,0xbf383f44bf4f3f59,0xbefe3f0ebf1d3f2b,0xbf653f6abf6e3f72,0xbf4f3f55bf5b3f60,0xbf7d3f7dbf7e3f7e,0xbf7a3f7bbf7c3f7c
.quad 0x3ecb3ce6bee53f48,0x3f57bf7d3f75bf3f,0xbe013f02bf4f3f7a,0x3f7fbf633f22be8e,0xbf1d3f5cbf7d3f7a,0x3f41beeb3dc93e8e,0xbf6e3f80bf733f48,0x3e563e0fbef13f3f,0xbf7d3f63bf323ede,0xbed83f30bf623f7c,0xbf463f0ebe950000,0xbf623f7bbf7f3f6d,0xbeb03dac3e3abede,0xbf7d3f6abf463f14,0x3e3abed13f1dbf48,0xbf323f02be953d66
.quad 0x3f28bf4d3f68bf7a,0xbe01bdac3e95bef8,0x3f73bf7d3f80bf7a,0x3efebf253f46bf60,0x3f7abf6f3f5ebf48,0x3f6bbf783f7fbf80,0x3f3cbf253f0bbede,0x3f79bf6f3f62bf51,0x3e95be483dc98000,0x3f22bf0e3ef1bec4,0xbe723e9bbebd3ede,0x3d2c3ce6bdc93e2c,0xbf323f3abf413f48,0xbf113f1abf223f2b,0xbf773f78bf793f7a,0xbf733f74bf753f76
.quad 0xbf2d3e9b3e01bf08,0xbf1d3f63bf803f6d,0x3c66bed13f3cbf72,0xbf803f6fbf383ec4,0x3f32bf6a3f80bf72,0xbf2d3eb73c66bec4,0x3f80bf743f4abf08,0x3e01beeb3f3cbf6d,0x3f41bf023e563de5,0x3f57bf783f7fbf6d,0x3dc93e48bef13f35,0x3f75bf553f22bec4,0xbf1d3f4dbf6e3f7e,0x3ecbbe0fbe013ec4,0xbf7d3f7fbf733f59,0xbee53f25bf4f3f6d
.quad 0xbf533f30bf053ea9,0xbf793f80bf7c3f6d,0xbe563ce63e1dbea9,0xbf4f3f30bf0b3ec4,0x3f05bf253f41bf59,0xbd8fbdac3e72bec4,0x3f77bf7d3f80bf7e,0x3f38bf4d3f5ebf6d,0x3f62bf553f46bf35,0x3f7fbf7b3f75bf6d,0x3ea2be803e3abde5,0x3f11bf023ee5bec4,0xbed83eebbefe3f08,0xbe873e9bbeb03ec4,0xbf6e3f6fbf703f72,0xbf683f6abf6b3f6d
.quad 0x3f62bf1a3e563e64,0x3ea2bf303f6ebf80,0x3dc93e9bbf283f67,0x3f7dbf783f4abef8,0xbf463f74bf7f3f67,0x3f17be80be013ef8,0xbf753f4dbf0b3e64,0xbee53f3abf6b3f80,0xbe95bce63eb0bf20,0xbf803f74bf4f3f14,0x3f22bf553f75bf80,0xbef13e483dc9bec4,0x3f7fbf6f3f4fbf20,0x3f11bf443f68bf7c,0x3ef1be803c663e64,0x3f7ebf6f3f53bf2b
.quad 0xbef13f25bf4a3f67,0x3eb0be0fbd8f3e8e,0xbf7f3f7fbf773f67,0xbf2d3f4dbf653f76,0xbf223f02bebd3e64,0xbf773f6abf573f3f,0x3e95bed13f05bf20,0xbe563dac3d2cbe2c,0x3f75bf7b3f7fbf80,0x3f46bf553f62bf6d,0x3f46bf3a3f2dbf20,0x3f6bbf633f5bbf51,0xbdc93e0fbe3a3e64,0x3d8fbce6bc663d66,0xbf623f63bf653f67,0xbf5b3f5cbf5e3f60
.quad 0xbf7d3f55bf053de5,0x3c663ed1bf413f76,0xbe56be483f11bf59,0xbf773f7dbf5b3f14,0x3f57bf7b3f7cbf59,0xbefe3e0f3e72bf14,0x3f4fbf0e3e723de5,0x3f38bf6a3f7fbf76,0xbe873f0ebf4a3f72,0x3f5bbf253ebdbd66,0xbf7f3f7bbf623f35,0xbe953f0ebf463f6d,0xbee53e483d8fbea9,0xbf803f74bf573f2b,0x3f2dbf553f70bf7e,0xbe56bce63e87bef8
.quad 0x3f6ebf553f32bf08,0x3f65bf783f80bf7c,0xbc663e48bebd3f08,0x3f28bf023eb0be2c,0xbf703f7bbf803f7e,0xbf113f30bf4a3f60,0xbf283f0ebee53ea9,0xbf703f63bf533f3f,0x3ef1bf0e3f22bf35,0x3dc9be483e95bec4,0x3f7ebf7b3f77bf72,0x3f7dbf7f3f80bf80,0x3e72be483e1dbde5,0x3ecbbeb73ea2be8e,0xbf533f55bf573f59,0xbf4a3f4dbf4f3f51
.quad 0x3f7cbf783f46bede,0xbeb0bdac3efebf51,0x3ea23dacbef13f48,0x3f6ebf803f68bf2b,0xbf653f7fbf753f48,0x3ecbbce6beb03f2b,0xbf113e803dc9bede,0xbf683f7fbf773f51,0x3f3cbf6a3f7fbf7a,0xbee53e0f3e3abef8,0x3f46bf0e3e958000,0x3f62bf7b3f7fbf6d,0xbf053f3abf623f7a,0x3efebe80bc663e8e,0xbf6b3f4dbf223ede,0xbf5b3f74bf7f3f7c
.quad 0x3e87beeb3f22bf48,0xbf0b3eb7be1dbd66,0x3f7ebf743f62bf48,0x3f53bf6a3f79bf80,0x3c663e0fbe953ede,0x3f17beeb3ea2be2c,0xbf7d3f80bf7f3f7a,0xbf4a3f5cbf6b3f76,0xbe953e48bdc90000,0xbf223f0ebef13ec4,0x3f68bf6f3f75bf7a,0x3f41bf4d3f57bf60,0x3f0bbf023ef1bede,0x3f2dbf253f1dbf14,0xbf413f44bf463f48,0xbf383f3abf3c3f3f
.quad 0xbf5e3f7fbf703f35,0x3f22be80be3a3f14,0xbed83ce63ebdbf35,0xbf623f7fbf733f3f,0x3f70bf803f6bbf35,0xbe95bdac3ee5bf3f,0x3e873dacbed83f35,0x3f7fbf783f53bf14,0xbf7c3f7dbf653f35,0xbdc93ed1bf2d3f60,0xbdc9be483ef1bf35,0xbf753f55bf223ec4,0x3f80bf783f5ebf35,0x3ef1bf303f5bbf76,0xbd8f3e9bbf053f35,0x3f46bf1a3ecbbe2c
.quad 0xbf7d3f6fbf573f35,0xbf463f63bf773f80,0x3e72bed13f11bf35,0xbef13e9bbe01bd66,0x3f73bf633f4fbf35,0x3f75bf7d3f80bf7c,0xbecb3f02bf1d3f35,0x3dc93ce6be1d3e8e,0xbf623f55bf463f35,0xbf7f3f7bbf753f6d,0x3f0bbf1a3f28bf35,0x3e95beb73ed8bef8,0x3f4abf443f3cbf35,0x3f62bf5c3f57bf51,0xbf2d3f30bf323f35,0xbf223f25bf283f2b
.quad 0x3f28bf6a3f80bf67,0xbf5b3f0ebe1dbe8e,0x3f05be0fbe873f20,0x3f53bf7b3f7abf51,0xbf793f7dbf5e3f20,0x3e3a3e48bf0b3f51,0x3d8fbed13f32bf67,0xbf793f55bf173e8e,0x3f6ebf443f05be64,0x3f1dbf553f77bf80,0xbf223f55bf753f80,0x3ef1be48bdc93ec4,0xbf0b3e9bbd2cbe64,0xbf7f3f7bbf653f3f,0x3f77bf803f7abf67,0x3eb0bf0e3f3cbf60
.quad 0xbd2c3e80bee53f20,0x3f38bf0e3ebdbe2c,0xbf703f5cbf413f20,0xbf6e3f7bbf803f7c,0x3f1dbf3a3f53bf67,0x3d2cbe483eb0bef8,0x3f11beeb3eb0be64,0x3f65bf553f41bf2b,0xbf753f7bbf7f3f80,0xbf463f55bf623f6d,0x3c66bdac3e1dbe64,0xbe873e48be013d66,0x3f73bf6f3f6bbf67,0x3f7dbf7b3f79bf76,0xbf173f1abf1d3f20,0xbf0b3f0ebf113f14
.quad 0xbebd3f3abf733f7e,0x3f7abf4d3ef1bd66,0xbf1d3e803e1dbf08,0xbf413f74bf7f3f60,0x3f7ebf783f4fbf08,0xbd8fbe9b3f22bf60,0xbecb3f30bf653f7e,0x3f57bf1a3e953d66,0xbf173e9b3c66bea9,0xbf703f80bf753f51,0x3f7fbf7b3f62bf35,0x3e95bf0e3f46bf6d,0xbed83f25bf533f72,0x3f17beb73dc93e2c,0xbf113eb7be01bde5,0xbf803f78bf623f3f
.quad 0x3f7fbf7d3f70bf59,0x3f1dbf443f62bf76,0xbee53f1abf3c3f59,0x3e87bdacbdc93e8e,0xbf0b3ed1be873de5,0xbf6e3f5cbf463f2b,0x3f80bf7f3f7abf72,0x3f5bbf6a3f75bf7c,0xbef13f0ebf223f35,0xbdc93e48be953ec4,0xbf053eebbecb3ea9,0xbf3c3f30bf223f14,0x3f80bf803f7fbf7e,0x3f7cbf7d3f7fbf80,0xbefe3f02bf053f08,0xbee53eebbef13ef8
.quad 0x3d2cbeeb3f4abf7a,0xbf7e3f74bf3c3ec4,0x3f32beb7bd2c3ede,0x3f2dbf6a3f80bf6d,0xbf803f6fbf3c3ede,0xbd2c3ed1bf383f6d,0x3f2dbf633f7ebf7a,0xbf1d3e9b3d2cbec4,0x3d8f3e80bf0b3f48,0x3f7abf5c3f28bec4,0xbf463f0ebe950000,0xbf623f7bbf7f3f6d,0x3f7ebf7d3f6bbf48,0x3ebdbf1a3f4abf6d,0xbf173f44bf653f7a,0x3ea2bdacbe1d3ec4
.quad 0xbe3abce63e72bede,0xbf5b3f3abf113ec4,0x3f57bf3a3f17bede,0x3f7dbf803f7abf6d,0xbf793f7fbf7f3f7a,0xbf283f44bf5b3f6d,0x3efebf1a3f32bf48,0x3c66be0f3e87bec4,0x3e95be483dc98000,0x3f22bf0e3ef1bec4,0xbf653f5cbf533f48,0xbf7c3f78bf733f6d,0x3f70bf743f77bf7a,0x3f5ebf633f68bf6d,0xbecb3ed1bed83ede,0xbeb03eb7bebd3ec4
.quad 0x3e953e0fbf0b3f59,0x3f65bf803f6bbf2b,0xbf463eebbd8fbea9,0xbf173f5cbf7e3f76,0x3f7fbf633f28bea9,0x3e1dbf023f4abf76,0xbf623f7dbf7a3f59,0x3ea23ce6bebd3f2b,0x3ef1bf3a3f68bf7e,0xbf383eebbe1dbe2c,0x3dc93e48bef13f35,0x3f75bf553f22bec4,0xbf223ed1be1dbde5,0xbf7c3f7fbf703f51,0x3f75bf5c3f38bf08,0x3f4abf6a3f7cbf80
.quad 0xbf753f7fbf7e3f72,0xbed83f1abf413f60,0x3f22bf443f5ebf72,0xbd2cbe0f3ea2bef8,0xbdc93e80becb3f08,0x3efebeb73e56bd66,0xbef13eb7be723de5,0xbf573f44bf2d3f14,0x3f62bf553f46bf35,0x3f7fbf7b3f75bf6d,0xbf7f3f80bf803f7e,0xbf6e3f74bf793f7c,0x3f46bf4d3f53bf59,0x3f28bf303f38bf3f,0xbe953e9bbea23ea9,0xbe723e80be873e8e
.quad 0xbf173e483e72bf20,0xbf323f6fbf7f3f60,0x3f57bf0e3e3a3e64,0x3efebf4d3f79bf7c,0xbf7a3f55bf113e64,0xbe873f1abf5b3f7c,0x3f7dbf7b3f5bbf20,0x3c66beb73f28bf60,0xbf5e3f7bbf7e3f67,0x3e723dacbecb3f2b,0x3f22bf553f75bf80,0xbef13e483dc9bec4,0xbea23f0ebf413f67,0x3f2dbeeb3e563d66,0xbd2cbe483ed8bf20,0xbf573f30befe3e8e
.quad 0x3ecbbe48bc663e64,0x3f73bf5c3f3cbf14,0xbf323f0ebecb3e64,0xbf7f3f78bf683f51,0x3f68bf553f3cbf20,0x3f7cbf803f7ebf76,0xbf7f3f7bbf733f67,0xbf683f74bf7c3f80,0x3f75bf7b3f7fbf80,0x3f46bf553f62bf6d,0xbf4a3f55bf5e3f67,0xbf173f25bf323f3f,0x3f05bf0e3f17bf20,0x3ebdbed13ee5bef8,0xbe3a3e48be563e64,0xbe013e0fbe1d3e2c
.quad 0x3f53bf023dc93ea9,0x3ed8bf443f77bf7c,0xbf653f25be95bde5,0xbecb3f3abf703f80,0x3f73bf443ef1bde5,0x3ebdbf303f68bf80,0xbf7c3f5cbf223ea9,0xbeb03f25bf5e3f7c,0x3f80bf6f3f46bf08,0x3ea2bf1a3f53bf76,0xbf7f3f7bbf623f35,0xbe953f0ebf463f6d,0x3f79bf803f75bf59,0x3e87bf023f38bf60,0xbf6e3f7dbf7f3f72,0xbe723eebbf283f51
.quad 0x3f5ebf743f7fbf7e,0x3e56bed13f17bf3f,0xbf4a3f63bf753f7e,0xbe3a3eb7bf053f2b,0x3f32bf4d3f62bf72,0x3e1dbe9b3ee5bf14,0xbf173f30bf463f59,0xbe013e80bebd3ef8,0x3ef1bf0e3f22bf35,0x3dc9be483e95bec4,0xbeb03ed1bef13f08,0xbd8f3e0fbe563e8e,0x3e56be803e95bea9,0x3d2cbdac3e01be2c,0xbd8f3dacbdc93de5,0xbc663ce6bd2c3d66
.quad 0x0,0x0,0x8000,0x0,0x0,0x0,0x8000,0x0,0x0,0x0,0x8000,0x0,0x0,0x0,0x8000,0x0
.quad 0x0,0x0,0x8000,0x0,0x0,0x0,0x8000,0x0,0x0,0x0,0x8000,0x0,0x0,0x0,0x8000,0x0
.quad 0x0,0x0,0x0,0x0,0x0,0x0,0x0,0x0,0x0,0x0,0x0,0x0,0x0,0x0,0x0,0x0
.quad 0x0,0x0,0x0,0x0,0x0,0x0,0x0,0x0,0x0,0x0,0x0,0x0,0x0,0x0,0x0,0x0
.quad 0xbf773f44bed88000,0xbdc93f02bf533f7c,0xbf703f3abecb8000,0xbe953f25bf653f80,0xbf683f30bebd8000,0xbef13f44bf733f80,0xbf5e3f25beb08000,0xbf223f5cbf7c3f7c,0xbf533f1abea28000,0xbf463f6fbf803f76,0xbf463f0ebe958000,0xbf623f7bbf7f3f6d,0xbf383f02be878000,0xbf753f80bf793f60,0xbf283eebbe728000,0xbf7f3f7dbf6e3f51
.quad 0xbf173ed1be568000,0xbf7f3f74bf5e3f3f,0xbf053eb7be3a8000,0xbf753f63bf4a3f2b,0xbee53e9bbe1d8000,0xbf623f4dbf323f14,0xbebd3e80be018000,0xbf463f30bf173ef8,0xbe953e48bdc98000,0xbf223f0ebef13ec4,0xbe563e0fbd8f8000,0xbef13ed1beb03e8e,0xbe013dacbd2c8000,0xbe953e80be563e2c,0xbd2c3ce6bc668000,0xbdc93dacbd8f3d66
.quad 0x3f7fbf6f3f32bea9,0xbe72be483f17bf60,0x3f79bf4d3efebde5,0x3e3abf0e3f57bf7c,0x3f5bbf1a3e873de5,0x3f11bf553f7abf7c,0x3f28beb73c663ea9,0x3f5bbf7b3f7dbf60,0x3ecbbdacbe723f08,0x3f7ebf7b3f5ebf2b,0x3dc93e48bef13f35,0x3f75bf553f22bec4,0xbe563eebbf2d3f59,0x3f41bf0e3ea2bd66,0xbefe3f30bf573f72,0x3ed8be48bd2c3e8e
.quad 0xbf3c3f5cbf733f7e,0x3c663e48becb3f14,0xbf683f78bf7f3f7e,0xbecb3f0ebf323f51,0xbf7e3f80bf7c3f72,0xbf3c3f55bf683f76,0xbf7c3f74bf683f59,0xbf733f7bbf7f3f80,0xbf623f55bf463f35,0xbf7f3f7bbf753f6d,0xbf323f25bf173f08,0xbf5e3f55bf4a3f3f,0xbee53ed1bebd3ea9,0xbf173f0ebf053ef8,0xbe1d3e0fbe013de5,0xbe563e48be3a3e2c
.quad 0xbf6b3f80bf653f20,0x3f0bbe0fbe953f2b,0xbf7e3f5cbf173e64,0xbd8f3eebbf463f76,0xbf4a3f02be1dbe64,0xbf283f63bf7f3f76,0xbebd3ce63ea2bf20,0xbf7a3f7dbf623f2b,0x3e1dbeeb3f38bf67,0xbf683f3abef13e2c,0x3f22bf553f75bf80,0xbef13e483dc9bec4,0x3f70bf7f3f7cbf67,0x3e1dbed13f22bf51,0x3f7cbf6a3f4abf20,0x3f38bf5c3f75bf80
.quad 0x3f41bf1a3ed8be64,0x3f7ebf7f3f75bf60,0x3ea2be0fbd2c3e64,0x3f5ebf443f22bef8,0xbe563eb7befe3f20,0x3ecbbe803dc93d66,0xbf2d3f44bf573f67,0xbe723eb7bef13f14,0xbf753f7bbf7f3f80,0xbf463f55bf623f6d,0xbf793f74bf6e3f67,0xbf803f80bf7f3f7c,0xbf383f30bf283f20,0xbf533f4dbf463f3f,0xbe873e80be723e64,0xbea23e9bbe953e8e
.quad 0x3f3cbf743f7ebf59,0xbf4a3eebbd2cbec4,0x3f80bf6a3f2dbea9,0xbd2cbeb73f32bf6d,0x3f38bed13d2c3ea9,0x3f3cbf6f3f80bf6d,0x3d2c3e9bbf1d3f59,0x3f7ebf633f2dbec4,0xbf283f5cbf7a3f7e,0x3f0bbe80bd8f3ec4,0xbf7f3f7bbf623f35,0xbe953f0ebf463f6d,0xbf4a3f1abebd3de5,0xbf6b3f7dbf7e3f6d,0xbe1dbdac3ea2bf08,0xbf653f44bf173ec4
.quad 0x3f11bf3a3f5bbf72,0xbe723ce63e3abec4,0x3f7abf803f7dbf72,0x3f17bf3a3f57bf6d,0x3f5bbf443f28bf08,0x3f7fbf7f3f79bf6d,0x3e87be0f3c663de5,0x3f32bf1a3efebec4,0xbef13f0ebf223f35,0xbdc93e48be953ec4,0xbf733f78bf7c3f7e,0xbf533f5cbf653f6d,0xbf683f63bf5e3f59,0xbf773f74bf703f6d,0xbebd3eb7beb03ea9,0xbed83ed1becb3ec4
.quad 0xbef13f4dbf7a3f7a,0x3f73bf3a3ebd3d66,0xbf7f3f74bf413ede,0x3e1d3e80bf1d3f60,0xbf223e9b3d8fbede,0xbf4f3f78bf7e3f60,0x3e95bf1a3f57bf7a,0xbf653f30becb3d66,0x3f75bf803f70bf48,0xbc66be9b3f17bf51,0x3f46bf0e3e958000,0x3f62bf7b3f7fbf6d,0xbdc93eb7bf173f48,0x3f53bf253ed8be2c,0xbf623f78bf803f7a,0xbe013eb7bf113f3f
.quad 0xbf623f44bf1d3ede,0xbf703f7dbf7f3f76,0xbdc9bdac3e87bede,0xbf3c3f1abee53e8e,0x3f46bf5c3f6ebf7a,0x3e87bed13f0bbf2b,0x3f75bf6a3f5bbf48,0x3f7abf7f3f80bf7c,0x3e95be483dc98000,0x3f22bf0e3ef1bec4,0xbf223f30bf3c3f48,0xbecb3eebbf053f14,0xbf7f3f7dbf7c3f7a,0xbf7f3f80bf803f80,0xbef13eebbee53ede,0xbf053f02befe3ef8
.quad 0x3e1dbf0e3f5bbf7e,0xbf803f6abf283e8e,0x3f7abf7b3f53bf08,0xbe87be0f3f05bf51,0x3f0bbe48be3a3f08,0x3f5ebf7d3f79bf51,0xbf173f55bf793f7e,0x3f32bed13d8f3e8e,0xbf773f55bf1d3ea9,0xbf053f44bf6e3f80,0xbdc9be483ef1bf35,0xbf753f55bf223ec4,0x3f65bf7b3f7fbf72,0x3d2cbe9b3f0bbf3f,0x3f3cbf0e3eb0bde5,0x3f7abf803f77bf60
.quad 0xbebd3f0ebf383f59,0x3ee5be803d2c3e2c,0xbf803f7bbf6e3f59,0xbf413f5cbf703f7c,0xbeb03e48bd2cbde5,0xbf533f3abf1d3ef8,0x3f41bf553f65bf72,0x3eb0beeb3f11bf2b,0x3f62bf553f46bf35,0x3f7fbf7b3f75bf6d,0xbe013e48be873ea9,0x3e1dbdac3c663d66,0xbf793f7bbf7d3f7e,0xbf6b3f6fbf733f76,0xbf113f0ebf0b3f08,0xbf1d3f1abf173f14
.quad 0x3e3a3e80bf223f67,0x3f70bf7f3f5ebf14,0xbf733f7fbf623f20,0x3ebd3ce6bed83f3f,0xbee53dac3e95bf20,0xbf6b3f80bf703f3f,0x3f53bf783f7fbf67,0xbed83dac3e87bf14,0x3f2dbed13dc93e64,0x3f65bf7d3f7cbf60,0xbf223f55bf753f80,0x3ef1be48bdc93ec4,0xbf5b3f30bef13e64,0xbf5e3f78bf803f76,0x3ecbbf1a3f46bf67,0xbf053e9bbd8fbe2c
.quad 0x3f77bf633f46bf20,0x3f57bf6f3f7dbf80,0xbe013e9bbef13f20,0x3f11bed13e72bd66,0xbf803f7dbf753f67,0xbf4f3f63bf733f7c,0xbe1d3ce63dc9be64,0xbf1d3f02becb3e8e,0x3f75bf7b3f7fbf80,0x3f46bf553f62bf6d,0x3ed8beb73e95be64,0x3f28bf1a3f0bbef8,0xbf573f5cbf623f67,0xbf3c3f44bf4a3f51,0xbf283f25bf223f20,0xbf323f30bf2d3f2b
.quad 0xbefe3dac3eb0bf35,0xbf463f78bf7c3f51,0x3f68bf803f6ebf35,0xbef13dac3ea2bf2b,0x3eb03ce6becb3f35,0x3f75bf7f3f65bf2b,0xbf773f7fbf683f35,0x3dc93e80bf113f51,0xbe3abe0f3ee5bf35,0xbf7f3f6abf3c3ef8,0x3f7fbf7b3f62bf35,0x3e95bf0e3f46bf6d,0x3c663e80befe3f35,0x3f62bf3a3f05be8e,0xbf7f3f74bf5b3f35,0xbf223f4dbf6b3f7c
.quad 0x3e1dbeb73f0bbf35,0xbf223eebbe873d66,0x3f79bf6a3f53bf35,0x3f62bf743f7ebf80,0xbea23eebbf173f35,0x3e95be0fbc663e2c,0xbf6b3f5cbf4a3f35,0xbf7f3f80bf7d3f76,0x3ef1bf0e3f22bf35,0x3dc9be483e95bec4,0x3f57bf4d3f41bf35,0x3f75bf6f3f68bf60,0xbf1d3f25bf2d3f35,0xbef13f02bf0b3f14,0xbf3c3f3abf383f35,0xbf463f44bf413f3f
.quad 0x3f41bed1bc663ede,0x3f05bf553f7dbf76,0xbf5b3f7dbf773f48,0x3f11be48be563f14,0xbe72be0f3efebf48,0xbf7c3f7bbf573f14,0x3f7fbf6a3f38bede,0x3e72bf0e3f4fbf76,0xbebd3f25bf5b3f7a,0x3f4abf0e3e873d66,0xbf463f0ebe958000,0xbf623f7bbf7f3f6d,0x3f57bf743f80bf7a,0xbd8fbe483ee5bf2b,0x3e87bce6be563ede,0x3f70bf553f2dbef8
.quad 0xbf803f78bf653f48,0xbf323f55bf6e3f7c,0x3eb0bf023f28bf48,0xbebd3e48bc66be2c,0x3f4abf303f11bede,0x3f80bf7b3f70bf60,0xbf533f63bf703f7a,0xbee53f0ebf283f3f,0xbe953e48bdc98000,0xbf223f0ebef13ec4,0x3f80bf7f3f7dbf7a,0x3f77bf7b3f7ebf80,0xbea23eb7becb3ede,0xbe1d3e48be723e8e,0xbf4f3f4dbf4a3f48,0xbf573f55bf533f51
.quad 0xbf6e3f30bea2bde5,0xbe563f1abf623f80,0x3f4abf783f7dbf59,0xbf283e9b3dc9bef8,0x3e013e80bf173f59,0x3f7fbf743f46bef8,0xbf6b3f3abee53de5,0xbf0b3f4dbf753f80,0x3f4fbf743f80bf72,0xbeb03ce63e95bf14,0x3dc93e48bef13f35,0x3f75bf553f22bec4,0xbf683f44bf113ea9,0xbf4f3f6fbf7f3f7c,0x3f53bf6f3f7ebf7e,0x3c66be803ef1bf2b
.quad 0x3d8f3e0fbeb03f08,0x3f4abf253ef1be8e,0xbf653f4dbf2d3f08,0xbf773f7fbf7f3f76,0x3f57bf6a3f77bf7e,0x3ebdbf023f22bf3f,0x3d2c3dacbe563ea9,0x3f05bed13e95be2c,0xbf623f55bf463f35,0xbf7f3f7bbf753f6d,0x3f5bbf633f6bbf72,0x3f2dbf3a3f46bf51,0x3c663ce6bd8f3de5,0x3e3abe0f3dc9bd66,0xbf5e3f5cbf5b3f59,0xbf653f63bf623f60
.quad 0x3f80bf633f1dbe64,0xbe01be9b3f2dbf6d,0xbf383f6fbf803f67,0x3f3cbed13c663ec4,0xbc66beb73f2dbf67,0xbf803f6abf323ec4,0x3f3cbeeb3e013e64,0x3f4abf743f80bf6d,0xbf7f3f78bf573f20,0xbe563f02bf413f6d,0x3f22bf553f75bf80,0xbef13e483dc9bec4,0x3e013e0fbecb3f20,0x3f6ebf4d3f1dbec4,0xbf4f3f25bee53e64,0xbf733f7fbf7d3f6d
.quad 0x3f7cbf803f79bf67,0x3f05bf303f53bf6d,0xbf0b3f30bf4f3f67,0x3e1d3ce6be563ec4,0xbe723dac3d8fbe64,0xbf413f25bf053ec4,0x3f5ebf4d3f38bf20,0x3f80bf7d3f77bf6d,0xbf753f7bbf7f3f80,0xbf463f55bf623f6d,0x3ee5bf023f11bf20,0x3e3abe803ea2bec4,0x3eb0be9b3e87be64,0x3efebeeb3ed8bec4,0xbf6b3f6abf683f67,0xbf703f6fbf6e3f6d
.quad 0xbf753f7dbf573f08,0x3ee5bce6becb3f3f,0x3f22bf633f7fbf72,0xbf4f3f02be01be8e,0xbdc93eebbf413f72,0x3f7dbf5c3f1dbe8e,0xbef13e0f3e56bf08,0xbf733f80bf6e3f3f,0x3f62bf303ed8bde5,0x3f32bf633f7dbf7c,0xbf7f3f7bbf623f35,0xbe953f0ebf463f6d,0x3f46bf6a3f7dbf7e,0xbe3abdac3eb0bf14,0xbe953f02bf323f59,0x3f1dbed13e3a3d66
.quad 0xbe953dac3e01bea9,0xbf683f4dbf283ef8,0x3f46bf253efebea9,0x3f80bf7d3f73bf60,0xbf7f3f78bf6b3f59,0xbf5e3f6fbf7a3f80,0x3f62bf6f3f79bf7e,0x3f0bbf253f3cbf51,0xbef13f0ebf223f35,0xbdc93e48be953ec4,0xbdc93ce63d2cbde5,0xbebd3e9bbe723e2c,0x3f22bf1a3f11bf08,0x3f41bf3a3f32bf2b,0xbf753f74bf733f72,0xbf793f78bf773f76
.quad 0x3f4fbf7b3f79bf48,0xbf383eb73d8fbef8,0xbf0b3f55bf7c3f7a,0x3f5ebf1a3e723e2c,0x3e56bf0e3f53bf7a,0xbf773f4dbf053e2c,0x3e1d3e48bf053f48,0x3f80bf6f3f41bef8,0xbefe3e483e01bede,0xbf793f7fbf6b3f3f,0x3f46bf0e3e958000,0x3f62bf7b3f7fbf6d,0xbf733f55bf283ede,0xbf3c3f63bf7a3f80,0x3f80bf7b3f68bf48,0x3f0bbf3a3f5ebf76
.quad 0xbf6b3f7bbf803f7a,0xbea23f02bf2d3f51,0x3f38bf553f6bbf7a,0x3d8fbe803ed8bf14,0xbed83f0ebf2d3f48,0x3e3abce6be013e8e,0x3d8fbe483ea2bede,0xbed83e9bbe3a3d66,0x3e95be483dc98000,0x3f22bf0e3ef1bec4,0xbf1d3f0ebefe3ede,0xbf4f3f44bf383f2b,0x3f5bbf553f4fbf48,0x3f6ebf6a3f65bf60,0xbf7c3f7bbf7a3f7a,0xbf7e3f7dbf7d3f7c
.quad 0xbf113f5cbf7f3f72,0x3f68bf253e873e2c,0x3ee5bf443f75bf7e,0xbf6b3f30beb0bd66,0xbea23f25bf623f7e,0x3f6ebf3a3ed8bd66,0x3e3abf023f46bf72,0xbf703f44befe3e2c,0xbd2c3eb7bf223f59,0x3f73bf4d3f11be8e,0xbdc9be483ef1bf35,0xbf753f55bf223ec4,0x3e723ce6be953f08,0x3f77bf5c3f32bef8,0xbebd3e0f3dc9bea9,0xbf793f63bf413f14
.quad 0x3efebe9b3dc93de5,0x3f7abf6a3f4fbf2b,0xbf1d3eebbe953de5,0xbf7c3f6fbf5b3f3f,0x3f38bf1a3ef1bea9,0x3f7dbf743f65bf51,0xbf4f3f3abf223f08,0xbf7e3f78bf6e3f60,0x3f62bf553f46bf35,0x3f7fbf7b3f75bf6d,0xbf703f6abf623f59,0xbf7f3f7dbf7a3f76,0x3f7abf783f75bf72,0x3f80bf7f3f7ebf7c,0xbf7f3f7fbf7f3f7e,0xbf803f80bf803f80
.quad 0xbf80,0x0,0x3f80,0x0,0xbf80,0x0,0x3f80,0x0,0xbf80,0x0,0x3f80,0x0,0xbf80,0x0,0x3f80,0x0
.quad 0xbf80,0x0,0x3f80,0x0,0xbf80,0x0,0x3f80,0x0,0xbf80,0x0,0x3f80,0x0,0xbf80,0x0,0x3f80,0x0
.quad 0x0,0x0,0x0,0x0,0x0,0x0,0x0,0x0,0x0,0x0,0x0,0x0,0x0,0x0,0x0,0x0
.quad 0x0,0x0,0x0,0x0,0x0,0x0,0x0,0x0,0x0,0x0,0x0,0x0,0x0,0x0,0x0,0x0
.size L_tab, 118784
.section .rodata,"a"
.p2align 6
.amdhsa_kernel recurrent_scan__spectral_fnet__dense_activation_relu__prompt_kernel
  .amdhsa_next_free_vgpr 256
  .amdhsa_next_free_sgpr 102
  .amdhsa_accum_offset 256
  .amdhsa_group_segment_fixed_size 0
  .amdhsa_kernarg_size 88
  .amdhsa_user_sgpr_count 2
  .amdhsa_user_sgpr_kernarg_segment_ptr 1
  .amdhsa_system_sgpr_workgroup_id_x 1
  .amdhsa_float_denorm_mode_32 3
.end_amdhsa_kernel
```
